```python
import torch

def _softmax(x, axis=-1):
    return torch.softmax(x, dim=axis)
def _gelu(x):
    return torch.nn.functional.gelu(x, approximate="tanh")
def _silu(x):
    return torch.nn.functional.silu(x)
def _sigmoid(x):
    return torch.sigmoid(x)
def _layernorm(x, axis=-1, eps=1e-5):
    m = x.mean(dim=axis, keepdim=True)
    v = x.var(dim=axis, keepdim=True, unbiased=False)
    return (x - m) / torch.sqrt(v + eps)
def _scatter_add(tgt, idx, src, axis=0):
    return tgt.clone().index_add_(axis, idx, src)
def _segment_sum(src, seg, n):
    out = torch.zeros((n,) + src.shape[1:], dtype=src.dtype)
    return out.index_add_(0, seg, src)
def _pad(x, pw):
    flat = tuple(v for pair in reversed(pw) for v in pair)
    return torch.nn.functional.pad(x, flat)

kernel_name = 'interleave_layers__sliding_block__swiglu_ffn__prompt'

def setup_inputs():

    _w = (lambda a: (lambda t: t.to(torch.bfloat16) if t.is_floating_point() else t)(torch.as_tensor(a)))
    def _A_setup():
        B, S, D = 1, 2048, 576
        return {
            "x": _w((lambda *s: torch.randn(*s, dtype=torch.bfloat16) * 0.05)(B, S, D)),
            "wqkv": _w((lambda *s: torch.randn(*s, dtype=torch.bfloat16) * 0.05)(D, 3 * D)),
            "wo": _w((lambda *s: torch.randn(*s, dtype=torch.bfloat16) * 0.05)(D, D)),
        }
    _A_in = _A_setup()

    def _B_setup():
        B, S, D, F = 1, 2048, 576, 4608
        return {
            "x": _w((lambda *s: torch.randn(*s, dtype=torch.bfloat16) * 0.05)(B, S, D)),
            "w_gate": _w((lambda *s: torch.randn(*s, dtype=torch.bfloat16) * 0.05)(D, F)),
            "w_up": _w((lambda *s: torch.randn(*s, dtype=torch.bfloat16) * 0.05)(D, F)),
            "w_down": _w((lambda *s: torch.randn(*s, dtype=torch.bfloat16) * 0.05)(F, D)),
        }
    _B_in = _B_setup()

    return {
        "A_x": _A_in["x"],
        "A_wqkv": _A_in["wqkv"],
        "A_wo": _A_in["wo"],
        "B_x": _B_in["x"],
        "B_w_gate": _B_in["w_gate"],
        "B_w_up": _B_in["w_up"],
        "B_w_down": _B_in["w_down"],
    }

def reference(A_x, A_wqkv, A_wo, B_x, B_w_gate, B_w_up, B_w_down):
    def _A_ref(x, wqkv, wo):
        B, S, D = x.shape
        H = 32; Dh = D // H; W = 256
        qkv = (lambda x, *d: x.permute(*d))((x @ wqkv).reshape(B, S, 3, H, Dh), 2, 0, 3, 1, 4)
        q, k, v = qkv[0], qkv[1], qkv[2]
        scores = torch.einsum("bhqd,bhkd->bhqk", q, k) * (Dh ** -0.5)
        idx = torch.arange(S)
        mask = (idx[:, None] - idx[None, :] >= 0) & (idx[:, None] - idx[None, :] < W)
        scores = torch.where(mask[None, None], scores, -1e9)
        p = _softmax(scores, axis=-1)
        o = torch.einsum("bhqk,bhkd->bhqd", p, v)
        return (lambda x, *d: x.permute(*d))(o, 0, 2, 1, 3).reshape(B, S, D) @ wo

    def _B_ref(x, w_gate, w_up, w_down):
        g = _silu(x @ w_gate)
        u = x @ w_up
        return (g * u) @ w_down

    x = A_x
    x = x + _A_ref(_layernorm(x, axis=-1), A_wqkv, A_wo)
    x = x + _B_ref(_layernorm(x, axis=-1), B_w_gate, B_w_up, B_w_down)
    x = x + _A_ref(_layernorm(x, axis=-1), A_wqkv, A_wo)
    x = x + _B_ref(_layernorm(x, axis=-1), B_w_gate, B_w_up, B_w_down)
    return x
```

```asm
; @launch grid=(256,1,1) block=(256,1,1) lds=163840
.amdgcn_target "amdgcn-amd-amdhsa--gfx950"
.text
.globl interleave_layers__sliding_block__swiglu_ffn__prompt_kernel
.p2align 8
.type interleave_layers__sliding_block__swiglu_ffn__prompt_kernel,@function
interleave_layers__sliding_block__swiglu_ffn__prompt_kernel:
    s_cmp_ge_u32 s2, 256
    s_cbranch_scc1 L_end
    s_load_dwordx4 s[36:39], s[0:1], 0
    s_load_dwordx2 s[46:47], s[0:1], 16
    s_load_dwordx4 s[40:43], s[0:1], 32
    s_load_dwordx2 s[44:45], s[0:1], 48
    s_load_dwordx2 s[6:7], s[0:1], 56
    s_load_dwordx2 s[84:85], s[0:1], 64
    s_load_dwordx2 s[4:5], s[0:1], 72
    v_lshrrev_b32 v2, 6, v0
    v_and_b32 v1, 63, v0
    v_readfirstlane_b32 s20, v2
    v_cmp_eq_u32 vcc, 0, v1
    v_lshlrev_b32 v1, 4, v1
    s_and_b32 s16, s2, 7
    s_lshr_b32 s17, s2, 3
    s_bfe_u32 s18, s2, 0x10002
    s_and_b32 s19, s2, 3
    v_mov_b32 v13, 1073741824
    s_mov_b32 s50, 0
    s_mov_b32 s51, 0
    s_mov_b32 s53, 9437184
    s_mov_b32 s67, 0
    v_cndmask_b32 v13, v13, 0, vcc
    s_cmp_eq_u32 s20, 1
    s_cbranch_scc1 L_p0_wq
    s_cmp_lg_u32 s20, 0
    s_cbranch_scc1 L_p0_23
    s_lshl_b32 s28, s16, 5
    s_add_u32 s28, s28, s17
    v_bfe_u32 v4, v0, 4, 2
    v_bfe_u32 v5, v0, 3, 1
    v_and_b32 v6, 7, v0
    s_and_b32 s21, s28, 1
    s_lshr_b32 s22, s28, 1
    s_lshl_b32 s23, s21, 7
    v_lshlrev_b32 v7, 8, v4
    v_lshl_add_u32 v7, v5, 10, v7
    v_lshl_add_u32 v7, v6, 4, v7
    v_add_u32 v7, s23, v7
    s_mul_i32 s24, s22, 18432
    v_mul_u32_u24 v11, 1152, v6
    v_lshl_add_u32 v11, v5, 6, v11
    v_and_b32 v9, 1, v4
    v_lshl_add_u32 v11, v9, 5, v11
    v_lshrrev_b32 v9, 1, v4
    v_lshl_add_u32 v11, v9, 4, v11
    s_mul_i32 s33, s28, 9216
    s_waitcnt lgkmcnt(0)
    s_mov_b32 s12, s36
    s_mov_b32 s13, s37
    s_mov_b32 s14, 2359296
    s_mov_b32 s15, 0x00020000
    buffer_load_dwordx4 v[16:19], v11, s[12:15], s33 offen offset:0 nt
    buffer_load_dwordx4 v[20:23], v11, s[12:15], s33 offen offset:128 nt
    buffer_load_dwordx4 v[24:27], v11, s[12:15], s33 offen offset:256 nt
    buffer_load_dwordx4 v[28:31], v11, s[12:15], s33 offen offset:384 nt
    buffer_load_dwordx4 v[32:35], v11, s[12:15], s33 offen offset:512 nt
    buffer_load_dwordx4 v[36:39], v11, s[12:15], s33 offen offset:640 nt
    buffer_load_dwordx4 v[40:43], v11, s[12:15], s33 offen offset:768 nt
    buffer_load_dwordx4 v[44:47], v11, s[12:15], s33 offen offset:896 nt
    buffer_load_dwordx4 v[48:51], v11, s[12:15], s33 offen offset:1024 nt
    s_barrier
    s_mov_b32 s8, s4
    s_mov_b32 s9, s5
    s_mov_b32 s10, 64192512
    s_mov_b32 s11, 0x00020000
    s_mov_b32 s86, 256
    s_mov_b32 s87, 0x00020000
    s_mov_b32 s30, 0x3f803f80
    s_mov_b32 s31, 0x3ae38e39
    s_mov_b32 s32, 0xffff0000
    s_lshr_b32 s56, s28, 4
    s_lshl_b32 s56, s56, 7
    s_and_b32 s27, s28, 15
    s_lshl_b32 s27, s27, 3
    s_add_u32 s56, s56, s27
    s_add_u32 s56, s56, 63864832
    s_add_u32 s25, s24, 0
    s_waitcnt vmcnt(8)
    v_permlane16_swap_b32 v16, v18
    v_permlane16_swap_b32 v17, v19
    buffer_store_dwordx4 v[16:19], v7, s[8:11], s25 offen offset:0 sc1
    s_waitcnt vmcnt(8)
    v_permlane16_swap_b32 v20, v22
    v_permlane16_swap_b32 v21, v23
    buffer_store_dwordx4 v[20:23], v7, s[8:11], s25 offen offset:2048 sc1
    s_add_u32 s25, s25, 4096
    s_waitcnt vmcnt(8)
    v_permlane16_swap_b32 v24, v26
    v_permlane16_swap_b32 v25, v27
    buffer_store_dwordx4 v[24:27], v7, s[8:11], s25 offen offset:0 sc1
    s_waitcnt vmcnt(8)
    v_permlane16_swap_b32 v28, v30
    v_permlane16_swap_b32 v29, v31
    buffer_store_dwordx4 v[28:31], v7, s[8:11], s25 offen offset:2048 sc1
    s_add_u32 s25, s25, 4096
    s_waitcnt vmcnt(8)
    v_permlane16_swap_b32 v32, v34
    v_permlane16_swap_b32 v33, v35
    buffer_store_dwordx4 v[32:35], v7, s[8:11], s25 offen offset:0 sc1
    s_waitcnt vmcnt(8)
    v_permlane16_swap_b32 v36, v38
    v_permlane16_swap_b32 v37, v39
    buffer_store_dwordx4 v[36:39], v7, s[8:11], s25 offen offset:2048 sc1
    s_add_u32 s25, s25, 4096
    s_waitcnt vmcnt(8)
    v_permlane16_swap_b32 v40, v42
    v_permlane16_swap_b32 v41, v43
    buffer_store_dwordx4 v[40:43], v7, s[8:11], s25 offen offset:0 sc1
    s_waitcnt vmcnt(8)
    v_permlane16_swap_b32 v44, v46
    v_permlane16_swap_b32 v45, v47
    buffer_store_dwordx4 v[44:47], v7, s[8:11], s25 offen offset:2048 sc1
    s_add_u32 s25, s25, 4096
    s_waitcnt vmcnt(8)
    v_permlane16_swap_b32 v48, v50
    v_permlane16_swap_b32 v49, v51
    buffer_store_dwordx4 v[48:51], v7, s[8:11], s25 offen offset:0 sc1
    v_mov_b32 v2, 0
    buffer_load_dwordx2 v[254:255], v2, s[84:87], 0 offen sc1
    v_mov_b32 v52, 0
    v_mov_b32 v53, 0
    v_mov_b32 v54, 0
    v_mov_b32 v55, 0
    v_dot2c_f32_bf16 v52, s30, v16
    v_dot2c_f32_bf16 v54, v16, v16
    v_dot2c_f32_bf16 v53, s30, v17
    v_dot2c_f32_bf16 v55, v17, v17
    v_dot2c_f32_bf16 v52, s30, v18
    v_dot2c_f32_bf16 v54, v18, v18
    v_dot2c_f32_bf16 v53, s30, v19
    v_dot2c_f32_bf16 v55, v19, v19
    v_dot2c_f32_bf16 v52, s30, v20
    v_dot2c_f32_bf16 v54, v20, v20
    v_dot2c_f32_bf16 v53, s30, v21
    v_dot2c_f32_bf16 v55, v21, v21
    v_dot2c_f32_bf16 v52, s30, v22
    v_dot2c_f32_bf16 v54, v22, v22
    v_dot2c_f32_bf16 v53, s30, v23
    v_dot2c_f32_bf16 v55, v23, v23
    v_dot2c_f32_bf16 v52, s30, v24
    v_dot2c_f32_bf16 v54, v24, v24
    v_dot2c_f32_bf16 v53, s30, v25
    v_dot2c_f32_bf16 v55, v25, v25
    v_dot2c_f32_bf16 v52, s30, v26
    v_dot2c_f32_bf16 v54, v26, v26
    v_dot2c_f32_bf16 v53, s30, v27
    v_dot2c_f32_bf16 v55, v27, v27
    v_dot2c_f32_bf16 v52, s30, v28
    v_dot2c_f32_bf16 v54, v28, v28
    v_dot2c_f32_bf16 v53, s30, v29
    v_dot2c_f32_bf16 v55, v29, v29
    v_dot2c_f32_bf16 v52, s30, v30
    v_dot2c_f32_bf16 v54, v30, v30
    v_dot2c_f32_bf16 v53, s30, v31
    v_dot2c_f32_bf16 v55, v31, v31
    v_dot2c_f32_bf16 v52, s30, v32
    v_dot2c_f32_bf16 v54, v32, v32
    v_dot2c_f32_bf16 v53, s30, v33
    v_dot2c_f32_bf16 v55, v33, v33
    v_dot2c_f32_bf16 v52, s30, v34
    v_dot2c_f32_bf16 v54, v34, v34
    v_dot2c_f32_bf16 v53, s30, v35
    v_dot2c_f32_bf16 v55, v35, v35
    v_dot2c_f32_bf16 v52, s30, v36
    v_dot2c_f32_bf16 v54, v36, v36
    v_dot2c_f32_bf16 v53, s30, v37
    v_dot2c_f32_bf16 v55, v37, v37
    v_dot2c_f32_bf16 v52, s30, v38
    v_dot2c_f32_bf16 v54, v38, v38
    v_dot2c_f32_bf16 v53, s30, v39
    v_dot2c_f32_bf16 v55, v39, v39
    v_dot2c_f32_bf16 v52, s30, v40
    v_dot2c_f32_bf16 v54, v40, v40
    v_dot2c_f32_bf16 v53, s30, v41
    v_dot2c_f32_bf16 v55, v41, v41
    v_dot2c_f32_bf16 v52, s30, v42
    v_dot2c_f32_bf16 v54, v42, v42
    v_dot2c_f32_bf16 v53, s30, v43
    v_dot2c_f32_bf16 v55, v43, v43
    v_dot2c_f32_bf16 v52, s30, v44
    v_dot2c_f32_bf16 v54, v44, v44
    v_dot2c_f32_bf16 v53, s30, v45
    v_dot2c_f32_bf16 v55, v45, v45
    v_dot2c_f32_bf16 v52, s30, v46
    v_dot2c_f32_bf16 v54, v46, v46
    v_dot2c_f32_bf16 v53, s30, v47
    v_dot2c_f32_bf16 v55, v47, v47
    v_dot2c_f32_bf16 v52, s30, v48
    v_dot2c_f32_bf16 v54, v48, v48
    v_dot2c_f32_bf16 v53, s30, v49
    v_dot2c_f32_bf16 v55, v49, v49
    v_dot2c_f32_bf16 v52, s30, v50
    v_dot2c_f32_bf16 v54, v50, v50
    v_dot2c_f32_bf16 v53, s30, v51
    v_dot2c_f32_bf16 v55, v51, v51
    s_nop 2
    v_add_f32 v52, v52, v53
    v_add_f32 v53, v54, v55
    s_nop 1
    v_add_f32_dpp v52, v52, v52 row_ror:8 row_mask:0xf bank_mask:0xf
    v_add_f32_dpp v53, v53, v53 row_ror:8 row_mask:0xf bank_mask:0xf
    v_mov_b32 v54, v52
    s_nop 1
    v_permlane16_swap_b32 v52, v54
    v_add_f32 v52, v52, v54
    v_mov_b32 v54, v52
    s_nop 1
    v_permlane32_swap_b32 v52, v54
    v_add_f32 v52, v52, v54
    v_mov_b32 v54, v53
    s_nop 1
    v_permlane16_swap_b32 v53, v54
    v_add_f32 v53, v53, v54
    v_mov_b32 v54, v53
    s_nop 1
    v_permlane32_swap_b32 v53, v54
    v_add_f32 v53, v53, v54
    v_mul_f32 v52, s31, v52
    v_mul_f32 v53, s31, v53
    v_fma_f32 v53, -v52, v52, v53
    v_max_f32 v53, 0, v53
    v_add_f32 v53, 0x3727c5ac, v53
    v_rsq_f32 v53, v53
    s_nop 0
    v_mul_f32 v52, v52, v53
    v_sub_f32 v52, 0, v52
    s_add_u32 s23, s24, 2359296
    v_lshlrev_b32 v54, 16, v16
    v_and_b32 v55, s32, v16
    v_pk_fma_f32 v[54:55], v[54:55], v[52:53], v[52:53] op_sel:[0,1,0] op_sel_hi:[1,1,0]
    v_cvt_pk_bf16_f32 v60, v54, v55
    v_lshlrev_b32 v56, 16, v17
    v_and_b32 v57, s32, v17
    v_pk_fma_f32 v[56:57], v[56:57], v[52:53], v[52:53] op_sel:[0,1,0] op_sel_hi:[1,1,0]
    v_cvt_pk_bf16_f32 v61, v56, v57
    v_lshlrev_b32 v54, 16, v18
    v_and_b32 v55, s32, v18
    v_pk_fma_f32 v[54:55], v[54:55], v[52:53], v[52:53] op_sel:[0,1,0] op_sel_hi:[1,1,0]
    v_cvt_pk_bf16_f32 v62, v54, v55
    v_lshlrev_b32 v56, 16, v19
    v_and_b32 v57, s32, v19
    v_pk_fma_f32 v[56:57], v[56:57], v[52:53], v[52:53] op_sel:[0,1,0] op_sel_hi:[1,1,0]
    v_cvt_pk_bf16_f32 v63, v56, v57
    buffer_store_dwordx4 v[60:63], v7, s[8:11], s23 offen offset:0 sc1
    v_lshlrev_b32 v54, 16, v20
    v_and_b32 v55, s32, v20
    v_pk_fma_f32 v[54:55], v[54:55], v[52:53], v[52:53] op_sel:[0,1,0] op_sel_hi:[1,1,0]
    v_cvt_pk_bf16_f32 v64, v54, v55
    v_lshlrev_b32 v56, 16, v21
    v_and_b32 v57, s32, v21
    v_pk_fma_f32 v[56:57], v[56:57], v[52:53], v[52:53] op_sel:[0,1,0] op_sel_hi:[1,1,0]
    v_cvt_pk_bf16_f32 v65, v56, v57
    v_lshlrev_b32 v54, 16, v22
    v_and_b32 v55, s32, v22
    v_pk_fma_f32 v[54:55], v[54:55], v[52:53], v[52:53] op_sel:[0,1,0] op_sel_hi:[1,1,0]
    v_cvt_pk_bf16_f32 v66, v54, v55
    v_lshlrev_b32 v56, 16, v23
    v_and_b32 v57, s32, v23
    v_pk_fma_f32 v[56:57], v[56:57], v[52:53], v[52:53] op_sel:[0,1,0] op_sel_hi:[1,1,0]
    v_cvt_pk_bf16_f32 v67, v56, v57
    buffer_store_dwordx4 v[64:67], v7, s[8:11], s23 offen offset:2048 sc1
    s_add_u32 s23, s23, 4096
    v_lshlrev_b32 v54, 16, v24
    v_and_b32 v55, s32, v24
    v_pk_fma_f32 v[54:55], v[54:55], v[52:53], v[52:53] op_sel:[0,1,0] op_sel_hi:[1,1,0]
    v_cvt_pk_bf16_f32 v60, v54, v55
    v_lshlrev_b32 v56, 16, v25
    v_and_b32 v57, s32, v25
    v_pk_fma_f32 v[56:57], v[56:57], v[52:53], v[52:53] op_sel:[0,1,0] op_sel_hi:[1,1,0]
    v_cvt_pk_bf16_f32 v61, v56, v57
    v_lshlrev_b32 v54, 16, v26
    v_and_b32 v55, s32, v26
    v_pk_fma_f32 v[54:55], v[54:55], v[52:53], v[52:53] op_sel:[0,1,0] op_sel_hi:[1,1,0]
    v_cvt_pk_bf16_f32 v62, v54, v55
    v_lshlrev_b32 v56, 16, v27
    v_and_b32 v57, s32, v27
    v_pk_fma_f32 v[56:57], v[56:57], v[52:53], v[52:53] op_sel:[0,1,0] op_sel_hi:[1,1,0]
    v_cvt_pk_bf16_f32 v63, v56, v57
    buffer_store_dwordx4 v[60:63], v7, s[8:11], s23 offen offset:0 sc1
    v_lshlrev_b32 v54, 16, v28
    v_and_b32 v55, s32, v28
    v_pk_fma_f32 v[54:55], v[54:55], v[52:53], v[52:53] op_sel:[0,1,0] op_sel_hi:[1,1,0]
    v_cvt_pk_bf16_f32 v64, v54, v55
    v_lshlrev_b32 v56, 16, v29
    v_and_b32 v57, s32, v29
    v_pk_fma_f32 v[56:57], v[56:57], v[52:53], v[52:53] op_sel:[0,1,0] op_sel_hi:[1,1,0]
    v_cvt_pk_bf16_f32 v65, v56, v57
    v_lshlrev_b32 v54, 16, v30
    v_and_b32 v55, s32, v30
    v_pk_fma_f32 v[54:55], v[54:55], v[52:53], v[52:53] op_sel:[0,1,0] op_sel_hi:[1,1,0]
    v_cvt_pk_bf16_f32 v66, v54, v55
    v_lshlrev_b32 v56, 16, v31
    v_and_b32 v57, s32, v31
    v_pk_fma_f32 v[56:57], v[56:57], v[52:53], v[52:53] op_sel:[0,1,0] op_sel_hi:[1,1,0]
    v_cvt_pk_bf16_f32 v67, v56, v57
    buffer_store_dwordx4 v[64:67], v7, s[8:11], s23 offen offset:2048 sc1
    s_add_u32 s23, s23, 4096
    v_lshlrev_b32 v54, 16, v32
    v_and_b32 v55, s32, v32
    v_pk_fma_f32 v[54:55], v[54:55], v[52:53], v[52:53] op_sel:[0,1,0] op_sel_hi:[1,1,0]
    v_cvt_pk_bf16_f32 v60, v54, v55
    v_lshlrev_b32 v56, 16, v33
    v_and_b32 v57, s32, v33
    v_pk_fma_f32 v[56:57], v[56:57], v[52:53], v[52:53] op_sel:[0,1,0] op_sel_hi:[1,1,0]
    v_cvt_pk_bf16_f32 v61, v56, v57
    v_lshlrev_b32 v54, 16, v34
    v_and_b32 v55, s32, v34
    v_pk_fma_f32 v[54:55], v[54:55], v[52:53], v[52:53] op_sel:[0,1,0] op_sel_hi:[1,1,0]
    v_cvt_pk_bf16_f32 v62, v54, v55
    v_lshlrev_b32 v56, 16, v35
    v_and_b32 v57, s32, v35
    v_pk_fma_f32 v[56:57], v[56:57], v[52:53], v[52:53] op_sel:[0,1,0] op_sel_hi:[1,1,0]
    v_cvt_pk_bf16_f32 v63, v56, v57
    buffer_store_dwordx4 v[60:63], v7, s[8:11], s23 offen offset:0 sc1
    v_lshlrev_b32 v54, 16, v36
    v_and_b32 v55, s32, v36
    v_pk_fma_f32 v[54:55], v[54:55], v[52:53], v[52:53] op_sel:[0,1,0] op_sel_hi:[1,1,0]
    v_cvt_pk_bf16_f32 v64, v54, v55
    v_lshlrev_b32 v56, 16, v37
    v_and_b32 v57, s32, v37
    v_pk_fma_f32 v[56:57], v[56:57], v[52:53], v[52:53] op_sel:[0,1,0] op_sel_hi:[1,1,0]
    v_cvt_pk_bf16_f32 v65, v56, v57
    v_lshlrev_b32 v54, 16, v38
    v_and_b32 v55, s32, v38
    v_pk_fma_f32 v[54:55], v[54:55], v[52:53], v[52:53] op_sel:[0,1,0] op_sel_hi:[1,1,0]
    v_cvt_pk_bf16_f32 v66, v54, v55
    v_lshlrev_b32 v56, 16, v39
    v_and_b32 v57, s32, v39
    v_pk_fma_f32 v[56:57], v[56:57], v[52:53], v[52:53] op_sel:[0,1,0] op_sel_hi:[1,1,0]
    v_cvt_pk_bf16_f32 v67, v56, v57
    buffer_store_dwordx4 v[64:67], v7, s[8:11], s23 offen offset:2048 sc1
    s_add_u32 s23, s23, 4096
    v_lshlrev_b32 v54, 16, v40
    v_and_b32 v55, s32, v40
    v_pk_fma_f32 v[54:55], v[54:55], v[52:53], v[52:53] op_sel:[0,1,0] op_sel_hi:[1,1,0]
    v_cvt_pk_bf16_f32 v60, v54, v55
    v_lshlrev_b32 v56, 16, v41
    v_and_b32 v57, s32, v41
    v_pk_fma_f32 v[56:57], v[56:57], v[52:53], v[52:53] op_sel:[0,1,0] op_sel_hi:[1,1,0]
    v_cvt_pk_bf16_f32 v61, v56, v57
    v_lshlrev_b32 v54, 16, v42
    v_and_b32 v55, s32, v42
    v_pk_fma_f32 v[54:55], v[54:55], v[52:53], v[52:53] op_sel:[0,1,0] op_sel_hi:[1,1,0]
    v_cvt_pk_bf16_f32 v62, v54, v55
    v_lshlrev_b32 v56, 16, v43
    v_and_b32 v57, s32, v43
    v_pk_fma_f32 v[56:57], v[56:57], v[52:53], v[52:53] op_sel:[0,1,0] op_sel_hi:[1,1,0]
    v_cvt_pk_bf16_f32 v63, v56, v57
    buffer_store_dwordx4 v[60:63], v7, s[8:11], s23 offen offset:0 sc1
    v_lshlrev_b32 v54, 16, v44
    v_and_b32 v55, s32, v44
    v_pk_fma_f32 v[54:55], v[54:55], v[52:53], v[52:53] op_sel:[0,1,0] op_sel_hi:[1,1,0]
    v_cvt_pk_bf16_f32 v64, v54, v55
    v_lshlrev_b32 v56, 16, v45
    v_and_b32 v57, s32, v45
    v_pk_fma_f32 v[56:57], v[56:57], v[52:53], v[52:53] op_sel:[0,1,0] op_sel_hi:[1,1,0]
    v_cvt_pk_bf16_f32 v65, v56, v57
    v_lshlrev_b32 v54, 16, v46
    v_and_b32 v55, s32, v46
    v_pk_fma_f32 v[54:55], v[54:55], v[52:53], v[52:53] op_sel:[0,1,0] op_sel_hi:[1,1,0]
    v_cvt_pk_bf16_f32 v66, v54, v55
    v_lshlrev_b32 v56, 16, v47
    v_and_b32 v57, s32, v47
    v_pk_fma_f32 v[56:57], v[56:57], v[52:53], v[52:53] op_sel:[0,1,0] op_sel_hi:[1,1,0]
    v_cvt_pk_bf16_f32 v67, v56, v57
    buffer_store_dwordx4 v[64:67], v7, s[8:11], s23 offen offset:2048 sc1
    s_add_u32 s23, s23, 4096
    v_lshlrev_b32 v54, 16, v48
    v_and_b32 v55, s32, v48
    v_pk_fma_f32 v[54:55], v[54:55], v[52:53], v[52:53] op_sel:[0,1,0] op_sel_hi:[1,1,0]
    v_cvt_pk_bf16_f32 v60, v54, v55
    v_lshlrev_b32 v56, 16, v49
    v_and_b32 v57, s32, v49
    v_pk_fma_f32 v[56:57], v[56:57], v[52:53], v[52:53] op_sel:[0,1,0] op_sel_hi:[1,1,0]
    v_cvt_pk_bf16_f32 v61, v56, v57
    v_lshlrev_b32 v54, 16, v50
    v_and_b32 v55, s32, v50
    v_pk_fma_f32 v[54:55], v[54:55], v[52:53], v[52:53] op_sel:[0,1,0] op_sel_hi:[1,1,0]
    v_cvt_pk_bf16_f32 v62, v54, v55
    v_lshlrev_b32 v56, 16, v51
    v_and_b32 v57, s32, v51
    v_pk_fma_f32 v[56:57], v[56:57], v[52:53], v[52:53] op_sel:[0,1,0] op_sel_hi:[1,1,0]
    v_cvt_pk_bf16_f32 v63, v56, v57
    buffer_store_dwordx4 v[60:63], v7, s[8:11], s23 offen offset:0 sc1
    s_barrier
    s_waitcnt vmcnt(0)
    s_mov_b32 s57, 300000
L_tok_a:
    v_readfirstlane_b32 s100, v254
    v_readfirstlane_b32 s101, v255
    s_sub_u32 s57, s57, 1
    s_min_u32 s94, s100, s101
    s_cmp_eq_u32 s57, 0
    s_cselect_b32 s94, 1, s94
    s_cmp_lg_u32 s94, 0
    s_cbranch_scc1 L_tokx_a
    v_mov_b32 v2, 0
    buffer_load_dwordx2 v[254:255], v2, s[84:87], 0 offen sc1
    s_waitcnt vmcnt(0)
    s_branch L_tok_a
L_tokx_a:
    v_mov_b32 v254, s100
    v_mov_b32 v255, s101
    buffer_store_dwordx2 v[254:255], v13, s[8:11], s56 offen sc1
    s_branch L_p0_wait
L_p0_wq:
    s_lshl_b32 s21, s18, 3
    s_and_b32 s22, s17, 7
    s_add_u32 s21, s21, s22
    s_lshr_b32 s29, s17, 3
    s_lshl_b32 s22, s19, 2
    s_add_u32 s22, s22, s29
    s_mul_i32 s33, s22, 72
    v_bfe_u32 v10, v0, 1, 5
    v_mul_u32_u24 v10, 3456, v10
    v_and_b32 v11, 1, v0
    v_lshl_add_u32 v10, v11, 4, v10
    v_mul_u32_u24 v12, 36, v11
    v_bfe_u32 v11, v0, 3, 3
    v_mul_u32_u24 v11, 3456, v11
    v_add_u32 v11, v11, v12
    v_bfe_u32 v12, v0, 1, 2
    v_cmp_eq_u32 vcc, 3, v12
    v_mul_u32_u24 v12, 1152, v12
    v_add_u32 v11, v11, v12
    v_mov_b32 v12, 1073741824
    v_cndmask_b32 v11, v11, v12, vcc
    s_lshl_b32 s80, s21, 3
    s_mov_b32 m0, 131072
    s_mov_b32 s82, 8
    s_mov_b32 s79, 858993460
    s_waitcnt lgkmcnt(0)
    s_mov_b32 s60, s38
    s_mov_b32 s61, s39
    s_mov_b32 s62, 1990656
    s_mov_b32 s63, 0x00020000
L_wq:
    s_mul_hi_u32 s81, s80, s79
    s_mul_i32 s30, s81, 5
    s_sub_u32 s30, s80, s30
    s_lshr_b32 s31, s30, 1
    s_add_u32 s31, s31, 1
    s_sub_u32 s34, s80, 90
    s_lshr_b32 s35, s34, 1
    s_and_b32 s34, s34, 1
    s_cmp_ge_u32 s80, 90
    s_cselect_b32 s81, s35, s81
    s_cselect_b32 s30, s34, s30
    s_cselect_b32 s31, 0, s31
    s_mul_i32 s34, s81, 110592
    s_add_u32 s34, s34, s33
    s_cmp_eq_u32 s30, 4
    s_cbranch_scc1 L_wqb
    s_mul_i32 s31, s31, 1152
    s_and_b32 s30, s30, 1
    s_mul_i32 s30, s30, 36
    s_add_u32 s34, s34, s31
    s_add_u32 s34, s34, s30
    buffer_load_dwordx4 v10, s[60:63], s34 offen lds
    s_add_u32 m0, m0, 1024
L_wqj:
    s_add_u32 s80, s80, 1
    s_sub_u32 s82, s82, 1
    s_cmp_lg_u32 s82, 0
    s_cbranch_scc1 L_wq
    s_branch L_wqx
L_wqb:
    s_add_u32 s34, s34, 32
    buffer_load_dword v11, s[60:63], s34 offen lds
    s_add_u32 m0, m0, 256
    s_add_u32 s34, s34, 27648
    buffer_load_dword v11, s[60:63], s34 offen lds
    s_add_u32 m0, m0, 256
    s_add_u32 s34, s34, 27648
    buffer_load_dword v11, s[60:63], s34 offen lds
    s_add_u32 m0, m0, 256
    s_add_u32 s34, s34, 27648
    buffer_load_dword v11, s[60:63], s34 offen lds
    s_add_u32 m0, m0, 256
    s_add_u32 s34, s34, 27648
    s_branch L_wqj
L_wqx:
    s_barrier
    s_mov_b32 s8, s4
    s_mov_b32 s9, s5
    s_mov_b32 s10, 64192512
    s_mov_b32 s11, 0x00020000
    s_mov_b32 s86, 256
    s_mov_b32 s87, 0x00020000
    s_lshl_b32 s21, s18, 3
    s_and_b32 s22, s17, 7
    s_add_u32 s21, s21, s22
    s_lshr_b32 s29, s17, 3
    s_lshl_b32 s22, s19, 2
    s_add_u32 s22, s22, s29
    s_mul_i32 s25, s22, 129024
    s_add_u32 s25, s25, 61767680
    s_lshl_b32 s30, s21, 13
    s_add_u32 s30, s30, s25
    s_add_u32 s31, s30, 4096
    v_lshrrev_b32 v3, 1, v1
    v_add_u32 v3, 131072, v3
    s_cmp_eq_u32 s21, 15
    s_cselect_b32 s32, 1073741824, s31
    s_lshl_b32 s24, s22, 7
    s_add_u32 s24, s24, 63890432
    s_lshl_b32 s27, s21, 3
    s_add_u32 s27, s27, s24
    s_waitcnt vmcnt(0)
    v_mov_b32 v2, 0
    buffer_load_dwordx2 v[254:255], v2, s[84:87], 0 offen sc1
    ds_read_b64_tr_b16 v[16:17], v3 offset:0
    ds_read_b64_tr_b16 v[18:19], v3 offset:512
    ds_read_b64_tr_b16 v[20:21], v3 offset:1024
    ds_read_b64_tr_b16 v[22:23], v3 offset:1536
    ds_read_b64_tr_b16 v[24:25], v3 offset:2048
    ds_read_b64_tr_b16 v[26:27], v3 offset:2560
    ds_read_b64_tr_b16 v[28:29], v3 offset:3072
    ds_read_b64_tr_b16 v[30:31], v3 offset:3584
    ds_read_b64_tr_b16 v[32:33], v3 offset:4096
    ds_read_b64_tr_b16 v[34:35], v3 offset:4608
    ds_read_b64_tr_b16 v[36:37], v3 offset:5120
    ds_read_b64_tr_b16 v[38:39], v3 offset:5632
    ds_read_b64_tr_b16 v[40:41], v3 offset:6144
    ds_read_b64_tr_b16 v[42:43], v3 offset:6656
    ds_read_b64_tr_b16 v[44:45], v3 offset:7168
    ds_read_b64_tr_b16 v[46:47], v3 offset:7680
    s_waitcnt lgkmcnt(14)
    buffer_store_dwordx4 v[16:19], v1, s[8:11], s30 offen offset:0 sc1
    s_waitcnt lgkmcnt(12)
    buffer_store_dwordx4 v[20:23], v1, s[8:11], s30 offen offset:1024 sc1
    s_waitcnt lgkmcnt(10)
    buffer_store_dwordx4 v[24:27], v1, s[8:11], s30 offen offset:2048 sc1
    s_waitcnt lgkmcnt(8)
    buffer_store_dwordx4 v[28:31], v1, s[8:11], s30 offen offset:3072 sc1
    s_waitcnt lgkmcnt(6)
    buffer_store_dwordx4 v[32:35], v1, s[8:11], s31 offen offset:0 sc1
    s_waitcnt lgkmcnt(4)
    buffer_store_dwordx4 v[36:39], v1, s[8:11], s31 offen offset:1024 sc1
    s_waitcnt lgkmcnt(2)
    buffer_store_dwordx4 v[40:43], v1, s[8:11], s32 offen offset:2048 sc1
    s_waitcnt lgkmcnt(0)
    buffer_store_dwordx4 v[44:47], v1, s[8:11], s32 offen offset:3072 sc1
    s_barrier
    s_waitcnt vmcnt(0)
    s_mov_b32 s57, 300000
L_tok_b:
    v_readfirstlane_b32 s100, v254
    v_readfirstlane_b32 s101, v255
    s_sub_u32 s57, s57, 1
    s_min_u32 s94, s100, s101
    s_cmp_eq_u32 s57, 0
    s_cselect_b32 s94, 1, s94
    s_cmp_lg_u32 s94, 0
    s_cbranch_scc1 L_tokx_b
    v_mov_b32 v2, 0
    buffer_load_dwordx2 v[254:255], v2, s[84:87], 0 offen sc1
    s_waitcnt vmcnt(0)
    s_branch L_tok_b
L_tokx_b:
    v_mov_b32 v254, s100
    v_mov_b32 v255, s101
    buffer_store_dwordx2 v[254:255], v13, s[8:11], s27 offen sc1
    s_mov_b32 s56, s24
    v_and_b32 v2, 15, v0
    v_lshlrev_b32 v2, 3, v2
    s_mov_b32 s57, 300000
    s_add_u32 s56, s56, s51
L_poll_q0:
    s_load_dwordx16 s[84:99], s[4:5], s56 glc
    s_sub_u32 s57, s57, 1
    s_cmp_eq_u32 s57, 0
    s_waitcnt lgkmcnt(0)
    s_cbranch_scc1 L_pollx_q
    s_xor_b64 s[84:85], s[84:85], s[100:101]
    s_xor_b64 s[86:87], s[86:87], s[100:101]
    s_xor_b64 s[88:89], s[88:89], s[100:101]
    s_xor_b64 s[90:91], s[90:91], s[100:101]
    s_xor_b64 s[92:93], s[92:93], s[100:101]
    s_xor_b64 s[94:95], s[94:95], s[100:101]
    s_xor_b64 s[96:97], s[96:97], s[100:101]
    s_xor_b64 s[98:99], s[98:99], s[100:101]
    s_or_b64 s[84:85], s[84:85], s[86:87]
    s_or_b64 s[84:85], s[84:85], s[88:89]
    s_or_b64 s[84:85], s[84:85], s[90:91]
    s_or_b64 s[84:85], s[84:85], s[92:93]
    s_or_b64 s[84:85], s[84:85], s[94:95]
    s_or_b64 s[84:85], s[84:85], s[96:97]
    s_or_b64 s[84:85], s[84:85], s[98:99]
    s_cbranch_scc0 2
    s_sleep 2
    s_branch L_poll_q0
    s_add_u32 s56, s56, 64
L_poll_q8:
    s_load_dwordx16 s[84:99], s[4:5], s56 glc
    s_sub_u32 s57, s57, 1
    s_cmp_eq_u32 s57, 0
    s_waitcnt lgkmcnt(0)
    s_cbranch_scc1 L_pollx_q
    s_xor_b64 s[84:85], s[84:85], s[100:101]
    s_xor_b64 s[86:87], s[86:87], s[100:101]
    s_xor_b64 s[88:89], s[88:89], s[100:101]
    s_xor_b64 s[90:91], s[90:91], s[100:101]
    s_xor_b64 s[92:93], s[92:93], s[100:101]
    s_xor_b64 s[94:95], s[94:95], s[100:101]
    s_xor_b64 s[96:97], s[96:97], s[100:101]
    s_xor_b64 s[98:99], s[98:99], s[100:101]
    s_or_b64 s[84:85], s[84:85], s[86:87]
    s_or_b64 s[84:85], s[84:85], s[88:89]
    s_or_b64 s[84:85], s[84:85], s[90:91]
    s_or_b64 s[84:85], s[84:85], s[92:93]
    s_or_b64 s[84:85], s[84:85], s[94:95]
    s_or_b64 s[84:85], s[84:85], s[96:97]
    s_or_b64 s[84:85], s[84:85], s[98:99]
    s_cbranch_scc0 2
    s_sleep 2
    s_branch L_poll_q8
L_pollx_q:
    s_branch L_p0_fetch
L_p0_23:
    s_sub_u32 s21, s20, 2
    v_bfe_u32 v4, v0, 3, 3
    v_and_b32 v5, 7, v0
    s_memrealtime s[94:95]
    s_lshl_b32 s23, s2, 1
    s_add_u32 s23, s23, s21
    s_mov_b32 s30, 1431655766
    s_mul_hi_u32 s25, s23, s30
    s_mul_i32 s30, s25, 3
    s_sub_u32 s28, s23, s30
    s_mul_i32 s28, s28, 6
    s_mov_b32 s30, 238609295
    s_mul_hi_u32 s26, s25, s30
    s_mul_i32 s30, s26, 18
    s_sub_u32 s25, s25, s30
    s_cmp_ge_u32 s25, 9
    s_cselect_b32 s27, 18, 0
    s_cselect_b32 s30, 9, 0
    s_sub_u32 s25, s25, s30
    s_mul_i32 s30, s26, 9
    s_add_u32 s25, s25, s30
    s_lshl_b32 s24, s25, 7
    s_mul_i32 s30, s28, 294912
    s_add_u32 s24, s24, s30
    v_mul_u32_u24 v6, 9216, v4
    v_lshl_add_u32 v6, v5, 4, v6
    s_waitcnt lgkmcnt(0)
    s_mov_b32 s8, s4
    s_mov_b32 s9, s5
    s_mov_b32 s10, 64192512
    s_mov_b32 s11, 0x00020000
    s_mov_b32 s86, 256
    s_mov_b32 s87, 0x00020000
    s_or_b32 s94, s94, 1
    s_or_b32 s95, s95, 0x80000000
    v_mov_b32 v16, s94
    v_mov_b32 v17, s95
    s_cmp_eq_u32 s23, 0
    s_cselect_b32 s30, 0, 1073741824
    buffer_store_dwordx2 v[16:17], v13, s[84:87], s30 offen sc1
    s_sub_u32 s30, s23, 486
    s_lshl_b32 s30, s30, 14
    s_add_u32 s30, s30, 63864832
    s_cmp_ge_u32 s23, 486
    s_cselect_b32 s30, s30, 1073741824
    s_add_u32 s31, s30, 8192
    v_lshlrev_b32 v2, 3, v1
    buffer_load_dword v22, v2, s[8:11], s30 offen
    buffer_load_dword v21, v2, s[8:11], s31 offen
    s_cmp_ge_u32 s2, 216
    s_cbranch_scc1 L_p0_wo
    s_add_u32 s29, s27, s28
    s_lshl_b32 s30, s25, 2
    s_add_u32 s30, s30, 0
    s_mov_b32 s33, 477218589
    s_mul_hi_u32 s31, s30, s33
    s_mul_i32 s33, s31, 9
    s_sub_u32 s30, s30, s33
    s_mul_i32 s31, s31, 486
    s_mul_i32 s30, s30, 36
    s_add_u32 s30, s30, s31
    s_add_u32 s30, s30, s29
    s_add_u32 s30, s30, 37376
    s_lshl_b32 s68, s30, 10
    s_lshl_b32 s30, s25, 2
    s_add_u32 s30, s30, 1
    s_mov_b32 s33, 477218589
    s_mul_hi_u32 s31, s30, s33
    s_mul_i32 s33, s31, 9
    s_sub_u32 s30, s30, s33
    s_mul_i32 s31, s31, 486
    s_mul_i32 s30, s30, 36
    s_add_u32 s30, s30, s31
    s_add_u32 s30, s30, s29
    s_add_u32 s30, s30, 37376
    s_lshl_b32 s69, s30, 10
    s_lshl_b32 s30, s25, 2
    s_add_u32 s30, s30, 2
    s_mov_b32 s33, 477218589
    s_mul_hi_u32 s31, s30, s33
    s_mul_i32 s33, s31, 9
    s_sub_u32 s30, s30, s33
    s_mul_i32 s31, s31, 486
    s_mul_i32 s30, s30, 36
    s_add_u32 s30, s30, s31
    s_add_u32 s30, s30, s29
    s_add_u32 s30, s30, 37376
    s_lshl_b32 s70, s30, 10
    s_lshl_b32 s30, s25, 2
    s_add_u32 s30, s30, 3
    s_mov_b32 s33, 477218589
    s_mul_hi_u32 s31, s30, s33
    s_mul_i32 s33, s31, 9
    s_sub_u32 s30, s30, s33
    s_mul_i32 s31, s31, 486
    s_mul_i32 s30, s30, 36
    s_add_u32 s30, s30, s31
    s_add_u32 s30, s30, s29
    s_add_u32 s30, s30, 37376
    s_lshl_b32 s71, s30, 10
    s_mov_b32 s30, 1431655766
    s_mul_hi_u32 s25, s2, s30
    s_mul_i32 s30, s25, 3
    s_sub_u32 s28, s2, s30
    s_mul_i32 s28, s28, 6
    s_mul_i32 s30, s21, 3
    s_add_u32 s28, s28, s30
    s_mul_i32 s30, s26, 9
    s_sub_u32 s25, s25, s30
    s_lshl_b32 s31, s25, 1
    s_add_u32 s31, s31, 0
    s_and_b32 s31, s31, 3
    s_and_b32 s30, s25, 14
    s_add_u32 s30, s30, 1
    s_cmp_eq_u32 s25, 8
    s_cselect_b32 s31, 0, s31
    s_cselect_b32 s30, 0, s30
    s_lshl_b32 s33, s26, 2
    s_add_u32 s31, s31, s33
    s_mul_i32 s31, s31, 486
    s_mul_i32 s30, s30, 18
    s_add_u32 s30, s30, s31
    s_add_u32 s30, s30, s28
    s_add_u32 s30, s30, 37700
    s_lshl_b32 s78, s30, 10
    s_lshl_b32 s31, s25, 1
    s_add_u32 s31, s31, 0
    s_and_b32 s31, s31, 3
    s_and_b32 s30, s25, 14
    s_add_u32 s30, s30, 2
    s_cmp_eq_u32 s25, 8
    s_cselect_b32 s31, 1, s31
    s_cselect_b32 s30, 0, s30
    s_lshl_b32 s33, s26, 2
    s_add_u32 s31, s31, s33
    s_mul_i32 s31, s31, 486
    s_mul_i32 s30, s30, 18
    s_add_u32 s30, s30, s31
    s_add_u32 s30, s30, s28
    s_add_u32 s30, s30, 37700
    s_lshl_b32 s79, s30, 10
    s_lshl_b32 s31, s25, 1
    s_add_u32 s31, s31, 1
    s_and_b32 s31, s31, 3
    s_and_b32 s30, s25, 14
    s_add_u32 s30, s30, 1
    s_cmp_eq_u32 s25, 8
    s_cselect_b32 s31, 2, s31
    s_cselect_b32 s30, 0, s30
    s_lshl_b32 s33, s26, 2
    s_add_u32 s31, s31, s33
    s_mul_i32 s31, s31, 486
    s_mul_i32 s30, s30, 18
    s_add_u32 s30, s30, s31
    s_add_u32 s30, s30, s28
    s_add_u32 s30, s30, 37700
    s_lshl_b32 s80, s30, 10
    s_lshl_b32 s31, s25, 1
    s_add_u32 s31, s31, 1
    s_and_b32 s31, s31, 3
    s_and_b32 s30, s25, 14
    s_add_u32 s30, s30, 2
    s_cmp_eq_u32 s25, 8
    s_cselect_b32 s31, 3, s31
    s_cselect_b32 s30, 0, s30
    s_lshl_b32 s33, s26, 2
    s_add_u32 s31, s31, s33
    s_mul_i32 s31, s31, 486
    s_mul_i32 s30, s30, 18
    s_add_u32 s30, s30, s31
    s_add_u32 s30, s30, s28
    s_add_u32 s30, s30, 37700
    s_lshl_b32 s81, s30, 10
    s_lshl_b32 s34, s25, 7
    s_mul_i32 s35, s26, 576
    s_lshr_b32 s30, s28, 2
    s_mul_i32 s30, s30, 144
    s_and_b32 s31, s28, 3
    s_lshl_b32 s31, s31, 5
    s_add_u32 s30, s30, s31
    s_mul_i32 s31, s28, 288
    s_sub_u32 s31, s31, 4480
    s_cmp_ge_u32 s28, 16
    s_cselect_b32 s30, s31, s30
    s_cselect_b32 s37, 144, 16
    s_add_u32 s30, s30, s35
    s_mul_i32 s30, s30, 1152
    s_add_u32 s72, s30, s34
    s_mul_i32 s37, s37, 1152
    s_add_u32 s73, s72, s37
    s_add_u32 s28, s28, 1
    s_lshr_b32 s30, s28, 2
    s_mul_i32 s30, s30, 144
    s_and_b32 s31, s28, 3
    s_lshl_b32 s31, s31, 5
    s_add_u32 s30, s30, s31
    s_mul_i32 s31, s28, 288
    s_sub_u32 s31, s31, 4480
    s_cmp_ge_u32 s28, 16
    s_cselect_b32 s30, s31, s30
    s_cselect_b32 s37, 144, 16
    s_add_u32 s30, s30, s35
    s_mul_i32 s30, s30, 1152
    s_add_u32 s74, s30, s34
    s_mul_i32 s37, s37, 1152
    s_add_u32 s75, s74, s37
    s_add_u32 s28, s28, 1
    s_lshr_b32 s30, s28, 2
    s_mul_i32 s30, s30, 144
    s_and_b32 s31, s28, 3
    s_lshl_b32 s31, s31, 5
    s_add_u32 s30, s30, s31
    s_mul_i32 s31, s28, 288
    s_sub_u32 s31, s31, 4480
    s_cmp_ge_u32 s28, 16
    s_cselect_b32 s30, s31, s30
    s_cselect_b32 s37, 144, 16
    s_add_u32 s30, s30, s35
    s_mul_i32 s30, s30, 1152
    s_add_u32 s76, s30, s34
    s_mul_i32 s37, s37, 1152
    s_add_u32 s77, s76, s37
    s_add_u32 s28, s28, 1
    s_barrier
    s_cmp_eq_u32 s27, 0
    s_cselect_b32 s60, s40, s42
    s_cselect_b32 s61, s41, s43
    s_mov_b32 s62, 5308416
    s_mov_b32 s63, 0x00020000
    buffer_load_dwordx4 v[128:131], v6, s[60:63], s24 offen nt
    s_add_u32 s24, s24, 73728
    buffer_load_dwordx4 v[132:135], v6, s[60:63], s24 offen nt
    s_add_u32 s24, s24, 73728
    buffer_load_dwordx4 v[136:139], v6, s[60:63], s24 offen nt
    s_add_u32 s24, s24, 73728
    buffer_load_dwordx4 v[140:143], v6, s[60:63], s24 offen nt
    s_add_u32 s24, s24, 73728
    s_barrier
    buffer_load_dwordx4 v[144:147], v6, s[60:63], s24 offen nt
    s_add_u32 s24, s24, 73728
    buffer_load_dwordx4 v[148:151], v6, s[60:63], s24 offen nt
    s_add_u32 s24, s24, 73728
    buffer_load_dwordx4 v[152:155], v6, s[60:63], s24 offen nt
    s_add_u32 s24, s24, 73728
    buffer_load_dwordx4 v[156:159], v6, s[60:63], s24 offen nt
    s_add_u32 s24, s24, 73728
    buffer_load_dwordx4 v[160:163], v6, s[60:63], s24 offen nt
    s_add_u32 s24, s24, 73728
    buffer_load_dwordx4 v[164:167], v6, s[60:63], s24 offen nt
    s_add_u32 s24, s24, 73728
    buffer_load_dwordx4 v[168:171], v6, s[60:63], s24 offen nt
    s_add_u32 s24, s24, 73728
    buffer_load_dwordx4 v[172:175], v6, s[60:63], s24 offen nt
    s_add_u32 s24, s24, 73728
    s_getpc_b64 s[12:13]
L_pc:
    s_mov_b32 s14, L_end-L_pc
    s_mov_b32 s15, 0x00020000
    v_lshlrev_b32 v2, 3, v1
    s_lshl_b32 s30, s17, 13
    s_cmp_eq_u32 s20, 3
    s_cselect_b32 s30, s30, 1073741824
    buffer_load_dword v20, v2, s[12:15], s30 offen
    v_mov_b32 v2, 0
    buffer_load_dwordx2 v[254:255], v2, s[84:87], 0 offen sc1
    s_mov_b32 s67, 1
    s_branch L_p0_wait
L_p0_wo:
    s_barrier
    s_barrier
    v_mov_b32 v2, 0
    buffer_load_dwordx2 v[254:255], v2, s[84:87], 0 offen sc1
    s_sub_u32 s23, s23, 432
    s_cmp_lt_u32 s23, 54
    s_cbranch_scc1 L_p0_wo2
    s_waitcnt vmcnt(0)
    s_mov_b32 s57, 300000
L_tok_d:
    v_readfirstlane_b32 s100, v254
    v_readfirstlane_b32 s101, v255
    s_sub_u32 s57, s57, 1
    s_min_u32 s94, s100, s101
    s_cmp_eq_u32 s57, 0
    s_cselect_b32 s94, 1, s94
    s_cmp_lg_u32 s94, 0
    s_cbranch_scc1 L_tokx_d
    v_mov_b32 v2, 0
    buffer_load_dwordx2 v[254:255], v2, s[84:87], 0 offen sc1
    s_waitcnt vmcnt(0)
    s_branch L_tok_d
L_tokx_d:
    s_branch L_p0_wait
L_p0_wo2:
    s_mov_b32 s12, s46
    s_mov_b32 s13, s47
    s_mov_b32 s14, 663552
    s_mov_b32 s15, 0x00020000
    s_mov_b32 s30, 1431655766
    s_mul_hi_u32 s27, s23, s30
    s_mul_i32 s30, s27, 3
    s_sub_u32 s25, s23, s30
    s_mul_i32 s25, s25, 3
    v_lshrrev_b32 v7, 1, v4
    v_mul_u32_u24 v7, 18, v7
    v_and_b32 v8, 1, v4
    v_add_u32 v7, v7, v8
    s_mul_i32 s30, s27, 36
    s_sub_u32 s31, s27, 16
    s_mul_i32 s31, s31, 288
    s_add_u32 s31, s31, 16
    s_cmp_lt_u32 s27, 16
    s_cselect_b32 s30, s30, s31
    s_mov_b32 s28, 20736
    s_mov_b32 s29, 9216
    s_cselect_b32 s28, s28, 165888
    s_cselect_b32 s29, s29, 82944
    s_cselect_b64 vcc, -1, 0
    s_mul_i32 s32, s30, 1152
    s_lshl_b32 s31, s25, 7
    s_add_u32 s32, s32, s31
    v_cndmask_b32 v8, v7, v4, vcc
    v_mul_u32_u24 v6, 1152, v8
    v_lshl_add_u32 v6, v5, 4, v6
    s_add_u32 s33, s32, s29
    s_add_u32 s34, s32, s28
    s_add_u32 s35, s34, s29
    buffer_load_dwordx4 v[128:131], v6, s[12:15], s32 offen offset:0 nt
    buffer_load_dwordx4 v[132:135], v6, s[12:15], s33 offen offset:0 nt
    buffer_load_dwordx4 v[136:139], v6, s[12:15], s34 offen offset:0 nt
    buffer_load_dwordx4 v[140:143], v6, s[12:15], s35 offen offset:0 nt
    buffer_load_dwordx4 v[144:147], v6, s[12:15], s32 offen offset:128 nt
    buffer_load_dwordx4 v[148:151], v6, s[12:15], s33 offen offset:128 nt
    buffer_load_dwordx4 v[152:155], v6, s[12:15], s34 offen offset:128 nt
    buffer_load_dwordx4 v[156:159], v6, s[12:15], s35 offen offset:128 nt
    buffer_load_dwordx4 v[160:163], v6, s[12:15], s32 offen offset:256 nt
    buffer_load_dwordx4 v[164:167], v6, s[12:15], s33 offen offset:256 nt
    buffer_load_dwordx4 v[168:171], v6, s[12:15], s34 offen offset:256 nt
    buffer_load_dwordx4 v[172:175], v6, s[12:15], s35 offen offset:256 nt
    s_add_u32 s30, s25, 0
    s_cmp_eq_u32 s30, 8
    s_mul_i32 s30, s30, 90
    s_cselect_b32 s30, 4, s30
    s_mul_i32 s31, s27, 5
    s_add_u32 s30, s30, s31
    s_add_u32 s30, s30, 34560
    s_lshl_b32 s72, s30, 10
    s_add_u32 s30, s25, 0
    s_cmp_eq_u32 s30, 8
    s_mul_i32 s30, s30, 90
    s_cselect_b32 s30, 93, s30
    s_mul_i32 s31, s27, 5
    s_add_u32 s30, s30, s31
    s_add_u32 s30, s30, 34561
    s_lshl_b32 s73, s30, 10
    s_add_u32 s30, s25, 0
    s_cmp_eq_u32 s30, 8
    s_mul_i32 s30, s30, 90
    s_cselect_b32 s30, 182, s30
    s_mul_i32 s31, s27, 5
    s_add_u32 s30, s30, s31
    s_add_u32 s30, s30, 34562
    s_lshl_b32 s74, s30, 10
    s_add_u32 s30, s25, 0
    s_cmp_eq_u32 s30, 8
    s_mul_i32 s30, s30, 90
    s_cselect_b32 s30, 271, s30
    s_mul_i32 s31, s27, 5
    s_add_u32 s30, s30, s31
    s_add_u32 s30, s30, 34563
    s_lshl_b32 s75, s30, 10
    s_add_u32 s30, s25, 1
    s_cmp_eq_u32 s30, 8
    s_mul_i32 s30, s30, 90
    s_cselect_b32 s30, 4, s30
    s_mul_i32 s31, s27, 5
    s_add_u32 s30, s30, s31
    s_add_u32 s30, s30, 34560
    s_lshl_b32 s76, s30, 10
    s_add_u32 s30, s25, 1
    s_cmp_eq_u32 s30, 8
    s_mul_i32 s30, s30, 90
    s_cselect_b32 s30, 93, s30
    s_mul_i32 s31, s27, 5
    s_add_u32 s30, s30, s31
    s_add_u32 s30, s30, 34561
    s_lshl_b32 s77, s30, 10
    s_add_u32 s30, s25, 1
    s_cmp_eq_u32 s30, 8
    s_mul_i32 s30, s30, 90
    s_cselect_b32 s30, 182, s30
    s_mul_i32 s31, s27, 5
    s_add_u32 s30, s30, s31
    s_add_u32 s30, s30, 34562
    s_lshl_b32 s78, s30, 10
    s_add_u32 s30, s25, 1
    s_cmp_eq_u32 s30, 8
    s_mul_i32 s30, s30, 90
    s_cselect_b32 s30, 271, s30
    s_mul_i32 s31, s27, 5
    s_add_u32 s30, s30, s31
    s_add_u32 s30, s30, 34563
    s_lshl_b32 s79, s30, 10
    s_add_u32 s30, s25, 2
    s_cmp_eq_u32 s30, 8
    s_mul_i32 s30, s30, 90
    s_cselect_b32 s30, 4, s30
    s_mul_i32 s31, s27, 5
    s_add_u32 s30, s30, s31
    s_add_u32 s30, s30, 34560
    s_lshl_b32 s80, s30, 10
    s_add_u32 s30, s25, 2
    s_cmp_eq_u32 s30, 8
    s_mul_i32 s30, s30, 90
    s_cselect_b32 s30, 93, s30
    s_mul_i32 s31, s27, 5
    s_add_u32 s30, s30, s31
    s_add_u32 s30, s30, 34561
    s_lshl_b32 s81, s30, 10
    s_add_u32 s30, s25, 2
    s_cmp_eq_u32 s30, 8
    s_mul_i32 s30, s30, 90
    s_cselect_b32 s30, 182, s30
    s_mul_i32 s31, s27, 5
    s_add_u32 s30, s30, s31
    s_add_u32 s30, s30, 34562
    s_lshl_b32 s82, s30, 10
    s_add_u32 s30, s25, 2
    s_cmp_eq_u32 s30, 8
    s_mul_i32 s30, s30, 90
    s_cselect_b32 s30, 271, s30
    s_mul_i32 s31, s27, 5
    s_add_u32 s30, s30, s31
    s_add_u32 s30, s30, 34563
    s_lshl_b32 s83, s30, 10
    s_lshl_b32 s66, s20, 13
    s_add_u32 s66, s66, 131072
    v_add_u32 v10, s66, v1
    v_bfe_u32 v11, v0, 2, 4
    v_lshlrev_b32 v11, 7, v11
    v_and_b32 v252, 3, v0
    v_lshl_add_u32 v11, v252, 3, v11
    v_add_u32 v11, s66, v11
    s_waitcnt vmcnt(0)
    s_waitcnt lgkmcnt(0)
    ds_write_b128 v10, v[128:131] offset:0
    ds_write_b128 v10, v[132:135] offset:1024
    ds_write_b128 v10, v[136:139] offset:2048
    ds_write_b128 v10, v[140:143] offset:3072
    s_waitcnt lgkmcnt(0)
    ds_read_b64_tr_b16 v[220:221], v11 offset:0
    ds_read_b64_tr_b16 v[222:223], v11 offset:2048
    ds_read_b64_tr_b16 v[224:225], v11 offset:32
    ds_read_b64_tr_b16 v[226:227], v11 offset:2080
    ds_read_b64_tr_b16 v[228:229], v11 offset:64
    ds_read_b64_tr_b16 v[230:231], v11 offset:2112
    ds_read_b64_tr_b16 v[232:233], v11 offset:96
    ds_read_b64_tr_b16 v[234:235], v11 offset:2144
    ds_write_b128 v10, v[144:147] offset:4096
    ds_write_b128 v10, v[148:151] offset:5120
    ds_write_b128 v10, v[152:155] offset:6144
    ds_write_b128 v10, v[156:159] offset:7168
    s_waitcnt lgkmcnt(0)
    buffer_store_dwordx4 v[220:223], v1, s[8:11], s72 offen offset:0 sc1
    buffer_store_dwordx4 v[224:227], v1, s[8:11], s73 offen offset:0 sc1
    buffer_store_dwordx4 v[228:231], v1, s[8:11], s74 offen offset:0 sc1
    buffer_store_dwordx4 v[232:235], v1, s[8:11], s75 offen offset:0 sc1
    ds_read_b64_tr_b16 v[236:237], v11 offset:4096
    ds_read_b64_tr_b16 v[238:239], v11 offset:6144
    ds_read_b64_tr_b16 v[240:241], v11 offset:4128
    ds_read_b64_tr_b16 v[242:243], v11 offset:6176
    ds_read_b64_tr_b16 v[244:245], v11 offset:4160
    ds_read_b64_tr_b16 v[246:247], v11 offset:6208
    ds_read_b64_tr_b16 v[248:249], v11 offset:4192
    ds_read_b64_tr_b16 v[250:251], v11 offset:6240
    ds_write_b128 v10, v[160:163] offset:0
    ds_write_b128 v10, v[164:167] offset:1024
    ds_write_b128 v10, v[168:171] offset:2048
    ds_write_b128 v10, v[172:175] offset:3072
    s_waitcnt lgkmcnt(0)
    buffer_store_dwordx4 v[236:239], v1, s[8:11], s76 offen offset:0 sc1
    buffer_store_dwordx4 v[240:243], v1, s[8:11], s77 offen offset:0 sc1
    buffer_store_dwordx4 v[244:247], v1, s[8:11], s78 offen offset:0 sc1
    buffer_store_dwordx4 v[248:251], v1, s[8:11], s79 offen offset:0 sc1
    ds_read_b64_tr_b16 v[220:221], v11 offset:0
    ds_read_b64_tr_b16 v[222:223], v11 offset:2048
    ds_read_b64_tr_b16 v[224:225], v11 offset:32
    ds_read_b64_tr_b16 v[226:227], v11 offset:2080
    ds_read_b64_tr_b16 v[228:229], v11 offset:64
    ds_read_b64_tr_b16 v[230:231], v11 offset:2112
    ds_read_b64_tr_b16 v[232:233], v11 offset:96
    ds_read_b64_tr_b16 v[234:235], v11 offset:2144
    s_waitcnt lgkmcnt(0)
    buffer_store_dwordx4 v[220:223], v1, s[8:11], s80 offen offset:0 sc1
    buffer_store_dwordx4 v[224:227], v1, s[8:11], s81 offen offset:0 sc1
    buffer_store_dwordx4 v[228:231], v1, s[8:11], s82 offen offset:0 sc1
    buffer_store_dwordx4 v[232:235], v1, s[8:11], s83 offen offset:0 sc1
    s_mov_b32 s57, 300000
L_tok_e:
    v_readfirstlane_b32 s100, v254
    v_readfirstlane_b32 s101, v255
    s_sub_u32 s57, s57, 1
    s_min_u32 s94, s100, s101
    s_cmp_eq_u32 s57, 0
    s_cselect_b32 s94, 1, s94
    s_cmp_lg_u32 s94, 0
    s_cbranch_scc1 L_tokx_e
    v_mov_b32 v2, 0
    buffer_load_dwordx2 v[254:255], v2, s[84:87], 0 offen sc1
    s_waitcnt vmcnt(0)
    s_branch L_tok_e
L_tokx_e:
    s_lshl_b32 s56, s23, 3
    s_add_u32 s56, s56, 63889408
    s_waitcnt vmcnt(0)
    v_mov_b32 v254, s100
    v_mov_b32 v255, s101
    buffer_store_dwordx2 v[254:255], v13, s[8:11], s56 offen sc1
L_p0_wait:
L_p0_fetch:
    s_lshl_b32 s21, s18, 3
    s_and_b32 s22, s17, 7
    s_add_u32 s21, s21, s22
    s_lshr_b32 s29, s17, 3
    s_lshl_b32 s22, s19, 2
    s_add_u32 s22, s22, s29
    s_mul_i32 s25, s22, 129024
    s_add_u32 s25, s25, 61767680
    s_lshl_b32 s26, s20, 12
    s_add_u32 s25, s25, s26
    s_mov_b32 m0, s26
    s_barrier
    buffer_load_dwordx4 v1, s[8:11], s25 offen offset:0 lds
    buffer_load_dwordx4 v1, s[8:11], s25 offen offset:1024 lds
    buffer_load_dwordx4 v1, s[8:11], s25 offen offset:2048 lds
    buffer_load_dwordx4 v1, s[8:11], s25 offen offset:3072 lds
    s_add_u32 m0, m0, 16384
    s_add_u32 s25, s25, 16384
    buffer_load_dwordx4 v1, s[8:11], s25 offen offset:0 lds
    buffer_load_dwordx4 v1, s[8:11], s25 offen offset:1024 lds
    buffer_load_dwordx4 v1, s[8:11], s25 offen offset:2048 lds
    buffer_load_dwordx4 v1, s[8:11], s25 offen offset:3072 lds
    s_add_u32 m0, m0, 16384
    s_add_u32 s25, s25, 16384
    buffer_load_dwordx4 v1, s[8:11], s25 offen offset:0 lds
    buffer_load_dwordx4 v1, s[8:11], s25 offen offset:1024 lds
    buffer_load_dwordx4 v1, s[8:11], s25 offen offset:2048 lds
    buffer_load_dwordx4 v1, s[8:11], s25 offen offset:3072 lds
    s_add_u32 m0, m0, 16384
    s_add_u32 s25, s25, 16384
    buffer_load_dwordx4 v1, s[8:11], s25 offen offset:0 lds
    buffer_load_dwordx4 v1, s[8:11], s25 offen offset:1024 lds
    buffer_load_dwordx4 v1, s[8:11], s25 offen offset:2048 lds
    buffer_load_dwordx4 v1, s[8:11], s25 offen offset:3072 lds
    s_add_u32 m0, m0, 16384
    s_add_u32 s25, s25, 16384
    buffer_load_dwordx4 v1, s[8:11], s25 offen offset:0 lds
    buffer_load_dwordx4 v1, s[8:11], s25 offen offset:1024 lds
    buffer_load_dwordx4 v1, s[8:11], s25 offen offset:2048 lds
    buffer_load_dwordx4 v1, s[8:11], s25 offen offset:3072 lds
    s_add_u32 m0, m0, 16384
    s_add_u32 s25, s25, 16384
    buffer_load_dwordx4 v1, s[8:11], s25 offen offset:0 lds
    buffer_load_dwordx4 v1, s[8:11], s25 offen offset:1024 lds
    buffer_load_dwordx4 v1, s[8:11], s25 offen offset:2048 lds
    buffer_load_dwordx4 v1, s[8:11], s25 offen offset:3072 lds
    s_add_u32 m0, m0, 16384
    s_add_u32 s25, s25, 16384
    buffer_load_dwordx4 v1, s[8:11], s25 offen offset:0 lds
    buffer_load_dwordx4 v1, s[8:11], s25 offen offset:1024 lds
    buffer_load_dwordx4 v1, s[8:11], s25 offen offset:2048 lds
    buffer_load_dwordx4 v1, s[8:11], s25 offen offset:3072 lds
    s_add_u32 m0, m0, 16384
    s_add_u32 s25, s25, 16384
    buffer_load_dwordx4 v1, s[8:11], s25 offen offset:0 lds
    buffer_load_dwordx4 v1, s[8:11], s25 offen offset:1024 lds
    buffer_load_dwordx4 v1, s[8:11], s25 offen offset:2048 lds
    buffer_load_dwordx4 v1, s[8:11], s25 offen offset:3072 lds
    s_add_u32 m0, m0, 16384
    s_add_u32 s25, s25, 16384
    s_cmp_eq_u32 s67, 0
    s_cbranch_scc1 L_layer
    buffer_load_dwordx4 a[160:163], v6, s[60:63], s24 offen nt
    s_add_u32 s24, s24, 73728
    buffer_load_dwordx4 a[164:167], v6, s[60:63], s24 offen nt
    s_add_u32 s24, s24, 73728
    buffer_load_dwordx4 a[168:171], v6, s[60:63], s24 offen nt
    s_add_u32 s24, s24, 73728
    buffer_load_dwordx4 a[172:175], v6, s[60:63], s24 offen nt
    s_add_u32 s24, s24, 73728
    buffer_load_dwordx4 a[176:179], v6, s[60:63], s24 offen nt
    s_add_u32 s24, s24, 73728
    buffer_load_dwordx4 a[180:183], v6, s[60:63], s24 offen nt
    s_add_u32 s24, s24, 73728
    buffer_load_dwordx4 a[184:187], v6, s[60:63], s24 offen nt
    s_add_u32 s24, s24, 73728
    buffer_load_dwordx4 a[188:191], v6, s[60:63], s24 offen nt
    s_add_u32 s24, s24, 73728
    buffer_load_dwordx4 a[192:195], v6, s[60:63], s24 offen nt
    s_add_u32 s24, s24, 73728
    buffer_load_dwordx4 a[196:199], v6, s[60:63], s24 offen nt
    s_add_u32 s24, s24, 73728
    buffer_load_dwordx4 a[200:203], v6, s[60:63], s24 offen nt
    s_add_u32 s24, s24, 73728
    buffer_load_dwordx4 a[204:207], v6, s[60:63], s24 offen nt
    s_add_u32 s24, s24, 73728
    s_mov_b32 s60, s44
    s_mov_b32 s61, s45
    s_mov_b32 s62, 5308416
    s_mov_b32 s63, 0x00020000
    s_waitcnt vmcnt(44)
    s_mov_b32 s57, 300000
L_tok_c:
    v_readfirstlane_b32 s100, v254
    v_readfirstlane_b32 s101, v255
    s_sub_u32 s57, s57, 1
    s_min_u32 s94, s100, s101
    s_cmp_eq_u32 s57, 0
    s_cselect_b32 s94, 1, s94
    s_cmp_lg_u32 s94, 0
    s_cbranch_scc1 L_tokx_c
    v_mov_b32 v2, 0
    buffer_load_dwordx2 v[254:255], v2, s[84:87], 0 offen sc1
    s_waitcnt vmcnt(0)
    s_branch L_tok_c
L_tokx_c:
L_layer:
    s_lshl_b32 s21, s18, 3
    s_and_b32 s22, s17, 7
    s_add_u32 s21, s21, s22
    s_lshr_b32 s29, s17, 3
    s_lshl_b32 s22, s19, 2
    s_add_u32 s22, s22, s29
    s_lshl_b32 s56, s21, 7
    s_add_u32 s56, s56, 63864832
    v_and_b32 v2, 15, v0
    v_lshlrev_b32 v2, 3, v2
    s_lshl_b32 s26, s21, 2
    s_add_u32 s26, s26, s20
    s_mul_i32 s23, s26, 36864
    s_add_u32 s23, s23, 2359296
    s_add_u32 s24, s23, 18432
    s_add_u32 s56, s56, s51
    s_mov_b32 s57, 300000
    s_cmp_eq_u32 s20, 0
    s_cselect_b32 s27, s56, 1073741824
    buffer_load_dwordx2 v[254:255], v2, s[8:11], s27 offen sc1
    s_and_b32 s29, s20, 1
    s_lshr_b32 s30, s20, 1
    s_mul_i32 s36, s29, 12288
    s_lshl_b32 s37, s30, 11
    s_add_u32 s36, s36, s37
    s_add_u32 s37, s37, 49152
    s_lshl_b32 s33, s29, 12
    s_lshl_b32 s34, s30, 11
    s_add_u32 s33, s33, s34
    s_add_u32 s33, s33, 61440
    v_add_u32 v248, s33, v1
    v_bfe_u32 v4, v0, 4, 2
    v_and_b32 v5, 1, v4
    v_lshlrev_b32 v5, 7, v5
    v_xor_b32 v5, v5, v1
    v_and_b32 v12, 15, v0
    v_lshlrev_b32 v3, 4, v12
    s_add_u32 s34, s37, 8192
    v_add_u32 v249, s34, v3
    v_add_u32 v244, s36, v1
    v_add_u32 v245, s37, v5
    v_and_b32 v3, 63, v0
    v_and_b32 v6, 3, v3
    v_lshrrev_b32 v7, 2, v3
    v_and_b32 v8, 1, v3
    v_lshlrev_b32 v8, 3, v8
    v_xor_b32 v7, v7, v8
    v_lshl_add_u32 v7, v6, 4, v7
    v_lshlrev_b32 v7, 4, v7
    s_add_u32 s36, s36, 24576
    v_add_u32 v246, s36, v7
    v_add_u32 v247, s37, v7
    s_lshl_b32 s49, s21, 2
    s_lshl_b32 s33, s30, 1
    s_add_u32 s49, s49, s33
    v_lshlrev_b32 v6, 2, v4
    v_mov_b32 v7, 0xf149f2ca
    v_add_u32 v8, 0, v6
    v_cmp_gt_u32 vcc, v8, v12
    s_nop 1
    v_cndmask_b32 v232, v7, 0, vcc
    v_cndmask_b32 v236, 0, v7, vcc
    v_add_u32 v8, 1, v6
    v_cmp_gt_u32 vcc, v8, v12
    s_nop 1
    v_cndmask_b32 v233, v7, 0, vcc
    v_cndmask_b32 v237, 0, v7, vcc
    v_add_u32 v8, 2, v6
    v_cmp_gt_u32 vcc, v8, v12
    s_nop 1
    v_cndmask_b32 v234, v7, 0, vcc
    v_cndmask_b32 v238, 0, v7, vcc
    v_add_u32 v8, 3, v6
    v_cmp_gt_u32 vcc, v8, v12
    s_nop 1
    v_cndmask_b32 v235, v7, 0, vcc
    v_cndmask_b32 v239, 0, v7, vcc
    v_cmp_eq_u32 s[38:39], 1, v4
    v_lshlrev_b32 v243, 2, v12
    v_add_u32 v243, 128, v243
    s_cmp_eq_u32 s29, 1
    s_cselect_b64 s[40:41], -1, 0
    s_andn2_b64 s[42:43], s[38:39], s[40:41]
    s_and_b64 s[44:45], s[38:39], s[40:41]
    s_lshl_b32 s36, s30, 12
    s_add_u32 s36, s36, 102400
    s_lshl_b32 s37, s29, 3
    s_add_u32 s37, s37, s36
    v_add_u32 v251, s37, v1
    s_lshl_b32 s37, s29, 11
    s_add_u32 s37, s37, s36
    v_add_u32 v230, s37, v1
    s_lshl_b32 s47, s49, 1
    s_mul_i32 s46, s47, 18432
    s_add_u32 s46, s46, 4718592
    s_mul_i32 s37, s29, 36864
    s_add_u32 s47, s46, s37
    s_lshl_b32 s37, s22, 10
    s_add_u32 s47, s47, s37
    s_add_u32 s48, s47, 18432
    s_lshl_b32 s37, s22, 7
    s_add_u32 s46, s46, s37
    s_add_u32 s46, s46, 16384
    s_cmp_eq_u32 s29, 0
    s_cselect_b32 s46, s46, 1073741824
    v_mul_u32_u24 v250, 18432, v4
    v_lshl_add_u32 v250, v12, 3, v250
    s_lshl_b32 s36, s30, 9
    s_add_u32 s36, s36, 110592
    v_lshrrev_b32 v231, 1, v1
    v_add_u32 v231, s36, v231
    s_lshl_b32 s37, s29, 2
    v_add_u32 v240, s37, v231
    v_mov_b32 v241, 0x30800000
    v_mov_b32 v242, 0x4e800000
    s_mov_b64 s[64:65], 0
    s_lshr_b32 s58, s17, 2
    s_mul_i32 s58, s58, 92160
    s_add_u32 s58, s58, 35389440
    s_lshl_b32 s59, s20, 12
    s_add_u32 s58, s58, s59
    s_lshl_b32 s39, s21, 7
    s_lshl_b32 s27, s22, 3
    s_add_u32 s39, s39, s27
    s_add_u32 s39, s39, 63875072
    s_cmp_lg_u32 s20, 0
    s_cbranch_scc1 L_pollx_w0
    s_branch L_look_a
L_poll_a:
    buffer_load_dwordx2 v[254:255], v2, s[8:11], s56 offen sc1
L_look_a:
    s_sub_u32 s57, s57, 1
    s_waitcnt vmcnt(0)
    v_cmp_eq_u64 vcc, s[100:101], v[254:255]
    s_cmp_eq_u32 s57, 0
    s_cbranch_scc1 L_pollx_a
    s_cmp_eq_u64 vcc, -1
    s_cbranch_scc0 L_poll_a
L_pollx_a:
L_pollx_w0:
    s_barrier
    buffer_load_dwordx4 a[0:3], v1, s[8:11], s23 offen offset:0 sc1
    buffer_load_dwordx4 a[4:7], v1, s[8:11], s24 offen offset:0 sc1
    buffer_load_dwordx4 a[8:11], v1, s[8:11], s23 offen offset:1024 sc1
    buffer_load_dwordx4 a[12:15], v1, s[8:11], s24 offen offset:1024 sc1
    buffer_load_dwordx4 a[16:19], v1, s[8:11], s23 offen offset:2048 sc1
    buffer_load_dwordx4 a[20:23], v1, s[8:11], s24 offen offset:2048 sc1
    buffer_load_dwordx4 a[24:27], v1, s[8:11], s23 offen offset:3072 sc1
    s_add_u32 s23, s23, 4096
    buffer_load_dwordx4 a[28:31], v1, s[8:11], s24 offen offset:3072 sc1
    s_add_u32 s24, s24, 4096
    buffer_load_dwordx4 a[32:35], v1, s[8:11], s23 offen offset:0 sc1
    buffer_load_dwordx4 a[36:39], v1, s[8:11], s24 offen offset:0 sc1
    s_mul_i32 s30, s22, 327680
    s_lshl_b32 s27, s26, 10
    s_add_u32 s30, s30, s27
    s_add_u32 s30, s30, s53
    s_lshl_b32 s56, s22, 7
    s_lshl_b32 s27, s21, 3
    s_add_u32 s56, s56, s27
    s_add_u32 s56, s56, 63866880
    s_add_u32 s56, s56, s51
    s_cmp_eq_u32 s20, 0
    s_cselect_b32 s56, s56, 1073741824
    s_mov_b32 s32, 0x3eae1a93
    s_mov_b32 s33, s32
    v_cmp_eq_u32 vcc, 0, v4
    v_cmp_eq_u32 s[34:35], 3, v4
    v_mov_b32 v8, s32
    v_mov_b32 v10, 0x3f803f80
    v_cndmask_b32 v8, 1.0, v8, vcc
    v_mov_b32 v9, v8
    s_lshl_b32 s27, s20, 10
    s_add_u32 s28, s27, 8192
    v_add_u32 v6, s28, v1
    v_add_u32 v7, s28, v5
    s_add_u32 s27, s27, 61440
    v_add_u32 v11, s27, v1
    s_lshl_b32 s36, s20, 1
    s_lshl_b32 s37, s21, 2
    s_add_u32 s37, s37, s36
    s_sub_i32 s37, s37, 8
    s_lshl_b32 s25, s37, 10
    s_mul_i32 s27, s22, 327680
    s_add_u32 s25, s25, s27
    s_add_u32 s25, s25, s53
    s_cmp_lt_i32 s37, 0
    s_cselect_b32 s25, 1073741824, s25
    s_lshl_b32 s36, s36, 10
    s_ashr_i32 s37, s37, 2
    s_cmp_lt_i32 s37, 0
    s_cselect_b32 s37, s21, s37
    s_lshl_b32 s37, s37, 3
    s_lshl_b32 s27, s22, 7
    s_add_u32 s37, s37, s27
    s_add_u32 s37, s37, 63866880
    s_add_u32 s38, s37, s51
    v_mov_b32 v12, 0
    s_waitcnt vmcnt(10)
    s_barrier
    v_mov_b32 v3, v1
    v_add_u32 v2, 0x10000, v1
    ds_read_b128 v[72:75], v3 offset:0
    ds_read_b128 v[76:79], v3 offset:1024
    ds_read_b128 v[80:83], v3 offset:2048
    ds_read_b128 v[84:87], v3 offset:3072
    ds_read_b128 v[88:91], v3 offset:4096
    ds_read_b128 v[92:95], v3 offset:5120
    ds_read_b128 v[96:99], v3 offset:6144
    s_waitcnt vmcnt(8)
    s_waitcnt lgkmcnt(6)
    v_mfma_f32_16x16x32_bf16 v[16:19], v[72:75], a[0:3], 0
    ds_read_b128 v[100:103], v3 offset:7168
    v_mfma_f32_16x16x32_bf16 v[20:23], v[72:75], a[4:7], 0
    buffer_load_dwordx4 a[40:43], v1, s[8:11], s23 offen offset:1024 sc1
    s_waitcnt lgkmcnt(6)
    v_mfma_f32_16x16x32_bf16 v[24:27], v[76:79], a[0:3], 0
    ds_read_b128 v[104:107], v3 offset:8192
    v_mfma_f32_16x16x32_bf16 v[28:31], v[76:79], a[4:7], 0
    buffer_load_dwordx4 a[44:47], v1, s[8:11], s24 offen offset:1024 sc1
    s_waitcnt lgkmcnt(6)
    v_mfma_f32_16x16x32_bf16 v[32:35], v[80:83], a[0:3], 0
    ds_read_b128 v[108:111], v3 offset:9216
    v_mfma_f32_16x16x32_bf16 v[36:39], v[80:83], a[4:7], 0
    buffer_load_dwordx4 a[48:51], v1, s[8:11], s23 offen offset:2048 sc1
    s_waitcnt lgkmcnt(6)
    v_mfma_f32_16x16x32_bf16 v[40:43], v[84:87], a[0:3], 0
    ds_read_b128 v[112:115], v3 offset:10240
    v_mfma_f32_16x16x32_bf16 v[44:47], v[84:87], a[4:7], 0
    buffer_load_dwordx4 a[52:55], v1, s[8:11], s24 offen offset:2048 sc1
    s_waitcnt lgkmcnt(6)
    v_mfma_f32_16x16x32_bf16 v[48:51], v[88:91], a[0:3], 0
    ds_read_b128 v[116:119], v3 offset:11264
    v_mfma_f32_16x16x32_bf16 v[52:55], v[88:91], a[4:7], 0
    s_waitcnt vmcnt(10)
    s_waitcnt lgkmcnt(6)
    v_mfma_f32_16x16x32_bf16 v[16:19], v[92:95], a[8:11], v[16:19]
    ds_read_b128 v[120:123], v3 offset:12288
    v_mfma_f32_16x16x32_bf16 v[20:23], v[92:95], a[12:15], v[20:23]
    buffer_load_dwordx4 a[56:59], v1, s[8:11], s23 offen offset:3072 sc1
    s_add_u32 s23, s23, 4096
    s_waitcnt lgkmcnt(6)
    v_mfma_f32_16x16x32_bf16 v[24:27], v[96:99], a[8:11], v[24:27]
    ds_read_b128 v[124:127], v3 offset:13312
    v_mfma_f32_16x16x32_bf16 v[28:31], v[96:99], a[12:15], v[28:31]
    buffer_load_dwordx4 a[60:63], v1, s[8:11], s24 offen offset:3072 sc1
    s_add_u32 s24, s24, 4096
    s_waitcnt lgkmcnt(6)
    v_mfma_f32_16x16x32_bf16 v[32:35], v[100:103], a[8:11], v[32:35]
    ds_read_b128 v[72:75], v3 offset:14336
    v_mfma_f32_16x16x32_bf16 v[36:39], v[100:103], a[12:15], v[36:39]
    s_waitcnt lgkmcnt(6)
    v_mfma_f32_16x16x32_bf16 v[40:43], v[104:107], a[8:11], v[40:43]
    ds_read_b128 v[76:79], v3 offset:15360
    v_mfma_f32_16x16x32_bf16 v[44:47], v[104:107], a[12:15], v[44:47]
    s_waitcnt lgkmcnt(6)
    v_mfma_f32_16x16x32_bf16 v[48:51], v[108:111], a[8:11], v[48:51]
    ds_read_b128 v[80:83], v3 offset:16384
    v_mfma_f32_16x16x32_bf16 v[52:55], v[108:111], a[12:15], v[52:55]
    s_waitcnt vmcnt(10)
    s_waitcnt lgkmcnt(6)
    v_mfma_f32_16x16x32_bf16 v[16:19], v[112:115], a[16:19], v[16:19]
    ds_read_b128 v[84:87], v3 offset:17408
    v_mfma_f32_16x16x32_bf16 v[20:23], v[112:115], a[20:23], v[20:23]
    buffer_load_dwordx4 a[64:67], v1, s[8:11], s23 offen offset:0 sc1
    s_waitcnt lgkmcnt(6)
    v_mfma_f32_16x16x32_bf16 v[24:27], v[116:119], a[16:19], v[24:27]
    ds_read_b128 v[88:91], v3 offset:18432
    v_mfma_f32_16x16x32_bf16 v[28:31], v[116:119], a[20:23], v[28:31]
    buffer_load_dwordx4 a[68:71], v1, s[8:11], s24 offen offset:0 sc1
    s_waitcnt lgkmcnt(6)
    v_mfma_f32_16x16x32_bf16 v[32:35], v[120:123], a[16:19], v[32:35]
    ds_read_b128 v[92:95], v3 offset:19456
    v_mfma_f32_16x16x32_bf16 v[36:39], v[120:123], a[20:23], v[36:39]
    s_waitcnt lgkmcnt(6)
    v_mfma_f32_16x16x32_bf16 v[40:43], v[124:127], a[16:19], v[40:43]
    ds_read_b128 v[96:99], v3 offset:20480
    v_mfma_f32_16x16x32_bf16 v[44:47], v[124:127], a[20:23], v[44:47]
    s_waitcnt lgkmcnt(6)
    v_mfma_f32_16x16x32_bf16 v[48:51], v[72:75], a[16:19], v[48:51]
    ds_read_b128 v[100:103], v3 offset:21504
    v_mfma_f32_16x16x32_bf16 v[52:55], v[72:75], a[20:23], v[52:55]
    s_waitcnt vmcnt(10)
    s_waitcnt lgkmcnt(6)
    v_mfma_f32_16x16x32_bf16 v[16:19], v[76:79], a[24:27], v[16:19]
    ds_read_b128 v[104:107], v3 offset:22528
    v_mfma_f32_16x16x32_bf16 v[20:23], v[76:79], a[28:31], v[20:23]
    buffer_load_dwordx4 a[72:75], v1, s[8:11], s23 offen offset:1024 sc1
    s_waitcnt lgkmcnt(6)
    v_mfma_f32_16x16x32_bf16 v[24:27], v[80:83], a[24:27], v[24:27]
    ds_read_b128 v[108:111], v3 offset:23552
    v_mfma_f32_16x16x32_bf16 v[28:31], v[80:83], a[28:31], v[28:31]
    buffer_load_dwordx4 a[76:79], v1, s[8:11], s24 offen offset:1024 sc1
    s_waitcnt lgkmcnt(6)
    v_mfma_f32_16x16x32_bf16 v[32:35], v[84:87], a[24:27], v[32:35]
    ds_read_b128 v[112:115], v3 offset:24576
    v_mfma_f32_16x16x32_bf16 v[36:39], v[84:87], a[28:31], v[36:39]
    s_waitcnt lgkmcnt(6)
    v_mfma_f32_16x16x32_bf16 v[40:43], v[88:91], a[24:27], v[40:43]
    ds_read_b128 v[116:119], v3 offset:25600
    v_mfma_f32_16x16x32_bf16 v[44:47], v[88:91], a[28:31], v[44:47]
    s_waitcnt lgkmcnt(6)
    v_mfma_f32_16x16x32_bf16 v[48:51], v[92:95], a[24:27], v[48:51]
    ds_read_b128 v[120:123], v3 offset:26624
    v_mfma_f32_16x16x32_bf16 v[52:55], v[92:95], a[28:31], v[52:55]
    s_waitcnt vmcnt(10)
    s_waitcnt lgkmcnt(6)
    v_mfma_f32_16x16x32_bf16 v[16:19], v[96:99], a[32:35], v[16:19]
    ds_read_b128 v[124:127], v3 offset:27648
    v_mfma_f32_16x16x32_bf16 v[20:23], v[96:99], a[36:39], v[20:23]
    buffer_load_dwordx4 a[80:83], v1, s[8:11], s23 offen offset:2048 sc1
    s_waitcnt lgkmcnt(6)
    v_mfma_f32_16x16x32_bf16 v[24:27], v[100:103], a[32:35], v[24:27]
    ds_read_b128 v[72:75], v3 offset:28672
    v_mfma_f32_16x16x32_bf16 v[28:31], v[100:103], a[36:39], v[28:31]
    buffer_load_dwordx4 a[84:87], v1, s[8:11], s24 offen offset:2048 sc1
    s_waitcnt lgkmcnt(6)
    v_mfma_f32_16x16x32_bf16 v[32:35], v[104:107], a[32:35], v[32:35]
    ds_read_b128 v[76:79], v3 offset:29696
    v_mfma_f32_16x16x32_bf16 v[36:39], v[104:107], a[36:39], v[36:39]
    s_waitcnt lgkmcnt(6)
    v_mfma_f32_16x16x32_bf16 v[40:43], v[108:111], a[32:35], v[40:43]
    ds_read_b128 v[80:83], v3 offset:30720
    v_mfma_f32_16x16x32_bf16 v[44:47], v[108:111], a[36:39], v[44:47]
    s_waitcnt lgkmcnt(6)
    v_mfma_f32_16x16x32_bf16 v[48:51], v[112:115], a[32:35], v[48:51]
    ds_read_b128 v[84:87], v3 offset:31744
    v_mfma_f32_16x16x32_bf16 v[52:55], v[112:115], a[36:39], v[52:55]
    s_waitcnt vmcnt(10)
    s_waitcnt lgkmcnt(6)
    v_mfma_f32_16x16x32_bf16 v[16:19], v[116:119], a[40:43], v[16:19]
    ds_read_b128 v[88:91], v3 offset:32768
    v_mfma_f32_16x16x32_bf16 v[20:23], v[116:119], a[44:47], v[20:23]
    buffer_load_dwordx4 a[88:91], v1, s[8:11], s23 offen offset:3072 sc1
    s_add_u32 s23, s23, 4096
    s_waitcnt lgkmcnt(6)
    v_mfma_f32_16x16x32_bf16 v[24:27], v[120:123], a[40:43], v[24:27]
    ds_read_b128 v[92:95], v3 offset:33792
    v_mfma_f32_16x16x32_bf16 v[28:31], v[120:123], a[44:47], v[28:31]
    buffer_load_dwordx4 a[92:95], v1, s[8:11], s24 offen offset:3072 sc1
    s_add_u32 s24, s24, 4096
    s_waitcnt lgkmcnt(6)
    v_mfma_f32_16x16x32_bf16 v[32:35], v[124:127], a[40:43], v[32:35]
    ds_read_b128 v[96:99], v3 offset:34816
    v_mfma_f32_16x16x32_bf16 v[36:39], v[124:127], a[44:47], v[36:39]
    s_waitcnt lgkmcnt(6)
    v_mfma_f32_16x16x32_bf16 v[40:43], v[72:75], a[40:43], v[40:43]
    ds_read_b128 v[100:103], v3 offset:35840
    v_mfma_f32_16x16x32_bf16 v[44:47], v[72:75], a[44:47], v[44:47]
    s_waitcnt lgkmcnt(6)
    v_mfma_f32_16x16x32_bf16 v[48:51], v[76:79], a[40:43], v[48:51]
    ds_read_b128 v[104:107], v3 offset:36864
    v_mfma_f32_16x16x32_bf16 v[52:55], v[76:79], a[44:47], v[52:55]
    s_waitcnt vmcnt(10)
    s_waitcnt lgkmcnt(6)
    v_mfma_f32_16x16x32_bf16 v[16:19], v[80:83], a[48:51], v[16:19]
    ds_read_b128 v[108:111], v3 offset:37888
    v_mfma_f32_16x16x32_bf16 v[20:23], v[80:83], a[52:55], v[20:23]
    buffer_load_dwordx4 a[96:99], v1, s[8:11], s23 offen offset:0 sc1
    s_waitcnt lgkmcnt(6)
    v_mfma_f32_16x16x32_bf16 v[24:27], v[84:87], a[48:51], v[24:27]
    ds_read_b128 v[112:115], v3 offset:38912
    v_mfma_f32_16x16x32_bf16 v[28:31], v[84:87], a[52:55], v[28:31]
    buffer_load_dwordx4 a[100:103], v1, s[8:11], s24 offen offset:0 sc1
    s_waitcnt lgkmcnt(6)
    v_mfma_f32_16x16x32_bf16 v[32:35], v[88:91], a[48:51], v[32:35]
    ds_read_b128 v[116:119], v3 offset:39936
    v_mfma_f32_16x16x32_bf16 v[36:39], v[88:91], a[52:55], v[36:39]
    s_waitcnt lgkmcnt(6)
    v_mfma_f32_16x16x32_bf16 v[40:43], v[92:95], a[48:51], v[40:43]
    ds_read_b128 v[120:123], v3 offset:40960
    v_mfma_f32_16x16x32_bf16 v[44:47], v[92:95], a[52:55], v[44:47]
    s_waitcnt lgkmcnt(6)
    v_mfma_f32_16x16x32_bf16 v[48:51], v[96:99], a[48:51], v[48:51]
    ds_read_b128 v[124:127], v3 offset:41984
    v_mfma_f32_16x16x32_bf16 v[52:55], v[96:99], a[52:55], v[52:55]
    s_waitcnt vmcnt(10)
    s_waitcnt lgkmcnt(6)
    v_mfma_f32_16x16x32_bf16 v[16:19], v[100:103], a[56:59], v[16:19]
    ds_read_b128 v[72:75], v3 offset:43008
    v_mfma_f32_16x16x32_bf16 v[20:23], v[100:103], a[60:63], v[20:23]
    buffer_load_dwordx4 a[104:107], v1, s[8:11], s23 offen offset:1024 sc1
    s_waitcnt lgkmcnt(6)
    v_mfma_f32_16x16x32_bf16 v[24:27], v[104:107], a[56:59], v[24:27]
    ds_read_b128 v[76:79], v3 offset:44032
    v_mfma_f32_16x16x32_bf16 v[28:31], v[104:107], a[60:63], v[28:31]
    buffer_load_dwordx4 a[108:111], v1, s[8:11], s24 offen offset:1024 sc1
    s_waitcnt lgkmcnt(6)
    v_mfma_f32_16x16x32_bf16 v[32:35], v[108:111], a[56:59], v[32:35]
    ds_read_b128 v[80:83], v3 offset:45056
    v_mfma_f32_16x16x32_bf16 v[36:39], v[108:111], a[60:63], v[36:39]
    s_waitcnt lgkmcnt(6)
    v_mfma_f32_16x16x32_bf16 v[40:43], v[112:115], a[56:59], v[40:43]
    ds_read_b128 v[84:87], v3 offset:46080
    v_mfma_f32_16x16x32_bf16 v[44:47], v[112:115], a[60:63], v[44:47]
    s_waitcnt lgkmcnt(6)
    v_mfma_f32_16x16x32_bf16 v[48:51], v[116:119], a[56:59], v[48:51]
    ds_read_b128 v[88:91], v3 offset:47104
    v_mfma_f32_16x16x32_bf16 v[52:55], v[116:119], a[60:63], v[52:55]
    s_waitcnt vmcnt(10)
    s_waitcnt lgkmcnt(6)
    v_mfma_f32_16x16x32_bf16 v[16:19], v[120:123], a[64:67], v[16:19]
    ds_read_b128 v[92:95], v3 offset:48128
    v_mfma_f32_16x16x32_bf16 v[20:23], v[120:123], a[68:71], v[20:23]
    buffer_load_dwordx4 a[112:115], v1, s[8:11], s23 offen offset:2048 sc1
    s_waitcnt lgkmcnt(6)
    v_mfma_f32_16x16x32_bf16 v[24:27], v[124:127], a[64:67], v[24:27]
    ds_read_b128 v[96:99], v3 offset:49152
    v_mfma_f32_16x16x32_bf16 v[28:31], v[124:127], a[68:71], v[28:31]
    buffer_load_dwordx4 a[116:119], v1, s[8:11], s24 offen offset:2048 sc1
    s_waitcnt lgkmcnt(6)
    v_mfma_f32_16x16x32_bf16 v[32:35], v[72:75], a[64:67], v[32:35]
    ds_read_b128 v[100:103], v3 offset:50176
    v_mfma_f32_16x16x32_bf16 v[36:39], v[72:75], a[68:71], v[36:39]
    s_waitcnt lgkmcnt(6)
    v_mfma_f32_16x16x32_bf16 v[40:43], v[76:79], a[64:67], v[40:43]
    ds_read_b128 v[104:107], v3 offset:51200
    v_mfma_f32_16x16x32_bf16 v[44:47], v[76:79], a[68:71], v[44:47]
    s_waitcnt lgkmcnt(6)
    v_mfma_f32_16x16x32_bf16 v[48:51], v[80:83], a[64:67], v[48:51]
    ds_read_b128 v[108:111], v3 offset:52224
    v_mfma_f32_16x16x32_bf16 v[52:55], v[80:83], a[68:71], v[52:55]
    s_waitcnt vmcnt(10)
    s_waitcnt lgkmcnt(6)
    v_mfma_f32_16x16x32_bf16 v[16:19], v[84:87], a[72:75], v[16:19]
    ds_read_b128 v[112:115], v3 offset:53248
    v_mfma_f32_16x16x32_bf16 v[20:23], v[84:87], a[76:79], v[20:23]
    buffer_load_dwordx4 a[120:123], v1, s[8:11], s23 offen offset:3072 sc1
    s_add_u32 s23, s23, 4096
    s_waitcnt lgkmcnt(6)
    v_mfma_f32_16x16x32_bf16 v[24:27], v[88:91], a[72:75], v[24:27]
    ds_read_b128 v[116:119], v3 offset:54272
    v_mfma_f32_16x16x32_bf16 v[28:31], v[88:91], a[76:79], v[28:31]
    buffer_load_dwordx4 a[124:127], v1, s[8:11], s24 offen offset:3072 sc1
    s_add_u32 s24, s24, 4096
    s_waitcnt lgkmcnt(6)
    v_mfma_f32_16x16x32_bf16 v[32:35], v[92:95], a[72:75], v[32:35]
    ds_read_b128 v[120:123], v3 offset:55296
    v_mfma_f32_16x16x32_bf16 v[36:39], v[92:95], a[76:79], v[36:39]
    s_waitcnt lgkmcnt(6)
    v_mfma_f32_16x16x32_bf16 v[40:43], v[96:99], a[72:75], v[40:43]
    ds_read_b128 v[124:127], v3 offset:56320
    v_mfma_f32_16x16x32_bf16 v[44:47], v[96:99], a[76:79], v[44:47]
    s_waitcnt lgkmcnt(6)
    v_mfma_f32_16x16x32_bf16 v[48:51], v[100:103], a[72:75], v[48:51]
    ds_read_b128 v[72:75], v3 offset:57344
    v_mfma_f32_16x16x32_bf16 v[52:55], v[100:103], a[76:79], v[52:55]
    s_waitcnt vmcnt(10)
    s_waitcnt lgkmcnt(6)
    v_mfma_f32_16x16x32_bf16 v[16:19], v[104:107], a[80:83], v[16:19]
    ds_read_b128 v[76:79], v3 offset:58368
    v_mfma_f32_16x16x32_bf16 v[20:23], v[104:107], a[84:87], v[20:23]
    buffer_load_dwordx4 a[128:131], v1, s[8:11], s23 offen offset:0 sc1
    s_waitcnt lgkmcnt(6)
    v_mfma_f32_16x16x32_bf16 v[24:27], v[108:111], a[80:83], v[24:27]
    ds_read_b128 v[80:83], v3 offset:59392
    v_mfma_f32_16x16x32_bf16 v[28:31], v[108:111], a[84:87], v[28:31]
    buffer_load_dwordx4 a[132:135], v1, s[8:11], s24 offen offset:0 sc1
    s_waitcnt lgkmcnt(6)
    v_mfma_f32_16x16x32_bf16 v[32:35], v[112:115], a[80:83], v[32:35]
    ds_read_b128 v[84:87], v3 offset:60416
    v_mfma_f32_16x16x32_bf16 v[36:39], v[112:115], a[84:87], v[36:39]
    s_waitcnt lgkmcnt(6)
    v_mfma_f32_16x16x32_bf16 v[40:43], v[116:119], a[80:83], v[40:43]
    ds_read_b128 v[88:91], v3 offset:61440
    v_mfma_f32_16x16x32_bf16 v[44:47], v[116:119], a[84:87], v[44:47]
    s_waitcnt lgkmcnt(6)
    v_mfma_f32_16x16x32_bf16 v[48:51], v[120:123], a[80:83], v[48:51]
    ds_read_b128 v[92:95], v2 offset:1024
    v_mfma_f32_16x16x32_bf16 v[52:55], v[120:123], a[84:87], v[52:55]
    s_waitcnt vmcnt(10)
    s_waitcnt lgkmcnt(6)
    v_mfma_f32_16x16x32_bf16 v[16:19], v[124:127], a[88:91], v[16:19]
    ds_read_b128 v[96:99], v2 offset:6144
    v_mfma_f32_16x16x32_bf16 v[20:23], v[124:127], a[92:95], v[20:23]
    buffer_load_dwordx4 a[136:139], v1, s[8:11], s23 offen offset:1024 sc1
    s_waitcnt lgkmcnt(6)
    v_mfma_f32_16x16x32_bf16 v[24:27], v[72:75], a[88:91], v[24:27]
    ds_read_b128 v[100:103], v2 offset:11264
    v_mfma_f32_16x16x32_bf16 v[28:31], v[72:75], a[92:95], v[28:31]
    buffer_load_dwordx4 a[140:143], v1, s[8:11], s24 offen offset:1024 sc1
    s_waitcnt lgkmcnt(6)
    v_mfma_f32_16x16x32_bf16 v[32:35], v[76:79], a[88:91], v[32:35]
    ds_read_b128 v[104:107], v2 offset:16384
    v_mfma_f32_16x16x32_bf16 v[36:39], v[76:79], a[92:95], v[36:39]
    s_waitcnt lgkmcnt(6)
    v_mfma_f32_16x16x32_bf16 v[40:43], v[80:83], a[88:91], v[40:43]
    ds_read_b128 v[108:111], v2 offset:21504
    v_mfma_f32_16x16x32_bf16 v[44:47], v[80:83], a[92:95], v[44:47]
    s_waitcnt lgkmcnt(6)
    v_mfma_f32_16x16x32_bf16 v[48:51], v[84:87], a[88:91], v[48:51]
    ds_read_b128 v[112:115], v3 offset:62464
    v_mfma_f32_16x16x32_bf16 v[52:55], v[84:87], a[92:95], v[52:55]
    s_waitcnt vmcnt(10)
    s_waitcnt lgkmcnt(6)
    v_mfma_f32_16x16x32_bf16 v[16:19], v[88:91], a[96:99], v[16:19]
    ds_read_b128 v[116:119], v2 offset:2048
    v_mfma_f32_16x16x32_bf16 v[20:23], v[88:91], a[100:103], v[20:23]
    s_waitcnt vmcnt(8)
    s_waitcnt lgkmcnt(6)
    v_mfma_f32_16x16x32_bf16 v[16:19], v[92:95], a[104:107], v[16:19]
    ds_read_b128 v[120:123], v2 offset:7168
    v_mfma_f32_16x16x32_bf16 v[20:23], v[92:95], a[108:111], v[20:23]
    s_waitcnt vmcnt(6)
    s_waitcnt lgkmcnt(6)
    v_mfma_f32_16x16x32_bf16 v[16:19], v[96:99], a[112:115], v[16:19]
    ds_read_b128 v[124:127], v2 offset:12288
    v_mfma_f32_16x16x32_bf16 v[20:23], v[96:99], a[116:119], v[20:23]
    s_waitcnt vmcnt(4)
    s_waitcnt lgkmcnt(6)
    v_mfma_f32_16x16x32_bf16 v[16:19], v[100:103], a[120:123], v[16:19]
    ds_read_b128 v[72:75], v2 offset:17408
    v_mfma_f32_16x16x32_bf16 v[20:23], v[100:103], a[124:127], v[20:23]
    s_waitcnt vmcnt(2)
    s_waitcnt lgkmcnt(6)
    v_mfma_f32_16x16x32_bf16 v[16:19], v[104:107], a[128:131], v[16:19]
    ds_read_b128 v[76:79], v2 offset:22528
    v_mfma_f32_16x16x32_bf16 v[20:23], v[104:107], a[132:135], v[20:23]
    s_waitcnt vmcnt(0)
    s_waitcnt lgkmcnt(6)
    v_mfma_f32_16x16x32_bf16 v[16:19], v[108:111], a[136:139], v[16:19]
    ds_read_b128 v[80:83], v3 offset:63488
    v_mfma_f32_16x16x32_bf16 v[20:23], v[108:111], a[140:143], v[20:23]
    s_waitcnt lgkmcnt(6)
    v_mfma_f32_16x16x32_bf16 v[24:27], v[112:115], a[96:99], v[24:27]
    ds_read_b128 v[84:87], v2 offset:3072
    v_mfma_f32_16x16x32_bf16 v[28:31], v[112:115], a[100:103], v[28:31]
    s_waitcnt lgkmcnt(6)
    v_mfma_f32_16x16x32_bf16 v[24:27], v[116:119], a[104:107], v[24:27]
    ds_read_b128 v[88:91], v2 offset:8192
    v_mfma_f32_16x16x32_bf16 v[28:31], v[116:119], a[108:111], v[28:31]
    s_waitcnt lgkmcnt(6)
    v_mfma_f32_16x16x32_bf16 v[24:27], v[120:123], a[112:115], v[24:27]
    ds_read_b128 v[92:95], v2 offset:13312
    v_cvt_pk_bf16_f32 v16, v16, v17
    v_cvt_pk_bf16_f32 v17, v18, v19
    v_mfma_f32_16x16x32_bf16 v[28:31], v[120:123], a[116:119], v[28:31]
    v_cvt_pk_bf16_f32 v18, v20, v21
    v_cvt_pk_bf16_f32 v19, v22, v23
    s_waitcnt lgkmcnt(6)
    v_mfma_f32_16x16x32_bf16 v[24:27], v[124:127], a[120:123], v[24:27]
    ds_read_b128 v[96:99], v2 offset:18432
    buffer_store_dwordx4 v[16:19], v1, s[8:11], s30 offen sc1
    v_mfma_f32_16x16x32_bf16 v[28:31], v[124:127], a[124:127], v[28:31]
    s_add_u32 s30, s30, 65536
    s_waitcnt lgkmcnt(6)
    v_mfma_f32_16x16x32_bf16 v[24:27], v[72:75], a[128:131], v[24:27]
    ds_read_b128 v[100:103], v2 offset:23552
    v_mfma_f32_16x16x32_bf16 v[28:31], v[72:75], a[132:135], v[28:31]
    s_waitcnt lgkmcnt(6)
    v_mfma_f32_16x16x32_bf16 v[24:27], v[76:79], a[136:139], v[24:27]
    ds_read_b128 v[104:107], v3 offset:64512
    v_mfma_f32_16x16x32_bf16 v[28:31], v[76:79], a[140:143], v[28:31]
    s_waitcnt lgkmcnt(6)
    v_mfma_f32_16x16x32_bf16 v[32:35], v[80:83], a[96:99], v[32:35]
    ds_read_b128 v[108:111], v2 offset:4096
    v_mfma_f32_16x16x32_bf16 v[36:39], v[80:83], a[100:103], v[36:39]
    s_waitcnt lgkmcnt(6)
    v_mfma_f32_16x16x32_bf16 v[32:35], v[84:87], a[104:107], v[32:35]
    ds_read_b128 v[112:115], v2 offset:9216
    v_mfma_f32_16x16x32_bf16 v[36:39], v[84:87], a[108:111], v[36:39]
    s_waitcnt lgkmcnt(6)
    v_mfma_f32_16x16x32_bf16 v[32:35], v[88:91], a[112:115], v[32:35]
    ds_read_b128 v[116:119], v2 offset:14336
    v_cvt_pk_bf16_f32 v24, v24, v25
    v_cvt_pk_bf16_f32 v25, v26, v27
    v_mfma_f32_16x16x32_bf16 v[36:39], v[88:91], a[116:119], v[36:39]
    v_cvt_pk_bf16_f32 v26, v28, v29
    v_cvt_pk_bf16_f32 v27, v30, v31
    s_waitcnt lgkmcnt(6)
    v_mfma_f32_16x16x32_bf16 v[32:35], v[92:95], a[120:123], v[32:35]
    ds_read_b128 v[120:123], v2 offset:19456
    buffer_store_dwordx4 v[24:27], v1, s[8:11], s30 offen sc1
    v_mfma_f32_16x16x32_bf16 v[36:39], v[92:95], a[124:127], v[36:39]
    s_add_u32 s30, s30, 65536
    s_waitcnt lgkmcnt(6)
    v_mfma_f32_16x16x32_bf16 v[32:35], v[96:99], a[128:131], v[32:35]
    ds_read_b128 v[124:127], v2 offset:24576
    v_mfma_f32_16x16x32_bf16 v[36:39], v[96:99], a[132:135], v[36:39]
    s_waitcnt lgkmcnt(6)
    v_mfma_f32_16x16x32_bf16 v[32:35], v[100:103], a[136:139], v[32:35]
    ds_read_b128 v[72:75], v2 offset:0
    v_mfma_f32_16x16x32_bf16 v[36:39], v[100:103], a[140:143], v[36:39]
    s_waitcnt lgkmcnt(6)
    v_mfma_f32_16x16x32_bf16 v[40:43], v[104:107], a[96:99], v[40:43]
    ds_read_b128 v[76:79], v2 offset:5120
    v_mfma_f32_16x16x32_bf16 v[44:47], v[104:107], a[100:103], v[44:47]
    s_waitcnt lgkmcnt(6)
    v_mfma_f32_16x16x32_bf16 v[40:43], v[108:111], a[104:107], v[40:43]
    ds_read_b128 v[80:83], v2 offset:10240
    v_mfma_f32_16x16x32_bf16 v[44:47], v[108:111], a[108:111], v[44:47]
    s_waitcnt lgkmcnt(6)
    v_mfma_f32_16x16x32_bf16 v[40:43], v[112:115], a[112:115], v[40:43]
    ds_read_b128 v[84:87], v2 offset:15360
    v_cvt_pk_bf16_f32 v32, v32, v33
    v_cvt_pk_bf16_f32 v33, v34, v35
    v_mfma_f32_16x16x32_bf16 v[44:47], v[112:115], a[116:119], v[44:47]
    v_cvt_pk_bf16_f32 v34, v36, v37
    v_cvt_pk_bf16_f32 v35, v38, v39
    s_waitcnt lgkmcnt(6)
    v_mfma_f32_16x16x32_bf16 v[40:43], v[116:119], a[120:123], v[40:43]
    ds_read_b128 v[88:91], v2 offset:20480
    buffer_store_dwordx4 v[32:35], v1, s[8:11], s30 offen sc1
    v_mfma_f32_16x16x32_bf16 v[44:47], v[116:119], a[124:127], v[44:47]
    s_add_u32 s30, s30, 65536
    s_waitcnt lgkmcnt(6)
    v_mfma_f32_16x16x32_bf16 v[40:43], v[120:123], a[128:131], v[40:43]
    ds_read_b128 v[92:95], v2 offset:25600
    v_mfma_f32_16x16x32_bf16 v[44:47], v[120:123], a[132:135], v[44:47]
    s_waitcnt lgkmcnt(6)
    v_mfma_f32_16x16x32_bf16 v[40:43], v[124:127], a[136:139], v[40:43]
    ds_read_b128 v[96:99], v2 offset:26624
    v_mfma_f32_16x16x32_bf16 v[44:47], v[124:127], a[140:143], v[44:47]
    s_waitcnt lgkmcnt(6)
    v_mfma_f32_16x16x32_bf16 v[48:51], v[72:75], a[96:99], v[48:51]
    ds_read_b128 v[100:103], v2 offset:27648
    v_mfma_f32_16x16x32_bf16 v[52:55], v[72:75], a[100:103], v[52:55]
    s_waitcnt lgkmcnt(6)
    v_mfma_f32_16x16x32_bf16 v[48:51], v[76:79], a[104:107], v[48:51]
    ds_read_b128 v[104:107], v2 offset:28672
    v_mfma_f32_16x16x32_bf16 v[52:55], v[76:79], a[108:111], v[52:55]
    s_waitcnt lgkmcnt(6)
    v_mfma_f32_16x16x32_bf16 v[48:51], v[80:83], a[112:115], v[48:51]
    ds_read_b128 v[108:111], v2 offset:29696
    v_cvt_pk_bf16_f32 v40, v40, v41
    v_cvt_pk_bf16_f32 v41, v42, v43
    v_mfma_f32_16x16x32_bf16 v[52:55], v[80:83], a[116:119], v[52:55]
    v_cvt_pk_bf16_f32 v42, v44, v45
    v_cvt_pk_bf16_f32 v43, v46, v47
    s_waitcnt lgkmcnt(6)
    v_mfma_f32_16x16x32_bf16 v[48:51], v[84:87], a[120:123], v[48:51]
    ds_read_b128 v[112:115], v2 offset:30720
    buffer_store_dwordx4 v[40:43], v1, s[8:11], s30 offen sc1
    v_mfma_f32_16x16x32_bf16 v[52:55], v[84:87], a[124:127], v[52:55]
    s_add_u32 s30, s30, 65536
    s_waitcnt lgkmcnt(6)
    v_mfma_f32_16x16x32_bf16 v[48:51], v[88:91], a[128:131], v[48:51]
    ds_read_b128 v[116:119], v2 offset:31744
    v_mfma_f32_16x16x32_bf16 v[52:55], v[88:91], a[132:135], v[52:55]
    s_waitcnt lgkmcnt(6)
    v_mfma_f32_16x16x32_bf16 v[48:51], v[92:95], a[136:139], v[48:51]
    ds_read_b128 v[120:123], v2 offset:32768
    v_mfma_f32_16x16x32_bf16 v[52:55], v[92:95], a[140:143], v[52:55]
    s_waitcnt lgkmcnt(6)
    v_mfma_f32_16x16x32_bf16 v[56:59], v[96:99], a[0:3], 0
    ds_read_b128 v[124:127], v2 offset:33792
    v_mfma_f32_16x16x32_bf16 v[60:63], v[96:99], a[4:7], 0
    s_waitcnt lgkmcnt(6)
    v_mfma_f32_16x16x32_bf16 v[64:67], v[100:103], a[0:3], 0
    ds_read_b128 v[72:75], v2 offset:34816
    v_mfma_f32_16x16x32_bf16 v[68:71], v[100:103], a[4:7], 0
    s_waitcnt lgkmcnt(6)
    v_mfma_f32_16x16x32_bf16 v[56:59], v[104:107], a[8:11], v[56:59]
    ds_read_b128 v[76:79], v2 offset:35840
    v_pk_mul_f32 v[48:49], v[48:49], v[8:9]
    v_pk_mul_f32 v[50:51], v[50:51], v[8:9]
    v_mfma_f32_16x16x32_bf16 v[60:63], v[104:107], a[12:15], v[60:63]
    v_pk_mul_f32 v[52:53], v[52:53], v[8:9]
    v_pk_mul_f32 v[54:55], v[54:55], v[8:9]
    v_cvt_pk_bf16_f32 v48, v48, v49
    s_waitcnt lgkmcnt(6)
    v_mfma_f32_16x16x32_bf16 v[64:67], v[108:111], a[8:11], v[64:67]
    ds_read_b128 v[80:83], v2 offset:36864
    v_cvt_pk_bf16_f32 v49, v50, v51
    v_cvt_pk_bf16_f32 v50, v52, v53
    v_mfma_f32_16x16x32_bf16 v[68:71], v[108:111], a[12:15], v[68:71]
    v_cvt_pk_bf16_f32 v51, v54, v55
    v_cndmask_b32 v48, v48, v10, s[34:35]
    v_cndmask_b32 v49, v49, v10, s[34:35]
    s_waitcnt lgkmcnt(6)
    v_mfma_f32_16x16x32_bf16 v[56:59], v[112:115], a[16:19], v[56:59]
    ds_read_b128 v[84:87], v2 offset:37888
    v_cndmask_b32 v50, v50, v10, s[34:35]
    v_cndmask_b32 v51, v51, v10, s[34:35]
    v_mfma_f32_16x16x32_bf16 v[60:63], v[112:115], a[20:23], v[60:63]
    buffer_store_dwordx4 v[48:51], v1, s[8:11], s30 offen sc1
    s_waitcnt lgkmcnt(6)
    v_mfma_f32_16x16x32_bf16 v[64:67], v[116:119], a[16:19], v[64:67]
    ds_read_b128 v[88:91], v2 offset:38912
    v_mfma_f32_16x16x32_bf16 v[68:71], v[116:119], a[20:23], v[68:71]
    s_waitcnt lgkmcnt(6)
    v_mfma_f32_16x16x32_bf16 v[56:59], v[120:123], a[24:27], v[56:59]
    ds_read_b128 v[92:95], v2 offset:39936
    v_mfma_f32_16x16x32_bf16 v[60:63], v[120:123], a[28:31], v[60:63]
    s_waitcnt lgkmcnt(6)
    v_mfma_f32_16x16x32_bf16 v[64:67], v[124:127], a[24:27], v[64:67]
    ds_read_b128 v[96:99], v2 offset:40960
    v_mfma_f32_16x16x32_bf16 v[68:71], v[124:127], a[28:31], v[68:71]
    s_waitcnt lgkmcnt(6)
    v_mfma_f32_16x16x32_bf16 v[56:59], v[72:75], a[32:35], v[56:59]
    ds_read_b128 v[100:103], v2 offset:41984
    v_mfma_f32_16x16x32_bf16 v[60:63], v[72:75], a[36:39], v[60:63]
    s_waitcnt lgkmcnt(6)
    v_mfma_f32_16x16x32_bf16 v[64:67], v[76:79], a[32:35], v[64:67]
    ds_read_b128 v[104:107], v2 offset:43008
    v_mfma_f32_16x16x32_bf16 v[68:71], v[76:79], a[36:39], v[68:71]
    s_waitcnt lgkmcnt(6)
    v_mfma_f32_16x16x32_bf16 v[56:59], v[80:83], a[40:43], v[56:59]
    ds_read_b128 v[108:111], v2 offset:44032
    v_mfma_f32_16x16x32_bf16 v[60:63], v[80:83], a[44:47], v[60:63]
    s_waitcnt lgkmcnt(6)
    v_mfma_f32_16x16x32_bf16 v[64:67], v[84:87], a[40:43], v[64:67]
    ds_read_b128 v[112:115], v2 offset:45056
    v_mfma_f32_16x16x32_bf16 v[68:71], v[84:87], a[44:47], v[68:71]
    s_waitcnt lgkmcnt(6)
    v_mfma_f32_16x16x32_bf16 v[56:59], v[88:91], a[48:51], v[56:59]
    ds_read_b128 v[116:119], v2 offset:46080
    v_mfma_f32_16x16x32_bf16 v[60:63], v[88:91], a[52:55], v[60:63]
    s_waitcnt lgkmcnt(6)
    v_mfma_f32_16x16x32_bf16 v[64:67], v[92:95], a[48:51], v[64:67]
    ds_read_b128 v[120:123], v2 offset:47104
    v_mfma_f32_16x16x32_bf16 v[68:71], v[92:95], a[52:55], v[68:71]
    s_waitcnt lgkmcnt(6)
    v_mfma_f32_16x16x32_bf16 v[56:59], v[96:99], a[56:59], v[56:59]
    ds_read_b128 v[124:127], v2 offset:48128
    v_mfma_f32_16x16x32_bf16 v[60:63], v[96:99], a[60:63], v[60:63]
    s_waitcnt lgkmcnt(6)
    v_mfma_f32_16x16x32_bf16 v[64:67], v[100:103], a[56:59], v[64:67]
    ds_read_b128 v[72:75], v2 offset:49152
    v_mfma_f32_16x16x32_bf16 v[68:71], v[100:103], a[60:63], v[68:71]
    s_waitcnt vmcnt(0)
    s_barrier
    v_mov_b32 v254, s100
    v_mov_b32 v255, s101
    buffer_store_dwordx2 v[254:255], v13, s[8:11], s56 offen sc1
    s_waitcnt lgkmcnt(6)
    v_mfma_f32_16x16x32_bf16 v[56:59], v[104:107], a[64:67], v[56:59]
    ds_read_b128 v[76:79], v2 offset:50176
    ds_write_b128 v6, v[16:19] offset:0
    v_mfma_f32_16x16x32_bf16 v[60:63], v[104:107], a[68:71], v[60:63]
    ds_write_b128 v6, v[24:27] offset:12288
    s_waitcnt lgkmcnt(8)
    v_mfma_f32_16x16x32_bf16 v[64:67], v[108:111], a[64:67], v[64:67]
    ds_read_b128 v[80:83], v2 offset:51200
    ds_write_b128 v7, v[32:35] offset:24576
    v_mfma_f32_16x16x32_bf16 v[68:71], v[108:111], a[68:71], v[68:71]
    ds_write_b128 v7, v[40:43] offset:36864
    s_waitcnt lgkmcnt(10)
    v_mfma_f32_16x16x32_bf16 v[56:59], v[112:115], a[72:75], v[56:59]
    ds_read_b128 v[84:87], v2 offset:52224
    ds_write_b128 v7, v[48:51] offset:49152
    v_mfma_f32_16x16x32_bf16 v[60:63], v[112:115], a[76:79], v[60:63]
    s_waitcnt lgkmcnt(11)
    v_mfma_f32_16x16x32_bf16 v[64:67], v[116:119], a[72:75], v[64:67]
    ds_read_b128 v[88:91], v2 offset:53248
    v_mfma_f32_16x16x32_bf16 v[68:71], v[116:119], a[76:79], v[68:71]
    s_waitcnt lgkmcnt(11)
    v_mfma_f32_16x16x32_bf16 v[56:59], v[120:123], a[80:83], v[56:59]
    ds_read_b128 v[92:95], v2 offset:54272
    v_mfma_f32_16x16x32_bf16 v[60:63], v[120:123], a[84:87], v[60:63]
    s_waitcnt lgkmcnt(11)
    v_mfma_f32_16x16x32_bf16 v[64:67], v[124:127], a[80:83], v[64:67]
    ds_read_b128 v[96:99], v2 offset:55296
    v_mfma_f32_16x16x32_bf16 v[68:71], v[124:127], a[84:87], v[68:71]
    s_waitcnt lgkmcnt(11)
    v_mfma_f32_16x16x32_bf16 v[56:59], v[72:75], a[88:91], v[56:59]
    ds_read_b128 v[100:103], v2 offset:56320
    v_mfma_f32_16x16x32_bf16 v[60:63], v[72:75], a[92:95], v[60:63]
    s_waitcnt lgkmcnt(11)
    v_mfma_f32_16x16x32_bf16 v[64:67], v[76:79], a[88:91], v[64:67]
    ds_read_b128 v[104:107], v2 offset:57344
    v_mfma_f32_16x16x32_bf16 v[68:71], v[76:79], a[92:95], v[68:71]
    s_waitcnt lgkmcnt(9)
    v_mfma_f32_16x16x32_bf16 v[56:59], v[80:83], a[96:99], v[56:59]
    ds_read_b128 v[108:111], v2 offset:59392
    v_mfma_f32_16x16x32_bf16 v[60:63], v[80:83], a[100:103], v[60:63]
    s_waitcnt lgkmcnt(7)
    v_mfma_f32_16x16x32_bf16 v[64:67], v[84:87], a[96:99], v[64:67]
    ds_read_b128 v[112:115], v2 offset:61440
    v_mfma_f32_16x16x32_bf16 v[68:71], v[84:87], a[100:103], v[68:71]
    s_waitcnt lgkmcnt(6)
    v_mfma_f32_16x16x32_bf16 v[56:59], v[88:91], a[104:107], v[56:59]
    ds_read_b128 v[116:119], v2 offset:58368
    v_mfma_f32_16x16x32_bf16 v[60:63], v[88:91], a[108:111], v[60:63]
    s_waitcnt lgkmcnt(6)
    v_mfma_f32_16x16x32_bf16 v[64:67], v[92:95], a[104:107], v[64:67]
    ds_read_b128 v[120:123], v2 offset:60416
    v_mfma_f32_16x16x32_bf16 v[68:71], v[92:95], a[108:111], v[68:71]
    s_waitcnt lgkmcnt(6)
    v_mfma_f32_16x16x32_bf16 v[56:59], v[96:99], a[112:115], v[56:59]
    ds_read_b128 v[124:127], v2 offset:62464
    v_mfma_f32_16x16x32_bf16 v[60:63], v[96:99], a[116:119], v[60:63]
    s_waitcnt lgkmcnt(6)
    v_mfma_f32_16x16x32_bf16 v[64:67], v[100:103], a[112:115], v[64:67]
    v_mfma_f32_16x16x32_bf16 v[68:71], v[100:103], a[116:119], v[68:71]
    buffer_load_dwordx2 v[252:253], v12, s[8:11], s38 offen sc1
    s_waitcnt lgkmcnt(5)
    v_mfma_f32_16x16x32_bf16 v[56:59], v[104:107], a[120:123], v[56:59]
    v_mfma_f32_16x16x32_bf16 v[60:63], v[104:107], a[124:127], v[60:63]
    s_waitcnt lgkmcnt(4)
    v_mfma_f32_16x16x32_bf16 v[56:59], v[108:111], a[128:131], v[56:59]
    v_mfma_f32_16x16x32_bf16 v[60:63], v[108:111], a[132:135], v[60:63]
    s_waitcnt lgkmcnt(3)
    v_mfma_f32_16x16x32_bf16 v[56:59], v[112:115], a[136:139], v[56:59]
    v_mfma_f32_16x16x32_bf16 v[60:63], v[112:115], a[140:143], v[60:63]
    s_waitcnt lgkmcnt(2)
    v_mfma_f32_16x16x32_bf16 v[64:67], v[116:119], a[120:123], v[64:67]
    v_mfma_f32_16x16x32_bf16 v[68:71], v[116:119], a[124:127], v[68:71]
    s_waitcnt lgkmcnt(1)
    v_mfma_f32_16x16x32_bf16 v[64:67], v[120:123], a[128:131], v[64:67]
    v_mfma_f32_16x16x32_bf16 v[68:71], v[120:123], a[132:135], v[68:71]
    s_waitcnt lgkmcnt(0)
    v_mfma_f32_16x16x32_bf16 v[64:67], v[124:127], a[136:139], v[64:67]
    v_pk_mul_f32 v[56:57], v[56:57], s[32:33]
    v_pk_mul_f32 v[58:59], v[58:59], s[32:33]
    v_pk_mul_f32 v[60:61], v[60:61], s[32:33]
    v_mfma_f32_16x16x32_bf16 v[68:71], v[124:127], a[140:143], v[68:71]
    v_pk_mul_f32 v[62:63], v[62:63], s[32:33]
    v_cvt_pk_bf16_f32 v56, v56, v57
    v_cvt_pk_bf16_f32 v57, v58, v59
    s_nop 3
    v_cvt_pk_bf16_f32 v58, v60, v61
    v_cvt_pk_bf16_f32 v59, v62, v63
    ds_write_b128 v11, v[56:59] offset:0
    v_pk_mul_f32 v[64:65], v[64:65], s[32:33]
    v_pk_mul_f32 v[66:67], v[66:67], s[32:33]
    v_pk_mul_f32 v[68:69], v[68:69], s[32:33]
    v_pk_mul_f32 v[70:71], v[70:71], s[32:33]
    v_cvt_pk_bf16_f32 v64, v64, v65
    v_cvt_pk_bf16_f32 v65, v66, v67
    v_cvt_pk_bf16_f32 v66, v68, v69
    v_cvt_pk_bf16_f32 v67, v70, v71
    ds_write_b128 v11, v[64:67] offset:4096
    s_waitcnt lgkmcnt(0)
    s_barrier
    ds_read_b64 v[16:17], v248 offset:0
    ds_read_b64 v[18:19], v249 offset:0
    ds_read_b64 v[20:21], v248 offset:8
    ds_read_b64 v[22:23], v249 offset:8
    ds_read_b64 v[24:25], v248 offset:1024
    ds_read_b64 v[26:27], v249 offset:1024
    ds_read_b64 v[28:29], v248 offset:1032
    ds_read_b64 v[30:31], v249 offset:1032
    ds_read_b64 a[64:65], v244 offset:8192
    ds_read_b64 a[66:67], v245 offset:8192
    ds_read_b64 a[68:69], v244 offset:8200
    ds_read_b64 a[70:71], v245 offset:8200
    ds_read_b64 a[72:73], v244 offset:9216
    ds_read_b64 a[74:75], v245 offset:9216
    ds_read_b64 a[76:77], v244 offset:9224
    ds_read_b64 a[78:79], v245 offset:9224
    ds_read_b64_tr_b16 a[144:145], v246 offset:8192
    ds_read_b64_tr_b16 a[146:147], v246 offset:8200
    ds_read_b64_tr_b16 a[148:149], v247 offset:8192
    ds_read_b64_tr_b16 a[150:151], v247 offset:8200
    ds_read_b64_tr_b16 a[152:153], v246 offset:9216
    ds_read_b64_tr_b16 a[154:155], v246 offset:9224
    ds_read_b64_tr_b16 a[156:157], v247 offset:9216
    ds_read_b64_tr_b16 a[158:159], v247 offset:9224
    s_waitcnt vmcnt(0)
    v_cmp_eq_u64 vcc, s[100:101], v[252:253]
    s_mov_b32 s56, s37
    v_mov_b32 v2, 0
    s_cmp_eq_u64 vcc, -1
    s_cbranch_scc1 L_pollx_b
    s_mov_b32 s57, 300000
    s_add_u32 s56, s56, s51
L_poll_b:
    buffer_load_dwordx2 v[254:255], v2, s[8:11], s56 offen sc1
    s_sub_u32 s57, s57, 1
    s_waitcnt vmcnt(0)
    v_cmp_eq_u64 vcc, s[100:101], v[254:255]
    s_cmp_eq_u32 s57, 0
    s_cbranch_scc1 L_pollx_b
    s_cmp_eq_u64 vcc, -1
    s_cbranch_scc0 L_poll_b
L_pollx_b:
    s_add_u32 m0, s36, 0
    s_add_u32 s28, s25, 0
    buffer_load_dwordx4 v1, s[8:11], s28 offen offset:0 lds
    buffer_load_dwordx4 v1, s[8:11], s28 offen offset:1024 lds
    s_add_u32 m0, s36, 12288
    s_add_u32 s28, s25, 65536
    buffer_load_dwordx4 v1, s[8:11], s28 offen offset:0 lds
    buffer_load_dwordx4 v1, s[8:11], s28 offen offset:1024 lds
    s_add_u32 m0, s36, 49152
    s_add_u32 s28, s25, 262144
    buffer_load_dwordx4 v5, s[8:11], s28 offen offset:0 lds
    buffer_load_dwordx4 v5, s[8:11], s28 offen offset:1024 lds
    s_add_u32 m0, s36, 24576
    s_add_u32 s28, s25, 131072
    buffer_load_dwordx4 v5, s[8:11], s28 offen offset:0 lds
    buffer_load_dwordx4 v5, s[8:11], s28 offen offset:1024 lds
    s_add_u32 m0, s36, 36864
    s_add_u32 s28, s25, 196608
    buffer_load_dwordx4 v5, s[8:11], s28 offen offset:0 lds
    buffer_load_dwordx4 v5, s[8:11], s28 offen offset:1024 lds
    s_cmp_lg_u32 s20, 0
    s_cbranch_scc1 L_pollx_w1
    s_cmp_lg_u32 s50, 0
    s_cbranch_scc1 L_pollx_w1
    s_mov_b32 s56, 63889408
    v_min_u32 v2, 53, v0
    v_lshlrev_b32 v2, 3, v2
    s_mov_b32 s57, 300000
    s_add_u32 s56, s56, s51
L_poll_w1:
    buffer_load_dwordx2 v[254:255], v2, s[8:11], s56 offen sc1
    s_sub_u32 s57, s57, 1
    s_waitcnt vmcnt(0)
    v_cmp_eq_u64 vcc, s[100:101], v[254:255]
    s_cmp_eq_u32 s57, 0
    s_cbranch_scc1 L_pollx_w1
    s_cmp_eq_u64 vcc, -1
    s_cbranch_scc0 L_poll_w1
L_pollx_w1:
    s_cmp_eq_u32 s67, 0
    s_cbranch_scc1 L_pke
    s_lshl_b32 s66, s20, 13
    s_add_u32 s66, s66, 131072
    v_add_u32 v10, s66, v1
    v_bfe_u32 v11, v0, 2, 4
    v_lshlrev_b32 v11, 7, v11
    v_and_b32 v252, 3, v0
    v_lshl_add_u32 v11, v252, 3, v11
    v_add_u32 v11, s66, v11
    s_waitcnt lgkmcnt(0)
    ds_write_b128 v10, v[128:131] offset:0
    ds_write_b128 v10, v[132:135] offset:1024
    ds_write_b128 v10, v[136:139] offset:2048
    ds_write_b128 v10, v[140:143] offset:3072
    s_waitcnt lgkmcnt(0)
    ds_read_b64_tr_b16 v[48:49], v11 offset:0
    ds_read_b64_tr_b16 v[50:51], v11 offset:2048
    ds_read_b64_tr_b16 v[52:53], v11 offset:32
    ds_read_b64_tr_b16 v[54:55], v11 offset:2080
    ds_read_b64_tr_b16 v[56:57], v11 offset:64
    ds_read_b64_tr_b16 v[58:59], v11 offset:2112
    ds_read_b64_tr_b16 v[60:61], v11 offset:96
    ds_read_b64_tr_b16 v[62:63], v11 offset:2144
    ds_write_b128 v10, v[144:147] offset:4096
    ds_write_b128 v10, v[148:151] offset:5120
    ds_write_b128 v10, v[152:155] offset:6144
    ds_write_b128 v10, v[156:159] offset:7168
    s_waitcnt lgkmcnt(0)
    buffer_store_dwordx4 v[48:51], v1, s[8:11], s68 offen offset:0 sc1
    buffer_store_dwordx4 v[52:55], v1, s[8:11], s69 offen offset:0 sc1
    buffer_store_dwordx4 v[56:59], v1, s[8:11], s70 offen offset:0 sc1
    buffer_store_dwordx4 v[60:63], v1, s[8:11], s71 offen offset:0 sc1
    ds_read_b64_tr_b16 v[64:65], v11 offset:4096
    ds_read_b64_tr_b16 v[66:67], v11 offset:6144
    ds_read_b64_tr_b16 v[68:69], v11 offset:4128
    ds_read_b64_tr_b16 v[70:71], v11 offset:6176
    ds_read_b64_tr_b16 v[72:73], v11 offset:4160
    ds_read_b64_tr_b16 v[74:75], v11 offset:6208
    ds_read_b64_tr_b16 v[76:77], v11 offset:4192
    ds_read_b64_tr_b16 v[78:79], v11 offset:6240
    ds_write_b128 v10, v[160:163] offset:0
    ds_write_b128 v10, v[164:167] offset:1024
    ds_write_b128 v10, v[168:171] offset:2048
    ds_write_b128 v10, v[172:175] offset:3072
    s_waitcnt lgkmcnt(0)
    buffer_store_dwordx4 v[64:67], v1, s[8:11], s68 offen offset:1024 sc1
    buffer_store_dwordx4 v[68:71], v1, s[8:11], s69 offen offset:1024 sc1
    buffer_store_dwordx4 v[72:75], v1, s[8:11], s70 offen offset:1024 sc1
    buffer_store_dwordx4 v[76:79], v1, s[8:11], s71 offen offset:1024 sc1
    ds_read_b64_tr_b16 v[48:49], v11 offset:0
    ds_read_b64_tr_b16 v[50:51], v11 offset:2048
    ds_read_b64_tr_b16 v[52:53], v11 offset:32
    ds_read_b64_tr_b16 v[54:55], v11 offset:2080
    ds_read_b64_tr_b16 v[56:57], v11 offset:64
    ds_read_b64_tr_b16 v[58:59], v11 offset:2112
    ds_read_b64_tr_b16 v[60:61], v11 offset:96
    ds_read_b64_tr_b16 v[62:63], v11 offset:2144
    ds_write_b128 v10, a[160:163] offset:4096
    ds_write_b128 v10, a[164:167] offset:5120
    ds_write_b128 v10, a[168:171] offset:6144
    ds_write_b128 v10, a[172:175] offset:7168
    s_waitcnt lgkmcnt(0)
    buffer_store_dwordx4 v[48:51], v1, s[8:11], s68 offen offset:2048 sc1
    buffer_store_dwordx4 v[52:55], v1, s[8:11], s69 offen offset:2048 sc1
    buffer_store_dwordx4 v[56:59], v1, s[8:11], s70 offen offset:2048 sc1
    buffer_store_dwordx4 v[60:63], v1, s[8:11], s71 offen offset:2048 sc1
    ds_read_b64_tr_b16 v[64:65], v11 offset:4096
    ds_read_b64_tr_b16 v[66:67], v11 offset:6144
    ds_read_b64_tr_b16 v[68:69], v11 offset:4128
    ds_read_b64_tr_b16 v[70:71], v11 offset:6176
    ds_read_b64_tr_b16 v[72:73], v11 offset:4160
    ds_read_b64_tr_b16 v[74:75], v11 offset:6208
    ds_read_b64_tr_b16 v[76:77], v11 offset:4192
    ds_read_b64_tr_b16 v[78:79], v11 offset:6240
    ds_write_b128 v10, a[176:179] offset:0
    ds_write_b128 v10, a[180:183] offset:1024
    ds_write_b128 v10, a[184:187] offset:2048
    ds_write_b128 v10, a[188:191] offset:3072
    s_waitcnt lgkmcnt(0)
    buffer_store_dwordx4 v[64:67], v1, s[8:11], s68 offen offset:3072 sc1
    s_add_u32 s68, s68, 4096
    buffer_store_dwordx4 v[68:71], v1, s[8:11], s69 offen offset:3072 sc1
    s_add_u32 s69, s69, 4096
    buffer_store_dwordx4 v[72:75], v1, s[8:11], s70 offen offset:3072 sc1
    s_add_u32 s70, s70, 4096
    buffer_store_dwordx4 v[76:79], v1, s[8:11], s71 offen offset:3072 sc1
    s_add_u32 s71, s71, 4096
    ds_read_b64_tr_b16 v[48:49], v11 offset:0
    ds_read_b64_tr_b16 v[50:51], v11 offset:2048
    ds_read_b64_tr_b16 v[52:53], v11 offset:32
    ds_read_b64_tr_b16 v[54:55], v11 offset:2080
    ds_read_b64_tr_b16 v[56:57], v11 offset:64
    ds_read_b64_tr_b16 v[58:59], v11 offset:2112
    ds_read_b64_tr_b16 v[60:61], v11 offset:96
    ds_read_b64_tr_b16 v[62:63], v11 offset:2144
    ds_write_b128 v10, a[192:195] offset:4096
    ds_write_b128 v10, a[196:199] offset:5120
    ds_write_b128 v10, a[200:203] offset:6144
    ds_write_b128 v10, a[204:207] offset:7168
    s_waitcnt lgkmcnt(0)
    buffer_store_dwordx4 v[48:51], v1, s[8:11], s68 offen offset:0 sc1
    buffer_store_dwordx4 v[52:55], v1, s[8:11], s69 offen offset:0 sc1
    buffer_store_dwordx4 v[56:59], v1, s[8:11], s70 offen offset:0 sc1
    buffer_store_dwordx4 v[60:63], v1, s[8:11], s71 offen offset:0 sc1
    ds_read_b64_tr_b16 v[64:65], v11 offset:4096
    ds_read_b64_tr_b16 v[66:67], v11 offset:6144
    ds_read_b64_tr_b16 v[68:69], v11 offset:4128
    ds_read_b64_tr_b16 v[70:71], v11 offset:6176
    ds_read_b64_tr_b16 v[72:73], v11 offset:4160
    ds_read_b64_tr_b16 v[74:75], v11 offset:6208
    ds_read_b64_tr_b16 v[76:77], v11 offset:4192
    ds_read_b64_tr_b16 v[78:79], v11 offset:6240
    s_waitcnt lgkmcnt(0)
    buffer_store_dwordx4 v[64:67], v1, s[8:11], s68 offen offset:1024 sc1
    buffer_store_dwordx4 v[68:71], v1, s[8:11], s69 offen offset:1024 sc1
    buffer_store_dwordx4 v[72:75], v1, s[8:11], s70 offen offset:1024 sc1
    buffer_store_dwordx4 v[76:79], v1, s[8:11], s71 offen offset:1024 sc1
L_pke:
    s_waitcnt lgkmcnt(0)
    v_cndmask_b32 v18, 0, v18, s[42:43]
    v_cndmask_b32 v19, 0, v19, s[44:45]
    v_cndmask_b32 v22, 0, v22, s[42:43]
    v_cndmask_b32 v23, 0, v23, s[44:45]
    v_cndmask_b32 v26, 0, v26, s[42:43]
    v_cndmask_b32 v27, 0, v27, s[44:45]
    v_cndmask_b32 v30, 0, v30, s[42:43]
    v_cndmask_b32 v31, 0, v31, s[44:45]
    v_bfe_u32 v10, v0, 3, 3
    v_mul_u32_u24 v10, 1152, v10
    v_and_b32 v11, 7, v0
    v_lshl_add_u32 v10, v11, 4, v10
    v_add_u32 v11, 9216, v10
    s_mov_b32 s56, s39
    s_cmp_eq_u32 s49, 0
    s_cbranch_scc1 L_attn_f16
    s_cmp_eq_u32 s49, 2
    s_cbranch_scc1 L_attn_f12
    s_cmp_eq_u32 s49, 4
    s_cbranch_scc1 L_attn_f8
    s_cmp_eq_u32 s49, 6
    s_cbranch_scc1 L_attn_f4
L_attn_f0:
    v_mfma_f32_16x16x32_bf16 v[48:51], a[64:67], v[16:19], v[236:239]
    v_mfma_f32_16x16x32_bf16 v[56:59], a[64:67], v[20:23], 0
    v_mfma_f32_16x16x32_bf16 v[60:63], a[68:71], v[20:23], v[236:239]
    v_mfma_f32_16x16x32_bf16 v[64:67], a[64:67], v[24:27], 0
    v_mfma_f32_16x16x32_bf16 v[68:71], a[68:71], v[24:27], 0
    v_mfma_f32_16x16x32_bf16 v[72:75], a[72:75], v[24:27], v[236:239]
    v_mfma_f32_16x16x32_bf16 v[80:83], a[64:67], v[28:31], 0
    v_mfma_f32_16x16x32_bf16 v[84:87], a[68:71], v[28:31], 0
    v_mfma_f32_16x16x32_bf16 v[88:91], a[72:75], v[28:31], 0
    v_mfma_f32_16x16x32_bf16 v[92:95], a[76:79], v[28:31], v[236:239]
    s_nop 2
    v_exp_f32 v48, v48
    v_exp_f32 v49, v49
    v_exp_f32 v50, v50
    v_exp_f32 v51, v51
    v_cvt_pk_bf16_f32 v48, v48, v49
    v_cvt_pk_bf16_f32 v49, v50, v51
    v_mov_b32 v50, 0
    v_mov_b32 v51, 0
    v_exp_f32 v56, v56
    v_exp_f32 v57, v57
    v_mfma_f32_16x16x32_bf16 v[192:195], a[144:147], v[48:51], 0
    v_exp_f32 v58, v58
    v_exp_f32 v59, v59
    v_exp_f32 v60, v60
    v_mfma_f32_16x16x32_bf16 v[196:199], a[148:151], v[48:51], 0
    v_cvt_pk_bf16_f32 v56, v56, v57
    v_exp_f32 v61, v61
    v_cvt_pk_bf16_f32 v57, v58, v59
    v_exp_f32 v62, v62
    v_exp_f32 v63, v63
    v_cvt_pk_bf16_f32 v58, v60, v61
    v_cvt_pk_bf16_f32 v59, v62, v63
    v_exp_f32 v64, v64
    v_exp_f32 v65, v65
    v_mfma_f32_16x16x32_bf16 v[200:203], a[144:147], v[56:59], 0
    v_exp_f32 v66, v66
    v_exp_f32 v67, v67
    v_exp_f32 v68, v68
    v_mfma_f32_16x16x32_bf16 v[204:207], a[148:151], v[56:59], 0
    v_cvt_pk_bf16_f32 v64, v64, v65
    v_exp_f32 v69, v69
    v_cvt_pk_bf16_f32 v65, v66, v67
    v_exp_f32 v70, v70
    v_exp_f32 v71, v71
    v_cvt_pk_bf16_f32 v66, v68, v69
    v_cvt_pk_bf16_f32 v67, v70, v71
    v_exp_f32 v72, v72
    v_exp_f32 v73, v73
    v_mfma_f32_16x16x32_bf16 v[208:211], a[144:147], v[64:67], 0
    v_exp_f32 v74, v74
    v_exp_f32 v75, v75
    v_mfma_f32_16x16x32_bf16 v[212:215], a[148:151], v[64:67], 0
    v_cvt_pk_bf16_f32 v72, v72, v73
    v_cvt_pk_bf16_f32 v73, v74, v75
    v_mov_b32 v74, 0
    v_mov_b32 v75, 0
    v_exp_f32 v80, v80
    v_exp_f32 v81, v81
    s_cmp_eq_u32 s67, 0
    s_cbranch_scc1 2
    s_waitcnt vmcnt(24)
    s_branch 1
    s_waitcnt vmcnt(0)
    s_barrier
    ds_read_b64 a[0:1], v244 offset:0
    v_exp_f32 v82, v82
    ds_read_b64 a[2:3], v245 offset:0
    ds_read_b64 a[4:5], v244 offset:8
    v_exp_f32 v83, v83
    ds_read_b64 a[6:7], v245 offset:8
    ds_read_b64 a[8:9], v244 offset:1024
    ds_read_b64 a[10:11], v245 offset:1024
    v_exp_f32 v84, v84
    v_mfma_f32_16x16x32_bf16 v[208:211], a[152:155], v[72:75], v[208:211]
    ds_read_b64 a[12:13], v244 offset:1032
    v_cvt_pk_bf16_f32 v80, v80, v81
    ds_read_b64 a[14:15], v245 offset:1032
    v_exp_f32 v85, v85
    ds_read_b64 a[16:17], v244 offset:2048
    ds_read_b64 a[18:19], v245 offset:2048
    v_cvt_pk_bf16_f32 v81, v82, v83
    ds_read_b64 a[20:21], v244 offset:2056
    v_exp_f32 v86, v86
    ds_read_b64 a[22:23], v245 offset:2056
    ds_read_b64 a[24:25], v244 offset:3072
    v_exp_f32 v87, v87
    v_mfma_f32_16x16x32_bf16 v[212:215], a[156:159], v[72:75], v[212:215]
    v_cvt_pk_bf16_f32 v82, v84, v85
    v_cvt_pk_bf16_f32 v83, v86, v87
    v_exp_f32 v88, v88
    v_exp_f32 v89, v89
    ds_read_b64 a[26:27], v245 offset:3072
    ds_read_b64 a[28:29], v244 offset:3080
    ds_read_b64 a[30:31], v245 offset:3080
    v_exp_f32 v90, v90
    v_mfma_f32_16x16x32_bf16 v[216:219], a[144:147], v[80:83], 0
    ds_read_b64 a[32:33], v244 offset:4096
    v_exp_f32 v91, v91
    ds_read_b64 a[34:35], v245 offset:4096
    ds_read_b64 a[36:37], v244 offset:4104
    v_mfma_f32_16x16x32_bf16 v[220:223], a[148:151], v[80:83], 0
    v_exp_f32 v92, v92
    ds_read_b64 a[38:39], v245 offset:4104
    ds_read_b64 a[40:41], v244 offset:5120
    s_waitcnt lgkmcnt(15)
    v_mfma_f32_16x16x32_bf16 v[96:99], a[0:3], v[16:19], v[232:235]
    v_cvt_pk_bf16_f32 v88, v88, v89
    ds_read_b64 a[42:43], v245 offset:5120
    v_exp_f32 v93, v93
    ds_read_b64 a[44:45], v244 offset:5128
    v_mfma_f32_16x16x32_bf16 v[100:103], a[4:7], v[16:19], 0
    ds_read_b64 a[46:47], v245 offset:5128
    v_cvt_pk_bf16_f32 v89, v90, v91
    ds_read_b64 a[48:49], v244 offset:6144
    v_exp_f32 v94, v94
    v_mfma_f32_16x16x32_bf16 v[104:107], a[8:11], v[16:19], 0
    ds_read_b64 a[50:51], v245 offset:6144
    ds_read_b64 a[52:53], v244 offset:6152
    v_exp_f32 v95, v95
    s_waitcnt lgkmcnt(15)
    v_mfma_f32_16x16x32_bf16 v[108:111], a[12:15], v[16:19], 0
    v_cvt_pk_bf16_f32 v90, v92, v93
    v_cvt_pk_bf16_f32 v91, v94, v95
    v_exp_f32 v96, v96
    v_exp_f32 v97, v97
    ds_read_b64 a[54:55], v245 offset:6152
    ds_read_b64 a[56:57], v244 offset:7168
    ds_read_b64 a[58:59], v245 offset:7168
    v_exp_f32 v98, v98
    ds_read_b64 a[60:61], v244 offset:7176
    v_mfma_f32_16x16x32_bf16 v[216:219], a[152:155], v[88:91], v[216:219]
    v_exp_f32 v99, v99
    ds_read_b64 a[62:63], v245 offset:7176
    ds_read_b64_tr_b16 a[80:81], v246 offset:0
    v_exp_f32 v100, v100
    ds_read_b64_tr_b16 a[82:83], v246 offset:8
    ds_read_b64_tr_b16 a[84:85], v247 offset:0
    v_mfma_f32_16x16x32_bf16 v[220:223], a[156:159], v[88:91], v[220:223]
    v_cvt_pk_bf16_f32 v96, v96, v97
    ds_read_b64_tr_b16 a[86:87], v247 offset:8
    v_exp_f32 v101, v101
    ds_read_b64_tr_b16 a[88:89], v246 offset:1024
    ds_read_b64_tr_b16 a[90:91], v246 offset:1032
    v_cvt_pk_bf16_f32 v97, v98, v99
    v_mfma_f32_16x16x32_bf16 v[112:115], a[16:19], v[16:19], 0
    ds_read_b64_tr_b16 a[92:93], v247 offset:1024
    v_exp_f32 v102, v102
    ds_read_b64_tr_b16 a[94:95], v247 offset:1032
    ds_read_b64_tr_b16 a[96:97], v246 offset:2048
    v_exp_f32 v103, v103
    v_mfma_f32_16x16x32_bf16 v[116:119], a[20:23], v[16:19], 0
    v_cvt_pk_bf16_f32 v98, v100, v101
    v_cvt_pk_bf16_f32 v99, v102, v103
    v_exp_f32 v104, v104
    v_exp_f32 v105, v105
    ds_read_b64_tr_b16 a[98:99], v246 offset:2056
    ds_read_b64_tr_b16 a[100:101], v247 offset:2048
    ds_read_b64_tr_b16 a[102:103], v247 offset:2056
    v_exp_f32 v106, v106
    ds_read_b64_tr_b16 a[104:105], v246 offset:3072
    s_waitcnt lgkmcnt(9)
    v_mfma_f32_16x16x32_bf16 v[192:195], a[80:83], v[96:99], v[192:195]
    v_exp_f32 v107, v107
    ds_read_b64_tr_b16 a[106:107], v246 offset:3080
    ds_read_b64_tr_b16 a[108:109], v247 offset:3072
    v_exp_f32 v108, v108
    ds_read_b64_tr_b16 a[110:111], v247 offset:3080
    ds_read_b64_tr_b16 a[112:113], v246 offset:4096
    v_mfma_f32_16x16x32_bf16 v[196:199], a[84:87], v[96:99], v[196:199]
    v_cvt_pk_bf16_f32 v104, v104, v105
    ds_read_b64_tr_b16 a[114:115], v246 offset:4104
    v_exp_f32 v109, v109
    ds_read_b64_tr_b16 a[116:117], v247 offset:4096
    ds_read_b64_tr_b16 a[118:119], v247 offset:4104
    v_cvt_pk_bf16_f32 v105, v106, v107
    v_mfma_f32_16x16x32_bf16 v[120:123], a[24:27], v[16:19], 0
    ds_read_b64_tr_b16 a[120:121], v246 offset:5120
    v_exp_f32 v110, v110
    ds_read_b64_tr_b16 a[122:123], v246 offset:5128
    ds_read_b64_tr_b16 a[124:125], v247 offset:5120
    v_exp_f32 v111, v111
    v_mfma_f32_16x16x32_bf16 v[124:127], a[28:31], v[16:19], 0
    v_cvt_pk_bf16_f32 v106, v108, v109
    v_cvt_pk_bf16_f32 v107, v110, v111
    v_exp_f32 v112, v112
    v_exp_f32 v113, v113
    ds_read_b64_tr_b16 a[126:127], v247 offset:5128
    ds_read_b64_tr_b16 a[128:129], v246 offset:6144
    v_exp_f32 v114, v114
    ds_read_b64_tr_b16 a[130:131], v246 offset:6152
    s_waitcnt lgkmcnt(15)
    v_mfma_f32_16x16x32_bf16 v[192:195], a[88:91], v[104:107], v[192:195]
    v_exp_f32 v115, v115
    ds_read_b64_tr_b16 a[132:133], v247 offset:6144
    v_exp_f32 v116, v116
    ds_read_b64_tr_b16 a[134:135], v247 offset:6152
    v_mfma_f32_16x16x32_bf16 v[196:199], a[92:95], v[104:107], v[196:199]
    v_cvt_pk_bf16_f32 v112, v112, v113
    ds_read_b64_tr_b16 a[136:137], v246 offset:7168
    v_exp_f32 v117, v117
    ds_read_b64_tr_b16 a[138:139], v246 offset:7176
    v_mfma_f32_16x16x32_bf16 v[48:51], a[32:35], v[16:19], 0
    v_cvt_pk_bf16_f32 v113, v114, v115
    ds_read_b64_tr_b16 a[140:141], v247 offset:7168
    v_exp_f32 v118, v118
    ds_read_b64_tr_b16 a[142:143], v247 offset:7176
    v_exp_f32 v119, v119
    v_mfma_f32_16x16x32_bf16 v[52:55], a[36:39], v[16:19], 0
    v_cvt_pk_bf16_f32 v114, v116, v117
    v_cvt_pk_bf16_f32 v115, v118, v119
    v_exp_f32 v120, v120
    v_exp_f32 v121, v121
    s_waitcnt lgkmcnt(0)
    s_mov_b32 m0, s59
    s_waitcnt vmcnt(0)
    s_barrier
    v_mov_b32 v254, s100
    v_mov_b32 v255, s101
    s_mov_b32 s30, 159072863
    s_mul_hi_u32 s27, s2, s30
    s_mul_i32 s27, s27, 5
    s_add_u32 s27, s27, s2
    s_lshl_b32 s27, s27, 3
    s_add_u32 s27, s27, 63885312
    s_cmp_lt_u32 s2, 216
    s_cselect_b32 s27, s27, 1073741824
    s_cmp_eq_u32 s20, 0
    s_cselect_b32 s27, s27, 1073741824
    buffer_store_dwordx2 v[254:255], v13, s[8:11], s27 offen sc1
    v_exp_f32 v122, v122
    v_mfma_f32_16x16x32_bf16 v[192:195], a[96:99], v[112:115], v[192:195]
    v_exp_f32 v123, v123
    s_cmp_eq_u32 s67, 0
    s_cbranch_scc1 L_pk_f0_0
    buffer_load_dwordx4 a[208:211], v10, s[60:63], s72 offen nt
    buffer_load_dwordx4 a[212:215], v11, s[60:63], s72 offen nt
    buffer_load_dwordx4 a[216:219], v10, s[60:63], s73 offen nt
    buffer_load_dwordx4 a[220:223], v11, s[60:63], s73 offen nt
L_pk_f0_0:
    v_exp_f32 v124, v124
    v_mfma_f32_16x16x32_bf16 v[196:199], a[100:103], v[112:115], v[196:199]
    v_cvt_pk_bf16_f32 v120, v120, v121
    v_exp_f32 v125, v125
    v_mfma_f32_16x16x32_bf16 v[56:59], a[40:43], v[16:19], 0
    v_cvt_pk_bf16_f32 v121, v122, v123
    v_exp_f32 v126, v126
    v_mfma_f32_16x16x32_bf16 v[60:63], a[44:47], v[16:19], 0
    v_exp_f32 v127, v127
    v_cvt_pk_bf16_f32 v122, v124, v125
    v_cvt_pk_bf16_f32 v123, v126, v127
    v_exp_f32 v48, v48
    v_exp_f32 v49, v49
    s_cmp_eq_u32 s67, 0
    s_cbranch_scc1 L_pk_f0_1
    buffer_load_dwordx4 a[224:227], v10, s[60:63], s74 offen nt
    buffer_load_dwordx4 a[228:231], v11, s[60:63], s74 offen nt
    buffer_load_dwordx4 a[232:235], v10, s[60:63], s75 offen nt
    buffer_load_dwordx4 a[236:239], v11, s[60:63], s75 offen nt
L_pk_f0_1:
    v_exp_f32 v50, v50
    v_mfma_f32_16x16x32_bf16 v[192:195], a[104:107], v[120:123], v[192:195]
    v_exp_f32 v51, v51
    v_exp_f32 v52, v52
    v_mfma_f32_16x16x32_bf16 v[196:199], a[108:111], v[120:123], v[196:199]
    v_cvt_pk_bf16_f32 v48, v48, v49
    v_exp_f32 v53, v53
    v_mfma_f32_16x16x32_bf16 v[64:67], a[48:51], v[16:19], 0
    v_cvt_pk_bf16_f32 v49, v50, v51
    v_exp_f32 v54, v54
    v_mfma_f32_16x16x32_bf16 v[68:71], a[52:55], v[16:19], 0
    v_exp_f32 v55, v55
    v_cvt_pk_bf16_f32 v50, v52, v53
    v_cvt_pk_bf16_f32 v51, v54, v55
    v_exp_f32 v56, v56
    v_exp_f32 v57, v57
    s_cmp_eq_u32 s67, 0
    s_cbranch_scc1 L_pk_f0_2
    buffer_load_dwordx4 a[240:243], v10, s[60:63], s76 offen nt
    buffer_load_dwordx4 a[244:247], v11, s[60:63], s76 offen nt
    buffer_load_dwordx4 a[248:251], v10, s[60:63], s77 offen nt
    buffer_load_dwordx4 a[252:255], v11, s[60:63], s77 offen nt
L_pk_f0_2:
    v_exp_f32 v58, v58
    v_mfma_f32_16x16x32_bf16 v[192:195], a[112:115], v[48:51], v[192:195]
    v_exp_f32 v59, v59
    v_exp_f32 v60, v60
    v_mfma_f32_16x16x32_bf16 v[196:199], a[116:119], v[48:51], v[196:199]
    v_cvt_pk_bf16_f32 v56, v56, v57
    v_exp_f32 v61, v61
    v_mfma_f32_16x16x32_bf16 v[72:75], a[56:59], v[16:19], 0
    v_cvt_pk_bf16_f32 v57, v58, v59
    v_exp_f32 v62, v62
    v_mfma_f32_16x16x32_bf16 v[76:79], a[60:63], v[16:19], 0
    v_exp_f32 v63, v63
    v_cvt_pk_bf16_f32 v58, v60, v61
    v_cvt_pk_bf16_f32 v59, v62, v63
    v_exp_f32 v64, v64
    v_exp_f32 v65, v65
    buffer_load_dwordx4 v1, s[8:11], s58 offen offset:0 lds
    v_exp_f32 v66, v66
    v_exp_f32 v67, v67
    v_mfma_f32_16x16x32_bf16 v[192:195], a[120:123], v[56:59], v[192:195]
    v_exp_f32 v68, v68
    v_mfma_f32_16x16x32_bf16 v[196:199], a[124:127], v[56:59], v[196:199]
    v_cvt_pk_bf16_f32 v64, v64, v65
    v_exp_f32 v69, v69
    v_cvt_pk_bf16_f32 v65, v66, v67
    v_mfma_f32_16x16x32_bf16 v[84:87], a[4:7], v[20:23], v[232:235]
    v_exp_f32 v70, v70
    v_exp_f32 v71, v71
    v_cvt_pk_bf16_f32 v66, v68, v69
    v_cvt_pk_bf16_f32 v67, v70, v71
    v_exp_f32 v72, v72
    v_exp_f32 v73, v73
    buffer_load_dwordx4 v1, s[8:11], s58 offen offset:1024 lds
    v_exp_f32 v74, v74
    v_mfma_f32_16x16x32_bf16 v[192:195], a[128:131], v[64:67], v[192:195]
    v_exp_f32 v75, v75
    v_exp_f32 v76, v76
    v_mfma_f32_16x16x32_bf16 v[196:199], a[132:135], v[64:67], v[196:199]
    v_cvt_pk_bf16_f32 v72, v72, v73
    v_exp_f32 v77, v77
    v_mfma_f32_16x16x32_bf16 v[88:91], a[8:11], v[20:23], 0
    v_cvt_pk_bf16_f32 v73, v74, v75
    v_exp_f32 v78, v78
    v_mfma_f32_16x16x32_bf16 v[92:95], a[12:15], v[20:23], 0
    v_exp_f32 v79, v79
    v_cvt_pk_bf16_f32 v74, v76, v77
    v_cvt_pk_bf16_f32 v75, v78, v79
    v_exp_f32 v84, v84
    v_exp_f32 v85, v85
    buffer_load_dwordx4 v1, s[8:11], s58 offen offset:2048 lds
    v_mfma_f32_16x16x32_bf16 v[192:195], a[136:139], v[72:75], v[192:195]
    v_exp_f32 v86, v86
    v_mfma_f32_16x16x32_bf16 v[196:199], a[140:143], v[72:75], v[196:199]
    v_exp_f32 v87, v87
    v_mfma_f32_16x16x32_bf16 v[96:99], a[16:19], v[20:23], 0
    v_mov_b32 v80, 0
    v_mfma_f32_16x16x32_bf16 v[100:103], a[20:23], v[20:23], 0
    v_mov_b32 v81, 0
    v_cvt_pk_bf16_f32 v82, v84, v85
    v_cvt_pk_bf16_f32 v83, v86, v87
    v_exp_f32 v88, v88
    v_exp_f32 v89, v89
    buffer_load_dwordx4 v1, s[8:11], s58 offen offset:3072 lds
    s_add_u32 m0, m0, 16384
    s_add_u32 s58, s58, 16384
    v_exp_f32 v90, v90
    v_exp_f32 v91, v91
    v_exp_f32 v92, v92
    v_cvt_pk_bf16_f32 v88, v88, v89
    v_mfma_f32_16x16x32_bf16 v[200:203], a[80:83], v[80:83], v[200:203]
    v_exp_f32 v93, v93
    v_cvt_pk_bf16_f32 v89, v90, v91
    v_exp_f32 v94, v94
    v_exp_f32 v95, v95
    v_cvt_pk_bf16_f32 v90, v92, v93
    v_mfma_f32_16x16x32_bf16 v[204:207], a[84:87], v[80:83], v[204:207]
    v_cvt_pk_bf16_f32 v91, v94, v95
    v_mov_b32 v228, v199
    v_mov_b32 v226, v199
    v_cndmask_b32 v196, v196, v198, s[40:41]
    v_cndmask_b32 v197, v197, v199, s[40:41]
    v_permlane32_swap_b32 v226, v228
    v_mov_b32 v226, v228
    s_nop 1
    v_permlane16_swap_b32 v226, v228
    v_mfma_f32_16x16x32_bf16 v[104:107], a[24:27], v[20:23], 0
    v_rcp_f32 v226, v228
    v_med3_f32 v229, v228, v241, v242
    v_sub_f32 v229, v229, v228
    v_fma_f32 v229, v192, 0, v229
    v_fma_f32 v229, v193, 0, v229
    v_mfma_f32_16x16x32_bf16 v[108:111], a[28:31], v[20:23], 0
    v_fma_f32 v229, v194, 0, v229
    v_fma_f32 v229, v195, 0, v229
    v_fma_f32 v229, v196, 0, v229
    v_fma_f32 v229, v197, 0, v229
    v_cmp_neq_f32 vcc, 0, v229
    v_pk_mul_f32 v[192:193], v[192:193], v[226:227] op_sel_hi:[1,0]
    v_pk_mul_f32 v[194:195], v[194:195], v[226:227] op_sel_hi:[1,0]
    v_pk_mul_f32 v[196:197], v[196:197], v[226:227] op_sel_hi:[1,0]
    s_or_b64 s[64:65], s[64:65], vcc
    v_cvt_pk_bf16_f32 v198, v196, v197
    v_cvt_pk_bf16_f32 v192, v192, v193
    v_cvt_pk_bf16_f32 v193, v194, v195
    ds_bpermute_b32 v227, v243, v198
    ds_write_b64 v251, v[192:193] offset:0
    v_exp_f32 v96, v96
    v_exp_f32 v97, v97
    buffer_load_dwordx4 v1, s[8:11], s58 offen offset:0 lds
    v_exp_f32 v98, v98
    v_mfma_f32_16x16x32_bf16 v[200:203], a[88:91], v[88:91], v[200:203]
    v_exp_f32 v99, v99
    v_exp_f32 v100, v100
    v_mfma_f32_16x16x32_bf16 v[204:207], a[92:95], v[88:91], v[204:207]
    v_cvt_pk_bf16_f32 v96, v96, v97
    v_exp_f32 v101, v101
    v_cvt_pk_bf16_f32 v97, v98, v99
    v_mfma_f32_16x16x32_bf16 v[112:115], a[32:35], v[20:23], 0
    v_exp_f32 v102, v102
    v_exp_f32 v103, v103
    v_mfma_f32_16x16x32_bf16 v[116:119], a[36:39], v[20:23], 0
    v_cvt_pk_bf16_f32 v98, v100, v101
    v_cvt_pk_bf16_f32 v99, v102, v103
    s_mov_b32 vcc_lo, 65535
    s_mov_b32 vcc_hi, 0
    s_waitcnt lgkmcnt(1)
    v_cndmask_b32 v12, v12, v227, vcc
    v_exp_f32 v104, v104
    v_exp_f32 v105, v105
    buffer_load_dwordx4 v1, s[8:11], s58 offen offset:1024 lds
    v_exp_f32 v106, v106
    v_mfma_f32_16x16x32_bf16 v[200:203], a[96:99], v[96:99], v[200:203]
    v_exp_f32 v107, v107
    v_exp_f32 v108, v108
    v_mfma_f32_16x16x32_bf16 v[204:207], a[100:103], v[96:99], v[204:207]
    v_cvt_pk_bf16_f32 v104, v104, v105
    v_exp_f32 v109, v109
    v_mfma_f32_16x16x32_bf16 v[120:123], a[40:43], v[20:23], 0
    v_cvt_pk_bf16_f32 v105, v106, v107
    v_exp_f32 v110, v110
    v_mfma_f32_16x16x32_bf16 v[124:127], a[44:47], v[20:23], 0
    v_exp_f32 v111, v111
    v_cvt_pk_bf16_f32 v106, v108, v109
    v_cvt_pk_bf16_f32 v107, v110, v111
    v_exp_f32 v112, v112
    v_exp_f32 v113, v113
    buffer_load_dwordx4 v1, s[8:11], s58 offen offset:2048 lds
    v_exp_f32 v114, v114
    v_mfma_f32_16x16x32_bf16 v[200:203], a[104:107], v[104:107], v[200:203]
    v_exp_f32 v115, v115
    v_exp_f32 v116, v116
    v_mfma_f32_16x16x32_bf16 v[204:207], a[108:111], v[104:107], v[204:207]
    v_cvt_pk_bf16_f32 v112, v112, v113
    v_exp_f32 v117, v117
    v_mfma_f32_16x16x32_bf16 v[48:51], a[48:51], v[20:23], 0
    v_cvt_pk_bf16_f32 v113, v114, v115
    v_exp_f32 v118, v118
    v_mfma_f32_16x16x32_bf16 v[52:55], a[52:55], v[20:23], 0
    v_exp_f32 v119, v119
    v_cvt_pk_bf16_f32 v114, v116, v117
    v_cvt_pk_bf16_f32 v115, v118, v119
    v_exp_f32 v120, v120
    v_exp_f32 v121, v121
    buffer_load_dwordx4 v1, s[8:11], s58 offen offset:3072 lds
    s_add_u32 m0, m0, 16384
    s_add_u32 s58, s58, 16384
    v_exp_f32 v122, v122
    v_mfma_f32_16x16x32_bf16 v[200:203], a[112:115], v[112:115], v[200:203]
    v_exp_f32 v123, v123
    v_exp_f32 v124, v124
    v_mfma_f32_16x16x32_bf16 v[204:207], a[116:119], v[112:115], v[204:207]
    v_cvt_pk_bf16_f32 v120, v120, v121
    v_exp_f32 v125, v125
    v_mfma_f32_16x16x32_bf16 v[56:59], a[56:59], v[20:23], 0
    v_cvt_pk_bf16_f32 v121, v122, v123
    v_exp_f32 v126, v126
    v_mfma_f32_16x16x32_bf16 v[60:63], a[60:63], v[20:23], 0
    v_exp_f32 v127, v127
    v_cvt_pk_bf16_f32 v122, v124, v125
    v_cvt_pk_bf16_f32 v123, v126, v127
    v_exp_f32 v48, v48
    v_exp_f32 v49, v49
    buffer_load_dwordx4 v1, s[8:11], s58 offen offset:0 lds
    v_exp_f32 v50, v50
    v_mfma_f32_16x16x32_bf16 v[200:203], a[120:123], v[120:123], v[200:203]
    v_exp_f32 v51, v51
    v_exp_f32 v52, v52
    v_mfma_f32_16x16x32_bf16 v[204:207], a[124:127], v[120:123], v[204:207]
    v_cvt_pk_bf16_f32 v48, v48, v49
    v_exp_f32 v53, v53
    v_mfma_f32_16x16x32_bf16 v[64:67], a[8:11], v[24:27], v[232:235]
    v_cvt_pk_bf16_f32 v49, v50, v51
    v_exp_f32 v54, v54
    v_mfma_f32_16x16x32_bf16 v[68:71], a[12:15], v[24:27], 0
    v_exp_f32 v55, v55
    v_cvt_pk_bf16_f32 v50, v52, v53
    v_cvt_pk_bf16_f32 v51, v54, v55
    v_exp_f32 v56, v56
    v_exp_f32 v57, v57
    buffer_load_dwordx4 v1, s[8:11], s58 offen offset:1024 lds
    v_exp_f32 v58, v58
    v_mfma_f32_16x16x32_bf16 v[200:203], a[128:131], v[48:51], v[200:203]
    v_exp_f32 v59, v59
    v_exp_f32 v60, v60
    v_mfma_f32_16x16x32_bf16 v[204:207], a[132:135], v[48:51], v[204:207]
    v_cvt_pk_bf16_f32 v56, v56, v57
    v_exp_f32 v61, v61
    v_mfma_f32_16x16x32_bf16 v[72:75], a[16:19], v[24:27], 0
    v_cvt_pk_bf16_f32 v57, v58, v59
    v_exp_f32 v62, v62
    v_mfma_f32_16x16x32_bf16 v[76:79], a[20:23], v[24:27], 0
    v_exp_f32 v63, v63
    v_cvt_pk_bf16_f32 v58, v60, v61
    v_cvt_pk_bf16_f32 v59, v62, v63
    v_exp_f32 v64, v64
    v_exp_f32 v65, v65
    buffer_load_dwordx4 v1, s[8:11], s58 offen offset:2048 lds
    v_exp_f32 v66, v66
    v_mfma_f32_16x16x32_bf16 v[200:203], a[136:139], v[56:59], v[200:203]
    v_exp_f32 v67, v67
    v_exp_f32 v68, v68
    v_mfma_f32_16x16x32_bf16 v[204:207], a[140:143], v[56:59], v[204:207]
    v_cvt_pk_bf16_f32 v64, v64, v65
    v_exp_f32 v69, v69
    v_mfma_f32_16x16x32_bf16 v[80:83], a[24:27], v[24:27], 0
    v_cvt_pk_bf16_f32 v65, v66, v67
    v_exp_f32 v70, v70
    v_mfma_f32_16x16x32_bf16 v[84:87], a[28:31], v[24:27], 0
    v_exp_f32 v71, v71
    v_cvt_pk_bf16_f32 v66, v68, v69
    v_cvt_pk_bf16_f32 v67, v70, v71
    v_exp_f32 v72, v72
    v_exp_f32 v73, v73
    buffer_load_dwordx4 v1, s[8:11], s58 offen offset:3072 lds
    s_add_u32 m0, m0, 16384
    s_add_u32 s58, s58, 16384
    v_exp_f32 v74, v74
    v_exp_f32 v75, v75
    v_exp_f32 v76, v76
    v_cvt_pk_bf16_f32 v72, v72, v73
    v_mfma_f32_16x16x32_bf16 v[208:211], a[88:91], v[64:67], v[208:211]
    v_exp_f32 v77, v77
    v_cvt_pk_bf16_f32 v73, v74, v75
    v_exp_f32 v78, v78
    v_exp_f32 v79, v79
    v_cvt_pk_bf16_f32 v74, v76, v77
    v_mfma_f32_16x16x32_bf16 v[212:215], a[92:95], v[64:67], v[212:215]
    v_cvt_pk_bf16_f32 v75, v78, v79
    v_mov_b32 v228, v207
    v_mov_b32 v226, v207
    v_cndmask_b32 v204, v204, v206, s[40:41]
    v_cndmask_b32 v205, v205, v207, s[40:41]
    v_permlane32_swap_b32 v226, v228
    v_mov_b32 v226, v228
    s_nop 1
    v_permlane16_swap_b32 v226, v228
    v_mfma_f32_16x16x32_bf16 v[88:91], a[32:35], v[24:27], 0
    v_rcp_f32 v226, v228
    v_med3_f32 v229, v228, v241, v242
    v_sub_f32 v229, v229, v228
    v_fma_f32 v229, v200, 0, v229
    v_fma_f32 v229, v201, 0, v229
    v_mfma_f32_16x16x32_bf16 v[92:95], a[36:39], v[24:27], 0
    v_fma_f32 v229, v202, 0, v229
    v_fma_f32 v229, v203, 0, v229
    v_fma_f32 v229, v204, 0, v229
    v_fma_f32 v229, v205, 0, v229
    v_cmp_neq_f32 vcc, 0, v229
    v_pk_mul_f32 v[200:201], v[200:201], v[226:227] op_sel_hi:[1,0]
    v_pk_mul_f32 v[202:203], v[202:203], v[226:227] op_sel_hi:[1,0]
    v_pk_mul_f32 v[204:205], v[204:205], v[226:227] op_sel_hi:[1,0]
    s_or_b64 s[64:65], s[64:65], vcc
    v_cvt_pk_bf16_f32 v206, v204, v205
    v_cvt_pk_bf16_f32 v200, v200, v201
    v_cvt_pk_bf16_f32 v201, v202, v203
    ds_bpermute_b32 v227, v243, v206
    ds_write_b64 v251, v[200:201] offset:1024
    v_exp_f32 v80, v80
    v_exp_f32 v81, v81
    buffer_load_dwordx4 v1, s[8:11], s58 offen offset:0 lds
    v_exp_f32 v82, v82
    v_mfma_f32_16x16x32_bf16 v[208:211], a[96:99], v[72:75], v[208:211]
    v_exp_f32 v83, v83
    v_exp_f32 v84, v84
    v_mfma_f32_16x16x32_bf16 v[212:215], a[100:103], v[72:75], v[212:215]
    v_cvt_pk_bf16_f32 v80, v80, v81
    v_exp_f32 v85, v85
    v_cvt_pk_bf16_f32 v81, v82, v83
    v_mfma_f32_16x16x32_bf16 v[96:99], a[40:43], v[24:27], 0
    v_exp_f32 v86, v86
    v_exp_f32 v87, v87
    v_mfma_f32_16x16x32_bf16 v[100:103], a[44:47], v[24:27], 0
    v_cvt_pk_bf16_f32 v82, v84, v85
    v_cvt_pk_bf16_f32 v83, v86, v87
    s_mov_b32 vcc_lo, 4294901760
    s_mov_b32 vcc_hi, 0
    s_waitcnt lgkmcnt(1)
    v_cndmask_b32 v12, v12, v227, vcc
    v_exp_f32 v88, v88
    v_exp_f32 v89, v89
    buffer_load_dwordx4 v1, s[8:11], s58 offen offset:1024 lds
    v_exp_f32 v90, v90
    v_mfma_f32_16x16x32_bf16 v[208:211], a[104:107], v[80:83], v[208:211]
    v_exp_f32 v91, v91
    v_exp_f32 v92, v92
    v_mfma_f32_16x16x32_bf16 v[212:215], a[108:111], v[80:83], v[212:215]
    v_cvt_pk_bf16_f32 v88, v88, v89
    v_exp_f32 v93, v93
    v_mfma_f32_16x16x32_bf16 v[104:107], a[48:51], v[24:27], 0
    v_cvt_pk_bf16_f32 v89, v90, v91
    v_exp_f32 v94, v94
    v_mfma_f32_16x16x32_bf16 v[108:111], a[52:55], v[24:27], 0
    v_exp_f32 v95, v95
    v_cvt_pk_bf16_f32 v90, v92, v93
    v_cvt_pk_bf16_f32 v91, v94, v95
    v_exp_f32 v96, v96
    v_exp_f32 v97, v97
    buffer_load_dwordx4 v1, s[8:11], s58 offen offset:2048 lds
    v_exp_f32 v98, v98
    v_mfma_f32_16x16x32_bf16 v[208:211], a[112:115], v[88:91], v[208:211]
    v_exp_f32 v99, v99
    v_exp_f32 v100, v100
    v_mfma_f32_16x16x32_bf16 v[212:215], a[116:119], v[88:91], v[212:215]
    v_cvt_pk_bf16_f32 v96, v96, v97
    v_exp_f32 v101, v101
    v_mfma_f32_16x16x32_bf16 v[112:115], a[56:59], v[24:27], 0
    v_cvt_pk_bf16_f32 v97, v98, v99
    v_exp_f32 v102, v102
    v_mfma_f32_16x16x32_bf16 v[116:119], a[60:63], v[24:27], 0
    v_exp_f32 v103, v103
    v_cvt_pk_bf16_f32 v98, v100, v101
    v_cvt_pk_bf16_f32 v99, v102, v103
    v_exp_f32 v104, v104
    v_exp_f32 v105, v105
    buffer_load_dwordx4 v1, s[8:11], s58 offen offset:3072 lds
    s_add_u32 m0, m0, 16384
    s_add_u32 s58, s58, 16384
    v_exp_f32 v106, v106
    v_exp_f32 v107, v107
    v_mfma_f32_16x16x32_bf16 v[208:211], a[120:123], v[96:99], v[208:211]
    v_exp_f32 v108, v108
    v_mfma_f32_16x16x32_bf16 v[212:215], a[124:127], v[96:99], v[212:215]
    v_cvt_pk_bf16_f32 v104, v104, v105
    v_exp_f32 v109, v109
    v_cvt_pk_bf16_f32 v105, v106, v107
    v_mfma_f32_16x16x32_bf16 v[124:127], a[12:15], v[28:31], v[232:235]
    v_exp_f32 v110, v110
    v_exp_f32 v111, v111
    v_cvt_pk_bf16_f32 v106, v108, v109
    v_cvt_pk_bf16_f32 v107, v110, v111
    v_exp_f32 v112, v112
    v_exp_f32 v113, v113
    buffer_load_dwordx4 v1, s[8:11], s58 offen offset:0 lds
    v_exp_f32 v114, v114
    v_mfma_f32_16x16x32_bf16 v[208:211], a[128:131], v[104:107], v[208:211]
    v_exp_f32 v115, v115
    v_exp_f32 v116, v116
    v_mfma_f32_16x16x32_bf16 v[212:215], a[132:135], v[104:107], v[212:215]
    v_cvt_pk_bf16_f32 v112, v112, v113
    v_exp_f32 v117, v117
    v_mfma_f32_16x16x32_bf16 v[48:51], a[16:19], v[28:31], 0
    v_cvt_pk_bf16_f32 v113, v114, v115
    v_exp_f32 v118, v118
    v_mfma_f32_16x16x32_bf16 v[52:55], a[20:23], v[28:31], 0
    v_exp_f32 v119, v119
    v_cvt_pk_bf16_f32 v114, v116, v117
    v_cvt_pk_bf16_f32 v115, v118, v119
    v_exp_f32 v124, v124
    v_exp_f32 v125, v125
    buffer_load_dwordx4 v1, s[8:11], s58 offen offset:1024 lds
    v_mfma_f32_16x16x32_bf16 v[208:211], a[136:139], v[112:115], v[208:211]
    v_exp_f32 v126, v126
    v_mfma_f32_16x16x32_bf16 v[212:215], a[140:143], v[112:115], v[212:215]
    v_exp_f32 v127, v127
    v_mfma_f32_16x16x32_bf16 v[56:59], a[24:27], v[28:31], 0
    v_mov_b32 v120, 0
    v_mfma_f32_16x16x32_bf16 v[60:63], a[28:31], v[28:31], 0
    v_mov_b32 v121, 0
    v_cvt_pk_bf16_f32 v122, v124, v125
    v_cvt_pk_bf16_f32 v123, v126, v127
    v_exp_f32 v48, v48
    v_exp_f32 v49, v49
    buffer_load_dwordx4 v1, s[8:11], s58 offen offset:2048 lds
    v_exp_f32 v50, v50
    v_exp_f32 v51, v51
    v_exp_f32 v52, v52
    v_cvt_pk_bf16_f32 v48, v48, v49
    v_mfma_f32_16x16x32_bf16 v[216:219], a[88:91], v[120:123], v[216:219]
    v_exp_f32 v53, v53
    v_cvt_pk_bf16_f32 v49, v50, v51
    v_exp_f32 v54, v54
    v_exp_f32 v55, v55
    v_cvt_pk_bf16_f32 v50, v52, v53
    v_mfma_f32_16x16x32_bf16 v[220:223], a[92:95], v[120:123], v[220:223]
    v_cvt_pk_bf16_f32 v51, v54, v55
    v_mov_b32 v228, v215
    v_mov_b32 v226, v215
    v_cndmask_b32 v212, v212, v214, s[40:41]
    v_cndmask_b32 v213, v213, v215, s[40:41]
    v_permlane32_swap_b32 v226, v228
    v_mov_b32 v226, v228
    s_nop 1
    v_permlane16_swap_b32 v226, v228
    v_mfma_f32_16x16x32_bf16 v[64:67], a[32:35], v[28:31], 0
    v_rcp_f32 v226, v228
    v_med3_f32 v229, v228, v241, v242
    v_sub_f32 v229, v229, v228
    v_fma_f32 v229, v208, 0, v229
    v_fma_f32 v229, v209, 0, v229
    v_mfma_f32_16x16x32_bf16 v[68:71], a[36:39], v[28:31], 0
    v_fma_f32 v229, v210, 0, v229
    v_fma_f32 v229, v211, 0, v229
    v_fma_f32 v229, v212, 0, v229
    v_fma_f32 v229, v213, 0, v229
    v_cmp_neq_f32 vcc, 0, v229
    v_pk_mul_f32 v[208:209], v[208:209], v[226:227] op_sel_hi:[1,0]
    v_pk_mul_f32 v[210:211], v[210:211], v[226:227] op_sel_hi:[1,0]
    v_pk_mul_f32 v[212:213], v[212:213], v[226:227] op_sel_hi:[1,0]
    s_or_b64 s[64:65], s[64:65], vcc
    v_cvt_pk_bf16_f32 v214, v212, v213
    v_cvt_pk_bf16_f32 v208, v208, v209
    v_cvt_pk_bf16_f32 v209, v210, v211
    ds_bpermute_b32 v227, v243, v214
    ds_write_b64 v251, v[208:209] offset:2048
    v_exp_f32 v56, v56
    v_exp_f32 v57, v57
    buffer_load_dwordx4 v1, s[8:11], s58 offen offset:3072 lds
    s_add_u32 m0, m0, 16384
    s_add_u32 s58, s58, 16384
    v_exp_f32 v58, v58
    v_mfma_f32_16x16x32_bf16 v[216:219], a[96:99], v[48:51], v[216:219]
    v_exp_f32 v59, v59
    v_exp_f32 v60, v60
    v_mfma_f32_16x16x32_bf16 v[220:223], a[100:103], v[48:51], v[220:223]
    v_cvt_pk_bf16_f32 v56, v56, v57
    v_exp_f32 v61, v61
    v_cvt_pk_bf16_f32 v57, v58, v59
    v_mfma_f32_16x16x32_bf16 v[72:75], a[40:43], v[28:31], 0
    v_exp_f32 v62, v62
    v_exp_f32 v63, v63
    v_mfma_f32_16x16x32_bf16 v[76:79], a[44:47], v[28:31], 0
    v_cvt_pk_bf16_f32 v58, v60, v61
    v_cvt_pk_bf16_f32 v59, v62, v63
    s_mov_b32 vcc_lo, 0
    s_mov_b32 vcc_hi, 65535
    s_waitcnt lgkmcnt(1)
    v_cndmask_b32 v12, v12, v227, vcc
    v_exp_f32 v64, v64
    v_exp_f32 v65, v65
    buffer_load_dwordx4 v1, s[8:11], s58 offen offset:0 lds
    v_exp_f32 v66, v66
    v_mfma_f32_16x16x32_bf16 v[216:219], a[104:107], v[56:59], v[216:219]
    v_exp_f32 v67, v67
    v_exp_f32 v68, v68
    v_mfma_f32_16x16x32_bf16 v[220:223], a[108:111], v[56:59], v[220:223]
    v_cvt_pk_bf16_f32 v64, v64, v65
    v_exp_f32 v69, v69
    v_mfma_f32_16x16x32_bf16 v[80:83], a[48:51], v[28:31], 0
    v_cvt_pk_bf16_f32 v65, v66, v67
    v_exp_f32 v70, v70
    v_mfma_f32_16x16x32_bf16 v[84:87], a[52:55], v[28:31], 0
    v_exp_f32 v71, v71
    v_cvt_pk_bf16_f32 v66, v68, v69
    v_cvt_pk_bf16_f32 v67, v70, v71
    v_exp_f32 v72, v72
    v_exp_f32 v73, v73
    buffer_load_dwordx4 v1, s[8:11], s58 offen offset:1024 lds
    v_exp_f32 v74, v74
    v_mfma_f32_16x16x32_bf16 v[216:219], a[112:115], v[64:67], v[216:219]
    v_exp_f32 v75, v75
    v_exp_f32 v76, v76
    v_mfma_f32_16x16x32_bf16 v[220:223], a[116:119], v[64:67], v[220:223]
    v_cvt_pk_bf16_f32 v72, v72, v73
    v_exp_f32 v77, v77
    v_mfma_f32_16x16x32_bf16 v[88:91], a[56:59], v[28:31], 0
    v_cvt_pk_bf16_f32 v73, v74, v75
    v_exp_f32 v78, v78
    v_mfma_f32_16x16x32_bf16 v[92:95], a[60:63], v[28:31], 0
    v_exp_f32 v79, v79
    v_cvt_pk_bf16_f32 v74, v76, v77
    v_cvt_pk_bf16_f32 v75, v78, v79
    v_exp_f32 v80, v80
    v_exp_f32 v81, v81
    buffer_load_dwordx4 v1, s[8:11], s58 offen offset:2048 lds
    v_exp_f32 v82, v82
    v_exp_f32 v83, v83
    v_mfma_f32_16x16x32_bf16 v[216:219], a[120:123], v[72:75], v[216:219]
    v_exp_f32 v84, v84
    v_cvt_pk_bf16_f32 v80, v80, v81
    v_exp_f32 v85, v85
    v_mfma_f32_16x16x32_bf16 v[220:223], a[124:127], v[72:75], v[220:223]
    v_cvt_pk_bf16_f32 v81, v82, v83
    v_exp_f32 v86, v86
    v_exp_f32 v87, v87
    v_cvt_pk_bf16_f32 v82, v84, v85
    v_cvt_pk_bf16_f32 v83, v86, v87
    v_exp_f32 v88, v88
    v_exp_f32 v89, v89
    buffer_load_dwordx4 v1, s[8:11], s58 offen offset:3072 lds
    s_add_u32 m0, m0, 16384
    s_add_u32 s58, s58, 16384
    v_exp_f32 v90, v90
    v_exp_f32 v91, v91
    v_mfma_f32_16x16x32_bf16 v[216:219], a[128:131], v[80:83], v[216:219]
    v_exp_f32 v92, v92
    v_cvt_pk_bf16_f32 v88, v88, v89
    v_exp_f32 v93, v93
    v_mfma_f32_16x16x32_bf16 v[220:223], a[132:135], v[80:83], v[220:223]
    v_cvt_pk_bf16_f32 v89, v90, v91
    v_exp_f32 v94, v94
    v_exp_f32 v95, v95
    v_cvt_pk_bf16_f32 v90, v92, v93
    v_cvt_pk_bf16_f32 v91, v94, v95
    s_nop 1
    v_mfma_f32_16x16x32_bf16 v[216:219], a[136:139], v[88:91], v[216:219]
    v_mfma_f32_16x16x32_bf16 v[220:223], a[140:143], v[88:91], v[220:223]
    s_nop 7
    v_mov_b32 v228, v223
    v_mov_b32 v226, v223
    v_cndmask_b32 v220, v220, v222, s[40:41]
    v_cndmask_b32 v221, v221, v223, s[40:41]
    v_permlane32_swap_b32 v226, v228
    v_mov_b32 v226, v228
    s_nop 1
    v_permlane16_swap_b32 v226, v228
    v_rcp_f32 v226, v228
    v_med3_f32 v229, v228, v241, v242
    v_sub_f32 v229, v229, v228
    v_fma_f32 v229, v216, 0, v229
    v_fma_f32 v229, v217, 0, v229
    v_fma_f32 v229, v218, 0, v229
    v_fma_f32 v229, v219, 0, v229
    v_fma_f32 v229, v220, 0, v229
    v_fma_f32 v229, v221, 0, v229
    v_cmp_neq_f32 vcc, 0, v229
    v_pk_mul_f32 v[216:217], v[216:217], v[226:227] op_sel_hi:[1,0]
    v_pk_mul_f32 v[218:219], v[218:219], v[226:227] op_sel_hi:[1,0]
    v_pk_mul_f32 v[220:221], v[220:221], v[226:227] op_sel_hi:[1,0]
    s_or_b64 s[64:65], s[64:65], vcc
    v_cvt_pk_bf16_f32 v222, v220, v221
    v_cvt_pk_bf16_f32 v216, v216, v217
    v_cvt_pk_bf16_f32 v217, v218, v219
    ds_bpermute_b32 v227, v243, v222
    ds_write_b64 v251, v[216:217] offset:3072
    s_mov_b32 vcc_lo, 0
    s_mov_b32 vcc_hi, 4294901760
    s_waitcnt lgkmcnt(1)
    v_cndmask_b32 v12, v12, v227, vcc
    ds_write_b32 v240, v12
    s_cmp_eq_u64 s[64:65], 0
    s_cbranch_scc1 L_attn_done
    s_waitcnt lgkmcnt(0)
    s_branch L_attn_er0
L_attn_f4:
    v_mfma_f32_16x16x32_bf16 v[48:51], a[64:67], v[16:19], v[236:239]
    v_mfma_f32_16x16x32_bf16 v[56:59], a[64:67], v[20:23], 0
    v_mfma_f32_16x16x32_bf16 v[60:63], a[68:71], v[20:23], v[236:239]
    v_mfma_f32_16x16x32_bf16 v[64:67], a[64:67], v[24:27], 0
    v_mfma_f32_16x16x32_bf16 v[68:71], a[68:71], v[24:27], 0
    v_mfma_f32_16x16x32_bf16 v[72:75], a[72:75], v[24:27], v[236:239]
    v_mfma_f32_16x16x32_bf16 v[80:83], a[64:67], v[28:31], 0
    v_mfma_f32_16x16x32_bf16 v[84:87], a[68:71], v[28:31], 0
    v_mfma_f32_16x16x32_bf16 v[88:91], a[72:75], v[28:31], 0
    v_mfma_f32_16x16x32_bf16 v[92:95], a[76:79], v[28:31], v[236:239]
    s_nop 2
    v_exp_f32 v48, v48
    v_exp_f32 v49, v49
    v_exp_f32 v50, v50
    v_exp_f32 v51, v51
    v_cvt_pk_bf16_f32 v48, v48, v49
    v_cvt_pk_bf16_f32 v49, v50, v51
    v_mov_b32 v50, 0
    v_mov_b32 v51, 0
    v_exp_f32 v56, v56
    v_exp_f32 v57, v57
    v_mfma_f32_16x16x32_bf16 v[192:195], a[144:147], v[48:51], 0
    v_exp_f32 v58, v58
    v_exp_f32 v59, v59
    v_exp_f32 v60, v60
    v_mfma_f32_16x16x32_bf16 v[196:199], a[148:151], v[48:51], 0
    v_cvt_pk_bf16_f32 v56, v56, v57
    v_exp_f32 v61, v61
    v_cvt_pk_bf16_f32 v57, v58, v59
    v_exp_f32 v62, v62
    v_exp_f32 v63, v63
    v_cvt_pk_bf16_f32 v58, v60, v61
    v_cvt_pk_bf16_f32 v59, v62, v63
    v_exp_f32 v64, v64
    v_exp_f32 v65, v65
    v_mfma_f32_16x16x32_bf16 v[200:203], a[144:147], v[56:59], 0
    v_exp_f32 v66, v66
    v_exp_f32 v67, v67
    v_exp_f32 v68, v68
    v_mfma_f32_16x16x32_bf16 v[204:207], a[148:151], v[56:59], 0
    v_cvt_pk_bf16_f32 v64, v64, v65
    v_exp_f32 v69, v69
    v_cvt_pk_bf16_f32 v65, v66, v67
    v_exp_f32 v70, v70
    v_exp_f32 v71, v71
    v_cvt_pk_bf16_f32 v66, v68, v69
    v_cvt_pk_bf16_f32 v67, v70, v71
    v_exp_f32 v72, v72
    v_exp_f32 v73, v73
    v_mfma_f32_16x16x32_bf16 v[208:211], a[144:147], v[64:67], 0
    v_exp_f32 v74, v74
    v_exp_f32 v75, v75
    v_mfma_f32_16x16x32_bf16 v[212:215], a[148:151], v[64:67], 0
    v_cvt_pk_bf16_f32 v72, v72, v73
    v_cvt_pk_bf16_f32 v73, v74, v75
    v_mov_b32 v74, 0
    v_mov_b32 v75, 0
    v_exp_f32 v80, v80
    v_exp_f32 v81, v81
    s_cmp_eq_u32 s67, 0
    s_cbranch_scc1 2
    s_waitcnt vmcnt(24)
    s_branch 1
    s_waitcnt vmcnt(0)
    s_barrier
    ds_read_b64 a[16:17], v244 offset:2048
    v_exp_f32 v82, v82
    ds_read_b64 a[18:19], v245 offset:2048
    ds_read_b64 a[20:21], v244 offset:2056
    v_exp_f32 v83, v83
    ds_read_b64 a[22:23], v245 offset:2056
    ds_read_b64 a[24:25], v244 offset:3072
    ds_read_b64 a[26:27], v245 offset:3072
    v_exp_f32 v84, v84
    v_mfma_f32_16x16x32_bf16 v[208:211], a[152:155], v[72:75], v[208:211]
    ds_read_b64 a[28:29], v244 offset:3080
    v_cvt_pk_bf16_f32 v80, v80, v81
    ds_read_b64 a[30:31], v245 offset:3080
    v_exp_f32 v85, v85
    ds_read_b64 a[32:33], v244 offset:4096
    ds_read_b64 a[34:35], v245 offset:4096
    v_cvt_pk_bf16_f32 v81, v82, v83
    ds_read_b64 a[36:37], v244 offset:4104
    v_exp_f32 v86, v86
    ds_read_b64 a[38:39], v245 offset:4104
    ds_read_b64 a[40:41], v244 offset:5120
    v_exp_f32 v87, v87
    v_mfma_f32_16x16x32_bf16 v[212:215], a[156:159], v[72:75], v[212:215]
    v_cvt_pk_bf16_f32 v82, v84, v85
    v_cvt_pk_bf16_f32 v83, v86, v87
    v_exp_f32 v88, v88
    v_exp_f32 v89, v89
    ds_read_b64 a[42:43], v245 offset:5120
    ds_read_b64 a[44:45], v244 offset:5128
    ds_read_b64 a[46:47], v245 offset:5128
    v_exp_f32 v90, v90
    v_mfma_f32_16x16x32_bf16 v[216:219], a[144:147], v[80:83], 0
    ds_read_b64 a[48:49], v244 offset:6144
    v_exp_f32 v91, v91
    ds_read_b64 a[50:51], v245 offset:6144
    ds_read_b64 a[52:53], v244 offset:6152
    v_mfma_f32_16x16x32_bf16 v[220:223], a[148:151], v[80:83], 0
    v_exp_f32 v92, v92
    ds_read_b64 a[54:55], v245 offset:6152
    ds_read_b64 a[56:57], v244 offset:7168
    s_waitcnt lgkmcnt(15)
    v_mfma_f32_16x16x32_bf16 v[96:99], a[16:19], v[16:19], 0
    v_cvt_pk_bf16_f32 v88, v88, v89
    ds_read_b64 a[58:59], v245 offset:7168
    v_exp_f32 v93, v93
    ds_read_b64 a[60:61], v244 offset:7176
    v_mfma_f32_16x16x32_bf16 v[100:103], a[20:23], v[16:19], 0
    ds_read_b64 a[62:63], v245 offset:7176
    v_cvt_pk_bf16_f32 v89, v90, v91
    ds_read_b64_tr_b16 a[96:97], v246 offset:2048
    v_exp_f32 v94, v94
    v_mfma_f32_16x16x32_bf16 v[104:107], a[24:27], v[16:19], 0
    ds_read_b64_tr_b16 a[98:99], v246 offset:2056
    ds_read_b64_tr_b16 a[100:101], v247 offset:2048
    v_exp_f32 v95, v95
    s_waitcnt lgkmcnt(15)
    v_mfma_f32_16x16x32_bf16 v[108:111], a[28:31], v[16:19], 0
    v_cvt_pk_bf16_f32 v90, v92, v93
    v_cvt_pk_bf16_f32 v91, v94, v95
    v_exp_f32 v96, v96
    v_exp_f32 v97, v97
    ds_read_b64_tr_b16 a[102:103], v247 offset:2056
    ds_read_b64_tr_b16 a[104:105], v246 offset:3072
    ds_read_b64_tr_b16 a[106:107], v246 offset:3080
    v_exp_f32 v98, v98
    ds_read_b64_tr_b16 a[108:109], v247 offset:3072
    v_mfma_f32_16x16x32_bf16 v[216:219], a[152:155], v[88:91], v[216:219]
    v_exp_f32 v99, v99
    ds_read_b64_tr_b16 a[110:111], v247 offset:3080
    ds_read_b64_tr_b16 a[112:113], v246 offset:4096
    v_exp_f32 v100, v100
    ds_read_b64_tr_b16 a[114:115], v246 offset:4104
    ds_read_b64_tr_b16 a[116:117], v247 offset:4096
    v_mfma_f32_16x16x32_bf16 v[220:223], a[156:159], v[88:91], v[220:223]
    v_cvt_pk_bf16_f32 v96, v96, v97
    ds_read_b64_tr_b16 a[118:119], v247 offset:4104
    v_exp_f32 v101, v101
    ds_read_b64_tr_b16 a[120:121], v246 offset:5120
    ds_read_b64_tr_b16 a[122:123], v246 offset:5128
    v_cvt_pk_bf16_f32 v97, v98, v99
    v_mfma_f32_16x16x32_bf16 v[112:115], a[32:35], v[16:19], 0
    ds_read_b64_tr_b16 a[124:125], v247 offset:5120
    v_exp_f32 v102, v102
    ds_read_b64_tr_b16 a[126:127], v247 offset:5128
    ds_read_b64_tr_b16 a[128:129], v246 offset:6144
    v_exp_f32 v103, v103
    v_mfma_f32_16x16x32_bf16 v[116:119], a[36:39], v[16:19], 0
    v_cvt_pk_bf16_f32 v98, v100, v101
    v_cvt_pk_bf16_f32 v99, v102, v103
    v_exp_f32 v104, v104
    v_exp_f32 v105, v105
    ds_read_b64_tr_b16 a[130:131], v246 offset:6152
    ds_read_b64_tr_b16 a[132:133], v247 offset:6144
    v_exp_f32 v106, v106
    s_waitcnt lgkmcnt(15)
    v_mfma_f32_16x16x32_bf16 v[192:195], a[96:99], v[96:99], v[192:195]
    v_exp_f32 v107, v107
    ds_read_b64_tr_b16 a[134:135], v247 offset:6152
    ds_read_b64_tr_b16 a[136:137], v246 offset:7168
    v_exp_f32 v108, v108
    v_mfma_f32_16x16x32_bf16 v[196:199], a[100:103], v[96:99], v[196:199]
    v_cvt_pk_bf16_f32 v104, v104, v105
    ds_read_b64_tr_b16 a[138:139], v246 offset:7176
    v_exp_f32 v109, v109
    ds_read_b64_tr_b16 a[140:141], v247 offset:7168
    v_cvt_pk_bf16_f32 v105, v106, v107
    v_mfma_f32_16x16x32_bf16 v[120:123], a[40:43], v[16:19], 0
    v_exp_f32 v110, v110
    ds_read_b64_tr_b16 a[142:143], v247 offset:7176
    v_mfma_f32_16x16x32_bf16 v[124:127], a[44:47], v[16:19], 0
    v_exp_f32 v111, v111
    v_cvt_pk_bf16_f32 v106, v108, v109
    v_cvt_pk_bf16_f32 v107, v110, v111
    v_exp_f32 v112, v112
    v_exp_f32 v113, v113
    s_waitcnt lgkmcnt(0)
    s_mov_b32 m0, s59
    s_waitcnt vmcnt(0)
    s_barrier
    v_mov_b32 v254, s100
    v_mov_b32 v255, s101
    s_mov_b32 s30, 159072863
    s_mul_hi_u32 s27, s2, s30
    s_mul_i32 s27, s27, 5
    s_add_u32 s27, s27, s2
    s_lshl_b32 s27, s27, 3
    s_add_u32 s27, s27, 63885312
    s_cmp_lt_u32 s2, 216
    s_cselect_b32 s27, s27, 1073741824
    s_cmp_eq_u32 s20, 0
    s_cselect_b32 s27, s27, 1073741824
    buffer_store_dwordx2 v[254:255], v13, s[8:11], s27 offen sc1
    v_exp_f32 v114, v114
    v_mfma_f32_16x16x32_bf16 v[192:195], a[104:107], v[104:107], v[192:195]
    v_exp_f32 v115, v115
    s_cmp_eq_u32 s67, 0
    s_cbranch_scc1 L_pk_f4_0
    buffer_load_dwordx4 a[208:211], v10, s[60:63], s72 offen nt
    buffer_load_dwordx4 a[212:215], v11, s[60:63], s72 offen nt
    buffer_load_dwordx4 a[216:219], v10, s[60:63], s73 offen nt
    buffer_load_dwordx4 a[220:223], v11, s[60:63], s73 offen nt
L_pk_f4_0:
    v_exp_f32 v116, v116
    v_mfma_f32_16x16x32_bf16 v[196:199], a[108:111], v[104:107], v[196:199]
    v_cvt_pk_bf16_f32 v112, v112, v113
    v_exp_f32 v117, v117
    v_mfma_f32_16x16x32_bf16 v[48:51], a[48:51], v[16:19], 0
    v_cvt_pk_bf16_f32 v113, v114, v115
    v_exp_f32 v118, v118
    v_mfma_f32_16x16x32_bf16 v[52:55], a[52:55], v[16:19], 0
    v_exp_f32 v119, v119
    v_cvt_pk_bf16_f32 v114, v116, v117
    v_cvt_pk_bf16_f32 v115, v118, v119
    v_exp_f32 v120, v120
    v_exp_f32 v121, v121
    s_cmp_eq_u32 s67, 0
    s_cbranch_scc1 L_pk_f4_1
    buffer_load_dwordx4 a[224:227], v10, s[60:63], s74 offen nt
    buffer_load_dwordx4 a[228:231], v11, s[60:63], s74 offen nt
    buffer_load_dwordx4 a[232:235], v10, s[60:63], s75 offen nt
    buffer_load_dwordx4 a[236:239], v11, s[60:63], s75 offen nt
L_pk_f4_1:
    v_exp_f32 v122, v122
    v_mfma_f32_16x16x32_bf16 v[192:195], a[112:115], v[112:115], v[192:195]
    v_exp_f32 v123, v123
    s_cmp_eq_u32 s67, 0
    s_cbranch_scc1 L_pk_f4_2
    buffer_load_dwordx4 a[240:243], v10, s[60:63], s76 offen nt
    buffer_load_dwordx4 a[244:247], v11, s[60:63], s76 offen nt
    buffer_load_dwordx4 a[248:251], v10, s[60:63], s77 offen nt
    buffer_load_dwordx4 a[252:255], v11, s[60:63], s77 offen nt
L_pk_f4_2:
    v_exp_f32 v124, v124
    v_mfma_f32_16x16x32_bf16 v[196:199], a[116:119], v[112:115], v[196:199]
    v_cvt_pk_bf16_f32 v120, v120, v121
    v_exp_f32 v125, v125
    v_mfma_f32_16x16x32_bf16 v[56:59], a[56:59], v[16:19], 0
    v_cvt_pk_bf16_f32 v121, v122, v123
    v_exp_f32 v126, v126
    v_mfma_f32_16x16x32_bf16 v[60:63], a[60:63], v[16:19], 0
    v_exp_f32 v127, v127
    v_cvt_pk_bf16_f32 v122, v124, v125
    v_cvt_pk_bf16_f32 v123, v126, v127
    v_exp_f32 v48, v48
    v_exp_f32 v49, v49
    buffer_load_dwordx4 v1, s[8:11], s58 offen offset:0 lds
    v_exp_f32 v50, v50
    v_mfma_f32_16x16x32_bf16 v[192:195], a[120:123], v[120:123], v[192:195]
    v_exp_f32 v51, v51
    buffer_load_dwordx4 v1, s[8:11], s58 offen offset:1024 lds
    v_exp_f32 v52, v52
    v_mfma_f32_16x16x32_bf16 v[196:199], a[124:127], v[120:123], v[196:199]
    v_cvt_pk_bf16_f32 v48, v48, v49
    v_exp_f32 v53, v53
    v_mfma_f32_16x16x32_bf16 v[64:67], a[16:19], v[20:23], 0
    v_cvt_pk_bf16_f32 v49, v50, v51
    v_exp_f32 v54, v54
    v_mfma_f32_16x16x32_bf16 v[68:71], a[20:23], v[20:23], 0
    v_exp_f32 v55, v55
    v_cvt_pk_bf16_f32 v50, v52, v53
    v_cvt_pk_bf16_f32 v51, v54, v55
    v_exp_f32 v56, v56
    v_exp_f32 v57, v57
    buffer_load_dwordx4 v1, s[8:11], s58 offen offset:2048 lds
    v_exp_f32 v58, v58
    v_mfma_f32_16x16x32_bf16 v[192:195], a[128:131], v[48:51], v[192:195]
    v_exp_f32 v59, v59
    buffer_load_dwordx4 v1, s[8:11], s58 offen offset:3072 lds
    s_add_u32 m0, m0, 16384
    s_add_u32 s58, s58, 16384
    v_exp_f32 v60, v60
    v_mfma_f32_16x16x32_bf16 v[196:199], a[132:135], v[48:51], v[196:199]
    v_cvt_pk_bf16_f32 v56, v56, v57
    v_exp_f32 v61, v61
    v_mfma_f32_16x16x32_bf16 v[72:75], a[24:27], v[20:23], 0
    v_cvt_pk_bf16_f32 v57, v58, v59
    v_exp_f32 v62, v62
    v_mfma_f32_16x16x32_bf16 v[76:79], a[28:31], v[20:23], 0
    v_exp_f32 v63, v63
    v_cvt_pk_bf16_f32 v58, v60, v61
    v_cvt_pk_bf16_f32 v59, v62, v63
    v_exp_f32 v64, v64
    v_exp_f32 v65, v65
    buffer_load_dwordx4 v1, s[8:11], s58 offen offset:0 lds
    v_exp_f32 v66, v66
    v_mfma_f32_16x16x32_bf16 v[192:195], a[136:139], v[56:59], v[192:195]
    v_exp_f32 v67, v67
    buffer_load_dwordx4 v1, s[8:11], s58 offen offset:1024 lds
    v_exp_f32 v68, v68
    v_mfma_f32_16x16x32_bf16 v[196:199], a[140:143], v[56:59], v[196:199]
    v_cvt_pk_bf16_f32 v64, v64, v65
    v_exp_f32 v69, v69
    v_mfma_f32_16x16x32_bf16 v[80:83], a[32:35], v[20:23], 0
    v_cvt_pk_bf16_f32 v65, v66, v67
    v_exp_f32 v70, v70
    v_mfma_f32_16x16x32_bf16 v[84:87], a[36:39], v[20:23], 0
    v_exp_f32 v71, v71
    v_cvt_pk_bf16_f32 v66, v68, v69
    v_cvt_pk_bf16_f32 v67, v70, v71
    v_exp_f32 v72, v72
    v_exp_f32 v73, v73
    buffer_load_dwordx4 v1, s[8:11], s58 offen offset:2048 lds
    v_exp_f32 v74, v74
    v_exp_f32 v75, v75
    v_exp_f32 v76, v76
    v_mfma_f32_16x16x32_bf16 v[200:203], a[96:99], v[64:67], v[200:203]
    v_cvt_pk_bf16_f32 v72, v72, v73
    v_exp_f32 v77, v77
    v_cvt_pk_bf16_f32 v73, v74, v75
    v_exp_f32 v78, v78
    buffer_load_dwordx4 v1, s[8:11], s58 offen offset:3072 lds
    s_add_u32 m0, m0, 16384
    s_add_u32 s58, s58, 16384
    v_exp_f32 v79, v79
    v_cvt_pk_bf16_f32 v74, v76, v77
    v_cvt_pk_bf16_f32 v75, v78, v79
    v_mov_b32 v228, v199
    v_mov_b32 v226, v199
    v_cndmask_b32 v196, v196, v198, s[40:41]
    v_mfma_f32_16x16x32_bf16 v[204:207], a[100:103], v[64:67], v[204:207]
    v_cndmask_b32 v197, v197, v199, s[40:41]
    v_permlane32_swap_b32 v226, v228
    v_mov_b32 v226, v228
    s_nop 1
    v_permlane16_swap_b32 v226, v228
    v_mfma_f32_16x16x32_bf16 v[88:91], a[40:43], v[20:23], 0
    v_rcp_f32 v226, v228
    v_med3_f32 v229, v228, v241, v242
    v_sub_f32 v229, v229, v228
    v_fma_f32 v229, v192, 0, v229
    v_fma_f32 v229, v193, 0, v229
    v_fma_f32 v229, v194, 0, v229
    v_mfma_f32_16x16x32_bf16 v[92:95], a[44:47], v[20:23], 0
    v_fma_f32 v229, v195, 0, v229
    v_fma_f32 v229, v196, 0, v229
    v_fma_f32 v229, v197, 0, v229
    v_cmp_neq_f32 vcc, 0, v229
    v_pk_mul_f32 v[192:193], v[192:193], v[226:227] op_sel_hi:[1,0]
    v_pk_mul_f32 v[194:195], v[194:195], v[226:227] op_sel_hi:[1,0]
    v_pk_mul_f32 v[196:197], v[196:197], v[226:227] op_sel_hi:[1,0]
    s_or_b64 s[64:65], s[64:65], vcc
    v_cvt_pk_bf16_f32 v198, v196, v197
    v_cvt_pk_bf16_f32 v192, v192, v193
    v_cvt_pk_bf16_f32 v193, v194, v195
    ds_bpermute_b32 v227, v243, v198
    ds_write_b64 v251, v[192:193] offset:0
    v_exp_f32 v80, v80
    v_exp_f32 v81, v81
    buffer_load_dwordx4 v1, s[8:11], s58 offen offset:0 lds
    v_exp_f32 v82, v82
    v_mfma_f32_16x16x32_bf16 v[200:203], a[104:107], v[72:75], v[200:203]
    v_exp_f32 v83, v83
    v_exp_f32 v84, v84
    v_mfma_f32_16x16x32_bf16 v[204:207], a[108:111], v[72:75], v[204:207]
    v_cvt_pk_bf16_f32 v80, v80, v81
    v_exp_f32 v85, v85
    v_cvt_pk_bf16_f32 v81, v82, v83
    v_mfma_f32_16x16x32_bf16 v[96:99], a[48:51], v[20:23], 0
    v_exp_f32 v86, v86
    v_exp_f32 v87, v87
    v_mfma_f32_16x16x32_bf16 v[100:103], a[52:55], v[20:23], 0
    v_cvt_pk_bf16_f32 v82, v84, v85
    v_cvt_pk_bf16_f32 v83, v86, v87
    s_mov_b32 vcc_lo, 65535
    s_mov_b32 vcc_hi, 0
    s_waitcnt lgkmcnt(1)
    v_cndmask_b32 v12, v12, v227, vcc
    v_exp_f32 v88, v88
    v_exp_f32 v89, v89
    buffer_load_dwordx4 v1, s[8:11], s58 offen offset:1024 lds
    v_exp_f32 v90, v90
    v_mfma_f32_16x16x32_bf16 v[200:203], a[112:115], v[80:83], v[200:203]
    v_exp_f32 v91, v91
    v_exp_f32 v92, v92
    v_mfma_f32_16x16x32_bf16 v[204:207], a[116:119], v[80:83], v[204:207]
    v_cvt_pk_bf16_f32 v88, v88, v89
    v_exp_f32 v93, v93
    v_mfma_f32_16x16x32_bf16 v[104:107], a[56:59], v[20:23], 0
    v_cvt_pk_bf16_f32 v89, v90, v91
    v_exp_f32 v94, v94
    v_mfma_f32_16x16x32_bf16 v[108:111], a[60:63], v[20:23], 0
    v_exp_f32 v95, v95
    v_cvt_pk_bf16_f32 v90, v92, v93
    v_cvt_pk_bf16_f32 v91, v94, v95
    v_exp_f32 v96, v96
    v_exp_f32 v97, v97
    buffer_load_dwordx4 v1, s[8:11], s58 offen offset:2048 lds
    v_exp_f32 v98, v98
    v_mfma_f32_16x16x32_bf16 v[200:203], a[120:123], v[88:91], v[200:203]
    v_exp_f32 v99, v99
    v_exp_f32 v100, v100
    v_mfma_f32_16x16x32_bf16 v[204:207], a[124:127], v[88:91], v[204:207]
    v_cvt_pk_bf16_f32 v96, v96, v97
    v_exp_f32 v101, v101
    v_mfma_f32_16x16x32_bf16 v[112:115], a[16:19], v[24:27], 0
    v_cvt_pk_bf16_f32 v97, v98, v99
    v_exp_f32 v102, v102
    v_mfma_f32_16x16x32_bf16 v[116:119], a[20:23], v[24:27], 0
    v_exp_f32 v103, v103
    v_cvt_pk_bf16_f32 v98, v100, v101
    v_cvt_pk_bf16_f32 v99, v102, v103
    v_exp_f32 v104, v104
    v_exp_f32 v105, v105
    buffer_load_dwordx4 v1, s[8:11], s58 offen offset:3072 lds
    s_add_u32 m0, m0, 16384
    s_add_u32 s58, s58, 16384
    v_exp_f32 v106, v106
    v_mfma_f32_16x16x32_bf16 v[200:203], a[128:131], v[96:99], v[200:203]
    v_exp_f32 v107, v107
    v_exp_f32 v108, v108
    v_mfma_f32_16x16x32_bf16 v[204:207], a[132:135], v[96:99], v[204:207]
    v_cvt_pk_bf16_f32 v104, v104, v105
    v_exp_f32 v109, v109
    v_mfma_f32_16x16x32_bf16 v[120:123], a[24:27], v[24:27], 0
    v_cvt_pk_bf16_f32 v105, v106, v107
    v_exp_f32 v110, v110
    v_mfma_f32_16x16x32_bf16 v[124:127], a[28:31], v[24:27], 0
    v_exp_f32 v111, v111
    v_cvt_pk_bf16_f32 v106, v108, v109
    v_cvt_pk_bf16_f32 v107, v110, v111
    v_exp_f32 v112, v112
    v_exp_f32 v113, v113
    buffer_load_dwordx4 v1, s[8:11], s58 offen offset:0 lds
    v_exp_f32 v114, v114
    v_mfma_f32_16x16x32_bf16 v[200:203], a[136:139], v[104:107], v[200:203]
    v_exp_f32 v115, v115
    v_exp_f32 v116, v116
    v_mfma_f32_16x16x32_bf16 v[204:207], a[140:143], v[104:107], v[204:207]
    v_cvt_pk_bf16_f32 v112, v112, v113
    v_exp_f32 v117, v117
    v_mfma_f32_16x16x32_bf16 v[48:51], a[32:35], v[24:27], 0
    v_cvt_pk_bf16_f32 v113, v114, v115
    v_exp_f32 v118, v118
    v_mfma_f32_16x16x32_bf16 v[52:55], a[36:39], v[24:27], 0
    v_exp_f32 v119, v119
    v_cvt_pk_bf16_f32 v114, v116, v117
    v_cvt_pk_bf16_f32 v115, v118, v119
    v_exp_f32 v120, v120
    v_exp_f32 v121, v121
    buffer_load_dwordx4 v1, s[8:11], s58 offen offset:1024 lds
    v_exp_f32 v122, v122
    v_exp_f32 v123, v123
    v_exp_f32 v124, v124
    v_cvt_pk_bf16_f32 v120, v120, v121
    v_mfma_f32_16x16x32_bf16 v[208:211], a[96:99], v[112:115], v[208:211]
    v_exp_f32 v125, v125
    v_cvt_pk_bf16_f32 v121, v122, v123
    v_exp_f32 v126, v126
    v_exp_f32 v127, v127
    v_cvt_pk_bf16_f32 v122, v124, v125
    v_mfma_f32_16x16x32_bf16 v[212:215], a[100:103], v[112:115], v[212:215]
    v_cvt_pk_bf16_f32 v123, v126, v127
    v_mov_b32 v228, v207
    v_mov_b32 v226, v207
    v_cndmask_b32 v204, v204, v206, s[40:41]
    v_cndmask_b32 v205, v205, v207, s[40:41]
    v_permlane32_swap_b32 v226, v228
    v_mov_b32 v226, v228
    s_nop 1
    v_permlane16_swap_b32 v226, v228
    v_mfma_f32_16x16x32_bf16 v[56:59], a[40:43], v[24:27], 0
    v_rcp_f32 v226, v228
    v_med3_f32 v229, v228, v241, v242
    v_sub_f32 v229, v229, v228
    v_fma_f32 v229, v200, 0, v229
    v_fma_f32 v229, v201, 0, v229
    v_mfma_f32_16x16x32_bf16 v[60:63], a[44:47], v[24:27], 0
    v_fma_f32 v229, v202, 0, v229
    v_fma_f32 v229, v203, 0, v229
    v_fma_f32 v229, v204, 0, v229
    v_fma_f32 v229, v205, 0, v229
    v_cmp_neq_f32 vcc, 0, v229
    v_pk_mul_f32 v[200:201], v[200:201], v[226:227] op_sel_hi:[1,0]
    v_pk_mul_f32 v[202:203], v[202:203], v[226:227] op_sel_hi:[1,0]
    v_pk_mul_f32 v[204:205], v[204:205], v[226:227] op_sel_hi:[1,0]
    s_or_b64 s[64:65], s[64:65], vcc
    v_cvt_pk_bf16_f32 v206, v204, v205
    v_cvt_pk_bf16_f32 v200, v200, v201
    v_cvt_pk_bf16_f32 v201, v202, v203
    ds_bpermute_b32 v227, v243, v206
    ds_write_b64 v251, v[200:201] offset:1024
    v_exp_f32 v48, v48
    v_exp_f32 v49, v49
    buffer_load_dwordx4 v1, s[8:11], s58 offen offset:2048 lds
    v_exp_f32 v50, v50
    v_mfma_f32_16x16x32_bf16 v[208:211], a[104:107], v[120:123], v[208:211]
    v_exp_f32 v51, v51
    v_exp_f32 v52, v52
    v_mfma_f32_16x16x32_bf16 v[212:215], a[108:111], v[120:123], v[212:215]
    v_cvt_pk_bf16_f32 v48, v48, v49
    v_exp_f32 v53, v53
    v_cvt_pk_bf16_f32 v49, v50, v51
    v_mfma_f32_16x16x32_bf16 v[64:67], a[48:51], v[24:27], 0
    v_exp_f32 v54, v54
    v_exp_f32 v55, v55
    v_mfma_f32_16x16x32_bf16 v[68:71], a[52:55], v[24:27], 0
    v_cvt_pk_bf16_f32 v50, v52, v53
    v_cvt_pk_bf16_f32 v51, v54, v55
    s_mov_b32 vcc_lo, 4294901760
    s_mov_b32 vcc_hi, 0
    s_waitcnt lgkmcnt(1)
    v_cndmask_b32 v12, v12, v227, vcc
    v_exp_f32 v56, v56
    v_exp_f32 v57, v57
    buffer_load_dwordx4 v1, s[8:11], s58 offen offset:3072 lds
    s_add_u32 m0, m0, 16384
    s_add_u32 s58, s58, 16384
    v_exp_f32 v58, v58
    v_mfma_f32_16x16x32_bf16 v[208:211], a[112:115], v[48:51], v[208:211]
    v_exp_f32 v59, v59
    v_exp_f32 v60, v60
    v_mfma_f32_16x16x32_bf16 v[212:215], a[116:119], v[48:51], v[212:215]
    v_cvt_pk_bf16_f32 v56, v56, v57
    v_exp_f32 v61, v61
    v_mfma_f32_16x16x32_bf16 v[72:75], a[56:59], v[24:27], 0
    v_cvt_pk_bf16_f32 v57, v58, v59
    v_exp_f32 v62, v62
    v_mfma_f32_16x16x32_bf16 v[76:79], a[60:63], v[24:27], 0
    v_exp_f32 v63, v63
    v_cvt_pk_bf16_f32 v58, v60, v61
    v_cvt_pk_bf16_f32 v59, v62, v63
    v_exp_f32 v64, v64
    v_exp_f32 v65, v65
    buffer_load_dwordx4 v1, s[8:11], s58 offen offset:0 lds
    v_exp_f32 v66, v66
    v_mfma_f32_16x16x32_bf16 v[208:211], a[120:123], v[56:59], v[208:211]
    v_exp_f32 v67, v67
    v_exp_f32 v68, v68
    v_mfma_f32_16x16x32_bf16 v[212:215], a[124:127], v[56:59], v[212:215]
    v_cvt_pk_bf16_f32 v64, v64, v65
    v_exp_f32 v69, v69
    v_mfma_f32_16x16x32_bf16 v[80:83], a[16:19], v[28:31], 0
    v_cvt_pk_bf16_f32 v65, v66, v67
    v_exp_f32 v70, v70
    v_mfma_f32_16x16x32_bf16 v[84:87], a[20:23], v[28:31], 0
    v_exp_f32 v71, v71
    v_cvt_pk_bf16_f32 v66, v68, v69
    v_cvt_pk_bf16_f32 v67, v70, v71
    v_exp_f32 v72, v72
    v_exp_f32 v73, v73
    buffer_load_dwordx4 v1, s[8:11], s58 offen offset:1024 lds
    v_exp_f32 v74, v74
    v_mfma_f32_16x16x32_bf16 v[208:211], a[128:131], v[64:67], v[208:211]
    v_exp_f32 v75, v75
    v_exp_f32 v76, v76
    v_mfma_f32_16x16x32_bf16 v[212:215], a[132:135], v[64:67], v[212:215]
    v_cvt_pk_bf16_f32 v72, v72, v73
    v_exp_f32 v77, v77
    v_mfma_f32_16x16x32_bf16 v[88:91], a[24:27], v[28:31], 0
    v_cvt_pk_bf16_f32 v73, v74, v75
    v_exp_f32 v78, v78
    v_mfma_f32_16x16x32_bf16 v[92:95], a[28:31], v[28:31], 0
    v_exp_f32 v79, v79
    v_cvt_pk_bf16_f32 v74, v76, v77
    v_cvt_pk_bf16_f32 v75, v78, v79
    v_exp_f32 v80, v80
    v_exp_f32 v81, v81
    buffer_load_dwordx4 v1, s[8:11], s58 offen offset:2048 lds
    v_exp_f32 v82, v82
    v_mfma_f32_16x16x32_bf16 v[208:211], a[136:139], v[72:75], v[208:211]
    v_exp_f32 v83, v83
    v_exp_f32 v84, v84
    v_mfma_f32_16x16x32_bf16 v[212:215], a[140:143], v[72:75], v[212:215]
    v_cvt_pk_bf16_f32 v80, v80, v81
    v_exp_f32 v85, v85
    v_mfma_f32_16x16x32_bf16 v[96:99], a[32:35], v[28:31], 0
    v_cvt_pk_bf16_f32 v81, v82, v83
    v_exp_f32 v86, v86
    v_mfma_f32_16x16x32_bf16 v[100:103], a[36:39], v[28:31], 0
    v_exp_f32 v87, v87
    v_cvt_pk_bf16_f32 v82, v84, v85
    v_cvt_pk_bf16_f32 v83, v86, v87
    v_exp_f32 v88, v88
    v_exp_f32 v89, v89
    buffer_load_dwordx4 v1, s[8:11], s58 offen offset:3072 lds
    s_add_u32 m0, m0, 16384
    s_add_u32 s58, s58, 16384
    v_exp_f32 v90, v90
    v_exp_f32 v91, v91
    v_exp_f32 v92, v92
    v_cvt_pk_bf16_f32 v88, v88, v89
    v_mfma_f32_16x16x32_bf16 v[216:219], a[96:99], v[80:83], v[216:219]
    v_exp_f32 v93, v93
    v_cvt_pk_bf16_f32 v89, v90, v91
    v_exp_f32 v94, v94
    v_exp_f32 v95, v95
    v_cvt_pk_bf16_f32 v90, v92, v93
    v_mfma_f32_16x16x32_bf16 v[220:223], a[100:103], v[80:83], v[220:223]
    v_cvt_pk_bf16_f32 v91, v94, v95
    v_mov_b32 v228, v215
    v_mov_b32 v226, v215
    v_cndmask_b32 v212, v212, v214, s[40:41]
    v_cndmask_b32 v213, v213, v215, s[40:41]
    v_permlane32_swap_b32 v226, v228
    v_mov_b32 v226, v228
    s_nop 1
    v_permlane16_swap_b32 v226, v228
    v_mfma_f32_16x16x32_bf16 v[104:107], a[40:43], v[28:31], 0
    v_rcp_f32 v226, v228
    v_med3_f32 v229, v228, v241, v242
    v_sub_f32 v229, v229, v228
    v_fma_f32 v229, v208, 0, v229
    v_fma_f32 v229, v209, 0, v229
    v_mfma_f32_16x16x32_bf16 v[108:111], a[44:47], v[28:31], 0
    v_fma_f32 v229, v210, 0, v229
    v_fma_f32 v229, v211, 0, v229
    v_fma_f32 v229, v212, 0, v229
    v_fma_f32 v229, v213, 0, v229
    v_cmp_neq_f32 vcc, 0, v229
    v_pk_mul_f32 v[208:209], v[208:209], v[226:227] op_sel_hi:[1,0]
    v_pk_mul_f32 v[210:211], v[210:211], v[226:227] op_sel_hi:[1,0]
    v_pk_mul_f32 v[212:213], v[212:213], v[226:227] op_sel_hi:[1,0]
    s_or_b64 s[64:65], s[64:65], vcc
    v_cvt_pk_bf16_f32 v214, v212, v213
    v_cvt_pk_bf16_f32 v208, v208, v209
    v_cvt_pk_bf16_f32 v209, v210, v211
    ds_bpermute_b32 v227, v243, v214
    ds_write_b64 v251, v[208:209] offset:2048
    v_exp_f32 v96, v96
    v_exp_f32 v97, v97
    buffer_load_dwordx4 v1, s[8:11], s58 offen offset:0 lds
    v_exp_f32 v98, v98
    v_mfma_f32_16x16x32_bf16 v[216:219], a[104:107], v[88:91], v[216:219]
    v_exp_f32 v99, v99
    v_exp_f32 v100, v100
    v_mfma_f32_16x16x32_bf16 v[220:223], a[108:111], v[88:91], v[220:223]
    v_cvt_pk_bf16_f32 v96, v96, v97
    v_exp_f32 v101, v101
    v_cvt_pk_bf16_f32 v97, v98, v99
    v_mfma_f32_16x16x32_bf16 v[112:115], a[48:51], v[28:31], 0
    v_exp_f32 v102, v102
    v_exp_f32 v103, v103
    v_mfma_f32_16x16x32_bf16 v[116:119], a[52:55], v[28:31], 0
    v_cvt_pk_bf16_f32 v98, v100, v101
    v_cvt_pk_bf16_f32 v99, v102, v103
    s_mov_b32 vcc_lo, 0
    s_mov_b32 vcc_hi, 65535
    s_waitcnt lgkmcnt(1)
    v_cndmask_b32 v12, v12, v227, vcc
    v_exp_f32 v104, v104
    v_exp_f32 v105, v105
    buffer_load_dwordx4 v1, s[8:11], s58 offen offset:1024 lds
    v_exp_f32 v106, v106
    v_mfma_f32_16x16x32_bf16 v[216:219], a[112:115], v[96:99], v[216:219]
    v_exp_f32 v107, v107
    v_exp_f32 v108, v108
    v_mfma_f32_16x16x32_bf16 v[220:223], a[116:119], v[96:99], v[220:223]
    v_cvt_pk_bf16_f32 v104, v104, v105
    v_exp_f32 v109, v109
    v_mfma_f32_16x16x32_bf16 v[120:123], a[56:59], v[28:31], 0
    v_cvt_pk_bf16_f32 v105, v106, v107
    v_exp_f32 v110, v110
    v_mfma_f32_16x16x32_bf16 v[124:127], a[60:63], v[28:31], 0
    v_exp_f32 v111, v111
    v_cvt_pk_bf16_f32 v106, v108, v109
    v_cvt_pk_bf16_f32 v107, v110, v111
    v_exp_f32 v112, v112
    v_exp_f32 v113, v113
    buffer_load_dwordx4 v1, s[8:11], s58 offen offset:2048 lds
    v_exp_f32 v114, v114
    v_exp_f32 v115, v115
    v_mfma_f32_16x16x32_bf16 v[216:219], a[120:123], v[104:107], v[216:219]
    v_exp_f32 v116, v116
    v_cvt_pk_bf16_f32 v112, v112, v113
    v_exp_f32 v117, v117
    v_mfma_f32_16x16x32_bf16 v[220:223], a[124:127], v[104:107], v[220:223]
    v_cvt_pk_bf16_f32 v113, v114, v115
    v_exp_f32 v118, v118
    v_exp_f32 v119, v119
    v_cvt_pk_bf16_f32 v114, v116, v117
    v_cvt_pk_bf16_f32 v115, v118, v119
    v_exp_f32 v120, v120
    v_exp_f32 v121, v121
    buffer_load_dwordx4 v1, s[8:11], s58 offen offset:3072 lds
    s_add_u32 m0, m0, 16384
    s_add_u32 s58, s58, 16384
    v_exp_f32 v122, v122
    v_exp_f32 v123, v123
    v_mfma_f32_16x16x32_bf16 v[216:219], a[128:131], v[112:115], v[216:219]
    v_exp_f32 v124, v124
    v_cvt_pk_bf16_f32 v120, v120, v121
    v_exp_f32 v125, v125
    v_mfma_f32_16x16x32_bf16 v[220:223], a[132:135], v[112:115], v[220:223]
    v_cvt_pk_bf16_f32 v121, v122, v123
    v_exp_f32 v126, v126
    v_exp_f32 v127, v127
    v_cvt_pk_bf16_f32 v122, v124, v125
    v_cvt_pk_bf16_f32 v123, v126, v127
    s_nop 1
    v_mfma_f32_16x16x32_bf16 v[216:219], a[136:139], v[120:123], v[216:219]
    v_mfma_f32_16x16x32_bf16 v[220:223], a[140:143], v[120:123], v[220:223]
    s_nop 7
    v_mov_b32 v228, v223
    v_mov_b32 v226, v223
    v_cndmask_b32 v220, v220, v222, s[40:41]
    v_cndmask_b32 v221, v221, v223, s[40:41]
    v_permlane32_swap_b32 v226, v228
    v_mov_b32 v226, v228
    s_nop 1
    v_permlane16_swap_b32 v226, v228
    v_rcp_f32 v226, v228
    v_med3_f32 v229, v228, v241, v242
    v_sub_f32 v229, v229, v228
    v_fma_f32 v229, v216, 0, v229
    v_fma_f32 v229, v217, 0, v229
    v_fma_f32 v229, v218, 0, v229
    v_fma_f32 v229, v219, 0, v229
    v_fma_f32 v229, v220, 0, v229
    v_fma_f32 v229, v221, 0, v229
    v_cmp_neq_f32 vcc, 0, v229
    v_pk_mul_f32 v[216:217], v[216:217], v[226:227] op_sel_hi:[1,0]
    v_pk_mul_f32 v[218:219], v[218:219], v[226:227] op_sel_hi:[1,0]
    v_pk_mul_f32 v[220:221], v[220:221], v[226:227] op_sel_hi:[1,0]
    s_or_b64 s[64:65], s[64:65], vcc
    v_cvt_pk_bf16_f32 v222, v220, v221
    v_cvt_pk_bf16_f32 v216, v216, v217
    v_cvt_pk_bf16_f32 v217, v218, v219
    ds_bpermute_b32 v227, v243, v222
    ds_write_b64 v251, v[216:217] offset:3072
    s_mov_b32 vcc_lo, 0
    s_mov_b32 vcc_hi, 4294901760
    s_waitcnt lgkmcnt(1)
    v_cndmask_b32 v12, v12, v227, vcc
    ds_write_b32 v240, v12
    s_cmp_eq_u64 s[64:65], 0
    s_cbranch_scc1 L_attn_done
    s_waitcnt lgkmcnt(0)
    s_branch L_attn_er4
L_attn_f8:
    v_mfma_f32_16x16x32_bf16 v[48:51], a[64:67], v[16:19], v[236:239]
    v_mfma_f32_16x16x32_bf16 v[56:59], a[64:67], v[20:23], 0
    v_mfma_f32_16x16x32_bf16 v[60:63], a[68:71], v[20:23], v[236:239]
    v_mfma_f32_16x16x32_bf16 v[64:67], a[64:67], v[24:27], 0
    v_mfma_f32_16x16x32_bf16 v[68:71], a[68:71], v[24:27], 0
    v_mfma_f32_16x16x32_bf16 v[72:75], a[72:75], v[24:27], v[236:239]
    v_mfma_f32_16x16x32_bf16 v[80:83], a[64:67], v[28:31], 0
    v_mfma_f32_16x16x32_bf16 v[84:87], a[68:71], v[28:31], 0
    v_mfma_f32_16x16x32_bf16 v[88:91], a[72:75], v[28:31], 0
    v_mfma_f32_16x16x32_bf16 v[92:95], a[76:79], v[28:31], v[236:239]
    s_nop 2
    v_exp_f32 v48, v48
    v_exp_f32 v49, v49
    v_exp_f32 v50, v50
    v_exp_f32 v51, v51
    v_cvt_pk_bf16_f32 v48, v48, v49
    v_cvt_pk_bf16_f32 v49, v50, v51
    v_mov_b32 v50, 0
    v_mov_b32 v51, 0
    v_exp_f32 v56, v56
    v_exp_f32 v57, v57
    v_mfma_f32_16x16x32_bf16 v[192:195], a[144:147], v[48:51], 0
    v_exp_f32 v58, v58
    v_exp_f32 v59, v59
    v_exp_f32 v60, v60
    v_mfma_f32_16x16x32_bf16 v[196:199], a[148:151], v[48:51], 0
    v_cvt_pk_bf16_f32 v56, v56, v57
    v_exp_f32 v61, v61
    v_cvt_pk_bf16_f32 v57, v58, v59
    v_exp_f32 v62, v62
    v_exp_f32 v63, v63
    v_cvt_pk_bf16_f32 v58, v60, v61
    v_cvt_pk_bf16_f32 v59, v62, v63
    v_exp_f32 v64, v64
    v_exp_f32 v65, v65
    v_mfma_f32_16x16x32_bf16 v[200:203], a[144:147], v[56:59], 0
    v_exp_f32 v66, v66
    v_exp_f32 v67, v67
    v_exp_f32 v68, v68
    v_mfma_f32_16x16x32_bf16 v[204:207], a[148:151], v[56:59], 0
    v_cvt_pk_bf16_f32 v64, v64, v65
    v_exp_f32 v69, v69
    v_cvt_pk_bf16_f32 v65, v66, v67
    v_exp_f32 v70, v70
    v_exp_f32 v71, v71
    v_cvt_pk_bf16_f32 v66, v68, v69
    v_cvt_pk_bf16_f32 v67, v70, v71
    v_exp_f32 v72, v72
    v_exp_f32 v73, v73
    v_mfma_f32_16x16x32_bf16 v[208:211], a[144:147], v[64:67], 0
    v_exp_f32 v74, v74
    v_exp_f32 v75, v75
    v_mfma_f32_16x16x32_bf16 v[212:215], a[148:151], v[64:67], 0
    v_cvt_pk_bf16_f32 v72, v72, v73
    v_cvt_pk_bf16_f32 v73, v74, v75
    v_mov_b32 v74, 0
    v_mov_b32 v75, 0
    v_exp_f32 v80, v80
    v_exp_f32 v81, v81
    s_cmp_eq_u32 s67, 0
    s_cbranch_scc1 2
    s_waitcnt vmcnt(24)
    s_branch 1
    s_waitcnt vmcnt(0)
    s_barrier
    ds_read_b64 a[32:33], v244 offset:4096
    v_exp_f32 v82, v82
    ds_read_b64 a[34:35], v245 offset:4096
    ds_read_b64 a[36:37], v244 offset:4104
    v_exp_f32 v83, v83
    ds_read_b64 a[38:39], v245 offset:4104
    ds_read_b64 a[40:41], v244 offset:5120
    ds_read_b64 a[42:43], v245 offset:5120
    v_exp_f32 v84, v84
    v_mfma_f32_16x16x32_bf16 v[208:211], a[152:155], v[72:75], v[208:211]
    ds_read_b64 a[44:45], v244 offset:5128
    v_cvt_pk_bf16_f32 v80, v80, v81
    ds_read_b64 a[46:47], v245 offset:5128
    v_exp_f32 v85, v85
    ds_read_b64 a[48:49], v244 offset:6144
    ds_read_b64 a[50:51], v245 offset:6144
    v_cvt_pk_bf16_f32 v81, v82, v83
    ds_read_b64 a[52:53], v244 offset:6152
    v_exp_f32 v86, v86
    ds_read_b64 a[54:55], v245 offset:6152
    ds_read_b64 a[56:57], v244 offset:7168
    v_exp_f32 v87, v87
    v_mfma_f32_16x16x32_bf16 v[212:215], a[156:159], v[72:75], v[212:215]
    v_cvt_pk_bf16_f32 v82, v84, v85
    v_cvt_pk_bf16_f32 v83, v86, v87
    v_exp_f32 v88, v88
    v_exp_f32 v89, v89
    ds_read_b64 a[58:59], v245 offset:7168
    ds_read_b64 a[60:61], v244 offset:7176
    ds_read_b64 a[62:63], v245 offset:7176
    v_exp_f32 v90, v90
    v_mfma_f32_16x16x32_bf16 v[216:219], a[144:147], v[80:83], 0
    ds_read_b64_tr_b16 a[112:113], v246 offset:4096
    v_exp_f32 v91, v91
    ds_read_b64_tr_b16 a[114:115], v246 offset:4104
    ds_read_b64_tr_b16 a[116:117], v247 offset:4096
    v_mfma_f32_16x16x32_bf16 v[220:223], a[148:151], v[80:83], 0
    v_exp_f32 v92, v92
    ds_read_b64_tr_b16 a[118:119], v247 offset:4104
    ds_read_b64_tr_b16 a[120:121], v246 offset:5120
    s_waitcnt lgkmcnt(15)
    v_mfma_f32_16x16x32_bf16 v[96:99], a[32:35], v[16:19], 0
    v_cvt_pk_bf16_f32 v88, v88, v89
    ds_read_b64_tr_b16 a[122:123], v246 offset:5128
    v_exp_f32 v93, v93
    ds_read_b64_tr_b16 a[124:125], v247 offset:5120
    v_mfma_f32_16x16x32_bf16 v[100:103], a[36:39], v[16:19], 0
    ds_read_b64_tr_b16 a[126:127], v247 offset:5128
    v_cvt_pk_bf16_f32 v89, v90, v91
    ds_read_b64_tr_b16 a[128:129], v246 offset:6144
    v_exp_f32 v94, v94
    v_mfma_f32_16x16x32_bf16 v[104:107], a[40:43], v[16:19], 0
    ds_read_b64_tr_b16 a[130:131], v246 offset:6152
    ds_read_b64_tr_b16 a[132:133], v247 offset:6144
    v_exp_f32 v95, v95
    s_waitcnt lgkmcnt(15)
    v_mfma_f32_16x16x32_bf16 v[108:111], a[44:47], v[16:19], 0
    v_cvt_pk_bf16_f32 v90, v92, v93
    v_cvt_pk_bf16_f32 v91, v94, v95
    v_exp_f32 v96, v96
    v_exp_f32 v97, v97
    ds_read_b64_tr_b16 a[134:135], v247 offset:6152
    ds_read_b64_tr_b16 a[136:137], v246 offset:7168
    v_exp_f32 v98, v98
    v_mfma_f32_16x16x32_bf16 v[216:219], a[152:155], v[88:91], v[216:219]
    v_exp_f32 v99, v99
    ds_read_b64_tr_b16 a[138:139], v246 offset:7176
    v_exp_f32 v100, v100
    v_mfma_f32_16x16x32_bf16 v[220:223], a[156:159], v[88:91], v[220:223]
    v_cvt_pk_bf16_f32 v96, v96, v97
    ds_read_b64_tr_b16 a[140:141], v247 offset:7168
    v_exp_f32 v101, v101
    v_mfma_f32_16x16x32_bf16 v[112:115], a[48:51], v[16:19], 0
    v_cvt_pk_bf16_f32 v97, v98, v99
    ds_read_b64_tr_b16 a[142:143], v247 offset:7176
    v_exp_f32 v102, v102
    v_mfma_f32_16x16x32_bf16 v[116:119], a[52:55], v[16:19], 0
    v_exp_f32 v103, v103
    v_cvt_pk_bf16_f32 v98, v100, v101
    v_cvt_pk_bf16_f32 v99, v102, v103
    v_exp_f32 v104, v104
    v_exp_f32 v105, v105
    s_waitcnt lgkmcnt(0)
    s_mov_b32 m0, s59
    s_waitcnt vmcnt(0)
    s_barrier
    v_mov_b32 v254, s100
    v_mov_b32 v255, s101
    s_mov_b32 s30, 159072863
    s_mul_hi_u32 s27, s2, s30
    s_mul_i32 s27, s27, 5
    s_add_u32 s27, s27, s2
    s_lshl_b32 s27, s27, 3
    s_add_u32 s27, s27, 63885312
    s_cmp_lt_u32 s2, 216
    s_cselect_b32 s27, s27, 1073741824
    s_cmp_eq_u32 s20, 0
    s_cselect_b32 s27, s27, 1073741824
    buffer_store_dwordx2 v[254:255], v13, s[8:11], s27 offen sc1
    v_exp_f32 v106, v106
    v_mfma_f32_16x16x32_bf16 v[192:195], a[112:115], v[96:99], v[192:195]
    v_exp_f32 v107, v107
    s_cmp_eq_u32 s67, 0
    s_cbranch_scc1 L_pk_f8_0
    buffer_load_dwordx4 a[208:211], v10, s[60:63], s72 offen nt
    buffer_load_dwordx4 a[212:215], v11, s[60:63], s72 offen nt
    buffer_load_dwordx4 a[216:219], v10, s[60:63], s73 offen nt
    buffer_load_dwordx4 a[220:223], v11, s[60:63], s73 offen nt
L_pk_f8_0:
    v_exp_f32 v108, v108
    v_mfma_f32_16x16x32_bf16 v[196:199], a[116:119], v[96:99], v[196:199]
    v_cvt_pk_bf16_f32 v104, v104, v105
    v_exp_f32 v109, v109
    v_mfma_f32_16x16x32_bf16 v[120:123], a[56:59], v[16:19], 0
    v_cvt_pk_bf16_f32 v105, v106, v107
    v_exp_f32 v110, v110
    v_mfma_f32_16x16x32_bf16 v[124:127], a[60:63], v[16:19], 0
    v_exp_f32 v111, v111
    v_cvt_pk_bf16_f32 v106, v108, v109
    v_cvt_pk_bf16_f32 v107, v110, v111
    v_exp_f32 v112, v112
    v_exp_f32 v113, v113
    s_cmp_eq_u32 s67, 0
    s_cbranch_scc1 L_pk_f8_1
    buffer_load_dwordx4 a[224:227], v10, s[60:63], s74 offen nt
    buffer_load_dwordx4 a[228:231], v11, s[60:63], s74 offen nt
    buffer_load_dwordx4 a[232:235], v10, s[60:63], s75 offen nt
    buffer_load_dwordx4 a[236:239], v11, s[60:63], s75 offen nt
L_pk_f8_1:
    v_exp_f32 v114, v114
    v_mfma_f32_16x16x32_bf16 v[192:195], a[120:123], v[104:107], v[192:195]
    v_exp_f32 v115, v115
    s_cmp_eq_u32 s67, 0
    s_cbranch_scc1 L_pk_f8_2
    buffer_load_dwordx4 a[240:243], v10, s[60:63], s76 offen nt
    buffer_load_dwordx4 a[244:247], v11, s[60:63], s76 offen nt
    buffer_load_dwordx4 a[248:251], v10, s[60:63], s77 offen nt
    buffer_load_dwordx4 a[252:255], v11, s[60:63], s77 offen nt
L_pk_f8_2:
    v_exp_f32 v116, v116
    v_mfma_f32_16x16x32_bf16 v[196:199], a[124:127], v[104:107], v[196:199]
    v_cvt_pk_bf16_f32 v112, v112, v113
    v_exp_f32 v117, v117
    v_mfma_f32_16x16x32_bf16 v[48:51], a[32:35], v[20:23], 0
    v_cvt_pk_bf16_f32 v113, v114, v115
    v_exp_f32 v118, v118
    v_mfma_f32_16x16x32_bf16 v[52:55], a[36:39], v[20:23], 0
    v_exp_f32 v119, v119
    v_cvt_pk_bf16_f32 v114, v116, v117
    v_cvt_pk_bf16_f32 v115, v118, v119
    v_exp_f32 v120, v120
    v_exp_f32 v121, v121
    buffer_load_dwordx4 v1, s[8:11], s58 offen offset:0 lds
    v_exp_f32 v122, v122
    v_mfma_f32_16x16x32_bf16 v[192:195], a[128:131], v[112:115], v[192:195]
    v_exp_f32 v123, v123
    buffer_load_dwordx4 v1, s[8:11], s58 offen offset:1024 lds
    v_exp_f32 v124, v124
    v_mfma_f32_16x16x32_bf16 v[196:199], a[132:135], v[112:115], v[196:199]
    v_cvt_pk_bf16_f32 v120, v120, v121
    v_exp_f32 v125, v125
    v_mfma_f32_16x16x32_bf16 v[56:59], a[40:43], v[20:23], 0
    v_cvt_pk_bf16_f32 v121, v122, v123
    v_exp_f32 v126, v126
    v_mfma_f32_16x16x32_bf16 v[60:63], a[44:47], v[20:23], 0
    v_exp_f32 v127, v127
    v_cvt_pk_bf16_f32 v122, v124, v125
    v_cvt_pk_bf16_f32 v123, v126, v127
    v_exp_f32 v48, v48
    v_exp_f32 v49, v49
    buffer_load_dwordx4 v1, s[8:11], s58 offen offset:2048 lds
    v_exp_f32 v50, v50
    v_mfma_f32_16x16x32_bf16 v[192:195], a[136:139], v[120:123], v[192:195]
    v_exp_f32 v51, v51
    buffer_load_dwordx4 v1, s[8:11], s58 offen offset:3072 lds
    s_add_u32 m0, m0, 16384
    s_add_u32 s58, s58, 16384
    v_exp_f32 v52, v52
    v_mfma_f32_16x16x32_bf16 v[196:199], a[140:143], v[120:123], v[196:199]
    v_cvt_pk_bf16_f32 v48, v48, v49
    v_exp_f32 v53, v53
    v_mfma_f32_16x16x32_bf16 v[64:67], a[48:51], v[20:23], 0
    v_cvt_pk_bf16_f32 v49, v50, v51
    v_exp_f32 v54, v54
    v_mfma_f32_16x16x32_bf16 v[68:71], a[52:55], v[20:23], 0
    v_exp_f32 v55, v55
    v_cvt_pk_bf16_f32 v50, v52, v53
    v_cvt_pk_bf16_f32 v51, v54, v55
    v_exp_f32 v56, v56
    v_exp_f32 v57, v57
    buffer_load_dwordx4 v1, s[8:11], s58 offen offset:0 lds
    v_exp_f32 v58, v58
    v_exp_f32 v59, v59
    v_exp_f32 v60, v60
    v_mfma_f32_16x16x32_bf16 v[200:203], a[112:115], v[48:51], v[200:203]
    v_cvt_pk_bf16_f32 v56, v56, v57
    v_exp_f32 v61, v61
    v_cvt_pk_bf16_f32 v57, v58, v59
    v_exp_f32 v62, v62
    buffer_load_dwordx4 v1, s[8:11], s58 offen offset:1024 lds
    v_exp_f32 v63, v63
    v_cvt_pk_bf16_f32 v58, v60, v61
    v_cvt_pk_bf16_f32 v59, v62, v63
    v_mov_b32 v228, v199
    v_mov_b32 v226, v199
    v_cndmask_b32 v196, v196, v198, s[40:41]
    v_mfma_f32_16x16x32_bf16 v[204:207], a[116:119], v[48:51], v[204:207]
    v_cndmask_b32 v197, v197, v199, s[40:41]
    v_permlane32_swap_b32 v226, v228
    v_mov_b32 v226, v228
    s_nop 1
    v_permlane16_swap_b32 v226, v228
    v_mfma_f32_16x16x32_bf16 v[72:75], a[56:59], v[20:23], 0
    v_rcp_f32 v226, v228
    v_med3_f32 v229, v228, v241, v242
    v_sub_f32 v229, v229, v228
    v_fma_f32 v229, v192, 0, v229
    v_fma_f32 v229, v193, 0, v229
    v_fma_f32 v229, v194, 0, v229
    v_mfma_f32_16x16x32_bf16 v[76:79], a[60:63], v[20:23], 0
    v_fma_f32 v229, v195, 0, v229
    v_fma_f32 v229, v196, 0, v229
    v_fma_f32 v229, v197, 0, v229
    v_cmp_neq_f32 vcc, 0, v229
    v_pk_mul_f32 v[192:193], v[192:193], v[226:227] op_sel_hi:[1,0]
    v_pk_mul_f32 v[194:195], v[194:195], v[226:227] op_sel_hi:[1,0]
    v_pk_mul_f32 v[196:197], v[196:197], v[226:227] op_sel_hi:[1,0]
    s_or_b64 s[64:65], s[64:65], vcc
    v_cvt_pk_bf16_f32 v198, v196, v197
    v_cvt_pk_bf16_f32 v192, v192, v193
    v_cvt_pk_bf16_f32 v193, v194, v195
    ds_bpermute_b32 v227, v243, v198
    ds_write_b64 v251, v[192:193] offset:0
    v_exp_f32 v64, v64
    v_exp_f32 v65, v65
    buffer_load_dwordx4 v1, s[8:11], s58 offen offset:2048 lds
    v_exp_f32 v66, v66
    v_mfma_f32_16x16x32_bf16 v[200:203], a[120:123], v[56:59], v[200:203]
    v_exp_f32 v67, v67
    v_exp_f32 v68, v68
    buffer_load_dwordx4 v1, s[8:11], s58 offen offset:3072 lds
    s_add_u32 m0, m0, 16384
    s_add_u32 s58, s58, 16384
    v_cvt_pk_bf16_f32 v64, v64, v65
    v_exp_f32 v69, v69
    v_mfma_f32_16x16x32_bf16 v[204:207], a[124:127], v[56:59], v[204:207]
    v_cvt_pk_bf16_f32 v65, v66, v67
    v_exp_f32 v70, v70
    v_mfma_f32_16x16x32_bf16 v[80:83], a[32:35], v[24:27], 0
    v_exp_f32 v71, v71
    v_mfma_f32_16x16x32_bf16 v[84:87], a[36:39], v[24:27], 0
    v_cvt_pk_bf16_f32 v66, v68, v69
    v_cvt_pk_bf16_f32 v67, v70, v71
    s_mov_b32 vcc_lo, 65535
    s_mov_b32 vcc_hi, 0
    s_waitcnt lgkmcnt(1)
    v_cndmask_b32 v12, v12, v227, vcc
    v_exp_f32 v72, v72
    v_exp_f32 v73, v73
    buffer_load_dwordx4 v1, s[8:11], s58 offen offset:0 lds
    v_exp_f32 v74, v74
    v_mfma_f32_16x16x32_bf16 v[200:203], a[128:131], v[64:67], v[200:203]
    v_exp_f32 v75, v75
    buffer_load_dwordx4 v1, s[8:11], s58 offen offset:1024 lds
    v_exp_f32 v76, v76
    v_mfma_f32_16x16x32_bf16 v[204:207], a[132:135], v[64:67], v[204:207]
    v_cvt_pk_bf16_f32 v72, v72, v73
    v_exp_f32 v77, v77
    v_mfma_f32_16x16x32_bf16 v[88:91], a[40:43], v[24:27], 0
    v_cvt_pk_bf16_f32 v73, v74, v75
    v_exp_f32 v78, v78
    v_mfma_f32_16x16x32_bf16 v[92:95], a[44:47], v[24:27], 0
    v_exp_f32 v79, v79
    v_cvt_pk_bf16_f32 v74, v76, v77
    v_cvt_pk_bf16_f32 v75, v78, v79
    v_exp_f32 v80, v80
    v_exp_f32 v81, v81
    buffer_load_dwordx4 v1, s[8:11], s58 offen offset:2048 lds
    v_exp_f32 v82, v82
    v_mfma_f32_16x16x32_bf16 v[200:203], a[136:139], v[72:75], v[200:203]
    v_exp_f32 v83, v83
    buffer_load_dwordx4 v1, s[8:11], s58 offen offset:3072 lds
    s_add_u32 m0, m0, 16384
    s_add_u32 s58, s58, 16384
    v_exp_f32 v84, v84
    v_mfma_f32_16x16x32_bf16 v[204:207], a[140:143], v[72:75], v[204:207]
    v_cvt_pk_bf16_f32 v80, v80, v81
    v_exp_f32 v85, v85
    v_mfma_f32_16x16x32_bf16 v[96:99], a[48:51], v[24:27], 0
    v_cvt_pk_bf16_f32 v81, v82, v83
    v_exp_f32 v86, v86
    v_mfma_f32_16x16x32_bf16 v[100:103], a[52:55], v[24:27], 0
    v_exp_f32 v87, v87
    v_cvt_pk_bf16_f32 v82, v84, v85
    v_cvt_pk_bf16_f32 v83, v86, v87
    v_exp_f32 v88, v88
    v_exp_f32 v89, v89
    buffer_load_dwordx4 v1, s[8:11], s58 offen offset:0 lds
    v_exp_f32 v90, v90
    v_exp_f32 v91, v91
    v_exp_f32 v92, v92
    v_mfma_f32_16x16x32_bf16 v[208:211], a[112:115], v[80:83], v[208:211]
    v_cvt_pk_bf16_f32 v88, v88, v89
    v_exp_f32 v93, v93
    v_cvt_pk_bf16_f32 v89, v90, v91
    v_exp_f32 v94, v94
    buffer_load_dwordx4 v1, s[8:11], s58 offen offset:1024 lds
    v_exp_f32 v95, v95
    v_cvt_pk_bf16_f32 v90, v92, v93
    v_cvt_pk_bf16_f32 v91, v94, v95
    v_mov_b32 v228, v207
    v_mov_b32 v226, v207
    v_cndmask_b32 v204, v204, v206, s[40:41]
    v_mfma_f32_16x16x32_bf16 v[212:215], a[116:119], v[80:83], v[212:215]
    v_cndmask_b32 v205, v205, v207, s[40:41]
    v_permlane32_swap_b32 v226, v228
    v_mov_b32 v226, v228
    s_nop 1
    v_permlane16_swap_b32 v226, v228
    v_mfma_f32_16x16x32_bf16 v[104:107], a[56:59], v[24:27], 0
    v_rcp_f32 v226, v228
    v_med3_f32 v229, v228, v241, v242
    v_sub_f32 v229, v229, v228
    v_fma_f32 v229, v200, 0, v229
    v_fma_f32 v229, v201, 0, v229
    v_fma_f32 v229, v202, 0, v229
    v_mfma_f32_16x16x32_bf16 v[108:111], a[60:63], v[24:27], 0
    v_fma_f32 v229, v203, 0, v229
    v_fma_f32 v229, v204, 0, v229
    v_fma_f32 v229, v205, 0, v229
    v_cmp_neq_f32 vcc, 0, v229
    v_pk_mul_f32 v[200:201], v[200:201], v[226:227] op_sel_hi:[1,0]
    v_pk_mul_f32 v[202:203], v[202:203], v[226:227] op_sel_hi:[1,0]
    v_pk_mul_f32 v[204:205], v[204:205], v[226:227] op_sel_hi:[1,0]
    s_or_b64 s[64:65], s[64:65], vcc
    v_cvt_pk_bf16_f32 v206, v204, v205
    v_cvt_pk_bf16_f32 v200, v200, v201
    v_cvt_pk_bf16_f32 v201, v202, v203
    ds_bpermute_b32 v227, v243, v206
    ds_write_b64 v251, v[200:201] offset:1024
    v_exp_f32 v96, v96
    v_exp_f32 v97, v97
    buffer_load_dwordx4 v1, s[8:11], s58 offen offset:2048 lds
    v_exp_f32 v98, v98
    v_mfma_f32_16x16x32_bf16 v[208:211], a[120:123], v[88:91], v[208:211]
    v_exp_f32 v99, v99
    v_exp_f32 v100, v100
    buffer_load_dwordx4 v1, s[8:11], s58 offen offset:3072 lds
    s_add_u32 m0, m0, 16384
    s_add_u32 s58, s58, 16384
    v_cvt_pk_bf16_f32 v96, v96, v97
    v_exp_f32 v101, v101
    v_mfma_f32_16x16x32_bf16 v[212:215], a[124:127], v[88:91], v[212:215]
    v_cvt_pk_bf16_f32 v97, v98, v99
    v_exp_f32 v102, v102
    v_mfma_f32_16x16x32_bf16 v[112:115], a[32:35], v[28:31], 0
    v_exp_f32 v103, v103
    v_mfma_f32_16x16x32_bf16 v[116:119], a[36:39], v[28:31], 0
    v_cvt_pk_bf16_f32 v98, v100, v101
    v_cvt_pk_bf16_f32 v99, v102, v103
    s_mov_b32 vcc_lo, 4294901760
    s_mov_b32 vcc_hi, 0
    s_waitcnt lgkmcnt(1)
    v_cndmask_b32 v12, v12, v227, vcc
    v_exp_f32 v104, v104
    v_exp_f32 v105, v105
    buffer_load_dwordx4 v1, s[8:11], s58 offen offset:0 lds
    v_exp_f32 v106, v106
    v_mfma_f32_16x16x32_bf16 v[208:211], a[128:131], v[96:99], v[208:211]
    v_exp_f32 v107, v107
    buffer_load_dwordx4 v1, s[8:11], s58 offen offset:1024 lds
    v_exp_f32 v108, v108
    v_mfma_f32_16x16x32_bf16 v[212:215], a[132:135], v[96:99], v[212:215]
    v_cvt_pk_bf16_f32 v104, v104, v105
    v_exp_f32 v109, v109
    v_mfma_f32_16x16x32_bf16 v[120:123], a[40:43], v[28:31], 0
    v_cvt_pk_bf16_f32 v105, v106, v107
    v_exp_f32 v110, v110
    v_mfma_f32_16x16x32_bf16 v[124:127], a[44:47], v[28:31], 0
    v_exp_f32 v111, v111
    v_cvt_pk_bf16_f32 v106, v108, v109
    v_cvt_pk_bf16_f32 v107, v110, v111
    v_exp_f32 v112, v112
    v_exp_f32 v113, v113
    buffer_load_dwordx4 v1, s[8:11], s58 offen offset:2048 lds
    v_exp_f32 v114, v114
    v_mfma_f32_16x16x32_bf16 v[208:211], a[136:139], v[104:107], v[208:211]
    v_exp_f32 v115, v115
    buffer_load_dwordx4 v1, s[8:11], s58 offen offset:3072 lds
    s_add_u32 m0, m0, 16384
    s_add_u32 s58, s58, 16384
    v_exp_f32 v116, v116
    v_mfma_f32_16x16x32_bf16 v[212:215], a[140:143], v[104:107], v[212:215]
    v_cvt_pk_bf16_f32 v112, v112, v113
    v_exp_f32 v117, v117
    v_mfma_f32_16x16x32_bf16 v[48:51], a[48:51], v[28:31], 0
    v_cvt_pk_bf16_f32 v113, v114, v115
    v_exp_f32 v118, v118
    v_mfma_f32_16x16x32_bf16 v[52:55], a[52:55], v[28:31], 0
    v_exp_f32 v119, v119
    v_cvt_pk_bf16_f32 v114, v116, v117
    v_cvt_pk_bf16_f32 v115, v118, v119
    v_exp_f32 v120, v120
    v_exp_f32 v121, v121
    buffer_load_dwordx4 v1, s[8:11], s58 offen offset:0 lds
    v_exp_f32 v122, v122
    v_exp_f32 v123, v123
    v_exp_f32 v124, v124
    v_mfma_f32_16x16x32_bf16 v[216:219], a[112:115], v[112:115], v[216:219]
    v_cvt_pk_bf16_f32 v120, v120, v121
    v_exp_f32 v125, v125
    v_cvt_pk_bf16_f32 v121, v122, v123
    v_exp_f32 v126, v126
    buffer_load_dwordx4 v1, s[8:11], s58 offen offset:1024 lds
    v_exp_f32 v127, v127
    v_cvt_pk_bf16_f32 v122, v124, v125
    v_cvt_pk_bf16_f32 v123, v126, v127
    v_mov_b32 v228, v215
    v_mov_b32 v226, v215
    v_cndmask_b32 v212, v212, v214, s[40:41]
    v_mfma_f32_16x16x32_bf16 v[220:223], a[116:119], v[112:115], v[220:223]
    v_cndmask_b32 v213, v213, v215, s[40:41]
    v_permlane32_swap_b32 v226, v228
    v_mov_b32 v226, v228
    s_nop 1
    v_permlane16_swap_b32 v226, v228
    v_mfma_f32_16x16x32_bf16 v[56:59], a[56:59], v[28:31], 0
    v_rcp_f32 v226, v228
    v_med3_f32 v229, v228, v241, v242
    v_sub_f32 v229, v229, v228
    v_fma_f32 v229, v208, 0, v229
    v_fma_f32 v229, v209, 0, v229
    v_fma_f32 v229, v210, 0, v229
    v_mfma_f32_16x16x32_bf16 v[60:63], a[60:63], v[28:31], 0
    v_fma_f32 v229, v211, 0, v229
    v_fma_f32 v229, v212, 0, v229
    v_fma_f32 v229, v213, 0, v229
    v_cmp_neq_f32 vcc, 0, v229
    v_pk_mul_f32 v[208:209], v[208:209], v[226:227] op_sel_hi:[1,0]
    v_pk_mul_f32 v[210:211], v[210:211], v[226:227] op_sel_hi:[1,0]
    v_pk_mul_f32 v[212:213], v[212:213], v[226:227] op_sel_hi:[1,0]
    s_or_b64 s[64:65], s[64:65], vcc
    v_cvt_pk_bf16_f32 v214, v212, v213
    v_cvt_pk_bf16_f32 v208, v208, v209
    v_cvt_pk_bf16_f32 v209, v210, v211
    ds_bpermute_b32 v227, v243, v214
    ds_write_b64 v251, v[208:209] offset:2048
    v_exp_f32 v48, v48
    v_exp_f32 v49, v49
    buffer_load_dwordx4 v1, s[8:11], s58 offen offset:2048 lds
    v_exp_f32 v50, v50
    v_exp_f32 v51, v51
    v_exp_f32 v52, v52
    v_mfma_f32_16x16x32_bf16 v[216:219], a[120:123], v[120:123], v[216:219]
    v_cvt_pk_bf16_f32 v48, v48, v49
    v_exp_f32 v53, v53
    v_cvt_pk_bf16_f32 v49, v50, v51
    v_exp_f32 v54, v54
    v_mfma_f32_16x16x32_bf16 v[220:223], a[124:127], v[120:123], v[220:223]
    v_exp_f32 v55, v55
    v_cvt_pk_bf16_f32 v50, v52, v53
    v_cvt_pk_bf16_f32 v51, v54, v55
    s_mov_b32 vcc_lo, 0
    s_mov_b32 vcc_hi, 65535
    s_waitcnt lgkmcnt(1)
    v_cndmask_b32 v12, v12, v227, vcc
    v_exp_f32 v56, v56
    v_exp_f32 v57, v57
    buffer_load_dwordx4 v1, s[8:11], s58 offen offset:3072 lds
    s_add_u32 m0, m0, 16384
    s_add_u32 s58, s58, 16384
    v_exp_f32 v58, v58
    v_exp_f32 v59, v59
    v_mfma_f32_16x16x32_bf16 v[216:219], a[128:131], v[48:51], v[216:219]
    v_exp_f32 v60, v60
    v_cvt_pk_bf16_f32 v56, v56, v57
    v_exp_f32 v61, v61
    v_mfma_f32_16x16x32_bf16 v[220:223], a[132:135], v[48:51], v[220:223]
    v_cvt_pk_bf16_f32 v57, v58, v59
    v_exp_f32 v62, v62
    v_exp_f32 v63, v63
    v_cvt_pk_bf16_f32 v58, v60, v61
    v_cvt_pk_bf16_f32 v59, v62, v63
    s_nop 1
    v_mfma_f32_16x16x32_bf16 v[216:219], a[136:139], v[56:59], v[216:219]
    v_mfma_f32_16x16x32_bf16 v[220:223], a[140:143], v[56:59], v[220:223]
    s_nop 7
    v_mov_b32 v228, v223
    v_mov_b32 v226, v223
    v_cndmask_b32 v220, v220, v222, s[40:41]
    v_cndmask_b32 v221, v221, v223, s[40:41]
    v_permlane32_swap_b32 v226, v228
    v_mov_b32 v226, v228
    s_nop 1
    v_permlane16_swap_b32 v226, v228
    v_rcp_f32 v226, v228
    v_med3_f32 v229, v228, v241, v242
    v_sub_f32 v229, v229, v228
    v_fma_f32 v229, v216, 0, v229
    v_fma_f32 v229, v217, 0, v229
    v_fma_f32 v229, v218, 0, v229
    v_fma_f32 v229, v219, 0, v229
    v_fma_f32 v229, v220, 0, v229
    v_fma_f32 v229, v221, 0, v229
    v_cmp_neq_f32 vcc, 0, v229
    v_pk_mul_f32 v[216:217], v[216:217], v[226:227] op_sel_hi:[1,0]
    v_pk_mul_f32 v[218:219], v[218:219], v[226:227] op_sel_hi:[1,0]
    v_pk_mul_f32 v[220:221], v[220:221], v[226:227] op_sel_hi:[1,0]
    s_or_b64 s[64:65], s[64:65], vcc
    v_cvt_pk_bf16_f32 v222, v220, v221
    v_cvt_pk_bf16_f32 v216, v216, v217
    v_cvt_pk_bf16_f32 v217, v218, v219
    ds_bpermute_b32 v227, v243, v222
    ds_write_b64 v251, v[216:217] offset:3072
    s_mov_b32 vcc_lo, 0
    s_mov_b32 vcc_hi, 4294901760
    s_waitcnt lgkmcnt(1)
    v_cndmask_b32 v12, v12, v227, vcc
    ds_write_b32 v240, v12
    s_cmp_eq_u64 s[64:65], 0
    s_cbranch_scc1 L_attn_done
    s_waitcnt lgkmcnt(0)
    s_branch L_attn_er8
L_attn_f12:
    v_mfma_f32_16x16x32_bf16 v[48:51], a[64:67], v[16:19], v[236:239]
    v_mfma_f32_16x16x32_bf16 v[56:59], a[64:67], v[20:23], 0
    v_mfma_f32_16x16x32_bf16 v[60:63], a[68:71], v[20:23], v[236:239]
    v_mfma_f32_16x16x32_bf16 v[64:67], a[64:67], v[24:27], 0
    v_mfma_f32_16x16x32_bf16 v[68:71], a[68:71], v[24:27], 0
    v_mfma_f32_16x16x32_bf16 v[72:75], a[72:75], v[24:27], v[236:239]
    v_mfma_f32_16x16x32_bf16 v[80:83], a[64:67], v[28:31], 0
    v_mfma_f32_16x16x32_bf16 v[84:87], a[68:71], v[28:31], 0
    v_mfma_f32_16x16x32_bf16 v[88:91], a[72:75], v[28:31], 0
    v_mfma_f32_16x16x32_bf16 v[92:95], a[76:79], v[28:31], v[236:239]
    s_nop 2
    v_exp_f32 v48, v48
    v_exp_f32 v49, v49
    v_exp_f32 v50, v50
    v_exp_f32 v51, v51
    v_cvt_pk_bf16_f32 v48, v48, v49
    v_cvt_pk_bf16_f32 v49, v50, v51
    v_mov_b32 v50, 0
    v_mov_b32 v51, 0
    v_exp_f32 v56, v56
    v_exp_f32 v57, v57
    v_mfma_f32_16x16x32_bf16 v[192:195], a[144:147], v[48:51], 0
    v_exp_f32 v58, v58
    v_exp_f32 v59, v59
    v_exp_f32 v60, v60
    v_mfma_f32_16x16x32_bf16 v[196:199], a[148:151], v[48:51], 0
    v_cvt_pk_bf16_f32 v56, v56, v57
    v_exp_f32 v61, v61
    v_cvt_pk_bf16_f32 v57, v58, v59
    v_exp_f32 v62, v62
    v_exp_f32 v63, v63
    v_cvt_pk_bf16_f32 v58, v60, v61
    v_cvt_pk_bf16_f32 v59, v62, v63
    v_exp_f32 v64, v64
    v_exp_f32 v65, v65
    v_mfma_f32_16x16x32_bf16 v[200:203], a[144:147], v[56:59], 0
    v_exp_f32 v66, v66
    v_exp_f32 v67, v67
    v_exp_f32 v68, v68
    v_mfma_f32_16x16x32_bf16 v[204:207], a[148:151], v[56:59], 0
    v_cvt_pk_bf16_f32 v64, v64, v65
    v_exp_f32 v69, v69
    v_cvt_pk_bf16_f32 v65, v66, v67
    v_exp_f32 v70, v70
    v_exp_f32 v71, v71
    v_cvt_pk_bf16_f32 v66, v68, v69
    v_cvt_pk_bf16_f32 v67, v70, v71
    v_exp_f32 v72, v72
    v_exp_f32 v73, v73
    v_mfma_f32_16x16x32_bf16 v[208:211], a[144:147], v[64:67], 0
    v_exp_f32 v74, v74
    v_exp_f32 v75, v75
    v_mfma_f32_16x16x32_bf16 v[212:215], a[148:151], v[64:67], 0
    v_cvt_pk_bf16_f32 v72, v72, v73
    v_cvt_pk_bf16_f32 v73, v74, v75
    v_mov_b32 v74, 0
    v_mov_b32 v75, 0
    v_exp_f32 v80, v80
    v_exp_f32 v81, v81
    s_cmp_eq_u32 s67, 0
    s_cbranch_scc1 2
    s_waitcnt vmcnt(24)
    s_branch 1
    s_waitcnt vmcnt(0)
    s_barrier
    ds_read_b64 a[48:49], v244 offset:6144
    v_exp_f32 v82, v82
    ds_read_b64 a[50:51], v245 offset:6144
    ds_read_b64 a[52:53], v244 offset:6152
    v_exp_f32 v83, v83
    ds_read_b64 a[54:55], v245 offset:6152
    ds_read_b64 a[56:57], v244 offset:7168
    ds_read_b64 a[58:59], v245 offset:7168
    v_exp_f32 v84, v84
    v_mfma_f32_16x16x32_bf16 v[208:211], a[152:155], v[72:75], v[208:211]
    ds_read_b64 a[60:61], v244 offset:7176
    v_cvt_pk_bf16_f32 v80, v80, v81
    ds_read_b64 a[62:63], v245 offset:7176
    v_exp_f32 v85, v85
    ds_read_b64_tr_b16 a[128:129], v246 offset:6144
    ds_read_b64_tr_b16 a[130:131], v246 offset:6152
    v_cvt_pk_bf16_f32 v81, v82, v83
    ds_read_b64_tr_b16 a[132:133], v247 offset:6144
    v_exp_f32 v86, v86
    ds_read_b64_tr_b16 a[134:135], v247 offset:6152
    ds_read_b64_tr_b16 a[136:137], v246 offset:7168
    v_exp_f32 v87, v87
    v_mfma_f32_16x16x32_bf16 v[212:215], a[156:159], v[72:75], v[212:215]
    v_cvt_pk_bf16_f32 v82, v84, v85
    v_cvt_pk_bf16_f32 v83, v86, v87
    v_exp_f32 v88, v88
    v_exp_f32 v89, v89
    ds_read_b64_tr_b16 a[138:139], v246 offset:7176
    v_mfma_f32_16x16x32_bf16 v[216:219], a[144:147], v[80:83], 0
    v_exp_f32 v90, v90
    ds_read_b64_tr_b16 a[140:141], v247 offset:7168
    v_exp_f32 v91, v91
    v_mfma_f32_16x16x32_bf16 v[220:223], a[148:151], v[80:83], 0
    v_exp_f32 v92, v92
    ds_read_b64_tr_b16 a[142:143], v247 offset:7176
    v_cvt_pk_bf16_f32 v88, v88, v89
    s_waitcnt lgkmcnt(14)
    v_mfma_f32_16x16x32_bf16 v[96:99], a[48:51], v[16:19], 0
    v_exp_f32 v93, v93
    s_waitcnt lgkmcnt(12)
    v_mfma_f32_16x16x32_bf16 v[100:103], a[52:55], v[16:19], 0
    v_cvt_pk_bf16_f32 v89, v90, v91
    s_waitcnt lgkmcnt(10)
    v_mfma_f32_16x16x32_bf16 v[104:107], a[56:59], v[16:19], 0
    v_exp_f32 v94, v94
    s_waitcnt lgkmcnt(8)
    v_mfma_f32_16x16x32_bf16 v[108:111], a[60:63], v[16:19], 0
    v_exp_f32 v95, v95
    v_cvt_pk_bf16_f32 v90, v92, v93
    v_cvt_pk_bf16_f32 v91, v94, v95
    v_exp_f32 v96, v96
    v_exp_f32 v97, v97
    s_waitcnt lgkmcnt(0)
    s_mov_b32 m0, s59
    s_waitcnt vmcnt(0)
    s_barrier
    v_mov_b32 v254, s100
    v_mov_b32 v255, s101
    s_mov_b32 s30, 159072863
    s_mul_hi_u32 s27, s2, s30
    s_mul_i32 s27, s27, 5
    s_add_u32 s27, s27, s2
    s_lshl_b32 s27, s27, 3
    s_add_u32 s27, s27, 63885312
    s_cmp_lt_u32 s2, 216
    s_cselect_b32 s27, s27, 1073741824
    s_cmp_eq_u32 s20, 0
    s_cselect_b32 s27, s27, 1073741824
    buffer_store_dwordx2 v[254:255], v13, s[8:11], s27 offen sc1
    v_exp_f32 v98, v98
    v_mfma_f32_16x16x32_bf16 v[216:219], a[152:155], v[88:91], v[216:219]
    v_exp_f32 v99, v99
    s_cmp_eq_u32 s67, 0
    s_cbranch_scc1 L_pk_f12_0
    buffer_load_dwordx4 a[208:211], v10, s[60:63], s72 offen nt
    buffer_load_dwordx4 a[212:215], v11, s[60:63], s72 offen nt
    buffer_load_dwordx4 a[216:219], v10, s[60:63], s73 offen nt
    buffer_load_dwordx4 a[220:223], v11, s[60:63], s73 offen nt
L_pk_f12_0:
    v_mfma_f32_16x16x32_bf16 v[220:223], a[156:159], v[88:91], v[220:223]
    v_exp_f32 v100, v100
    s_cmp_eq_u32 s67, 0
    s_cbranch_scc1 L_pk_f12_1
    buffer_load_dwordx4 a[224:227], v10, s[60:63], s74 offen nt
    buffer_load_dwordx4 a[228:231], v11, s[60:63], s74 offen nt
    buffer_load_dwordx4 a[232:235], v10, s[60:63], s75 offen nt
    buffer_load_dwordx4 a[236:239], v11, s[60:63], s75 offen nt
L_pk_f12_1:
    v_cvt_pk_bf16_f32 v96, v96, v97
    v_exp_f32 v101, v101
    v_mfma_f32_16x16x32_bf16 v[112:115], a[48:51], v[20:23], 0
    v_cvt_pk_bf16_f32 v97, v98, v99
    s_cmp_eq_u32 s67, 0
    s_cbranch_scc1 L_pk_f12_2
    buffer_load_dwordx4 a[240:243], v10, s[60:63], s76 offen nt
    buffer_load_dwordx4 a[244:247], v11, s[60:63], s76 offen nt
    buffer_load_dwordx4 a[248:251], v10, s[60:63], s77 offen nt
    buffer_load_dwordx4 a[252:255], v11, s[60:63], s77 offen nt
L_pk_f12_2:
    v_exp_f32 v102, v102
    v_mfma_f32_16x16x32_bf16 v[116:119], a[52:55], v[20:23], 0
    v_exp_f32 v103, v103
    v_cvt_pk_bf16_f32 v98, v100, v101
    v_cvt_pk_bf16_f32 v99, v102, v103
    v_exp_f32 v104, v104
    v_exp_f32 v105, v105
    buffer_load_dwordx4 v1, s[8:11], s58 offen offset:0 lds
    v_exp_f32 v106, v106
    v_mfma_f32_16x16x32_bf16 v[192:195], a[128:131], v[96:99], v[192:195]
    v_exp_f32 v107, v107
    buffer_load_dwordx4 v1, s[8:11], s58 offen offset:1024 lds
    v_mfma_f32_16x16x32_bf16 v[196:199], a[132:135], v[96:99], v[196:199]
    v_exp_f32 v108, v108
    buffer_load_dwordx4 v1, s[8:11], s58 offen offset:2048 lds
    v_cvt_pk_bf16_f32 v104, v104, v105
    v_exp_f32 v109, v109
    v_mfma_f32_16x16x32_bf16 v[120:123], a[56:59], v[20:23], 0
    v_cvt_pk_bf16_f32 v105, v106, v107
    buffer_load_dwordx4 v1, s[8:11], s58 offen offset:3072 lds
    s_add_u32 m0, m0, 16384
    s_add_u32 s58, s58, 16384
    v_exp_f32 v110, v110
    v_mfma_f32_16x16x32_bf16 v[124:127], a[60:63], v[20:23], 0
    v_exp_f32 v111, v111
    v_cvt_pk_bf16_f32 v106, v108, v109
    v_cvt_pk_bf16_f32 v107, v110, v111
    v_exp_f32 v112, v112
    v_exp_f32 v113, v113
    buffer_load_dwordx4 v1, s[8:11], s58 offen offset:0 lds
    v_exp_f32 v114, v114
    v_mfma_f32_16x16x32_bf16 v[192:195], a[136:139], v[104:107], v[192:195]
    v_exp_f32 v115, v115
    buffer_load_dwordx4 v1, s[8:11], s58 offen offset:1024 lds
    v_mfma_f32_16x16x32_bf16 v[196:199], a[140:143], v[104:107], v[196:199]
    v_exp_f32 v116, v116
    buffer_load_dwordx4 v1, s[8:11], s58 offen offset:2048 lds
    v_cvt_pk_bf16_f32 v112, v112, v113
    v_exp_f32 v117, v117
    v_mfma_f32_16x16x32_bf16 v[48:51], a[48:51], v[24:27], 0
    v_cvt_pk_bf16_f32 v113, v114, v115
    buffer_load_dwordx4 v1, s[8:11], s58 offen offset:3072 lds
    s_add_u32 m0, m0, 16384
    s_add_u32 s58, s58, 16384
    v_exp_f32 v118, v118
    v_mfma_f32_16x16x32_bf16 v[52:55], a[52:55], v[24:27], 0
    v_exp_f32 v119, v119
    v_cvt_pk_bf16_f32 v114, v116, v117
    v_cvt_pk_bf16_f32 v115, v118, v119
    v_exp_f32 v120, v120
    v_exp_f32 v121, v121
    buffer_load_dwordx4 v1, s[8:11], s58 offen offset:0 lds
    v_exp_f32 v122, v122
    v_exp_f32 v123, v123
    v_mfma_f32_16x16x32_bf16 v[200:203], a[128:131], v[112:115], v[200:203]
    v_exp_f32 v124, v124
    v_cvt_pk_bf16_f32 v120, v120, v121
    v_exp_f32 v125, v125
    buffer_load_dwordx4 v1, s[8:11], s58 offen offset:1024 lds
    v_cvt_pk_bf16_f32 v121, v122, v123
    v_exp_f32 v126, v126
    v_exp_f32 v127, v127
    v_mfma_f32_16x16x32_bf16 v[204:207], a[132:135], v[112:115], v[204:207]
    v_cvt_pk_bf16_f32 v122, v124, v125
    v_cvt_pk_bf16_f32 v123, v126, v127
    v_mov_b32 v228, v199
    v_mov_b32 v226, v199
    v_cndmask_b32 v196, v196, v198, s[40:41]
    buffer_load_dwordx4 v1, s[8:11], s58 offen offset:2048 lds
    v_cndmask_b32 v197, v197, v199, s[40:41]
    v_permlane32_swap_b32 v226, v228
    v_mov_b32 v226, v228
    s_nop 1
    v_permlane16_swap_b32 v226, v228
    v_mfma_f32_16x16x32_bf16 v[56:59], a[56:59], v[24:27], 0
    v_rcp_f32 v226, v228
    v_med3_f32 v229, v228, v241, v242
    v_sub_f32 v229, v229, v228
    buffer_load_dwordx4 v1, s[8:11], s58 offen offset:3072 lds
    s_add_u32 m0, m0, 16384
    s_add_u32 s58, s58, 16384
    v_fma_f32 v229, v192, 0, v229
    v_fma_f32 v229, v193, 0, v229
    v_fma_f32 v229, v194, 0, v229
    v_fma_f32 v229, v195, 0, v229
    v_fma_f32 v229, v196, 0, v229
    v_mfma_f32_16x16x32_bf16 v[60:63], a[60:63], v[24:27], 0
    v_fma_f32 v229, v197, 0, v229
    v_cmp_neq_f32 vcc, 0, v229
    v_pk_mul_f32 v[192:193], v[192:193], v[226:227] op_sel_hi:[1,0]
    v_pk_mul_f32 v[194:195], v[194:195], v[226:227] op_sel_hi:[1,0]
    v_pk_mul_f32 v[196:197], v[196:197], v[226:227] op_sel_hi:[1,0]
    s_or_b64 s[64:65], s[64:65], vcc
    v_cvt_pk_bf16_f32 v198, v196, v197
    v_cvt_pk_bf16_f32 v192, v192, v193
    v_cvt_pk_bf16_f32 v193, v194, v195
    ds_bpermute_b32 v227, v243, v198
    ds_write_b64 v251, v[192:193] offset:0
    v_exp_f32 v48, v48
    v_exp_f32 v49, v49
    buffer_load_dwordx4 v1, s[8:11], s58 offen offset:0 lds
    v_exp_f32 v50, v50
    v_mfma_f32_16x16x32_bf16 v[200:203], a[136:139], v[120:123], v[200:203]
    v_exp_f32 v51, v51
    buffer_load_dwordx4 v1, s[8:11], s58 offen offset:1024 lds
    v_exp_f32 v52, v52
    v_cvt_pk_bf16_f32 v48, v48, v49
    v_mfma_f32_16x16x32_bf16 v[204:207], a[140:143], v[120:123], v[204:207]
    v_exp_f32 v53, v53
    buffer_load_dwordx4 v1, s[8:11], s58 offen offset:2048 lds
    v_cvt_pk_bf16_f32 v49, v50, v51
    v_exp_f32 v54, v54
    v_mfma_f32_16x16x32_bf16 v[64:67], a[48:51], v[28:31], 0
    v_exp_f32 v55, v55
    v_cvt_pk_bf16_f32 v50, v52, v53
    v_mfma_f32_16x16x32_bf16 v[68:71], a[52:55], v[28:31], 0
    v_cvt_pk_bf16_f32 v51, v54, v55
    s_mov_b32 vcc_lo, 65535
    s_mov_b32 vcc_hi, 0
    s_waitcnt lgkmcnt(1)
    v_cndmask_b32 v12, v12, v227, vcc
    v_exp_f32 v56, v56
    v_exp_f32 v57, v57
    buffer_load_dwordx4 v1, s[8:11], s58 offen offset:3072 lds
    s_add_u32 m0, m0, 16384
    s_add_u32 s58, s58, 16384
    v_exp_f32 v58, v58
    v_exp_f32 v59, v59
    v_mfma_f32_16x16x32_bf16 v[208:211], a[128:131], v[48:51], v[208:211]
    v_exp_f32 v60, v60
    v_cvt_pk_bf16_f32 v56, v56, v57
    v_exp_f32 v61, v61
    v_cvt_pk_bf16_f32 v57, v58, v59
    buffer_load_dwordx4 v1, s[8:11], s58 offen offset:0 lds
    v_exp_f32 v62, v62
    v_exp_f32 v63, v63
    v_cvt_pk_bf16_f32 v58, v60, v61
    v_cvt_pk_bf16_f32 v59, v62, v63
    v_mfma_f32_16x16x32_bf16 v[212:215], a[132:135], v[48:51], v[212:215]
    v_mov_b32 v228, v207
    v_mov_b32 v226, v207
    v_cndmask_b32 v204, v204, v206, s[40:41]
    v_cndmask_b32 v205, v205, v207, s[40:41]
    v_permlane32_swap_b32 v226, v228
    v_mov_b32 v226, v228
    s_nop 1
    v_permlane16_swap_b32 v226, v228
    buffer_load_dwordx4 v1, s[8:11], s58 offen offset:1024 lds
    v_rcp_f32 v226, v228
    v_mfma_f32_16x16x32_bf16 v[72:75], a[56:59], v[28:31], 0
    v_med3_f32 v229, v228, v241, v242
    v_sub_f32 v229, v229, v228
    v_fma_f32 v229, v200, 0, v229
    v_fma_f32 v229, v201, 0, v229
    v_fma_f32 v229, v202, 0, v229
    v_fma_f32 v229, v203, 0, v229
    v_mfma_f32_16x16x32_bf16 v[76:79], a[60:63], v[28:31], 0
    v_fma_f32 v229, v204, 0, v229
    v_fma_f32 v229, v205, 0, v229
    v_cmp_neq_f32 vcc, 0, v229
    v_pk_mul_f32 v[200:201], v[200:201], v[226:227] op_sel_hi:[1,0]
    v_pk_mul_f32 v[202:203], v[202:203], v[226:227] op_sel_hi:[1,0]
    v_pk_mul_f32 v[204:205], v[204:205], v[226:227] op_sel_hi:[1,0]
    s_or_b64 s[64:65], s[64:65], vcc
    v_cvt_pk_bf16_f32 v206, v204, v205
    v_cvt_pk_bf16_f32 v200, v200, v201
    v_cvt_pk_bf16_f32 v201, v202, v203
    ds_bpermute_b32 v227, v243, v206
    ds_write_b64 v251, v[200:201] offset:1024
    v_exp_f32 v64, v64
    v_exp_f32 v65, v65
    buffer_load_dwordx4 v1, s[8:11], s58 offen offset:2048 lds
    v_exp_f32 v66, v66
    buffer_load_dwordx4 v1, s[8:11], s58 offen offset:3072 lds
    s_add_u32 m0, m0, 16384
    s_add_u32 s58, s58, 16384
    v_exp_f32 v67, v67
    v_exp_f32 v68, v68
    v_mfma_f32_16x16x32_bf16 v[208:211], a[136:139], v[56:59], v[208:211]
    v_cvt_pk_bf16_f32 v64, v64, v65
    v_exp_f32 v69, v69
    v_cvt_pk_bf16_f32 v65, v66, v67
    buffer_load_dwordx4 v1, s[8:11], s58 offen offset:0 lds
    v_exp_f32 v70, v70
    v_exp_f32 v71, v71
    v_mfma_f32_16x16x32_bf16 v[212:215], a[140:143], v[56:59], v[212:215]
    v_cvt_pk_bf16_f32 v66, v68, v69
    v_cvt_pk_bf16_f32 v67, v70, v71
    s_mov_b32 vcc_lo, 4294901760
    s_mov_b32 vcc_hi, 0
    s_waitcnt lgkmcnt(1)
    v_cndmask_b32 v12, v12, v227, vcc
    v_exp_f32 v72, v72
    v_exp_f32 v73, v73
    buffer_load_dwordx4 v1, s[8:11], s58 offen offset:1024 lds
    v_exp_f32 v74, v74
    v_exp_f32 v75, v75
    v_exp_f32 v76, v76
    v_cvt_pk_bf16_f32 v72, v72, v73
    buffer_load_dwordx4 v1, s[8:11], s58 offen offset:2048 lds
    v_exp_f32 v77, v77
    v_cvt_pk_bf16_f32 v73, v74, v75
    v_exp_f32 v78, v78
    v_exp_f32 v79, v79
    v_cvt_pk_bf16_f32 v74, v76, v77
    v_mfma_f32_16x16x32_bf16 v[216:219], a[128:131], v[64:67], v[216:219]
    v_cvt_pk_bf16_f32 v75, v78, v79
    v_mov_b32 v228, v215
    v_mov_b32 v226, v215
    v_cndmask_b32 v212, v212, v214, s[40:41]
    v_cndmask_b32 v213, v213, v215, s[40:41]
    v_permlane32_swap_b32 v226, v228
    v_mov_b32 v226, v228
    s_nop 1
    v_permlane16_swap_b32 v226, v228
    buffer_load_dwordx4 v1, s[8:11], s58 offen offset:3072 lds
    s_add_u32 m0, m0, 16384
    s_add_u32 s58, s58, 16384
    v_rcp_f32 v226, v228
    v_med3_f32 v229, v228, v241, v242
    v_sub_f32 v229, v229, v228
    v_fma_f32 v229, v208, 0, v229
    v_fma_f32 v229, v209, 0, v229
    v_mfma_f32_16x16x32_bf16 v[220:223], a[132:135], v[64:67], v[220:223]
    v_fma_f32 v229, v210, 0, v229
    v_fma_f32 v229, v211, 0, v229
    v_fma_f32 v229, v212, 0, v229
    v_fma_f32 v229, v213, 0, v229
    v_cmp_neq_f32 vcc, 0, v229
    v_pk_mul_f32 v[208:209], v[208:209], v[226:227] op_sel_hi:[1,0]
    v_pk_mul_f32 v[210:211], v[210:211], v[226:227] op_sel_hi:[1,0]
    v_pk_mul_f32 v[212:213], v[212:213], v[226:227] op_sel_hi:[1,0]
    s_or_b64 s[64:65], s[64:65], vcc
    v_cvt_pk_bf16_f32 v214, v212, v213
    v_cvt_pk_bf16_f32 v208, v208, v209
    v_cvt_pk_bf16_f32 v209, v210, v211
    ds_bpermute_b32 v227, v243, v214
    ds_write_b64 v251, v[208:209] offset:2048
    s_mov_b32 vcc_lo, 0
    s_mov_b32 vcc_hi, 65535
    s_waitcnt lgkmcnt(1)
    v_cndmask_b32 v12, v12, v227, vcc
    v_mfma_f32_16x16x32_bf16 v[216:219], a[136:139], v[72:75], v[216:219]
    v_mfma_f32_16x16x32_bf16 v[220:223], a[140:143], v[72:75], v[220:223]
    s_nop 7
    v_mov_b32 v228, v223
    v_mov_b32 v226, v223
    v_cndmask_b32 v220, v220, v222, s[40:41]
    v_cndmask_b32 v221, v221, v223, s[40:41]
    v_permlane32_swap_b32 v226, v228
    v_mov_b32 v226, v228
    s_nop 1
    v_permlane16_swap_b32 v226, v228
    v_rcp_f32 v226, v228
    v_med3_f32 v229, v228, v241, v242
    v_sub_f32 v229, v229, v228
    v_fma_f32 v229, v216, 0, v229
    v_fma_f32 v229, v217, 0, v229
    v_fma_f32 v229, v218, 0, v229
    v_fma_f32 v229, v219, 0, v229
    v_fma_f32 v229, v220, 0, v229
    v_fma_f32 v229, v221, 0, v229
    v_cmp_neq_f32 vcc, 0, v229
    v_pk_mul_f32 v[216:217], v[216:217], v[226:227] op_sel_hi:[1,0]
    v_pk_mul_f32 v[218:219], v[218:219], v[226:227] op_sel_hi:[1,0]
    v_pk_mul_f32 v[220:221], v[220:221], v[226:227] op_sel_hi:[1,0]
    s_or_b64 s[64:65], s[64:65], vcc
    v_cvt_pk_bf16_f32 v222, v220, v221
    v_cvt_pk_bf16_f32 v216, v216, v217
    v_cvt_pk_bf16_f32 v217, v218, v219
    ds_bpermute_b32 v227, v243, v222
    ds_write_b64 v251, v[216:217] offset:3072
    s_mov_b32 vcc_lo, 0
    s_mov_b32 vcc_hi, 4294901760
    s_waitcnt lgkmcnt(1)
    v_cndmask_b32 v12, v12, v227, vcc
    ds_write_b32 v240, v12
    s_cmp_eq_u64 s[64:65], 0
    s_cbranch_scc1 L_attn_done
    s_waitcnt lgkmcnt(0)
    s_branch L_attn_er12
L_attn_f16:
    v_mfma_f32_16x16x32_bf16 v[48:51], a[64:67], v[16:19], v[236:239]
    v_mfma_f32_16x16x32_bf16 v[56:59], a[64:67], v[20:23], 0
    v_mfma_f32_16x16x32_bf16 v[60:63], a[68:71], v[20:23], v[236:239]
    v_mfma_f32_16x16x32_bf16 v[64:67], a[64:67], v[24:27], 0
    v_mfma_f32_16x16x32_bf16 v[68:71], a[68:71], v[24:27], 0
    v_mfma_f32_16x16x32_bf16 v[72:75], a[72:75], v[24:27], v[236:239]
    v_mfma_f32_16x16x32_bf16 v[80:83], a[64:67], v[28:31], 0
    v_mfma_f32_16x16x32_bf16 v[84:87], a[68:71], v[28:31], 0
    v_mfma_f32_16x16x32_bf16 v[88:91], a[72:75], v[28:31], 0
    v_mfma_f32_16x16x32_bf16 v[92:95], a[76:79], v[28:31], v[236:239]
    s_nop 2
    v_exp_f32 v48, v48
    v_exp_f32 v49, v49
    v_exp_f32 v50, v50
    v_exp_f32 v51, v51
    v_cvt_pk_bf16_f32 v48, v48, v49
    v_cvt_pk_bf16_f32 v49, v50, v51
    v_mov_b32 v50, 0
    v_mov_b32 v51, 0
    v_exp_f32 v56, v56
    v_exp_f32 v57, v57
    v_mfma_f32_16x16x32_bf16 v[192:195], a[144:147], v[48:51], 0
    v_exp_f32 v58, v58
    v_exp_f32 v59, v59
    v_exp_f32 v60, v60
    v_mfma_f32_16x16x32_bf16 v[196:199], a[148:151], v[48:51], 0
    v_cvt_pk_bf16_f32 v56, v56, v57
    v_exp_f32 v61, v61
    v_cvt_pk_bf16_f32 v57, v58, v59
    v_exp_f32 v62, v62
    v_exp_f32 v63, v63
    v_cvt_pk_bf16_f32 v58, v60, v61
    v_cvt_pk_bf16_f32 v59, v62, v63
    v_exp_f32 v64, v64
    v_exp_f32 v65, v65
    v_mfma_f32_16x16x32_bf16 v[200:203], a[144:147], v[56:59], 0
    v_exp_f32 v66, v66
    v_exp_f32 v67, v67
    v_exp_f32 v68, v68
    v_cvt_pk_bf16_f32 v64, v64, v65
    v_exp_f32 v69, v69
    v_cvt_pk_bf16_f32 v65, v66, v67
    v_exp_f32 v70, v70
    v_exp_f32 v71, v71
    v_cvt_pk_bf16_f32 v66, v68, v69
    v_cvt_pk_bf16_f32 v67, v70, v71
    v_mov_b32 v228, v199
    v_mov_b32 v226, v199
    v_cndmask_b32 v196, v196, v198, s[40:41]
    v_mfma_f32_16x16x32_bf16 v[204:207], a[148:151], v[56:59], 0
    v_cndmask_b32 v197, v197, v199, s[40:41]
    v_permlane32_swap_b32 v226, v228
    v_mov_b32 v226, v228
    s_nop 1
    v_permlane16_swap_b32 v226, v228
    v_rcp_f32 v226, v228
    v_med3_f32 v229, v228, v241, v242
    v_sub_f32 v229, v229, v228
    v_fma_f32 v229, v192, 0, v229
    v_fma_f32 v229, v193, 0, v229
    v_fma_f32 v229, v194, 0, v229
    v_fma_f32 v229, v195, 0, v229
    v_fma_f32 v229, v196, 0, v229
    v_fma_f32 v229, v197, 0, v229
    v_cmp_neq_f32 vcc, 0, v229
    v_pk_mul_f32 v[192:193], v[192:193], v[226:227] op_sel_hi:[1,0]
    v_pk_mul_f32 v[194:195], v[194:195], v[226:227] op_sel_hi:[1,0]
    v_pk_mul_f32 v[196:197], v[196:197], v[226:227] op_sel_hi:[1,0]
    s_or_b64 s[64:65], s[64:65], vcc
    v_cvt_pk_bf16_f32 v198, v196, v197
    v_cvt_pk_bf16_f32 v192, v192, v193
    v_cvt_pk_bf16_f32 v193, v194, v195
    ds_bpermute_b32 v227, v243, v198
    ds_write_b64 v251, v[192:193] offset:0
    v_exp_f32 v72, v72
    v_exp_f32 v73, v73
    v_mfma_f32_16x16x32_bf16 v[208:211], a[144:147], v[64:67], 0
    v_exp_f32 v74, v74
    v_exp_f32 v75, v75
    v_cvt_pk_bf16_f32 v72, v72, v73
    v_cvt_pk_bf16_f32 v73, v74, v75
    v_mov_b32 v74, 0
    v_mov_b32 v75, 0
    s_nop 7
    s_mov_b32 vcc_lo, 65535
    s_mov_b32 vcc_hi, 0
    s_waitcnt lgkmcnt(1)
    v_cndmask_b32 v12, v12, v227, vcc
    v_mfma_f32_16x16x32_bf16 v[212:215], a[148:151], v[64:67], 0
    v_mov_b32 v228, v207
    v_mov_b32 v226, v207
    v_cndmask_b32 v204, v204, v206, s[40:41]
    v_cndmask_b32 v205, v205, v207, s[40:41]
    v_permlane32_swap_b32 v226, v228
    v_mov_b32 v226, v228
    s_nop 1
    v_permlane16_swap_b32 v226, v228
    v_rcp_f32 v226, v228
    v_med3_f32 v229, v228, v241, v242
    v_sub_f32 v229, v229, v228
    v_fma_f32 v229, v200, 0, v229
    v_fma_f32 v229, v201, 0, v229
    v_fma_f32 v229, v202, 0, v229
    v_fma_f32 v229, v203, 0, v229
    v_fma_f32 v229, v204, 0, v229
    v_fma_f32 v229, v205, 0, v229
    v_cmp_neq_f32 vcc, 0, v229
    v_pk_mul_f32 v[200:201], v[200:201], v[226:227] op_sel_hi:[1,0]
    v_pk_mul_f32 v[202:203], v[202:203], v[226:227] op_sel_hi:[1,0]
    v_pk_mul_f32 v[204:205], v[204:205], v[226:227] op_sel_hi:[1,0]
    s_or_b64 s[64:65], s[64:65], vcc
    v_cvt_pk_bf16_f32 v206, v204, v205
    v_cvt_pk_bf16_f32 v200, v200, v201
    v_cvt_pk_bf16_f32 v201, v202, v203
    ds_bpermute_b32 v227, v243, v206
    ds_write_b64 v251, v[200:201] offset:1024
    v_exp_f32 v80, v80
    v_exp_f32 v81, v81
    s_cmp_eq_u32 s67, 0
    s_cbranch_scc1 2
    s_waitcnt vmcnt(24)
    s_branch 1
    s_waitcnt vmcnt(0)
    s_barrier
    v_exp_f32 v82, v82
    v_exp_f32 v83, v83
    v_exp_f32 v84, v84
    v_mfma_f32_16x16x32_bf16 v[208:211], a[152:155], v[72:75], v[208:211]
    v_cvt_pk_bf16_f32 v80, v80, v81
    v_exp_f32 v85, v85
    v_cvt_pk_bf16_f32 v81, v82, v83
    v_exp_f32 v86, v86
    v_mfma_f32_16x16x32_bf16 v[212:215], a[156:159], v[72:75], v[212:215]
    v_exp_f32 v87, v87
    v_cvt_pk_bf16_f32 v82, v84, v85
    v_cvt_pk_bf16_f32 v83, v86, v87
    s_mov_b32 vcc_lo, 4294901760
    s_mov_b32 vcc_hi, 0
    s_waitcnt lgkmcnt(1)
    v_cndmask_b32 v12, v12, v227, vcc
    v_exp_f32 v88, v88
    v_exp_f32 v89, v89
    s_waitcnt lgkmcnt(0)
    s_mov_b32 m0, s59
    s_waitcnt vmcnt(0)
    s_barrier
    v_mov_b32 v254, s100
    v_mov_b32 v255, s101
    s_mov_b32 s30, 159072863
    s_mul_hi_u32 s27, s2, s30
    s_mul_i32 s27, s27, 5
    s_add_u32 s27, s27, s2
    s_lshl_b32 s27, s27, 3
    s_add_u32 s27, s27, 63885312
    s_cmp_lt_u32 s2, 216
    s_cselect_b32 s27, s27, 1073741824
    s_cmp_eq_u32 s20, 0
    s_cselect_b32 s27, s27, 1073741824
    buffer_store_dwordx2 v[254:255], v13, s[8:11], s27 offen sc1
    s_cmp_eq_u32 s67, 0
    s_cbranch_scc1 L_pk_f16_0
    buffer_load_dwordx4 a[208:211], v10, s[60:63], s72 offen nt
    buffer_load_dwordx4 a[212:215], v11, s[60:63], s72 offen nt
    buffer_load_dwordx4 a[216:219], v10, s[60:63], s73 offen nt
    buffer_load_dwordx4 a[220:223], v11, s[60:63], s73 offen nt
L_pk_f16_0:
    v_exp_f32 v90, v90
    s_cmp_eq_u32 s67, 0
    s_cbranch_scc1 L_pk_f16_1
    buffer_load_dwordx4 a[224:227], v10, s[60:63], s74 offen nt
    buffer_load_dwordx4 a[228:231], v11, s[60:63], s74 offen nt
    buffer_load_dwordx4 a[232:235], v10, s[60:63], s75 offen nt
    buffer_load_dwordx4 a[236:239], v11, s[60:63], s75 offen nt
L_pk_f16_1:
    v_exp_f32 v91, v91
    s_cmp_eq_u32 s67, 0
    s_cbranch_scc1 L_pk_f16_2
    buffer_load_dwordx4 a[240:243], v10, s[60:63], s76 offen nt
    buffer_load_dwordx4 a[244:247], v11, s[60:63], s76 offen nt
    buffer_load_dwordx4 a[248:251], v10, s[60:63], s77 offen nt
    buffer_load_dwordx4 a[252:255], v11, s[60:63], s77 offen nt
L_pk_f16_2:
    buffer_load_dwordx4 v1, s[8:11], s58 offen offset:0 lds
    v_exp_f32 v92, v92
    buffer_load_dwordx4 v1, s[8:11], s58 offen offset:1024 lds
    v_cvt_pk_bf16_f32 v88, v88, v89
    buffer_load_dwordx4 v1, s[8:11], s58 offen offset:2048 lds
    v_exp_f32 v93, v93
    buffer_load_dwordx4 v1, s[8:11], s58 offen offset:3072 lds
    s_add_u32 m0, m0, 16384
    s_add_u32 s58, s58, 16384
    buffer_load_dwordx4 v1, s[8:11], s58 offen offset:0 lds
    v_cvt_pk_bf16_f32 v89, v90, v91
    v_exp_f32 v94, v94
    buffer_load_dwordx4 v1, s[8:11], s58 offen offset:1024 lds
    buffer_load_dwordx4 v1, s[8:11], s58 offen offset:2048 lds
    v_exp_f32 v95, v95
    buffer_load_dwordx4 v1, s[8:11], s58 offen offset:3072 lds
    s_add_u32 m0, m0, 16384
    s_add_u32 s58, s58, 16384
    v_cvt_pk_bf16_f32 v90, v92, v93
    buffer_load_dwordx4 v1, s[8:11], s58 offen offset:0 lds
    v_cvt_pk_bf16_f32 v91, v94, v95
    buffer_load_dwordx4 v1, s[8:11], s58 offen offset:1024 lds
    v_mov_b32 v228, v215
    v_mov_b32 v226, v215
    v_mfma_f32_16x16x32_bf16 v[216:219], a[144:147], v[80:83], 0
    v_cndmask_b32 v212, v212, v214, s[40:41]
    buffer_load_dwordx4 v1, s[8:11], s58 offen offset:2048 lds
    v_cndmask_b32 v213, v213, v215, s[40:41]
    buffer_load_dwordx4 v1, s[8:11], s58 offen offset:3072 lds
    s_add_u32 m0, m0, 16384
    s_add_u32 s58, s58, 16384
    v_permlane32_swap_b32 v226, v228
    v_mov_b32 v226, v228
    s_nop 1
    v_permlane16_swap_b32 v226, v228
    buffer_load_dwordx4 v1, s[8:11], s58 offen offset:0 lds
    buffer_load_dwordx4 v1, s[8:11], s58 offen offset:1024 lds
    buffer_load_dwordx4 v1, s[8:11], s58 offen offset:2048 lds
    buffer_load_dwordx4 v1, s[8:11], s58 offen offset:3072 lds
    s_add_u32 m0, m0, 16384
    s_add_u32 s58, s58, 16384
    v_rcp_f32 v226, v228
    buffer_load_dwordx4 v1, s[8:11], s58 offen offset:0 lds
    v_med3_f32 v229, v228, v241, v242
    buffer_load_dwordx4 v1, s[8:11], s58 offen offset:1024 lds
    v_sub_f32 v229, v229, v228
    buffer_load_dwordx4 v1, s[8:11], s58 offen offset:2048 lds
    v_fma_f32 v229, v208, 0, v229
    v_fma_f32 v229, v209, 0, v229
    buffer_load_dwordx4 v1, s[8:11], s58 offen offset:3072 lds
    s_add_u32 m0, m0, 16384
    s_add_u32 s58, s58, 16384
    v_fma_f32 v229, v210, 0, v229
    buffer_load_dwordx4 v1, s[8:11], s58 offen offset:0 lds
    v_fma_f32 v229, v211, 0, v229
    buffer_load_dwordx4 v1, s[8:11], s58 offen offset:1024 lds
    v_fma_f32 v229, v212, 0, v229
    v_fma_f32 v229, v213, 0, v229
    buffer_load_dwordx4 v1, s[8:11], s58 offen offset:2048 lds
    v_cmp_neq_f32 vcc, 0, v229
    buffer_load_dwordx4 v1, s[8:11], s58 offen offset:3072 lds
    s_add_u32 m0, m0, 16384
    s_add_u32 s58, s58, 16384
    v_pk_mul_f32 v[208:209], v[208:209], v[226:227] op_sel_hi:[1,0]
    v_mfma_f32_16x16x32_bf16 v[220:223], a[148:151], v[80:83], 0
    v_pk_mul_f32 v[210:211], v[210:211], v[226:227] op_sel_hi:[1,0]
    v_pk_mul_f32 v[212:213], v[212:213], v[226:227] op_sel_hi:[1,0]
    s_or_b64 s[64:65], s[64:65], vcc
    v_cvt_pk_bf16_f32 v214, v212, v213
    v_cvt_pk_bf16_f32 v208, v208, v209
    v_cvt_pk_bf16_f32 v209, v210, v211
    ds_bpermute_b32 v227, v243, v214
    ds_write_b64 v251, v[208:209] offset:2048
    s_mov_b32 vcc_lo, 0
    s_mov_b32 vcc_hi, 65535
    s_waitcnt lgkmcnt(1)
    v_cndmask_b32 v12, v12, v227, vcc
    v_mfma_f32_16x16x32_bf16 v[216:219], a[152:155], v[88:91], v[216:219]
    v_mfma_f32_16x16x32_bf16 v[220:223], a[156:159], v[88:91], v[220:223]
    s_nop 7
    v_mov_b32 v228, v223
    v_mov_b32 v226, v223
    v_cndmask_b32 v220, v220, v222, s[40:41]
    v_cndmask_b32 v221, v221, v223, s[40:41]
    v_permlane32_swap_b32 v226, v228
    v_mov_b32 v226, v228
    s_nop 1
    v_permlane16_swap_b32 v226, v228
    v_rcp_f32 v226, v228
    v_med3_f32 v229, v228, v241, v242
    v_sub_f32 v229, v229, v228
    v_fma_f32 v229, v216, 0, v229
    v_fma_f32 v229, v217, 0, v229
    v_fma_f32 v229, v218, 0, v229
    v_fma_f32 v229, v219, 0, v229
    v_fma_f32 v229, v220, 0, v229
    v_fma_f32 v229, v221, 0, v229
    v_cmp_neq_f32 vcc, 0, v229
    v_pk_mul_f32 v[216:217], v[216:217], v[226:227] op_sel_hi:[1,0]
    v_pk_mul_f32 v[218:219], v[218:219], v[226:227] op_sel_hi:[1,0]
    v_pk_mul_f32 v[220:221], v[220:221], v[226:227] op_sel_hi:[1,0]
    s_or_b64 s[64:65], s[64:65], vcc
    v_cvt_pk_bf16_f32 v222, v220, v221
    v_cvt_pk_bf16_f32 v216, v216, v217
    v_cvt_pk_bf16_f32 v217, v218, v219
    ds_bpermute_b32 v227, v243, v222
    ds_write_b64 v251, v[216:217] offset:3072
    s_mov_b32 vcc_lo, 0
    s_mov_b32 vcc_hi, 4294901760
    s_waitcnt lgkmcnt(1)
    v_cndmask_b32 v12, v12, v227, vcc
    ds_write_b32 v240, v12
    s_cmp_eq_u64 s[64:65], 0
    s_cbranch_scc1 L_attn_done
    s_waitcnt lgkmcnt(0)
    s_branch L_attn_er16
L_attn_er0:
    v_mfma_f32_16x16x32_bf16 v[48:51], a[0:3], v[16:19], v[232:235]
    v_mfma_f32_16x16x32_bf16 v[52:55], a[4:7], v[16:19], 0
    v_mfma_f32_16x16x32_bf16 v[56:59], a[8:11], v[16:19], 0
    v_mfma_f32_16x16x32_bf16 v[60:63], a[12:15], v[16:19], 0
    v_mfma_f32_16x16x32_bf16 v[64:67], a[16:19], v[16:19], 0
    v_mfma_f32_16x16x32_bf16 v[68:71], a[20:23], v[16:19], 0
    v_mfma_f32_16x16x32_bf16 v[72:75], a[24:27], v[16:19], 0
    v_mfma_f32_16x16x32_bf16 v[76:79], a[28:31], v[16:19], 0
    v_mfma_f32_16x16x32_bf16 v[80:83], a[32:35], v[16:19], 0
    v_mfma_f32_16x16x32_bf16 v[84:87], a[36:39], v[16:19], 0
    v_mfma_f32_16x16x32_bf16 v[88:91], a[40:43], v[16:19], 0
    v_mfma_f32_16x16x32_bf16 v[92:95], a[44:47], v[16:19], 0
    v_mfma_f32_16x16x32_bf16 v[96:99], a[48:51], v[16:19], 0
    v_mfma_f32_16x16x32_bf16 v[100:103], a[52:55], v[16:19], 0
    v_mfma_f32_16x16x32_bf16 v[104:107], a[56:59], v[16:19], 0
    v_mfma_f32_16x16x32_bf16 v[108:111], a[60:63], v[16:19], 0
    v_mfma_f32_16x16x32_bf16 v[112:115], a[64:67], v[16:19], v[236:239]
    s_nop 7
    v_mfma_f32_16x16x32_bf16 v[124:127], a[4:7], v[20:23], v[232:235]
    v_max_f32 v224, v48, v50
    v_max_f32 v225, v49, v51
    v_max3_f32 v224, v224, v52, v54
    v_max3_f32 v225, v225, v53, v55
    v_max3_f32 v224, v224, v56, v58
    v_max3_f32 v225, v225, v57, v59
    v_max3_f32 v224, v224, v60, v62
    v_max3_f32 v225, v225, v61, v63
    v_max3_f32 v224, v224, v64, v66
    v_max3_f32 v225, v225, v65, v67
    v_max3_f32 v224, v224, v68, v70
    v_max3_f32 v225, v225, v69, v71
    v_max3_f32 v224, v224, v72, v74
    v_max3_f32 v225, v225, v73, v75
    v_max3_f32 v224, v224, v76, v78
    v_mfma_f32_16x16x32_bf16 v[128:131], a[8:11], v[20:23], 0
    v_max3_f32 v225, v225, v77, v79
    v_max3_f32 v224, v224, v80, v82
    v_max3_f32 v225, v225, v81, v83
    v_max3_f32 v224, v224, v84, v86
    v_max3_f32 v225, v225, v85, v87
    v_max3_f32 v224, v224, v88, v90
    v_max3_f32 v225, v225, v89, v91
    v_max3_f32 v224, v224, v92, v94
    v_max3_f32 v225, v225, v93, v95
    v_max3_f32 v224, v224, v96, v98
    v_max3_f32 v225, v225, v97, v99
    v_max3_f32 v224, v224, v100, v102
    v_max3_f32 v225, v225, v101, v103
    v_max3_f32 v224, v224, v104, v106
    v_max3_f32 v225, v225, v105, v107
    v_mfma_f32_16x16x32_bf16 v[132:135], a[12:15], v[20:23], 0
    v_max3_f32 v224, v224, v108, v110
    v_max3_f32 v225, v225, v109, v111
    v_max3_f32 v224, v224, v112, v114
    v_max3_f32 v225, v225, v113, v115
    v_max_f32 v224, v224, v225
    v_mov_b32 v225, v224
    s_nop 1
    v_permlane16_swap_b32 v224, v225
    v_max_f32 v224, v224, v225
    v_mov_b32 v225, v224
    s_nop 1
    v_permlane32_swap_b32 v224, v225
    v_max_f32 v224, v224, v225
    v_sub_f32 v48, v48, v224
    v_sub_f32 v49, v49, v224
    v_mfma_f32_16x16x32_bf16 v[136:139], a[16:19], v[20:23], 0
    v_sub_f32 v50, v50, v224
    v_sub_f32 v51, v51, v224
    v_exp_f32 v48, v48
    v_exp_f32 v49, v49
    v_exp_f32 v50, v50
    v_exp_f32 v51, v51
    v_sub_f32 v52, v52, v224
    v_sub_f32 v53, v53, v224
    v_sub_f32 v54, v54, v224
    v_sub_f32 v55, v55, v224
    v_exp_f32 v52, v52
    v_mfma_f32_16x16x32_bf16 v[140:143], a[20:23], v[20:23], 0
    v_exp_f32 v53, v53
    v_exp_f32 v54, v54
    v_exp_f32 v55, v55
    v_cvt_pk_bf16_f32 v48, v48, v49
    v_cvt_pk_bf16_f32 v49, v50, v51
    v_cvt_pk_bf16_f32 v50, v52, v53
    v_cvt_pk_bf16_f32 v51, v54, v55
    v_sub_f32 v56, v56, v224
    v_sub_f32 v57, v57, v224
    v_sub_f32 v58, v58, v224
    v_sub_f32 v59, v59, v224
    v_mfma_f32_16x16x32_bf16 v[144:147], a[24:27], v[20:23], 0
    v_exp_f32 v56, v56
    v_exp_f32 v57, v57
    v_exp_f32 v58, v58
    v_exp_f32 v59, v59
    v_sub_f32 v60, v60, v224
    v_sub_f32 v61, v61, v224
    v_sub_f32 v62, v62, v224
    v_sub_f32 v63, v63, v224
    v_exp_f32 v60, v60
    v_exp_f32 v61, v61
    v_mfma_f32_16x16x32_bf16 v[148:151], a[28:31], v[20:23], 0
    v_exp_f32 v62, v62
    v_exp_f32 v63, v63
    v_cvt_pk_bf16_f32 v56, v56, v57
    v_cvt_pk_bf16_f32 v57, v58, v59
    v_cvt_pk_bf16_f32 v58, v60, v61
    v_cvt_pk_bf16_f32 v59, v62, v63
    v_sub_f32 v64, v64, v224
    v_sub_f32 v65, v65, v224
    v_sub_f32 v66, v66, v224
    v_sub_f32 v67, v67, v224
    v_exp_f32 v64, v64
    v_mfma_f32_16x16x32_bf16 v[152:155], a[32:35], v[20:23], 0
    v_exp_f32 v65, v65
    v_exp_f32 v66, v66
    v_exp_f32 v67, v67
    v_sub_f32 v68, v68, v224
    v_sub_f32 v69, v69, v224
    v_sub_f32 v70, v70, v224
    v_sub_f32 v71, v71, v224
    v_exp_f32 v68, v68
    v_exp_f32 v69, v69
    v_exp_f32 v70, v70
    v_mfma_f32_16x16x32_bf16 v[156:159], a[36:39], v[20:23], 0
    v_exp_f32 v71, v71
    v_cvt_pk_bf16_f32 v64, v64, v65
    v_cvt_pk_bf16_f32 v65, v66, v67
    v_cvt_pk_bf16_f32 v66, v68, v69
    v_cvt_pk_bf16_f32 v67, v70, v71
    v_sub_f32 v72, v72, v224
    v_sub_f32 v73, v73, v224
    v_sub_f32 v74, v74, v224
    v_sub_f32 v75, v75, v224
    v_exp_f32 v72, v72
    v_exp_f32 v73, v73
    v_mfma_f32_16x16x32_bf16 v[160:163], a[40:43], v[20:23], 0
    v_exp_f32 v74, v74
    v_exp_f32 v75, v75
    v_sub_f32 v76, v76, v224
    v_sub_f32 v77, v77, v224
    v_sub_f32 v78, v78, v224
    v_sub_f32 v79, v79, v224
    v_exp_f32 v76, v76
    v_exp_f32 v77, v77
    v_exp_f32 v78, v78
    v_exp_f32 v79, v79
    v_mfma_f32_16x16x32_bf16 v[164:167], a[44:47], v[20:23], 0
    v_cvt_pk_bf16_f32 v72, v72, v73
    v_cvt_pk_bf16_f32 v73, v74, v75
    v_cvt_pk_bf16_f32 v74, v76, v77
    v_cvt_pk_bf16_f32 v75, v78, v79
    v_sub_f32 v80, v80, v224
    v_sub_f32 v81, v81, v224
    v_sub_f32 v82, v82, v224
    v_sub_f32 v83, v83, v224
    v_exp_f32 v80, v80
    v_exp_f32 v81, v81
    v_exp_f32 v82, v82
    v_mfma_f32_16x16x32_bf16 v[168:171], a[48:51], v[20:23], 0
    v_exp_f32 v83, v83
    v_sub_f32 v84, v84, v224
    v_sub_f32 v85, v85, v224
    v_sub_f32 v86, v86, v224
    v_sub_f32 v87, v87, v224
    v_exp_f32 v84, v84
    v_exp_f32 v85, v85
    v_exp_f32 v86, v86
    v_exp_f32 v87, v87
    v_cvt_pk_bf16_f32 v80, v80, v81
    v_mfma_f32_16x16x32_bf16 v[172:175], a[52:55], v[20:23], 0
    v_cvt_pk_bf16_f32 v81, v82, v83
    v_cvt_pk_bf16_f32 v82, v84, v85
    v_cvt_pk_bf16_f32 v83, v86, v87
    v_sub_f32 v88, v88, v224
    v_sub_f32 v89, v89, v224
    v_sub_f32 v90, v90, v224
    v_sub_f32 v91, v91, v224
    v_exp_f32 v88, v88
    v_exp_f32 v89, v89
    v_exp_f32 v90, v90
    v_exp_f32 v91, v91
    v_mfma_f32_16x16x32_bf16 v[176:179], a[56:59], v[20:23], 0
    v_sub_f32 v92, v92, v224
    v_sub_f32 v93, v93, v224
    v_sub_f32 v94, v94, v224
    v_sub_f32 v95, v95, v224
    v_exp_f32 v92, v92
    v_exp_f32 v93, v93
    v_exp_f32 v94, v94
    v_exp_f32 v95, v95
    v_cvt_pk_bf16_f32 v88, v88, v89
    v_cvt_pk_bf16_f32 v89, v90, v91
    v_cvt_pk_bf16_f32 v90, v92, v93
    v_mfma_f32_16x16x32_bf16 v[180:183], a[60:63], v[20:23], 0
    v_cvt_pk_bf16_f32 v91, v94, v95
    v_sub_f32 v96, v96, v224
    v_sub_f32 v97, v97, v224
    v_sub_f32 v98, v98, v224
    v_sub_f32 v99, v99, v224
    v_exp_f32 v96, v96
    v_exp_f32 v97, v97
    v_exp_f32 v98, v98
    v_exp_f32 v99, v99
    v_sub_f32 v100, v100, v224
    v_sub_f32 v101, v101, v224
    v_mfma_f32_16x16x32_bf16 v[184:187], a[64:67], v[20:23], 0
    v_sub_f32 v102, v102, v224
    v_sub_f32 v103, v103, v224
    v_exp_f32 v100, v100
    v_exp_f32 v101, v101
    v_exp_f32 v102, v102
    v_exp_f32 v103, v103
    v_cvt_pk_bf16_f32 v96, v96, v97
    v_cvt_pk_bf16_f32 v97, v98, v99
    v_cvt_pk_bf16_f32 v98, v100, v101
    v_cvt_pk_bf16_f32 v99, v102, v103
    v_sub_f32 v104, v104, v224
    v_mfma_f32_16x16x32_bf16 v[188:191], a[68:71], v[20:23], v[236:239]
    v_sub_f32 v105, v105, v224
    v_sub_f32 v106, v106, v224
    v_sub_f32 v107, v107, v224
    v_exp_f32 v104, v104
    v_exp_f32 v105, v105
    v_exp_f32 v106, v106
    v_exp_f32 v107, v107
    v_sub_f32 v108, v108, v224
    v_sub_f32 v109, v109, v224
    v_sub_f32 v110, v110, v224
    v_sub_f32 v111, v111, v224
    v_exp_f32 v108, v108
    v_exp_f32 v109, v109
    v_exp_f32 v110, v110
    v_exp_f32 v111, v111
    v_cvt_pk_bf16_f32 v104, v104, v105
    v_cvt_pk_bf16_f32 v105, v106, v107
    v_cvt_pk_bf16_f32 v106, v108, v109
    v_cvt_pk_bf16_f32 v107, v110, v111
    v_sub_f32 v112, v112, v224
    v_sub_f32 v113, v113, v224
    v_sub_f32 v114, v114, v224
    v_sub_f32 v115, v115, v224
    v_exp_f32 v112, v112
    v_exp_f32 v113, v113
    v_exp_f32 v114, v114
    v_exp_f32 v115, v115
    v_cvt_pk_bf16_f32 v112, v112, v113
    v_cvt_pk_bf16_f32 v113, v114, v115
    v_mov_b32 v114, 0
    v_mov_b32 v115, 0
    s_nop 1
    v_max_f32 v224, v124, v126
    v_max_f32 v225, v125, v127
    v_mfma_f32_16x16x32_bf16 v[192:195], a[80:83], v[48:51], 0
    v_max3_f32 v224, v224, v128, v130
    v_max3_f32 v225, v225, v129, v131
    v_max3_f32 v224, v224, v132, v134
    v_max3_f32 v225, v225, v133, v135
    v_max3_f32 v224, v224, v136, v138
    v_max3_f32 v225, v225, v137, v139
    v_max3_f32 v224, v224, v140, v142
    v_max3_f32 v225, v225, v141, v143
    v_mfma_f32_16x16x32_bf16 v[192:195], a[88:91], v[56:59], v[192:195]
    v_max3_f32 v224, v224, v144, v146
    v_max3_f32 v225, v225, v145, v147
    v_max3_f32 v224, v224, v148, v150
    v_max3_f32 v225, v225, v149, v151
    v_max3_f32 v224, v224, v152, v154
    v_max3_f32 v225, v225, v153, v155
    v_max3_f32 v224, v224, v156, v158
    v_mfma_f32_16x16x32_bf16 v[192:195], a[96:99], v[64:67], v[192:195]
    v_max3_f32 v225, v225, v157, v159
    v_max3_f32 v224, v224, v160, v162
    v_max3_f32 v225, v225, v161, v163
    v_max3_f32 v224, v224, v164, v166
    v_max3_f32 v225, v225, v165, v167
    v_max3_f32 v224, v224, v168, v170
    v_max3_f32 v225, v225, v169, v171
    v_mfma_f32_16x16x32_bf16 v[192:195], a[104:107], v[72:75], v[192:195]
    v_max3_f32 v224, v224, v172, v174
    v_max3_f32 v225, v225, v173, v175
    v_max3_f32 v224, v224, v176, v178
    v_max3_f32 v225, v225, v177, v179
    v_max3_f32 v224, v224, v180, v182
    v_max3_f32 v225, v225, v181, v183
    v_max3_f32 v224, v224, v184, v186
    v_mfma_f32_16x16x32_bf16 v[192:195], a[112:115], v[80:83], v[192:195]
    v_max3_f32 v225, v225, v185, v187
    v_max3_f32 v224, v224, v188, v190
    v_max3_f32 v225, v225, v189, v191
    v_max_f32 v224, v224, v225
    v_mov_b32 v225, v224
    s_nop 1
    v_permlane16_swap_b32 v224, v225
    v_max_f32 v224, v224, v225
    v_mfma_f32_16x16x32_bf16 v[192:195], a[120:123], v[88:91], v[192:195]
    v_mov_b32 v225, v224
    s_nop 1
    v_permlane32_swap_b32 v224, v225
    v_max_f32 v224, v224, v225
    v_sub_f32 v124, v124, v224
    v_sub_f32 v125, v125, v224
    v_sub_f32 v126, v126, v224
    v_mfma_f32_16x16x32_bf16 v[192:195], a[128:131], v[96:99], v[192:195]
    v_sub_f32 v127, v127, v224
    v_exp_f32 v124, v124
    v_exp_f32 v125, v125
    v_exp_f32 v126, v126
    v_mfma_f32_16x16x32_bf16 v[192:195], a[136:139], v[104:107], v[192:195]
    v_exp_f32 v127, v127
    v_mov_b32 v120, 0
    v_mov_b32 v121, 0
    v_cvt_pk_bf16_f32 v122, v124, v125
    v_cvt_pk_bf16_f32 v123, v126, v127
    v_sub_f32 v128, v128, v224
    v_mfma_f32_16x16x32_bf16 v[192:195], a[144:147], v[112:115], v[192:195]
    v_sub_f32 v129, v129, v224
    v_sub_f32 v130, v130, v224
    v_sub_f32 v131, v131, v224
    v_exp_f32 v128, v128
    v_exp_f32 v129, v129
    v_exp_f32 v130, v130
    v_mfma_f32_16x16x32_bf16 v[196:199], a[84:87], v[48:51], 0
    v_exp_f32 v131, v131
    v_sub_f32 v132, v132, v224
    v_sub_f32 v133, v133, v224
    v_sub_f32 v134, v134, v224
    v_sub_f32 v135, v135, v224
    v_mfma_f32_16x16x32_bf16 v[196:199], a[92:95], v[56:59], v[196:199]
    v_exp_f32 v132, v132
    v_exp_f32 v133, v133
    v_exp_f32 v134, v134
    v_exp_f32 v135, v135
    v_mfma_f32_16x16x32_bf16 v[196:199], a[100:103], v[64:67], v[196:199]
    v_cvt_pk_bf16_f32 v128, v128, v129
    v_cvt_pk_bf16_f32 v129, v130, v131
    v_cvt_pk_bf16_f32 v130, v132, v133
    v_cvt_pk_bf16_f32 v131, v134, v135
    v_sub_f32 v136, v136, v224
    v_sub_f32 v137, v137, v224
    v_mfma_f32_16x16x32_bf16 v[196:199], a[108:111], v[72:75], v[196:199]
    v_sub_f32 v138, v138, v224
    v_sub_f32 v139, v139, v224
    v_exp_f32 v136, v136
    v_exp_f32 v137, v137
    v_exp_f32 v138, v138
    v_mfma_f32_16x16x32_bf16 v[196:199], a[116:119], v[80:83], v[196:199]
    v_exp_f32 v139, v139
    v_sub_f32 v140, v140, v224
    v_sub_f32 v141, v141, v224
    v_sub_f32 v142, v142, v224
    v_sub_f32 v143, v143, v224
    v_exp_f32 v140, v140
    v_mfma_f32_16x16x32_bf16 v[196:199], a[124:127], v[88:91], v[196:199]
    v_exp_f32 v141, v141
    v_exp_f32 v142, v142
    v_exp_f32 v143, v143
    v_mfma_f32_16x16x32_bf16 v[196:199], a[132:135], v[96:99], v[196:199]
    v_cvt_pk_bf16_f32 v136, v136, v137
    v_cvt_pk_bf16_f32 v137, v138, v139
    v_cvt_pk_bf16_f32 v138, v140, v141
    v_cvt_pk_bf16_f32 v139, v142, v143
    v_sub_f32 v144, v144, v224
    v_sub_f32 v145, v145, v224
    v_sub_f32 v146, v146, v224
    v_mfma_f32_16x16x32_bf16 v[196:199], a[140:143], v[104:107], v[196:199]
    v_sub_f32 v147, v147, v224
    v_exp_f32 v144, v144
    v_exp_f32 v145, v145
    v_exp_f32 v146, v146
    v_mfma_f32_16x16x32_bf16 v[196:199], a[148:151], v[112:115], v[196:199]
    v_exp_f32 v147, v147
    v_sub_f32 v148, v148, v224
    v_sub_f32 v149, v149, v224
    v_sub_f32 v150, v150, v224
    v_sub_f32 v151, v151, v224
    v_exp_f32 v148, v148
    v_mfma_f32_16x16x32_bf16 v[48:51], a[8:11], v[24:27], v[232:235]
    v_exp_f32 v149, v149
    v_exp_f32 v150, v150
    v_exp_f32 v151, v151
    v_cvt_pk_bf16_f32 v144, v144, v145
    v_mfma_f32_16x16x32_bf16 v[52:55], a[12:15], v[24:27], 0
    v_cvt_pk_bf16_f32 v145, v146, v147
    v_cvt_pk_bf16_f32 v146, v148, v149
    v_cvt_pk_bf16_f32 v147, v150, v151
    v_sub_f32 v152, v152, v224
    v_sub_f32 v153, v153, v224
    v_sub_f32 v154, v154, v224
    v_sub_f32 v155, v155, v224
    v_mfma_f32_16x16x32_bf16 v[56:59], a[16:19], v[24:27], 0
    v_exp_f32 v152, v152
    v_exp_f32 v153, v153
    v_exp_f32 v154, v154
    v_exp_f32 v155, v155
    v_mfma_f32_16x16x32_bf16 v[60:63], a[20:23], v[24:27], 0
    v_sub_f32 v156, v156, v224
    v_sub_f32 v157, v157, v224
    v_sub_f32 v158, v158, v224
    v_sub_f32 v159, v159, v224
    v_exp_f32 v156, v156
    v_mfma_f32_16x16x32_bf16 v[64:67], a[24:27], v[24:27], 0
    v_exp_f32 v157, v157
    v_exp_f32 v158, v158
    v_exp_f32 v159, v159
    v_cvt_pk_bf16_f32 v152, v152, v153
    v_cvt_pk_bf16_f32 v153, v154, v155
    v_mfma_f32_16x16x32_bf16 v[68:71], a[28:31], v[24:27], 0
    v_cvt_pk_bf16_f32 v154, v156, v157
    v_cvt_pk_bf16_f32 v155, v158, v159
    v_sub_f32 v160, v160, v224
    v_sub_f32 v161, v161, v224
    v_sub_f32 v162, v162, v224
    v_sub_f32 v163, v163, v224
    v_exp_f32 v160, v160
    v_mfma_f32_16x16x32_bf16 v[72:75], a[32:35], v[24:27], 0
    v_exp_f32 v161, v161
    v_exp_f32 v162, v162
    v_exp_f32 v163, v163
    v_mfma_f32_16x16x32_bf16 v[76:79], a[36:39], v[24:27], 0
    v_sub_f32 v164, v164, v224
    v_sub_f32 v165, v165, v224
    v_sub_f32 v166, v166, v224
    v_sub_f32 v167, v167, v224
    v_exp_f32 v164, v164
    v_exp_f32 v165, v165
    v_mfma_f32_16x16x32_bf16 v[80:83], a[40:43], v[24:27], 0
    v_exp_f32 v166, v166
    v_exp_f32 v167, v167
    v_cvt_pk_bf16_f32 v160, v160, v161
    v_cvt_pk_bf16_f32 v161, v162, v163
    v_cvt_pk_bf16_f32 v162, v164, v165
    v_mfma_f32_16x16x32_bf16 v[84:87], a[44:47], v[24:27], 0
    v_cvt_pk_bf16_f32 v163, v166, v167
    v_sub_f32 v168, v168, v224
    v_sub_f32 v169, v169, v224
    v_sub_f32 v170, v170, v224
    v_sub_f32 v171, v171, v224
    v_exp_f32 v168, v168
    v_mfma_f32_16x16x32_bf16 v[88:91], a[48:51], v[24:27], 0
    v_exp_f32 v169, v169
    v_exp_f32 v170, v170
    v_exp_f32 v171, v171
    v_sub_f32 v172, v172, v224
    v_mfma_f32_16x16x32_bf16 v[92:95], a[52:55], v[24:27], 0
    v_sub_f32 v173, v173, v224
    v_sub_f32 v174, v174, v224
    v_sub_f32 v175, v175, v224
    v_exp_f32 v172, v172
    v_exp_f32 v173, v173
    v_mfma_f32_16x16x32_bf16 v[96:99], a[56:59], v[24:27], 0
    v_exp_f32 v174, v174
    v_exp_f32 v175, v175
    v_cvt_pk_bf16_f32 v168, v168, v169
    v_cvt_pk_bf16_f32 v169, v170, v171
    v_cvt_pk_bf16_f32 v170, v172, v173
    v_mfma_f32_16x16x32_bf16 v[100:103], a[60:63], v[24:27], 0
    v_cvt_pk_bf16_f32 v171, v174, v175
    v_sub_f32 v176, v176, v224
    v_sub_f32 v177, v177, v224
    v_sub_f32 v178, v178, v224
    v_sub_f32 v179, v179, v224
    v_exp_f32 v176, v176
    v_exp_f32 v177, v177
    v_mfma_f32_16x16x32_bf16 v[104:107], a[64:67], v[24:27], 0
    v_exp_f32 v178, v178
    v_exp_f32 v179, v179
    v_sub_f32 v180, v180, v224
    v_sub_f32 v181, v181, v224
    v_mfma_f32_16x16x32_bf16 v[108:111], a[68:71], v[24:27], 0
    v_sub_f32 v182, v182, v224
    v_sub_f32 v183, v183, v224
    v_exp_f32 v180, v180
    v_exp_f32 v181, v181
    v_exp_f32 v182, v182
    v_mfma_f32_16x16x32_bf16 v[112:115], a[72:75], v[24:27], v[236:239]
    v_exp_f32 v183, v183
    v_cvt_pk_bf16_f32 v176, v176, v177
    v_cvt_pk_bf16_f32 v177, v178, v179
    v_cvt_pk_bf16_f32 v178, v180, v181
    v_cvt_pk_bf16_f32 v179, v182, v183
    v_sub_f32 v184, v184, v224
    v_sub_f32 v185, v185, v224
    v_sub_f32 v186, v186, v224
    v_sub_f32 v187, v187, v224
    v_exp_f32 v184, v184
    v_exp_f32 v185, v185
    v_exp_f32 v186, v186
    v_exp_f32 v187, v187
    v_sub_f32 v188, v188, v224
    v_sub_f32 v189, v189, v224
    v_sub_f32 v190, v190, v224
    v_sub_f32 v191, v191, v224
    v_exp_f32 v188, v188
    v_exp_f32 v189, v189
    v_exp_f32 v190, v190
    v_exp_f32 v191, v191
    v_cvt_pk_bf16_f32 v184, v184, v185
    v_cvt_pk_bf16_f32 v185, v186, v187
    v_cvt_pk_bf16_f32 v186, v188, v189
    v_cvt_pk_bf16_f32 v187, v190, v191
    s_nop 1
    v_mov_b32 v228, v199
    v_mov_b32 v226, v199
    v_mfma_f32_16x16x32_bf16 v[200:203], a[80:83], v[120:123], 0
    v_cndmask_b32 v196, v196, v198, s[40:41]
    v_cndmask_b32 v197, v197, v199, s[40:41]
    v_permlane32_swap_b32 v226, v228
    v_mov_b32 v226, v228
    s_nop 1
    v_permlane16_swap_b32 v226, v228
    v_rcp_f32 v226, v228
    v_mfma_f32_16x16x32_bf16 v[200:203], a[88:91], v[128:131], v[200:203]
    s_nop 0
    v_pk_mul_f32 v[192:193], v[192:193], v[226:227] op_sel_hi:[1,0]
    v_pk_mul_f32 v[194:195], v[194:195], v[226:227] op_sel_hi:[1,0]
    v_pk_mul_f32 v[196:197], v[196:197], v[226:227] op_sel_hi:[1,0]
    v_cvt_pk_bf16_f32 v198, v196, v197
    v_cvt_pk_bf16_f32 v192, v192, v193
    v_cvt_pk_bf16_f32 v193, v194, v195
    v_mfma_f32_16x16x32_bf16 v[200:203], a[96:99], v[136:139], v[200:203]
    ds_bpermute_b32 v227, v243, v198
    ds_write_b64 v251, v[192:193] offset:0
    s_mov_b32 vcc_lo, 65535
    s_mov_b32 vcc_hi, 0
    s_waitcnt lgkmcnt(1)
    v_cndmask_b32 v12, v12, v227, vcc
    v_max_f32 v224, v48, v50
    v_max_f32 v225, v49, v51
    v_mfma_f32_16x16x32_bf16 v[200:203], a[104:107], v[144:147], v[200:203]
    v_max3_f32 v224, v224, v52, v54
    v_max3_f32 v225, v225, v53, v55
    v_max3_f32 v224, v224, v56, v58
    v_max3_f32 v225, v225, v57, v59
    v_max3_f32 v224, v224, v60, v62
    v_max3_f32 v225, v225, v61, v63
    v_max3_f32 v224, v224, v64, v66
    v_max3_f32 v225, v225, v65, v67
    v_mfma_f32_16x16x32_bf16 v[200:203], a[112:115], v[152:155], v[200:203]
    v_max3_f32 v224, v224, v68, v70
    v_max3_f32 v225, v225, v69, v71
    v_max3_f32 v224, v224, v72, v74
    v_max3_f32 v225, v225, v73, v75
    v_max3_f32 v224, v224, v76, v78
    v_max3_f32 v225, v225, v77, v79
    v_max3_f32 v224, v224, v80, v82
    v_max3_f32 v225, v225, v81, v83
    v_mfma_f32_16x16x32_bf16 v[200:203], a[120:123], v[160:163], v[200:203]
    v_max3_f32 v224, v224, v84, v86
    v_max3_f32 v225, v225, v85, v87
    v_max3_f32 v224, v224, v88, v90
    v_max3_f32 v225, v225, v89, v91
    v_max3_f32 v224, v224, v92, v94
    v_max3_f32 v225, v225, v93, v95
    v_max3_f32 v224, v224, v96, v98
    v_max3_f32 v225, v225, v97, v99
    v_mfma_f32_16x16x32_bf16 v[200:203], a[128:131], v[168:171], v[200:203]
    v_max3_f32 v224, v224, v100, v102
    v_max3_f32 v225, v225, v101, v103
    v_max3_f32 v224, v224, v104, v106
    v_max3_f32 v225, v225, v105, v107
    v_max3_f32 v224, v224, v108, v110
    v_max3_f32 v225, v225, v109, v111
    v_max3_f32 v224, v224, v112, v114
    v_mfma_f32_16x16x32_bf16 v[200:203], a[136:139], v[176:179], v[200:203]
    v_max3_f32 v225, v225, v113, v115
    v_max_f32 v224, v224, v225
    v_mov_b32 v225, v224
    s_nop 1
    v_permlane16_swap_b32 v224, v225
    v_max_f32 v224, v224, v225
    v_mov_b32 v225, v224
    s_nop 1
    v_permlane32_swap_b32 v224, v225
    v_max_f32 v224, v224, v225
    v_mfma_f32_16x16x32_bf16 v[200:203], a[144:147], v[184:187], v[200:203]
    v_sub_f32 v48, v48, v224
    v_sub_f32 v49, v49, v224
    v_sub_f32 v50, v50, v224
    v_sub_f32 v51, v51, v224
    v_exp_f32 v48, v48
    v_mfma_f32_16x16x32_bf16 v[204:207], a[84:87], v[120:123], 0
    v_exp_f32 v49, v49
    v_exp_f32 v50, v50
    v_exp_f32 v51, v51
    v_sub_f32 v52, v52, v224
    v_sub_f32 v53, v53, v224
    v_mfma_f32_16x16x32_bf16 v[204:207], a[92:95], v[128:131], v[204:207]
    v_sub_f32 v54, v54, v224
    v_sub_f32 v55, v55, v224
    v_exp_f32 v52, v52
    v_exp_f32 v53, v53
    v_exp_f32 v54, v54
    v_mfma_f32_16x16x32_bf16 v[204:207], a[100:103], v[136:139], v[204:207]
    v_exp_f32 v55, v55
    v_cvt_pk_bf16_f32 v48, v48, v49
    v_cvt_pk_bf16_f32 v49, v50, v51
    v_cvt_pk_bf16_f32 v50, v52, v53
    v_cvt_pk_bf16_f32 v51, v54, v55
    v_sub_f32 v56, v56, v224
    v_sub_f32 v57, v57, v224
    v_mfma_f32_16x16x32_bf16 v[204:207], a[108:111], v[144:147], v[204:207]
    v_sub_f32 v58, v58, v224
    v_sub_f32 v59, v59, v224
    v_exp_f32 v56, v56
    v_exp_f32 v57, v57
    v_exp_f32 v58, v58
    v_mfma_f32_16x16x32_bf16 v[204:207], a[116:119], v[152:155], v[204:207]
    v_exp_f32 v59, v59
    v_sub_f32 v60, v60, v224
    v_sub_f32 v61, v61, v224
    v_sub_f32 v62, v62, v224
    v_sub_f32 v63, v63, v224
    v_exp_f32 v60, v60
    v_mfma_f32_16x16x32_bf16 v[204:207], a[124:127], v[160:163], v[204:207]
    v_exp_f32 v61, v61
    v_exp_f32 v62, v62
    v_exp_f32 v63, v63
    v_cvt_pk_bf16_f32 v56, v56, v57
    v_mfma_f32_16x16x32_bf16 v[204:207], a[132:135], v[168:171], v[204:207]
    v_cvt_pk_bf16_f32 v57, v58, v59
    v_cvt_pk_bf16_f32 v58, v60, v61
    v_cvt_pk_bf16_f32 v59, v62, v63
    v_sub_f32 v64, v64, v224
    v_sub_f32 v65, v65, v224
    v_sub_f32 v66, v66, v224
    v_sub_f32 v67, v67, v224
    v_exp_f32 v64, v64
    v_mfma_f32_16x16x32_bf16 v[204:207], a[140:143], v[176:179], v[204:207]
    v_exp_f32 v65, v65
    v_exp_f32 v66, v66
    v_exp_f32 v67, v67
    v_sub_f32 v68, v68, v224
    v_mfma_f32_16x16x32_bf16 v[204:207], a[148:151], v[184:187], v[204:207]
    v_sub_f32 v69, v69, v224
    v_sub_f32 v70, v70, v224
    v_sub_f32 v71, v71, v224
    v_exp_f32 v68, v68
    v_exp_f32 v69, v69
    v_exp_f32 v70, v70
    v_mfma_f32_16x16x32_bf16 v[124:127], a[12:15], v[28:31], v[232:235]
    v_exp_f32 v71, v71
    v_cvt_pk_bf16_f32 v64, v64, v65
    v_cvt_pk_bf16_f32 v65, v66, v67
    v_cvt_pk_bf16_f32 v66, v68, v69
    v_cvt_pk_bf16_f32 v67, v70, v71
    v_sub_f32 v72, v72, v224
    v_mfma_f32_16x16x32_bf16 v[128:131], a[16:19], v[28:31], 0
    v_sub_f32 v73, v73, v224
    v_sub_f32 v74, v74, v224
    v_sub_f32 v75, v75, v224
    v_exp_f32 v72, v72
    v_exp_f32 v73, v73
    v_mfma_f32_16x16x32_bf16 v[132:135], a[20:23], v[28:31], 0
    v_exp_f32 v74, v74
    v_exp_f32 v75, v75
    v_sub_f32 v76, v76, v224
    v_sub_f32 v77, v77, v224
    v_sub_f32 v78, v78, v224
    v_sub_f32 v79, v79, v224
    v_mfma_f32_16x16x32_bf16 v[136:139], a[24:27], v[28:31], 0
    v_exp_f32 v76, v76
    v_exp_f32 v77, v77
    v_exp_f32 v78, v78
    v_exp_f32 v79, v79
    v_mfma_f32_16x16x32_bf16 v[140:143], a[28:31], v[28:31], 0
    v_cvt_pk_bf16_f32 v72, v72, v73
    v_cvt_pk_bf16_f32 v73, v74, v75
    v_cvt_pk_bf16_f32 v74, v76, v77
    v_cvt_pk_bf16_f32 v75, v78, v79
    v_sub_f32 v80, v80, v224
    v_sub_f32 v81, v81, v224
    v_sub_f32 v82, v82, v224
    v_sub_f32 v83, v83, v224
    v_mfma_f32_16x16x32_bf16 v[144:147], a[32:35], v[28:31], 0
    v_exp_f32 v80, v80
    v_exp_f32 v81, v81
    v_exp_f32 v82, v82
    v_exp_f32 v83, v83
    v_mfma_f32_16x16x32_bf16 v[148:151], a[36:39], v[28:31], 0
    v_sub_f32 v84, v84, v224
    v_sub_f32 v85, v85, v224
    v_sub_f32 v86, v86, v224
    v_sub_f32 v87, v87, v224
    v_exp_f32 v84, v84
    v_exp_f32 v85, v85
    v_mfma_f32_16x16x32_bf16 v[152:155], a[40:43], v[28:31], 0
    v_exp_f32 v86, v86
    v_exp_f32 v87, v87
    v_cvt_pk_bf16_f32 v80, v80, v81
    v_cvt_pk_bf16_f32 v81, v82, v83
    v_cvt_pk_bf16_f32 v82, v84, v85
    v_mfma_f32_16x16x32_bf16 v[156:159], a[44:47], v[28:31], 0
    v_cvt_pk_bf16_f32 v83, v86, v87
    v_sub_f32 v88, v88, v224
    v_sub_f32 v89, v89, v224
    v_sub_f32 v90, v90, v224
    v_sub_f32 v91, v91, v224
    v_exp_f32 v88, v88
    v_exp_f32 v89, v89
    v_mfma_f32_16x16x32_bf16 v[160:163], a[48:51], v[28:31], 0
    v_exp_f32 v90, v90
    v_exp_f32 v91, v91
    v_sub_f32 v92, v92, v224
    v_sub_f32 v93, v93, v224
    v_sub_f32 v94, v94, v224
    v_mfma_f32_16x16x32_bf16 v[164:167], a[52:55], v[28:31], 0
    v_sub_f32 v95, v95, v224
    v_exp_f32 v92, v92
    v_exp_f32 v93, v93
    v_exp_f32 v94, v94
    v_exp_f32 v95, v95
    v_mfma_f32_16x16x32_bf16 v[168:171], a[56:59], v[28:31], 0
    v_cvt_pk_bf16_f32 v88, v88, v89
    v_cvt_pk_bf16_f32 v89, v90, v91
    v_cvt_pk_bf16_f32 v90, v92, v93
    v_cvt_pk_bf16_f32 v91, v94, v95
    v_sub_f32 v96, v96, v224
    v_sub_f32 v97, v97, v224
    v_sub_f32 v98, v98, v224
    v_mfma_f32_16x16x32_bf16 v[172:175], a[60:63], v[28:31], 0
    v_sub_f32 v99, v99, v224
    v_exp_f32 v96, v96
    v_exp_f32 v97, v97
    v_exp_f32 v98, v98
    v_exp_f32 v99, v99
    v_mfma_f32_16x16x32_bf16 v[176:179], a[64:67], v[28:31], 0
    v_sub_f32 v100, v100, v224
    v_sub_f32 v101, v101, v224
    v_sub_f32 v102, v102, v224
    v_sub_f32 v103, v103, v224
    v_exp_f32 v100, v100
    v_mfma_f32_16x16x32_bf16 v[180:183], a[68:71], v[28:31], 0
    v_exp_f32 v101, v101
    v_exp_f32 v102, v102
    v_exp_f32 v103, v103
    v_cvt_pk_bf16_f32 v96, v96, v97
    v_cvt_pk_bf16_f32 v97, v98, v99
    v_mfma_f32_16x16x32_bf16 v[184:187], a[72:75], v[28:31], 0
    v_cvt_pk_bf16_f32 v98, v100, v101
    v_cvt_pk_bf16_f32 v99, v102, v103
    v_sub_f32 v104, v104, v224
    v_sub_f32 v105, v105, v224
    v_sub_f32 v106, v106, v224
    v_sub_f32 v107, v107, v224
    v_exp_f32 v104, v104
    v_mfma_f32_16x16x32_bf16 v[188:191], a[76:79], v[28:31], v[236:239]
    v_exp_f32 v105, v105
    v_exp_f32 v106, v106
    v_exp_f32 v107, v107
    v_sub_f32 v108, v108, v224
    v_sub_f32 v109, v109, v224
    v_sub_f32 v110, v110, v224
    v_sub_f32 v111, v111, v224
    v_exp_f32 v108, v108
    v_exp_f32 v109, v109
    v_exp_f32 v110, v110
    v_exp_f32 v111, v111
    v_cvt_pk_bf16_f32 v104, v104, v105
    v_cvt_pk_bf16_f32 v105, v106, v107
    v_cvt_pk_bf16_f32 v106, v108, v109
    v_cvt_pk_bf16_f32 v107, v110, v111
    v_sub_f32 v112, v112, v224
    v_sub_f32 v113, v113, v224
    v_sub_f32 v114, v114, v224
    v_sub_f32 v115, v115, v224
    v_exp_f32 v112, v112
    v_exp_f32 v113, v113
    v_exp_f32 v114, v114
    v_exp_f32 v115, v115
    v_cvt_pk_bf16_f32 v112, v112, v113
    v_cvt_pk_bf16_f32 v113, v114, v115
    v_mov_b32 v114, 0
    v_mov_b32 v115, 0
    s_nop 1
    v_mov_b32 v228, v207
    v_mov_b32 v226, v207
    v_mfma_f32_16x16x32_bf16 v[208:211], a[88:91], v[48:51], 0
    v_cndmask_b32 v204, v204, v206, s[40:41]
    v_cndmask_b32 v205, v205, v207, s[40:41]
    v_permlane32_swap_b32 v226, v228
    v_mov_b32 v226, v228
    s_nop 1
    v_permlane16_swap_b32 v226, v228
    v_rcp_f32 v226, v228
    s_nop 0
    v_pk_mul_f32 v[200:201], v[200:201], v[226:227] op_sel_hi:[1,0]
    v_pk_mul_f32 v[202:203], v[202:203], v[226:227] op_sel_hi:[1,0]
    v_pk_mul_f32 v[204:205], v[204:205], v[226:227] op_sel_hi:[1,0]
    v_cvt_pk_bf16_f32 v206, v204, v205
    v_cvt_pk_bf16_f32 v200, v200, v201
    v_cvt_pk_bf16_f32 v201, v202, v203
    v_mfma_f32_16x16x32_bf16 v[208:211], a[96:99], v[56:59], v[208:211]
    ds_bpermute_b32 v227, v243, v206
    ds_write_b64 v251, v[200:201] offset:1024
    s_mov_b32 vcc_lo, 4294901760
    s_mov_b32 vcc_hi, 0
    s_waitcnt lgkmcnt(1)
    v_cndmask_b32 v12, v12, v227, vcc
    v_max_f32 v224, v124, v126
    v_max_f32 v225, v125, v127
    v_max3_f32 v224, v224, v128, v130
    v_max3_f32 v225, v225, v129, v131
    v_max3_f32 v224, v224, v132, v134
    v_max3_f32 v225, v225, v133, v135
    v_max3_f32 v224, v224, v136, v138
    v_max3_f32 v225, v225, v137, v139
    v_max3_f32 v224, v224, v140, v142
    v_mfma_f32_16x16x32_bf16 v[208:211], a[104:107], v[64:67], v[208:211]
    v_max3_f32 v225, v225, v141, v143
    v_max3_f32 v224, v224, v144, v146
    v_max3_f32 v225, v225, v145, v147
    v_max3_f32 v224, v224, v148, v150
    v_max3_f32 v225, v225, v149, v151
    v_max3_f32 v224, v224, v152, v154
    v_max3_f32 v225, v225, v153, v155
    v_max3_f32 v224, v224, v156, v158
    v_max3_f32 v225, v225, v157, v159
    v_max3_f32 v224, v224, v160, v162
    v_max3_f32 v225, v225, v161, v163
    v_max3_f32 v224, v224, v164, v166
    v_max3_f32 v225, v225, v165, v167
    v_max3_f32 v224, v224, v168, v170
    v_max3_f32 v225, v225, v169, v171
    v_mfma_f32_16x16x32_bf16 v[208:211], a[112:115], v[72:75], v[208:211]
    v_max3_f32 v224, v224, v172, v174
    v_max3_f32 v225, v225, v173, v175
    v_max3_f32 v224, v224, v176, v178
    v_max3_f32 v225, v225, v177, v179
    v_max3_f32 v224, v224, v180, v182
    v_max3_f32 v225, v225, v181, v183
    v_max3_f32 v224, v224, v184, v186
    v_max3_f32 v225, v225, v185, v187
    v_max3_f32 v224, v224, v188, v190
    v_max3_f32 v225, v225, v189, v191
    v_max_f32 v224, v224, v225
    v_mov_b32 v225, v224
    s_nop 1
    v_permlane16_swap_b32 v224, v225
    v_max_f32 v224, v224, v225
    v_mfma_f32_16x16x32_bf16 v[208:211], a[120:123], v[80:83], v[208:211]
    v_mov_b32 v225, v224
    s_nop 1
    v_permlane32_swap_b32 v224, v225
    v_max_f32 v224, v224, v225
    v_sub_f32 v124, v124, v224
    v_sub_f32 v125, v125, v224
    v_sub_f32 v126, v126, v224
    v_sub_f32 v127, v127, v224
    v_exp_f32 v124, v124
    v_exp_f32 v125, v125
    v_exp_f32 v126, v126
    v_exp_f32 v127, v127
    v_mfma_f32_16x16x32_bf16 v[208:211], a[128:131], v[88:91], v[208:211]
    v_mov_b32 v120, 0
    v_mov_b32 v121, 0
    v_cvt_pk_bf16_f32 v122, v124, v125
    v_cvt_pk_bf16_f32 v123, v126, v127
    v_sub_f32 v128, v128, v224
    v_sub_f32 v129, v129, v224
    v_sub_f32 v130, v130, v224
    v_sub_f32 v131, v131, v224
    v_exp_f32 v128, v128
    v_exp_f32 v129, v129
    v_exp_f32 v130, v130
    v_exp_f32 v131, v131
    v_mfma_f32_16x16x32_bf16 v[208:211], a[136:139], v[96:99], v[208:211]
    v_sub_f32 v132, v132, v224
    v_sub_f32 v133, v133, v224
    v_sub_f32 v134, v134, v224
    v_sub_f32 v135, v135, v224
    v_exp_f32 v132, v132
    v_exp_f32 v133, v133
    v_exp_f32 v134, v134
    v_exp_f32 v135, v135
    v_cvt_pk_bf16_f32 v128, v128, v129
    v_cvt_pk_bf16_f32 v129, v130, v131
    v_mfma_f32_16x16x32_bf16 v[208:211], a[144:147], v[104:107], v[208:211]
    v_cvt_pk_bf16_f32 v130, v132, v133
    v_cvt_pk_bf16_f32 v131, v134, v135
    v_sub_f32 v136, v136, v224
    v_sub_f32 v137, v137, v224
    v_sub_f32 v138, v138, v224
    v_sub_f32 v139, v139, v224
    v_exp_f32 v136, v136
    v_exp_f32 v137, v137
    v_exp_f32 v138, v138
    v_exp_f32 v139, v139
    v_sub_f32 v140, v140, v224
    v_mfma_f32_16x16x32_bf16 v[208:211], a[152:155], v[112:115], v[208:211]
    v_sub_f32 v141, v141, v224
    v_sub_f32 v142, v142, v224
    v_sub_f32 v143, v143, v224
    v_exp_f32 v140, v140
    v_exp_f32 v141, v141
    v_exp_f32 v142, v142
    v_exp_f32 v143, v143
    v_cvt_pk_bf16_f32 v136, v136, v137
    v_cvt_pk_bf16_f32 v137, v138, v139
    v_cvt_pk_bf16_f32 v138, v140, v141
    v_cvt_pk_bf16_f32 v139, v142, v143
    v_sub_f32 v144, v144, v224
    v_mfma_f32_16x16x32_bf16 v[212:215], a[92:95], v[48:51], 0
    v_sub_f32 v145, v145, v224
    v_sub_f32 v146, v146, v224
    v_sub_f32 v147, v147, v224
    v_exp_f32 v144, v144
    v_exp_f32 v145, v145
    v_exp_f32 v146, v146
    v_exp_f32 v147, v147
    v_sub_f32 v148, v148, v224
    v_sub_f32 v149, v149, v224
    v_sub_f32 v150, v150, v224
    v_sub_f32 v151, v151, v224
    v_mfma_f32_16x16x32_bf16 v[212:215], a[100:103], v[56:59], v[212:215]
    v_exp_f32 v148, v148
    v_exp_f32 v149, v149
    v_exp_f32 v150, v150
    v_exp_f32 v151, v151
    v_cvt_pk_bf16_f32 v144, v144, v145
    v_cvt_pk_bf16_f32 v145, v146, v147
    v_cvt_pk_bf16_f32 v146, v148, v149
    v_cvt_pk_bf16_f32 v147, v150, v151
    v_sub_f32 v152, v152, v224
    v_sub_f32 v153, v153, v224
    v_sub_f32 v154, v154, v224
    v_mfma_f32_16x16x32_bf16 v[212:215], a[108:111], v[64:67], v[212:215]
    v_sub_f32 v155, v155, v224
    v_exp_f32 v152, v152
    v_exp_f32 v153, v153
    v_exp_f32 v154, v154
    v_exp_f32 v155, v155
    v_sub_f32 v156, v156, v224
    v_sub_f32 v157, v157, v224
    v_sub_f32 v158, v158, v224
    v_sub_f32 v159, v159, v224
    v_exp_f32 v156, v156
    v_mfma_f32_16x16x32_bf16 v[212:215], a[116:119], v[72:75], v[212:215]
    v_exp_f32 v157, v157
    v_exp_f32 v158, v158
    v_exp_f32 v159, v159
    v_cvt_pk_bf16_f32 v152, v152, v153
    v_cvt_pk_bf16_f32 v153, v154, v155
    v_cvt_pk_bf16_f32 v154, v156, v157
    v_cvt_pk_bf16_f32 v155, v158, v159
    v_sub_f32 v160, v160, v224
    v_sub_f32 v161, v161, v224
    v_sub_f32 v162, v162, v224
    v_sub_f32 v163, v163, v224
    v_exp_f32 v160, v160
    v_mfma_f32_16x16x32_bf16 v[212:215], a[124:127], v[80:83], v[212:215]
    v_exp_f32 v161, v161
    v_exp_f32 v162, v162
    v_exp_f32 v163, v163
    v_sub_f32 v164, v164, v224
    v_sub_f32 v165, v165, v224
    v_sub_f32 v166, v166, v224
    v_sub_f32 v167, v167, v224
    v_exp_f32 v164, v164
    v_exp_f32 v165, v165
    v_exp_f32 v166, v166
    v_mfma_f32_16x16x32_bf16 v[212:215], a[132:135], v[88:91], v[212:215]
    v_exp_f32 v167, v167
    v_cvt_pk_bf16_f32 v160, v160, v161
    v_cvt_pk_bf16_f32 v161, v162, v163
    v_cvt_pk_bf16_f32 v162, v164, v165
    v_cvt_pk_bf16_f32 v163, v166, v167
    v_sub_f32 v168, v168, v224
    v_sub_f32 v169, v169, v224
    v_sub_f32 v170, v170, v224
    v_sub_f32 v171, v171, v224
    v_exp_f32 v168, v168
    v_exp_f32 v169, v169
    v_mfma_f32_16x16x32_bf16 v[212:215], a[140:143], v[96:99], v[212:215]
    v_exp_f32 v170, v170
    v_exp_f32 v171, v171
    v_sub_f32 v172, v172, v224
    v_sub_f32 v173, v173, v224
    v_sub_f32 v174, v174, v224
    v_sub_f32 v175, v175, v224
    v_exp_f32 v172, v172
    v_exp_f32 v173, v173
    v_exp_f32 v174, v174
    v_exp_f32 v175, v175
    v_mfma_f32_16x16x32_bf16 v[212:215], a[148:151], v[104:107], v[212:215]
    v_cvt_pk_bf16_f32 v168, v168, v169
    v_cvt_pk_bf16_f32 v169, v170, v171
    v_cvt_pk_bf16_f32 v170, v172, v173
    v_cvt_pk_bf16_f32 v171, v174, v175
    v_sub_f32 v176, v176, v224
    v_sub_f32 v177, v177, v224
    v_sub_f32 v178, v178, v224
    v_sub_f32 v179, v179, v224
    v_exp_f32 v176, v176
    v_exp_f32 v177, v177
    v_exp_f32 v178, v178
    v_exp_f32 v179, v179
    v_mfma_f32_16x16x32_bf16 v[212:215], a[156:159], v[112:115], v[212:215]
    v_sub_f32 v180, v180, v224
    v_sub_f32 v181, v181, v224
    v_sub_f32 v182, v182, v224
    v_sub_f32 v183, v183, v224
    v_exp_f32 v180, v180
    v_exp_f32 v181, v181
    v_exp_f32 v182, v182
    v_exp_f32 v183, v183
    v_cvt_pk_bf16_f32 v176, v176, v177
    v_cvt_pk_bf16_f32 v177, v178, v179
    v_cvt_pk_bf16_f32 v178, v180, v181
    v_cvt_pk_bf16_f32 v179, v182, v183
    v_sub_f32 v184, v184, v224
    v_sub_f32 v185, v185, v224
    v_sub_f32 v186, v186, v224
    v_sub_f32 v187, v187, v224
    v_exp_f32 v184, v184
    v_exp_f32 v185, v185
    v_exp_f32 v186, v186
    v_exp_f32 v187, v187
    v_sub_f32 v188, v188, v224
    v_sub_f32 v189, v189, v224
    v_sub_f32 v190, v190, v224
    v_sub_f32 v191, v191, v224
    v_exp_f32 v188, v188
    v_exp_f32 v189, v189
    v_exp_f32 v190, v190
    v_exp_f32 v191, v191
    v_cvt_pk_bf16_f32 v184, v184, v185
    v_cvt_pk_bf16_f32 v185, v186, v187
    v_cvt_pk_bf16_f32 v186, v188, v189
    v_cvt_pk_bf16_f32 v187, v190, v191
    s_nop 1
    v_mfma_f32_16x16x32_bf16 v[216:219], a[88:91], v[120:123], 0
    v_mov_b32 v228, v215
    v_mov_b32 v226, v215
    v_mfma_f32_16x16x32_bf16 v[216:219], a[96:99], v[128:131], v[216:219]
    v_cndmask_b32 v212, v212, v214, s[40:41]
    v_mfma_f32_16x16x32_bf16 v[216:219], a[104:107], v[136:139], v[216:219]
    v_cndmask_b32 v213, v213, v215, s[40:41]
    v_mfma_f32_16x16x32_bf16 v[216:219], a[112:115], v[144:147], v[216:219]
    v_permlane32_swap_b32 v226, v228
    v_mov_b32 v226, v228
    s_nop 1
    v_permlane16_swap_b32 v226, v228
    v_mfma_f32_16x16x32_bf16 v[216:219], a[120:123], v[152:155], v[216:219]
    v_mfma_f32_16x16x32_bf16 v[216:219], a[128:131], v[160:163], v[216:219]
    v_mfma_f32_16x16x32_bf16 v[216:219], a[136:139], v[168:171], v[216:219]
    v_mfma_f32_16x16x32_bf16 v[216:219], a[144:147], v[176:179], v[216:219]
    v_rcp_f32 v226, v228
    v_mfma_f32_16x16x32_bf16 v[216:219], a[152:155], v[184:187], v[216:219]
    v_mfma_f32_16x16x32_bf16 v[220:223], a[92:95], v[120:123], 0
    s_nop 0
    v_mfma_f32_16x16x32_bf16 v[220:223], a[100:103], v[128:131], v[220:223]
    v_pk_mul_f32 v[208:209], v[208:209], v[226:227] op_sel_hi:[1,0]
    v_pk_mul_f32 v[210:211], v[210:211], v[226:227] op_sel_hi:[1,0]
    v_mfma_f32_16x16x32_bf16 v[220:223], a[108:111], v[136:139], v[220:223]
    v_pk_mul_f32 v[212:213], v[212:213], v[226:227] op_sel_hi:[1,0]
    v_mfma_f32_16x16x32_bf16 v[220:223], a[116:119], v[144:147], v[220:223]
    v_cvt_pk_bf16_f32 v214, v212, v213
    v_mfma_f32_16x16x32_bf16 v[220:223], a[124:127], v[152:155], v[220:223]
    v_cvt_pk_bf16_f32 v208, v208, v209
    v_mfma_f32_16x16x32_bf16 v[220:223], a[132:135], v[160:163], v[220:223]
    v_cvt_pk_bf16_f32 v209, v210, v211
    v_mfma_f32_16x16x32_bf16 v[220:223], a[140:143], v[168:171], v[220:223]
    ds_bpermute_b32 v227, v243, v214
    ds_write_b64 v251, v[208:209] offset:2048
    v_mfma_f32_16x16x32_bf16 v[220:223], a[148:151], v[176:179], v[220:223]
    s_mov_b32 vcc_lo, 0
    s_mov_b32 vcc_hi, 65535
    v_mfma_f32_16x16x32_bf16 v[220:223], a[156:159], v[184:187], v[220:223]
    s_waitcnt lgkmcnt(1)
    v_cndmask_b32 v12, v12, v227, vcc
    s_nop 7
    v_mov_b32 v228, v223
    v_mov_b32 v226, v223
    v_cndmask_b32 v220, v220, v222, s[40:41]
    v_cndmask_b32 v221, v221, v223, s[40:41]
    v_permlane32_swap_b32 v226, v228
    v_mov_b32 v226, v228
    s_nop 1
    v_permlane16_swap_b32 v226, v228
    v_rcp_f32 v226, v228
    s_nop 0
    v_pk_mul_f32 v[216:217], v[216:217], v[226:227] op_sel_hi:[1,0]
    v_pk_mul_f32 v[218:219], v[218:219], v[226:227] op_sel_hi:[1,0]
    v_pk_mul_f32 v[220:221], v[220:221], v[226:227] op_sel_hi:[1,0]
    v_cvt_pk_bf16_f32 v222, v220, v221
    v_cvt_pk_bf16_f32 v216, v216, v217
    v_cvt_pk_bf16_f32 v217, v218, v219
    ds_bpermute_b32 v227, v243, v222
    ds_write_b64 v251, v[216:217] offset:3072
    s_mov_b32 vcc_lo, 0
    s_mov_b32 vcc_hi, 4294901760
    s_waitcnt lgkmcnt(1)
    v_cndmask_b32 v12, v12, v227, vcc
    ds_write_b32 v240, v12
    s_branch L_attn_done
L_attn_er4:
    v_mfma_f32_16x16x32_bf16 v[64:67], a[16:19], v[16:19], 0
    v_mfma_f32_16x16x32_bf16 v[68:71], a[20:23], v[16:19], 0
    v_mfma_f32_16x16x32_bf16 v[72:75], a[24:27], v[16:19], 0
    v_mfma_f32_16x16x32_bf16 v[76:79], a[28:31], v[16:19], 0
    v_mfma_f32_16x16x32_bf16 v[80:83], a[32:35], v[16:19], 0
    v_mfma_f32_16x16x32_bf16 v[84:87], a[36:39], v[16:19], 0
    v_mfma_f32_16x16x32_bf16 v[88:91], a[40:43], v[16:19], 0
    v_mfma_f32_16x16x32_bf16 v[92:95], a[44:47], v[16:19], 0
    v_mfma_f32_16x16x32_bf16 v[96:99], a[48:51], v[16:19], 0
    v_mfma_f32_16x16x32_bf16 v[100:103], a[52:55], v[16:19], 0
    v_mfma_f32_16x16x32_bf16 v[104:107], a[56:59], v[16:19], 0
    v_mfma_f32_16x16x32_bf16 v[108:111], a[60:63], v[16:19], 0
    v_mfma_f32_16x16x32_bf16 v[112:115], a[64:67], v[16:19], v[236:239]
    s_nop 7
    v_mfma_f32_16x16x32_bf16 v[136:139], a[16:19], v[20:23], 0
    v_max_f32 v224, v64, v66
    v_max_f32 v225, v65, v67
    v_max3_f32 v224, v224, v68, v70
    v_max3_f32 v225, v225, v69, v71
    v_max3_f32 v224, v224, v72, v74
    v_max3_f32 v225, v225, v73, v75
    v_max3_f32 v224, v224, v76, v78
    v_max3_f32 v225, v225, v77, v79
    v_max3_f32 v224, v224, v80, v82
    v_max3_f32 v225, v225, v81, v83
    v_max3_f32 v224, v224, v84, v86
    v_max3_f32 v225, v225, v85, v87
    v_max3_f32 v224, v224, v88, v90
    v_max3_f32 v225, v225, v89, v91
    v_max3_f32 v224, v224, v92, v94
    v_mfma_f32_16x16x32_bf16 v[140:143], a[20:23], v[20:23], 0
    v_max3_f32 v225, v225, v93, v95
    v_max3_f32 v224, v224, v96, v98
    v_max3_f32 v225, v225, v97, v99
    v_max3_f32 v224, v224, v100, v102
    v_max3_f32 v225, v225, v101, v103
    v_max3_f32 v224, v224, v104, v106
    v_max3_f32 v225, v225, v105, v107
    v_max3_f32 v224, v224, v108, v110
    v_max3_f32 v225, v225, v109, v111
    v_max3_f32 v224, v224, v112, v114
    v_max3_f32 v225, v225, v113, v115
    v_max_f32 v224, v224, v225
    v_mov_b32 v225, v224
    s_nop 1
    v_permlane16_swap_b32 v224, v225
    v_max_f32 v224, v224, v225
    v_mfma_f32_16x16x32_bf16 v[144:147], a[24:27], v[20:23], 0
    v_mov_b32 v225, v224
    s_nop 1
    v_permlane32_swap_b32 v224, v225
    v_max_f32 v224, v224, v225
    v_sub_f32 v64, v64, v224
    v_sub_f32 v65, v65, v224
    v_sub_f32 v66, v66, v224
    v_sub_f32 v67, v67, v224
    v_exp_f32 v64, v64
    v_exp_f32 v65, v65
    v_mfma_f32_16x16x32_bf16 v[148:151], a[28:31], v[20:23], 0
    v_exp_f32 v66, v66
    v_exp_f32 v67, v67
    v_sub_f32 v68, v68, v224
    v_sub_f32 v69, v69, v224
    v_sub_f32 v70, v70, v224
    v_sub_f32 v71, v71, v224
    v_exp_f32 v68, v68
    v_exp_f32 v69, v69
    v_exp_f32 v70, v70
    v_mfma_f32_16x16x32_bf16 v[152:155], a[32:35], v[20:23], 0
    v_exp_f32 v71, v71
    v_cvt_pk_bf16_f32 v64, v64, v65
    v_cvt_pk_bf16_f32 v65, v66, v67
    v_cvt_pk_bf16_f32 v66, v68, v69
    v_cvt_pk_bf16_f32 v67, v70, v71
    v_sub_f32 v72, v72, v224
    v_sub_f32 v73, v73, v224
    v_sub_f32 v74, v74, v224
    v_sub_f32 v75, v75, v224
    v_exp_f32 v72, v72
    v_exp_f32 v73, v73
    v_mfma_f32_16x16x32_bf16 v[156:159], a[36:39], v[20:23], 0
    v_exp_f32 v74, v74
    v_exp_f32 v75, v75
    v_sub_f32 v76, v76, v224
    v_sub_f32 v77, v77, v224
    v_sub_f32 v78, v78, v224
    v_sub_f32 v79, v79, v224
    v_exp_f32 v76, v76
    v_exp_f32 v77, v77
    v_exp_f32 v78, v78
    v_mfma_f32_16x16x32_bf16 v[160:163], a[40:43], v[20:23], 0
    v_exp_f32 v79, v79
    v_cvt_pk_bf16_f32 v72, v72, v73
    v_cvt_pk_bf16_f32 v73, v74, v75
    v_cvt_pk_bf16_f32 v74, v76, v77
    v_cvt_pk_bf16_f32 v75, v78, v79
    v_sub_f32 v80, v80, v224
    v_sub_f32 v81, v81, v224
    v_sub_f32 v82, v82, v224
    v_sub_f32 v83, v83, v224
    v_exp_f32 v80, v80
    v_exp_f32 v81, v81
    v_mfma_f32_16x16x32_bf16 v[164:167], a[44:47], v[20:23], 0
    v_exp_f32 v82, v82
    v_exp_f32 v83, v83
    v_sub_f32 v84, v84, v224
    v_sub_f32 v85, v85, v224
    v_sub_f32 v86, v86, v224
    v_sub_f32 v87, v87, v224
    v_exp_f32 v84, v84
    v_exp_f32 v85, v85
    v_exp_f32 v86, v86
    v_mfma_f32_16x16x32_bf16 v[168:171], a[48:51], v[20:23], 0
    v_exp_f32 v87, v87
    v_cvt_pk_bf16_f32 v80, v80, v81
    v_cvt_pk_bf16_f32 v81, v82, v83
    v_cvt_pk_bf16_f32 v82, v84, v85
    v_cvt_pk_bf16_f32 v83, v86, v87
    v_sub_f32 v88, v88, v224
    v_sub_f32 v89, v89, v224
    v_sub_f32 v90, v90, v224
    v_sub_f32 v91, v91, v224
    v_exp_f32 v88, v88
    v_exp_f32 v89, v89
    v_mfma_f32_16x16x32_bf16 v[172:175], a[52:55], v[20:23], 0
    v_exp_f32 v90, v90
    v_exp_f32 v91, v91
    v_sub_f32 v92, v92, v224
    v_sub_f32 v93, v93, v224
    v_sub_f32 v94, v94, v224
    v_sub_f32 v95, v95, v224
    v_exp_f32 v92, v92
    v_exp_f32 v93, v93
    v_exp_f32 v94, v94
    v_mfma_f32_16x16x32_bf16 v[176:179], a[56:59], v[20:23], 0
    v_exp_f32 v95, v95
    v_cvt_pk_bf16_f32 v88, v88, v89
    v_cvt_pk_bf16_f32 v89, v90, v91
    v_cvt_pk_bf16_f32 v90, v92, v93
    v_cvt_pk_bf16_f32 v91, v94, v95
    v_sub_f32 v96, v96, v224
    v_sub_f32 v97, v97, v224
    v_sub_f32 v98, v98, v224
    v_sub_f32 v99, v99, v224
    v_exp_f32 v96, v96
    v_exp_f32 v97, v97
    v_mfma_f32_16x16x32_bf16 v[180:183], a[60:63], v[20:23], 0
    v_exp_f32 v98, v98
    v_exp_f32 v99, v99
    v_sub_f32 v100, v100, v224
    v_sub_f32 v101, v101, v224
    v_sub_f32 v102, v102, v224
    v_sub_f32 v103, v103, v224
    v_exp_f32 v100, v100
    v_exp_f32 v101, v101
    v_exp_f32 v102, v102
    v_mfma_f32_16x16x32_bf16 v[184:187], a[64:67], v[20:23], 0
    v_exp_f32 v103, v103
    v_cvt_pk_bf16_f32 v96, v96, v97
    v_cvt_pk_bf16_f32 v97, v98, v99
    v_cvt_pk_bf16_f32 v98, v100, v101
    v_cvt_pk_bf16_f32 v99, v102, v103
    v_sub_f32 v104, v104, v224
    v_sub_f32 v105, v105, v224
    v_sub_f32 v106, v106, v224
    v_sub_f32 v107, v107, v224
    v_exp_f32 v104, v104
    v_exp_f32 v105, v105
    v_exp_f32 v106, v106
    v_mfma_f32_16x16x32_bf16 v[188:191], a[68:71], v[20:23], v[236:239]
    v_exp_f32 v107, v107
    v_sub_f32 v108, v108, v224
    v_sub_f32 v109, v109, v224
    v_sub_f32 v110, v110, v224
    v_sub_f32 v111, v111, v224
    v_exp_f32 v108, v108
    v_exp_f32 v109, v109
    v_exp_f32 v110, v110
    v_exp_f32 v111, v111
    v_cvt_pk_bf16_f32 v104, v104, v105
    v_cvt_pk_bf16_f32 v105, v106, v107
    v_cvt_pk_bf16_f32 v106, v108, v109
    v_cvt_pk_bf16_f32 v107, v110, v111
    v_sub_f32 v112, v112, v224
    v_sub_f32 v113, v113, v224
    v_sub_f32 v114, v114, v224
    v_sub_f32 v115, v115, v224
    v_exp_f32 v112, v112
    v_exp_f32 v113, v113
    v_exp_f32 v114, v114
    v_exp_f32 v115, v115
    v_cvt_pk_bf16_f32 v112, v112, v113
    v_cvt_pk_bf16_f32 v113, v114, v115
    v_mov_b32 v114, 0
    v_mov_b32 v115, 0
    s_nop 1
    v_max_f32 v224, v136, v138
    v_max_f32 v225, v137, v139
    v_mfma_f32_16x16x32_bf16 v[192:195], a[96:99], v[64:67], 0
    v_max3_f32 v224, v224, v140, v142
    v_max3_f32 v225, v225, v141, v143
    v_max3_f32 v224, v224, v144, v146
    v_max3_f32 v225, v225, v145, v147
    v_max3_f32 v224, v224, v148, v150
    v_max3_f32 v225, v225, v149, v151
    v_max3_f32 v224, v224, v152, v154
    v_max3_f32 v225, v225, v153, v155
    v_mfma_f32_16x16x32_bf16 v[192:195], a[104:107], v[72:75], v[192:195]
    v_max3_f32 v224, v224, v156, v158
    v_max3_f32 v225, v225, v157, v159
    v_max3_f32 v224, v224, v160, v162
    v_max3_f32 v225, v225, v161, v163
    v_max3_f32 v224, v224, v164, v166
    v_max3_f32 v225, v225, v165, v167
    v_max3_f32 v224, v224, v168, v170
    v_mfma_f32_16x16x32_bf16 v[192:195], a[112:115], v[80:83], v[192:195]
    v_max3_f32 v225, v225, v169, v171
    v_max3_f32 v224, v224, v172, v174
    v_max3_f32 v225, v225, v173, v175
    v_max3_f32 v224, v224, v176, v178
    v_max3_f32 v225, v225, v177, v179
    v_max3_f32 v224, v224, v180, v182
    v_max3_f32 v225, v225, v181, v183
    v_mfma_f32_16x16x32_bf16 v[192:195], a[120:123], v[88:91], v[192:195]
    v_max3_f32 v224, v224, v184, v186
    v_max3_f32 v225, v225, v185, v187
    v_max3_f32 v224, v224, v188, v190
    v_max3_f32 v225, v225, v189, v191
    v_max_f32 v224, v224, v225
    v_mov_b32 v225, v224
    s_nop 1
    v_permlane16_swap_b32 v224, v225
    v_max_f32 v224, v224, v225
    v_mfma_f32_16x16x32_bf16 v[192:195], a[128:131], v[96:99], v[192:195]
    v_mov_b32 v225, v224
    s_nop 1
    v_permlane32_swap_b32 v224, v225
    v_max_f32 v224, v224, v225
    v_sub_f32 v136, v136, v224
    v_mfma_f32_16x16x32_bf16 v[192:195], a[136:139], v[104:107], v[192:195]
    v_sub_f32 v137, v137, v224
    v_sub_f32 v138, v138, v224
    v_sub_f32 v139, v139, v224
    v_exp_f32 v136, v136
    v_exp_f32 v137, v137
    v_exp_f32 v138, v138
    v_mfma_f32_16x16x32_bf16 v[192:195], a[144:147], v[112:115], v[192:195]
    v_exp_f32 v139, v139
    v_sub_f32 v140, v140, v224
    v_sub_f32 v141, v141, v224
    v_sub_f32 v142, v142, v224
    v_sub_f32 v143, v143, v224
    v_mfma_f32_16x16x32_bf16 v[196:199], a[100:103], v[64:67], 0
    v_exp_f32 v140, v140
    v_exp_f32 v141, v141
    v_exp_f32 v142, v142
    v_exp_f32 v143, v143
    v_mfma_f32_16x16x32_bf16 v[196:199], a[108:111], v[72:75], v[196:199]
    v_cvt_pk_bf16_f32 v136, v136, v137
    v_cvt_pk_bf16_f32 v137, v138, v139
    v_cvt_pk_bf16_f32 v138, v140, v141
    v_cvt_pk_bf16_f32 v139, v142, v143
    v_sub_f32 v144, v144, v224
    v_sub_f32 v145, v145, v224
    v_mfma_f32_16x16x32_bf16 v[196:199], a[116:119], v[80:83], v[196:199]
    v_sub_f32 v146, v146, v224
    v_sub_f32 v147, v147, v224
    v_exp_f32 v144, v144
    v_exp_f32 v145, v145
    v_exp_f32 v146, v146
    v_mfma_f32_16x16x32_bf16 v[196:199], a[124:127], v[88:91], v[196:199]
    v_exp_f32 v147, v147
    v_sub_f32 v148, v148, v224
    v_sub_f32 v149, v149, v224
    v_sub_f32 v150, v150, v224
    v_sub_f32 v151, v151, v224
    v_mfma_f32_16x16x32_bf16 v[196:199], a[132:135], v[96:99], v[196:199]
    v_exp_f32 v148, v148
    v_exp_f32 v149, v149
    v_exp_f32 v150, v150
    v_exp_f32 v151, v151
    v_mfma_f32_16x16x32_bf16 v[196:199], a[140:143], v[104:107], v[196:199]
    v_cvt_pk_bf16_f32 v144, v144, v145
    v_cvt_pk_bf16_f32 v145, v146, v147
    v_cvt_pk_bf16_f32 v146, v148, v149
    v_cvt_pk_bf16_f32 v147, v150, v151
    v_sub_f32 v152, v152, v224
    v_sub_f32 v153, v153, v224
    v_sub_f32 v154, v154, v224
    v_mfma_f32_16x16x32_bf16 v[196:199], a[148:151], v[112:115], v[196:199]
    v_sub_f32 v155, v155, v224
    v_exp_f32 v152, v152
    v_exp_f32 v153, v153
    v_exp_f32 v154, v154
    v_mfma_f32_16x16x32_bf16 v[56:59], a[16:19], v[24:27], 0
    v_exp_f32 v155, v155
    v_sub_f32 v156, v156, v224
    v_sub_f32 v157, v157, v224
    v_sub_f32 v158, v158, v224
    v_sub_f32 v159, v159, v224
    v_exp_f32 v156, v156
    v_mfma_f32_16x16x32_bf16 v[60:63], a[20:23], v[24:27], 0
    v_exp_f32 v157, v157
    v_exp_f32 v158, v158
    v_exp_f32 v159, v159
    v_mfma_f32_16x16x32_bf16 v[64:67], a[24:27], v[24:27], 0
    v_cvt_pk_bf16_f32 v152, v152, v153
    v_cvt_pk_bf16_f32 v153, v154, v155
    v_cvt_pk_bf16_f32 v154, v156, v157
    v_cvt_pk_bf16_f32 v155, v158, v159
    v_sub_f32 v160, v160, v224
    v_sub_f32 v161, v161, v224
    v_sub_f32 v162, v162, v224
    v_mfma_f32_16x16x32_bf16 v[68:71], a[28:31], v[24:27], 0
    v_sub_f32 v163, v163, v224
    v_exp_f32 v160, v160
    v_exp_f32 v161, v161
    v_exp_f32 v162, v162
    v_exp_f32 v163, v163
    v_mfma_f32_16x16x32_bf16 v[72:75], a[32:35], v[24:27], 0
    v_sub_f32 v164, v164, v224
    v_sub_f32 v165, v165, v224
    v_sub_f32 v166, v166, v224
    v_sub_f32 v167, v167, v224
    v_exp_f32 v164, v164
    v_mfma_f32_16x16x32_bf16 v[76:79], a[36:39], v[24:27], 0
    v_exp_f32 v165, v165
    v_exp_f32 v166, v166
    v_exp_f32 v167, v167
    v_cvt_pk_bf16_f32 v160, v160, v161
    v_mfma_f32_16x16x32_bf16 v[80:83], a[40:43], v[24:27], 0
    v_cvt_pk_bf16_f32 v161, v162, v163
    v_cvt_pk_bf16_f32 v162, v164, v165
    v_cvt_pk_bf16_f32 v163, v166, v167
    v_sub_f32 v168, v168, v224
    v_sub_f32 v169, v169, v224
    v_sub_f32 v170, v170, v224
    v_sub_f32 v171, v171, v224
    v_mfma_f32_16x16x32_bf16 v[84:87], a[44:47], v[24:27], 0
    v_exp_f32 v168, v168
    v_exp_f32 v169, v169
    v_exp_f32 v170, v170
    v_exp_f32 v171, v171
    v_mfma_f32_16x16x32_bf16 v[88:91], a[48:51], v[24:27], 0
    v_sub_f32 v172, v172, v224
    v_sub_f32 v173, v173, v224
    v_sub_f32 v174, v174, v224
    v_sub_f32 v175, v175, v224
    v_exp_f32 v172, v172
    v_mfma_f32_16x16x32_bf16 v[92:95], a[52:55], v[24:27], 0
    v_exp_f32 v173, v173
    v_exp_f32 v174, v174
    v_exp_f32 v175, v175
    v_cvt_pk_bf16_f32 v168, v168, v169
    v_cvt_pk_bf16_f32 v169, v170, v171
    v_mfma_f32_16x16x32_bf16 v[96:99], a[56:59], v[24:27], 0
    v_cvt_pk_bf16_f32 v170, v172, v173
    v_cvt_pk_bf16_f32 v171, v174, v175
    v_sub_f32 v176, v176, v224
    v_sub_f32 v177, v177, v224
    v_sub_f32 v178, v178, v224
    v_sub_f32 v179, v179, v224
    v_exp_f32 v176, v176
    v_mfma_f32_16x16x32_bf16 v[100:103], a[60:63], v[24:27], 0
    v_exp_f32 v177, v177
    v_exp_f32 v178, v178
    v_exp_f32 v179, v179
    v_mfma_f32_16x16x32_bf16 v[104:107], a[64:67], v[24:27], 0
    v_sub_f32 v180, v180, v224
    v_sub_f32 v181, v181, v224
    v_sub_f32 v182, v182, v224
    v_sub_f32 v183, v183, v224
    v_exp_f32 v180, v180
    v_exp_f32 v181, v181
    v_mfma_f32_16x16x32_bf16 v[108:111], a[68:71], v[24:27], 0
    v_exp_f32 v182, v182
    v_exp_f32 v183, v183
    v_cvt_pk_bf16_f32 v176, v176, v177
    v_cvt_pk_bf16_f32 v177, v178, v179
    v_mfma_f32_16x16x32_bf16 v[112:115], a[72:75], v[24:27], v[236:239]
    v_cvt_pk_bf16_f32 v178, v180, v181
    v_cvt_pk_bf16_f32 v179, v182, v183
    v_sub_f32 v184, v184, v224
    v_sub_f32 v185, v185, v224
    v_sub_f32 v186, v186, v224
    v_sub_f32 v187, v187, v224
    v_exp_f32 v184, v184
    v_exp_f32 v185, v185
    v_exp_f32 v186, v186
    v_exp_f32 v187, v187
    v_sub_f32 v188, v188, v224
    v_sub_f32 v189, v189, v224
    v_sub_f32 v190, v190, v224
    v_sub_f32 v191, v191, v224
    v_exp_f32 v188, v188
    v_exp_f32 v189, v189
    v_exp_f32 v190, v190
    v_exp_f32 v191, v191
    v_cvt_pk_bf16_f32 v184, v184, v185
    v_cvt_pk_bf16_f32 v185, v186, v187
    v_cvt_pk_bf16_f32 v186, v188, v189
    v_cvt_pk_bf16_f32 v187, v190, v191
    s_nop 1
    v_mov_b32 v228, v199
    v_mov_b32 v226, v199
    v_mfma_f32_16x16x32_bf16 v[200:203], a[96:99], v[136:139], 0
    v_cndmask_b32 v196, v196, v198, s[40:41]
    v_cndmask_b32 v197, v197, v199, s[40:41]
    v_permlane32_swap_b32 v226, v228
    v_mov_b32 v226, v228
    s_nop 1
    v_permlane16_swap_b32 v226, v228
    v_rcp_f32 v226, v228
    v_mfma_f32_16x16x32_bf16 v[200:203], a[104:107], v[144:147], v[200:203]
    s_nop 0
    v_pk_mul_f32 v[192:193], v[192:193], v[226:227] op_sel_hi:[1,0]
    v_pk_mul_f32 v[194:195], v[194:195], v[226:227] op_sel_hi:[1,0]
    v_pk_mul_f32 v[196:197], v[196:197], v[226:227] op_sel_hi:[1,0]
    v_cvt_pk_bf16_f32 v198, v196, v197
    v_cvt_pk_bf16_f32 v192, v192, v193
    v_cvt_pk_bf16_f32 v193, v194, v195
    ds_bpermute_b32 v227, v243, v198
    v_mfma_f32_16x16x32_bf16 v[200:203], a[112:115], v[152:155], v[200:203]
    ds_write_b64 v251, v[192:193] offset:0
    s_mov_b32 vcc_lo, 65535
    s_mov_b32 vcc_hi, 0
    s_waitcnt lgkmcnt(1)
    v_cndmask_b32 v12, v12, v227, vcc
    v_max_f32 v224, v56, v58
    v_max_f32 v225, v57, v59
    v_max3_f32 v224, v224, v60, v62
    v_mfma_f32_16x16x32_bf16 v[200:203], a[120:123], v[160:163], v[200:203]
    v_max3_f32 v225, v225, v61, v63
    v_max3_f32 v224, v224, v64, v66
    v_max3_f32 v225, v225, v65, v67
    v_max3_f32 v224, v224, v68, v70
    v_max3_f32 v225, v225, v69, v71
    v_max3_f32 v224, v224, v72, v74
    v_max3_f32 v225, v225, v73, v75
    v_max3_f32 v224, v224, v76, v78
    v_mfma_f32_16x16x32_bf16 v[200:203], a[128:131], v[168:171], v[200:203]
    v_max3_f32 v225, v225, v77, v79
    v_max3_f32 v224, v224, v80, v82
    v_max3_f32 v225, v225, v81, v83
    v_max3_f32 v224, v224, v84, v86
    v_max3_f32 v225, v225, v85, v87
    v_max3_f32 v224, v224, v88, v90
    v_max3_f32 v225, v225, v89, v91
    v_max3_f32 v224, v224, v92, v94
    v_mfma_f32_16x16x32_bf16 v[200:203], a[136:139], v[176:179], v[200:203]
    v_max3_f32 v225, v225, v93, v95
    v_max3_f32 v224, v224, v96, v98
    v_max3_f32 v225, v225, v97, v99
    v_max3_f32 v224, v224, v100, v102
    v_max3_f32 v225, v225, v101, v103
    v_max3_f32 v224, v224, v104, v106
    v_max3_f32 v225, v225, v105, v107
    v_max3_f32 v224, v224, v108, v110
    v_max3_f32 v225, v225, v109, v111
    v_mfma_f32_16x16x32_bf16 v[200:203], a[144:147], v[184:187], v[200:203]
    v_max3_f32 v224, v224, v112, v114
    v_max3_f32 v225, v225, v113, v115
    v_max_f32 v224, v224, v225
    v_mov_b32 v225, v224
    s_nop 1
    v_permlane16_swap_b32 v224, v225
    v_max_f32 v224, v224, v225
    v_mov_b32 v225, v224
    s_nop 1
    v_permlane32_swap_b32 v224, v225
    v_max_f32 v224, v224, v225
    v_mfma_f32_16x16x32_bf16 v[204:207], a[100:103], v[136:139], 0
    v_sub_f32 v56, v56, v224
    v_sub_f32 v57, v57, v224
    v_sub_f32 v58, v58, v224
    v_sub_f32 v59, v59, v224
    v_exp_f32 v56, v56
    v_mfma_f32_16x16x32_bf16 v[204:207], a[108:111], v[144:147], v[204:207]
    v_exp_f32 v57, v57
    v_exp_f32 v58, v58
    v_exp_f32 v59, v59
    v_sub_f32 v60, v60, v224
    v_mfma_f32_16x16x32_bf16 v[204:207], a[116:119], v[152:155], v[204:207]
    v_sub_f32 v61, v61, v224
    v_sub_f32 v62, v62, v224
    v_sub_f32 v63, v63, v224
    v_exp_f32 v60, v60
    v_exp_f32 v61, v61
    v_exp_f32 v62, v62
    v_mfma_f32_16x16x32_bf16 v[204:207], a[124:127], v[160:163], v[204:207]
    v_exp_f32 v63, v63
    v_cvt_pk_bf16_f32 v56, v56, v57
    v_cvt_pk_bf16_f32 v57, v58, v59
    v_cvt_pk_bf16_f32 v58, v60, v61
    v_cvt_pk_bf16_f32 v59, v62, v63
    v_sub_f32 v64, v64, v224
    v_sub_f32 v65, v65, v224
    v_mfma_f32_16x16x32_bf16 v[204:207], a[132:135], v[168:171], v[204:207]
    v_sub_f32 v66, v66, v224
    v_sub_f32 v67, v67, v224
    v_exp_f32 v64, v64
    v_exp_f32 v65, v65
    v_exp_f32 v66, v66
    v_mfma_f32_16x16x32_bf16 v[204:207], a[140:143], v[176:179], v[204:207]
    v_exp_f32 v67, v67
    v_sub_f32 v68, v68, v224
    v_sub_f32 v69, v69, v224
    v_sub_f32 v70, v70, v224
    v_sub_f32 v71, v71, v224
    v_exp_f32 v68, v68
    v_mfma_f32_16x16x32_bf16 v[204:207], a[148:151], v[184:187], v[204:207]
    v_exp_f32 v69, v69
    v_exp_f32 v70, v70
    v_exp_f32 v71, v71
    v_cvt_pk_bf16_f32 v64, v64, v65
    v_cvt_pk_bf16_f32 v65, v66, v67
    v_mfma_f32_16x16x32_bf16 v[128:131], a[16:19], v[28:31], 0
    v_cvt_pk_bf16_f32 v66, v68, v69
    v_cvt_pk_bf16_f32 v67, v70, v71
    v_sub_f32 v72, v72, v224
    v_sub_f32 v73, v73, v224
    v_sub_f32 v74, v74, v224
    v_sub_f32 v75, v75, v224
    v_exp_f32 v72, v72
    v_mfma_f32_16x16x32_bf16 v[132:135], a[20:23], v[28:31], 0
    v_exp_f32 v73, v73
    v_exp_f32 v74, v74
    v_exp_f32 v75, v75
    v_sub_f32 v76, v76, v224
    v_sub_f32 v77, v77, v224
    v_sub_f32 v78, v78, v224
    v_mfma_f32_16x16x32_bf16 v[136:139], a[24:27], v[28:31], 0
    v_sub_f32 v79, v79, v224
    v_exp_f32 v76, v76
    v_exp_f32 v77, v77
    v_exp_f32 v78, v78
    v_exp_f32 v79, v79
    v_mfma_f32_16x16x32_bf16 v[140:143], a[28:31], v[28:31], 0
    v_cvt_pk_bf16_f32 v72, v72, v73
    v_cvt_pk_bf16_f32 v73, v74, v75
    v_cvt_pk_bf16_f32 v74, v76, v77
    v_cvt_pk_bf16_f32 v75, v78, v79
    v_sub_f32 v80, v80, v224
    v_sub_f32 v81, v81, v224
    v_sub_f32 v82, v82, v224
    v_mfma_f32_16x16x32_bf16 v[144:147], a[32:35], v[28:31], 0
    v_sub_f32 v83, v83, v224
    v_exp_f32 v80, v80
    v_exp_f32 v81, v81
    v_exp_f32 v82, v82
    v_exp_f32 v83, v83
    v_mfma_f32_16x16x32_bf16 v[148:151], a[36:39], v[28:31], 0
    v_sub_f32 v84, v84, v224
    v_sub_f32 v85, v85, v224
    v_sub_f32 v86, v86, v224
    v_sub_f32 v87, v87, v224
    v_exp_f32 v84, v84
    v_exp_f32 v85, v85
    v_mfma_f32_16x16x32_bf16 v[152:155], a[40:43], v[28:31], 0
    v_exp_f32 v86, v86
    v_exp_f32 v87, v87
    v_cvt_pk_bf16_f32 v80, v80, v81
    v_cvt_pk_bf16_f32 v81, v82, v83
    v_cvt_pk_bf16_f32 v82, v84, v85
    v_mfma_f32_16x16x32_bf16 v[156:159], a[44:47], v[28:31], 0
    v_cvt_pk_bf16_f32 v83, v86, v87
    v_sub_f32 v88, v88, v224
    v_sub_f32 v89, v89, v224
    v_sub_f32 v90, v90, v224
    v_sub_f32 v91, v91, v224
    v_exp_f32 v88, v88
    v_exp_f32 v89, v89
    v_mfma_f32_16x16x32_bf16 v[160:163], a[48:51], v[28:31], 0
    v_exp_f32 v90, v90
    v_exp_f32 v91, v91
    v_sub_f32 v92, v92, v224
    v_sub_f32 v93, v93, v224
    v_sub_f32 v94, v94, v224
    v_sub_f32 v95, v95, v224
    v_mfma_f32_16x16x32_bf16 v[164:167], a[52:55], v[28:31], 0
    v_exp_f32 v92, v92
    v_exp_f32 v93, v93
    v_exp_f32 v94, v94
    v_exp_f32 v95, v95
    v_mfma_f32_16x16x32_bf16 v[168:171], a[56:59], v[28:31], 0
    v_cvt_pk_bf16_f32 v88, v88, v89
    v_cvt_pk_bf16_f32 v89, v90, v91
    v_cvt_pk_bf16_f32 v90, v92, v93
    v_cvt_pk_bf16_f32 v91, v94, v95
    v_sub_f32 v96, v96, v224
    v_sub_f32 v97, v97, v224
    v_sub_f32 v98, v98, v224
    v_sub_f32 v99, v99, v224
    v_mfma_f32_16x16x32_bf16 v[172:175], a[60:63], v[28:31], 0
    v_exp_f32 v96, v96
    v_exp_f32 v97, v97
    v_exp_f32 v98, v98
    v_exp_f32 v99, v99
    v_mfma_f32_16x16x32_bf16 v[176:179], a[64:67], v[28:31], 0
    v_sub_f32 v100, v100, v224
    v_sub_f32 v101, v101, v224
    v_sub_f32 v102, v102, v224
    v_sub_f32 v103, v103, v224
    v_exp_f32 v100, v100
    v_exp_f32 v101, v101
    v_exp_f32 v102, v102
    v_mfma_f32_16x16x32_bf16 v[180:183], a[68:71], v[28:31], 0
    v_exp_f32 v103, v103
    v_cvt_pk_bf16_f32 v96, v96, v97
    v_cvt_pk_bf16_f32 v97, v98, v99
    v_cvt_pk_bf16_f32 v98, v100, v101
    v_cvt_pk_bf16_f32 v99, v102, v103
    v_sub_f32 v104, v104, v224
    v_mfma_f32_16x16x32_bf16 v[184:187], a[72:75], v[28:31], 0
    v_sub_f32 v105, v105, v224
    v_sub_f32 v106, v106, v224
    v_sub_f32 v107, v107, v224
    v_exp_f32 v104, v104
    v_exp_f32 v105, v105
    v_exp_f32 v106, v106
    v_mfma_f32_16x16x32_bf16 v[188:191], a[76:79], v[28:31], v[236:239]
    v_exp_f32 v107, v107
    v_sub_f32 v108, v108, v224
    v_sub_f32 v109, v109, v224
    v_sub_f32 v110, v110, v224
    v_sub_f32 v111, v111, v224
    v_exp_f32 v108, v108
    v_exp_f32 v109, v109
    v_exp_f32 v110, v110
    v_exp_f32 v111, v111
    v_cvt_pk_bf16_f32 v104, v104, v105
    v_cvt_pk_bf16_f32 v105, v106, v107
    v_cvt_pk_bf16_f32 v106, v108, v109
    v_cvt_pk_bf16_f32 v107, v110, v111
    v_sub_f32 v112, v112, v224
    v_sub_f32 v113, v113, v224
    v_sub_f32 v114, v114, v224
    v_sub_f32 v115, v115, v224
    v_exp_f32 v112, v112
    v_exp_f32 v113, v113
    v_exp_f32 v114, v114
    v_exp_f32 v115, v115
    v_cvt_pk_bf16_f32 v112, v112, v113
    v_cvt_pk_bf16_f32 v113, v114, v115
    v_mov_b32 v114, 0
    v_mov_b32 v115, 0
    s_nop 1
    v_mov_b32 v228, v207
    v_mov_b32 v226, v207
    v_mfma_f32_16x16x32_bf16 v[208:211], a[96:99], v[56:59], 0
    v_cndmask_b32 v204, v204, v206, s[40:41]
    v_cndmask_b32 v205, v205, v207, s[40:41]
    v_permlane32_swap_b32 v226, v228
    v_mov_b32 v226, v228
    s_nop 1
    v_permlane16_swap_b32 v226, v228
    v_rcp_f32 v226, v228
    s_nop 0
    v_pk_mul_f32 v[200:201], v[200:201], v[226:227] op_sel_hi:[1,0]
    v_pk_mul_f32 v[202:203], v[202:203], v[226:227] op_sel_hi:[1,0]
    v_pk_mul_f32 v[204:205], v[204:205], v[226:227] op_sel_hi:[1,0]
    v_cvt_pk_bf16_f32 v206, v204, v205
    v_cvt_pk_bf16_f32 v200, v200, v201
    v_cvt_pk_bf16_f32 v201, v202, v203
    ds_bpermute_b32 v227, v243, v206
    v_mfma_f32_16x16x32_bf16 v[208:211], a[104:107], v[64:67], v[208:211]
    ds_write_b64 v251, v[200:201] offset:1024
    s_mov_b32 vcc_lo, 4294901760
    s_mov_b32 vcc_hi, 0
    s_waitcnt lgkmcnt(1)
    v_cndmask_b32 v12, v12, v227, vcc
    v_max_f32 v224, v128, v130
    v_max_f32 v225, v129, v131
    v_max3_f32 v224, v224, v132, v134
    v_max3_f32 v225, v225, v133, v135
    v_max3_f32 v224, v224, v136, v138
    v_max3_f32 v225, v225, v137, v139
    v_max3_f32 v224, v224, v140, v142
    v_max3_f32 v225, v225, v141, v143
    v_max3_f32 v224, v224, v144, v146
    v_max3_f32 v225, v225, v145, v147
    v_max3_f32 v224, v224, v148, v150
    v_mfma_f32_16x16x32_bf16 v[208:211], a[112:115], v[72:75], v[208:211]
    v_max3_f32 v225, v225, v149, v151
    v_max3_f32 v224, v224, v152, v154
    v_max3_f32 v225, v225, v153, v155
    v_max3_f32 v224, v224, v156, v158
    v_max3_f32 v225, v225, v157, v159
    v_max3_f32 v224, v224, v160, v162
    v_max3_f32 v225, v225, v161, v163
    v_max3_f32 v224, v224, v164, v166
    v_max3_f32 v225, v225, v165, v167
    v_max3_f32 v224, v224, v168, v170
    v_max3_f32 v225, v225, v169, v171
    v_max3_f32 v224, v224, v172, v174
    v_max3_f32 v225, v225, v173, v175
    v_max3_f32 v224, v224, v176, v178
    v_max3_f32 v225, v225, v177, v179
    v_max3_f32 v224, v224, v180, v182
    v_mfma_f32_16x16x32_bf16 v[208:211], a[120:123], v[80:83], v[208:211]
    v_max3_f32 v225, v225, v181, v183
    v_max3_f32 v224, v224, v184, v186
    v_max3_f32 v225, v225, v185, v187
    v_max3_f32 v224, v224, v188, v190
    v_max3_f32 v225, v225, v189, v191
    v_max_f32 v224, v224, v225
    v_mov_b32 v225, v224
    s_nop 1
    v_permlane16_swap_b32 v224, v225
    v_max_f32 v224, v224, v225
    v_mov_b32 v225, v224
    s_nop 1
    v_permlane32_swap_b32 v224, v225
    v_max_f32 v224, v224, v225
    v_sub_f32 v128, v128, v224
    v_sub_f32 v129, v129, v224
    v_mfma_f32_16x16x32_bf16 v[208:211], a[128:131], v[88:91], v[208:211]
    v_sub_f32 v130, v130, v224
    v_sub_f32 v131, v131, v224
    v_exp_f32 v128, v128
    v_exp_f32 v129, v129
    v_exp_f32 v130, v130
    v_exp_f32 v131, v131
    v_sub_f32 v132, v132, v224
    v_sub_f32 v133, v133, v224
    v_sub_f32 v134, v134, v224
    v_sub_f32 v135, v135, v224
    v_exp_f32 v132, v132
    v_mfma_f32_16x16x32_bf16 v[208:211], a[136:139], v[96:99], v[208:211]
    v_exp_f32 v133, v133
    v_exp_f32 v134, v134
    v_exp_f32 v135, v135
    v_cvt_pk_bf16_f32 v128, v128, v129
    v_cvt_pk_bf16_f32 v129, v130, v131
    v_cvt_pk_bf16_f32 v130, v132, v133
    v_cvt_pk_bf16_f32 v131, v134, v135
    v_sub_f32 v136, v136, v224
    v_sub_f32 v137, v137, v224
    v_sub_f32 v138, v138, v224
    v_sub_f32 v139, v139, v224
    v_exp_f32 v136, v136
    v_mfma_f32_16x16x32_bf16 v[208:211], a[144:147], v[104:107], v[208:211]
    v_exp_f32 v137, v137
    v_exp_f32 v138, v138
    v_exp_f32 v139, v139
    v_sub_f32 v140, v140, v224
    v_sub_f32 v141, v141, v224
    v_sub_f32 v142, v142, v224
    v_sub_f32 v143, v143, v224
    v_exp_f32 v140, v140
    v_exp_f32 v141, v141
    v_exp_f32 v142, v142
    v_exp_f32 v143, v143
    v_mfma_f32_16x16x32_bf16 v[208:211], a[152:155], v[112:115], v[208:211]
    v_cvt_pk_bf16_f32 v136, v136, v137
    v_cvt_pk_bf16_f32 v137, v138, v139
    v_cvt_pk_bf16_f32 v138, v140, v141
    v_cvt_pk_bf16_f32 v139, v142, v143
    v_sub_f32 v144, v144, v224
    v_sub_f32 v145, v145, v224
    v_sub_f32 v146, v146, v224
    v_sub_f32 v147, v147, v224
    v_exp_f32 v144, v144
    v_exp_f32 v145, v145
    v_exp_f32 v146, v146
    v_exp_f32 v147, v147
    v_mfma_f32_16x16x32_bf16 v[212:215], a[100:103], v[56:59], 0
    v_sub_f32 v148, v148, v224
    v_sub_f32 v149, v149, v224
    v_sub_f32 v150, v150, v224
    v_sub_f32 v151, v151, v224
    v_exp_f32 v148, v148
    v_exp_f32 v149, v149
    v_exp_f32 v150, v150
    v_exp_f32 v151, v151
    v_cvt_pk_bf16_f32 v144, v144, v145
    v_cvt_pk_bf16_f32 v145, v146, v147
    v_cvt_pk_bf16_f32 v146, v148, v149
    v_mfma_f32_16x16x32_bf16 v[212:215], a[108:111], v[64:67], v[212:215]
    v_cvt_pk_bf16_f32 v147, v150, v151
    v_sub_f32 v152, v152, v224
    v_sub_f32 v153, v153, v224
    v_sub_f32 v154, v154, v224
    v_sub_f32 v155, v155, v224
    v_exp_f32 v152, v152
    v_exp_f32 v153, v153
    v_exp_f32 v154, v154
    v_exp_f32 v155, v155
    v_sub_f32 v156, v156, v224
    v_sub_f32 v157, v157, v224
    v_sub_f32 v158, v158, v224
    v_mfma_f32_16x16x32_bf16 v[212:215], a[116:119], v[72:75], v[212:215]
    v_sub_f32 v159, v159, v224
    v_exp_f32 v156, v156
    v_exp_f32 v157, v157
    v_exp_f32 v158, v158
    v_exp_f32 v159, v159
    v_cvt_pk_bf16_f32 v152, v152, v153
    v_cvt_pk_bf16_f32 v153, v154, v155
    v_cvt_pk_bf16_f32 v154, v156, v157
    v_cvt_pk_bf16_f32 v155, v158, v159
    v_sub_f32 v160, v160, v224
    v_sub_f32 v161, v161, v224
    v_sub_f32 v162, v162, v224
    v_mfma_f32_16x16x32_bf16 v[212:215], a[124:127], v[80:83], v[212:215]
    v_sub_f32 v163, v163, v224
    v_exp_f32 v160, v160
    v_exp_f32 v161, v161
    v_exp_f32 v162, v162
    v_exp_f32 v163, v163
    v_sub_f32 v164, v164, v224
    v_sub_f32 v165, v165, v224
    v_sub_f32 v166, v166, v224
    v_sub_f32 v167, v167, v224
    v_exp_f32 v164, v164
    v_exp_f32 v165, v165
    v_mfma_f32_16x16x32_bf16 v[212:215], a[132:135], v[88:91], v[212:215]
    v_exp_f32 v166, v166
    v_exp_f32 v167, v167
    v_cvt_pk_bf16_f32 v160, v160, v161
    v_cvt_pk_bf16_f32 v161, v162, v163
    v_cvt_pk_bf16_f32 v162, v164, v165
    v_cvt_pk_bf16_f32 v163, v166, v167
    v_sub_f32 v168, v168, v224
    v_sub_f32 v169, v169, v224
    v_sub_f32 v170, v170, v224
    v_sub_f32 v171, v171, v224
    v_exp_f32 v168, v168
    v_exp_f32 v169, v169
    v_mfma_f32_16x16x32_bf16 v[212:215], a[140:143], v[96:99], v[212:215]
    v_exp_f32 v170, v170
    v_exp_f32 v171, v171
    v_sub_f32 v172, v172, v224
    v_sub_f32 v173, v173, v224
    v_sub_f32 v174, v174, v224
    v_sub_f32 v175, v175, v224
    v_exp_f32 v172, v172
    v_exp_f32 v173, v173
    v_exp_f32 v174, v174
    v_exp_f32 v175, v175
    v_mfma_f32_16x16x32_bf16 v[212:215], a[148:151], v[104:107], v[212:215]
    v_cvt_pk_bf16_f32 v168, v168, v169
    v_cvt_pk_bf16_f32 v169, v170, v171
    v_cvt_pk_bf16_f32 v170, v172, v173
    v_cvt_pk_bf16_f32 v171, v174, v175
    v_sub_f32 v176, v176, v224
    v_sub_f32 v177, v177, v224
    v_sub_f32 v178, v178, v224
    v_sub_f32 v179, v179, v224
    v_exp_f32 v176, v176
    v_exp_f32 v177, v177
    v_exp_f32 v178, v178
    v_exp_f32 v179, v179
    v_mfma_f32_16x16x32_bf16 v[212:215], a[156:159], v[112:115], v[212:215]
    v_sub_f32 v180, v180, v224
    v_sub_f32 v181, v181, v224
    v_sub_f32 v182, v182, v224
    v_sub_f32 v183, v183, v224
    v_exp_f32 v180, v180
    v_exp_f32 v181, v181
    v_exp_f32 v182, v182
    v_exp_f32 v183, v183
    v_cvt_pk_bf16_f32 v176, v176, v177
    v_cvt_pk_bf16_f32 v177, v178, v179
    v_cvt_pk_bf16_f32 v178, v180, v181
    v_cvt_pk_bf16_f32 v179, v182, v183
    v_sub_f32 v184, v184, v224
    v_sub_f32 v185, v185, v224
    v_sub_f32 v186, v186, v224
    v_sub_f32 v187, v187, v224
    v_exp_f32 v184, v184
    v_exp_f32 v185, v185
    v_exp_f32 v186, v186
    v_exp_f32 v187, v187
    v_sub_f32 v188, v188, v224
    v_sub_f32 v189, v189, v224
    v_sub_f32 v190, v190, v224
    v_sub_f32 v191, v191, v224
    v_exp_f32 v188, v188
    v_exp_f32 v189, v189
    v_exp_f32 v190, v190
    v_exp_f32 v191, v191
    v_cvt_pk_bf16_f32 v184, v184, v185
    v_cvt_pk_bf16_f32 v185, v186, v187
    v_cvt_pk_bf16_f32 v186, v188, v189
    v_cvt_pk_bf16_f32 v187, v190, v191
    s_nop 1
    v_mfma_f32_16x16x32_bf16 v[216:219], a[96:99], v[128:131], 0
    v_mov_b32 v228, v215
    v_mov_b32 v226, v215
    v_mfma_f32_16x16x32_bf16 v[216:219], a[104:107], v[136:139], v[216:219]
    v_cndmask_b32 v212, v212, v214, s[40:41]
    v_mfma_f32_16x16x32_bf16 v[216:219], a[112:115], v[144:147], v[216:219]
    v_cndmask_b32 v213, v213, v215, s[40:41]
    v_permlane32_swap_b32 v226, v228
    v_mov_b32 v226, v228
    s_nop 1
    v_permlane16_swap_b32 v226, v228
    v_mfma_f32_16x16x32_bf16 v[216:219], a[120:123], v[152:155], v[216:219]
    v_mfma_f32_16x16x32_bf16 v[216:219], a[128:131], v[160:163], v[216:219]
    v_mfma_f32_16x16x32_bf16 v[216:219], a[136:139], v[168:171], v[216:219]
    v_mfma_f32_16x16x32_bf16 v[216:219], a[144:147], v[176:179], v[216:219]
    v_rcp_f32 v226, v228
    v_mfma_f32_16x16x32_bf16 v[216:219], a[152:155], v[184:187], v[216:219]
    v_mfma_f32_16x16x32_bf16 v[220:223], a[100:103], v[128:131], 0
    s_nop 0
    v_pk_mul_f32 v[208:209], v[208:209], v[226:227] op_sel_hi:[1,0]
    v_mfma_f32_16x16x32_bf16 v[220:223], a[108:111], v[136:139], v[220:223]
    v_pk_mul_f32 v[210:211], v[210:211], v[226:227] op_sel_hi:[1,0]
    v_mfma_f32_16x16x32_bf16 v[220:223], a[116:119], v[144:147], v[220:223]
    v_pk_mul_f32 v[212:213], v[212:213], v[226:227] op_sel_hi:[1,0]
    v_mfma_f32_16x16x32_bf16 v[220:223], a[124:127], v[152:155], v[220:223]
    v_cvt_pk_bf16_f32 v214, v212, v213
    v_cvt_pk_bf16_f32 v208, v208, v209
    v_mfma_f32_16x16x32_bf16 v[220:223], a[132:135], v[160:163], v[220:223]
    v_cvt_pk_bf16_f32 v209, v210, v211
    v_mfma_f32_16x16x32_bf16 v[220:223], a[140:143], v[168:171], v[220:223]
    ds_bpermute_b32 v227, v243, v214
    v_mfma_f32_16x16x32_bf16 v[220:223], a[148:151], v[176:179], v[220:223]
    ds_write_b64 v251, v[208:209] offset:2048
    s_mov_b32 vcc_lo, 0
    s_mov_b32 vcc_hi, 65535
    v_mfma_f32_16x16x32_bf16 v[220:223], a[156:159], v[184:187], v[220:223]
    s_waitcnt lgkmcnt(1)
    v_cndmask_b32 v12, v12, v227, vcc
    s_nop 7
    v_mov_b32 v228, v223
    v_mov_b32 v226, v223
    v_cndmask_b32 v220, v220, v222, s[40:41]
    v_cndmask_b32 v221, v221, v223, s[40:41]
    v_permlane32_swap_b32 v226, v228
    v_mov_b32 v226, v228
    s_nop 1
    v_permlane16_swap_b32 v226, v228
    v_rcp_f32 v226, v228
    s_nop 0
    v_pk_mul_f32 v[216:217], v[216:217], v[226:227] op_sel_hi:[1,0]
    v_pk_mul_f32 v[218:219], v[218:219], v[226:227] op_sel_hi:[1,0]
    v_pk_mul_f32 v[220:221], v[220:221], v[226:227] op_sel_hi:[1,0]
    v_cvt_pk_bf16_f32 v222, v220, v221
    v_cvt_pk_bf16_f32 v216, v216, v217
    v_cvt_pk_bf16_f32 v217, v218, v219
    ds_bpermute_b32 v227, v243, v222
    ds_write_b64 v251, v[216:217] offset:3072
    s_mov_b32 vcc_lo, 0
    s_mov_b32 vcc_hi, 4294901760
    s_waitcnt lgkmcnt(1)
    v_cndmask_b32 v12, v12, v227, vcc
    ds_write_b32 v240, v12
    s_branch L_attn_done
L_attn_er8:
    v_mfma_f32_16x16x32_bf16 v[80:83], a[32:35], v[16:19], 0
    v_mfma_f32_16x16x32_bf16 v[84:87], a[36:39], v[16:19], 0
    v_mfma_f32_16x16x32_bf16 v[88:91], a[40:43], v[16:19], 0
    v_mfma_f32_16x16x32_bf16 v[92:95], a[44:47], v[16:19], 0
    v_mfma_f32_16x16x32_bf16 v[96:99], a[48:51], v[16:19], 0
    v_mfma_f32_16x16x32_bf16 v[100:103], a[52:55], v[16:19], 0
    v_mfma_f32_16x16x32_bf16 v[104:107], a[56:59], v[16:19], 0
    v_mfma_f32_16x16x32_bf16 v[108:111], a[60:63], v[16:19], 0
    v_mfma_f32_16x16x32_bf16 v[112:115], a[64:67], v[16:19], v[236:239]
    s_nop 7
    v_mfma_f32_16x16x32_bf16 v[152:155], a[32:35], v[20:23], 0
    v_max_f32 v224, v80, v82
    v_max_f32 v225, v81, v83
    v_max3_f32 v224, v224, v84, v86
    v_max3_f32 v225, v225, v85, v87
    v_max3_f32 v224, v224, v88, v90
    v_max3_f32 v225, v225, v89, v91
    v_max3_f32 v224, v224, v92, v94
    v_max3_f32 v225, v225, v93, v95
    v_max3_f32 v224, v224, v96, v98
    v_max3_f32 v225, v225, v97, v99
    v_max3_f32 v224, v224, v100, v102
    v_max3_f32 v225, v225, v101, v103
    v_max3_f32 v224, v224, v104, v106
    v_max3_f32 v225, v225, v105, v107
    v_mfma_f32_16x16x32_bf16 v[156:159], a[36:39], v[20:23], 0
    v_max3_f32 v224, v224, v108, v110
    v_max3_f32 v225, v225, v109, v111
    v_max3_f32 v224, v224, v112, v114
    v_max3_f32 v225, v225, v113, v115
    v_max_f32 v224, v224, v225
    v_mov_b32 v225, v224
    s_nop 1
    v_permlane16_swap_b32 v224, v225
    v_max_f32 v224, v224, v225
    v_mov_b32 v225, v224
    s_nop 1
    v_permlane32_swap_b32 v224, v225
    v_max_f32 v224, v224, v225
    v_sub_f32 v80, v80, v224
    v_mfma_f32_16x16x32_bf16 v[160:163], a[40:43], v[20:23], 0
    v_sub_f32 v81, v81, v224
    v_sub_f32 v82, v82, v224
    v_sub_f32 v83, v83, v224
    v_exp_f32 v80, v80
    v_exp_f32 v81, v81
    v_exp_f32 v82, v82
    v_exp_f32 v83, v83
    v_sub_f32 v84, v84, v224
    v_sub_f32 v85, v85, v224
    v_sub_f32 v86, v86, v224
    v_mfma_f32_16x16x32_bf16 v[164:167], a[44:47], v[20:23], 0
    v_sub_f32 v87, v87, v224
    v_exp_f32 v84, v84
    v_exp_f32 v85, v85
    v_exp_f32 v86, v86
    v_exp_f32 v87, v87
    v_cvt_pk_bf16_f32 v80, v80, v81
    v_cvt_pk_bf16_f32 v81, v82, v83
    v_cvt_pk_bf16_f32 v82, v84, v85
    v_cvt_pk_bf16_f32 v83, v86, v87
    v_sub_f32 v88, v88, v224
    v_mfma_f32_16x16x32_bf16 v[168:171], a[48:51], v[20:23], 0
    v_sub_f32 v89, v89, v224
    v_sub_f32 v90, v90, v224
    v_sub_f32 v91, v91, v224
    v_exp_f32 v88, v88
    v_exp_f32 v89, v89
    v_exp_f32 v90, v90
    v_exp_f32 v91, v91
    v_sub_f32 v92, v92, v224
    v_sub_f32 v93, v93, v224
    v_sub_f32 v94, v94, v224
    v_mfma_f32_16x16x32_bf16 v[172:175], a[52:55], v[20:23], 0
    v_sub_f32 v95, v95, v224
    v_exp_f32 v92, v92
    v_exp_f32 v93, v93
    v_exp_f32 v94, v94
    v_exp_f32 v95, v95
    v_cvt_pk_bf16_f32 v88, v88, v89
    v_cvt_pk_bf16_f32 v89, v90, v91
    v_cvt_pk_bf16_f32 v90, v92, v93
    v_cvt_pk_bf16_f32 v91, v94, v95
    v_sub_f32 v96, v96, v224
    v_mfma_f32_16x16x32_bf16 v[176:179], a[56:59], v[20:23], 0
    v_sub_f32 v97, v97, v224
    v_sub_f32 v98, v98, v224
    v_sub_f32 v99, v99, v224
    v_exp_f32 v96, v96
    v_exp_f32 v97, v97
    v_exp_f32 v98, v98
    v_exp_f32 v99, v99
    v_sub_f32 v100, v100, v224
    v_sub_f32 v101, v101, v224
    v_sub_f32 v102, v102, v224
    v_mfma_f32_16x16x32_bf16 v[180:183], a[60:63], v[20:23], 0
    v_sub_f32 v103, v103, v224
    v_exp_f32 v100, v100
    v_exp_f32 v101, v101
    v_exp_f32 v102, v102
    v_exp_f32 v103, v103
    v_cvt_pk_bf16_f32 v96, v96, v97
    v_cvt_pk_bf16_f32 v97, v98, v99
    v_cvt_pk_bf16_f32 v98, v100, v101
    v_cvt_pk_bf16_f32 v99, v102, v103
    v_sub_f32 v104, v104, v224
    v_mfma_f32_16x16x32_bf16 v[184:187], a[64:67], v[20:23], 0
    v_sub_f32 v105, v105, v224
    v_sub_f32 v106, v106, v224
    v_sub_f32 v107, v107, v224
    v_exp_f32 v104, v104
    v_exp_f32 v105, v105
    v_exp_f32 v106, v106
    v_exp_f32 v107, v107
    v_sub_f32 v108, v108, v224
    v_sub_f32 v109, v109, v224
    v_sub_f32 v110, v110, v224
    v_mfma_f32_16x16x32_bf16 v[188:191], a[68:71], v[20:23], v[236:239]
    v_sub_f32 v111, v111, v224
    v_exp_f32 v108, v108
    v_exp_f32 v109, v109
    v_exp_f32 v110, v110
    v_exp_f32 v111, v111
    v_cvt_pk_bf16_f32 v104, v104, v105
    v_cvt_pk_bf16_f32 v105, v106, v107
    v_cvt_pk_bf16_f32 v106, v108, v109
    v_cvt_pk_bf16_f32 v107, v110, v111
    v_sub_f32 v112, v112, v224
    v_sub_f32 v113, v113, v224
    v_sub_f32 v114, v114, v224
    v_sub_f32 v115, v115, v224
    v_exp_f32 v112, v112
    v_exp_f32 v113, v113
    v_exp_f32 v114, v114
    v_exp_f32 v115, v115
    v_cvt_pk_bf16_f32 v112, v112, v113
    v_cvt_pk_bf16_f32 v113, v114, v115
    v_mov_b32 v114, 0
    v_mov_b32 v115, 0
    s_nop 1
    v_max_f32 v224, v152, v154
    v_max_f32 v225, v153, v155
    v_mfma_f32_16x16x32_bf16 v[192:195], a[112:115], v[80:83], 0
    v_max3_f32 v224, v224, v156, v158
    v_max3_f32 v225, v225, v157, v159
    v_max3_f32 v224, v224, v160, v162
    v_max3_f32 v225, v225, v161, v163
    v_max3_f32 v224, v224, v164, v166
    v_max3_f32 v225, v225, v165, v167
    v_max3_f32 v224, v224, v168, v170
    v_max3_f32 v225, v225, v169, v171
    v_mfma_f32_16x16x32_bf16 v[192:195], a[120:123], v[88:91], v[192:195]
    v_max3_f32 v224, v224, v172, v174
    v_max3_f32 v225, v225, v173, v175
    v_max3_f32 v224, v224, v176, v178
    v_max3_f32 v225, v225, v177, v179
    v_max3_f32 v224, v224, v180, v182
    v_max3_f32 v225, v225, v181, v183
    v_max3_f32 v224, v224, v184, v186
    v_mfma_f32_16x16x32_bf16 v[192:195], a[128:131], v[96:99], v[192:195]
    v_max3_f32 v225, v225, v185, v187
    v_max3_f32 v224, v224, v188, v190
    v_max3_f32 v225, v225, v189, v191
    v_max_f32 v224, v224, v225
    v_mov_b32 v225, v224
    s_nop 1
    v_permlane16_swap_b32 v224, v225
    v_max_f32 v224, v224, v225
    v_mfma_f32_16x16x32_bf16 v[192:195], a[136:139], v[104:107], v[192:195]
    v_mov_b32 v225, v224
    s_nop 1
    v_permlane32_swap_b32 v224, v225
    v_max_f32 v224, v224, v225
    v_sub_f32 v152, v152, v224
    v_sub_f32 v153, v153, v224
    v_mfma_f32_16x16x32_bf16 v[192:195], a[144:147], v[112:115], v[192:195]
    v_sub_f32 v154, v154, v224
    v_sub_f32 v155, v155, v224
    v_exp_f32 v152, v152
    v_exp_f32 v153, v153
    v_exp_f32 v154, v154
    v_mfma_f32_16x16x32_bf16 v[196:199], a[116:119], v[80:83], 0
    v_exp_f32 v155, v155
    v_sub_f32 v156, v156, v224
    v_sub_f32 v157, v157, v224
    v_sub_f32 v158, v158, v224
    v_sub_f32 v159, v159, v224
    v_mfma_f32_16x16x32_bf16 v[196:199], a[124:127], v[88:91], v[196:199]
    v_exp_f32 v156, v156
    v_exp_f32 v157, v157
    v_exp_f32 v158, v158
    v_exp_f32 v159, v159
    v_mfma_f32_16x16x32_bf16 v[196:199], a[132:135], v[96:99], v[196:199]
    v_cvt_pk_bf16_f32 v152, v152, v153
    v_cvt_pk_bf16_f32 v153, v154, v155
    v_cvt_pk_bf16_f32 v154, v156, v157
    v_cvt_pk_bf16_f32 v155, v158, v159
    v_sub_f32 v160, v160, v224
    v_sub_f32 v161, v161, v224
    v_sub_f32 v162, v162, v224
    v_mfma_f32_16x16x32_bf16 v[196:199], a[140:143], v[104:107], v[196:199]
    v_sub_f32 v163, v163, v224
    v_exp_f32 v160, v160
    v_exp_f32 v161, v161
    v_exp_f32 v162, v162
    v_mfma_f32_16x16x32_bf16 v[196:199], a[148:151], v[112:115], v[196:199]
    v_exp_f32 v163, v163
    v_sub_f32 v164, v164, v224
    v_sub_f32 v165, v165, v224
    v_sub_f32 v166, v166, v224
    v_sub_f32 v167, v167, v224
    v_exp_f32 v164, v164
    v_mfma_f32_16x16x32_bf16 v[72:75], a[32:35], v[24:27], 0
    v_exp_f32 v165, v165
    v_exp_f32 v166, v166
    v_exp_f32 v167, v167
    v_mfma_f32_16x16x32_bf16 v[76:79], a[36:39], v[24:27], 0
    v_cvt_pk_bf16_f32 v160, v160, v161
    v_cvt_pk_bf16_f32 v161, v162, v163
    v_cvt_pk_bf16_f32 v162, v164, v165
    v_cvt_pk_bf16_f32 v163, v166, v167
    v_sub_f32 v168, v168, v224
    v_sub_f32 v169, v169, v224
    v_sub_f32 v170, v170, v224
    v_mfma_f32_16x16x32_bf16 v[80:83], a[40:43], v[24:27], 0
    v_sub_f32 v171, v171, v224
    v_exp_f32 v168, v168
    v_exp_f32 v169, v169
    v_exp_f32 v170, v170
    v_exp_f32 v171, v171
    v_mfma_f32_16x16x32_bf16 v[84:87], a[44:47], v[24:27], 0
    v_sub_f32 v172, v172, v224
    v_sub_f32 v173, v173, v224
    v_sub_f32 v174, v174, v224
    v_sub_f32 v175, v175, v224
    v_exp_f32 v172, v172
    v_mfma_f32_16x16x32_bf16 v[88:91], a[48:51], v[24:27], 0
    v_exp_f32 v173, v173
    v_exp_f32 v174, v174
    v_exp_f32 v175, v175
    v_cvt_pk_bf16_f32 v168, v168, v169
    v_mfma_f32_16x16x32_bf16 v[92:95], a[52:55], v[24:27], 0
    v_cvt_pk_bf16_f32 v169, v170, v171
    v_cvt_pk_bf16_f32 v170, v172, v173
    v_cvt_pk_bf16_f32 v171, v174, v175
    v_sub_f32 v176, v176, v224
    v_sub_f32 v177, v177, v224
    v_sub_f32 v178, v178, v224
    v_sub_f32 v179, v179, v224
    v_mfma_f32_16x16x32_bf16 v[96:99], a[56:59], v[24:27], 0
    v_exp_f32 v176, v176
    v_exp_f32 v177, v177
    v_exp_f32 v178, v178
    v_exp_f32 v179, v179
    v_mfma_f32_16x16x32_bf16 v[100:103], a[60:63], v[24:27], 0
    v_sub_f32 v180, v180, v224
    v_sub_f32 v181, v181, v224
    v_sub_f32 v182, v182, v224
    v_sub_f32 v183, v183, v224
    v_exp_f32 v180, v180
    v_mfma_f32_16x16x32_bf16 v[104:107], a[64:67], v[24:27], 0
    v_exp_f32 v181, v181
    v_exp_f32 v182, v182
    v_exp_f32 v183, v183
    v_cvt_pk_bf16_f32 v176, v176, v177
    v_mfma_f32_16x16x32_bf16 v[108:111], a[68:71], v[24:27], 0
    v_cvt_pk_bf16_f32 v177, v178, v179
    v_cvt_pk_bf16_f32 v178, v180, v181
    v_cvt_pk_bf16_f32 v179, v182, v183
    v_sub_f32 v184, v184, v224
    v_sub_f32 v185, v185, v224
    v_sub_f32 v186, v186, v224
    v_sub_f32 v187, v187, v224
    v_exp_f32 v184, v184
    v_mfma_f32_16x16x32_bf16 v[112:115], a[72:75], v[24:27], v[236:239]
    v_exp_f32 v185, v185
    v_exp_f32 v186, v186
    v_exp_f32 v187, v187
    v_sub_f32 v188, v188, v224
    v_sub_f32 v189, v189, v224
    v_sub_f32 v190, v190, v224
    v_sub_f32 v191, v191, v224
    v_exp_f32 v188, v188
    v_exp_f32 v189, v189
    v_exp_f32 v190, v190
    v_exp_f32 v191, v191
    v_cvt_pk_bf16_f32 v184, v184, v185
    v_cvt_pk_bf16_f32 v185, v186, v187
    v_cvt_pk_bf16_f32 v186, v188, v189
    v_cvt_pk_bf16_f32 v187, v190, v191
    s_nop 1
    v_mov_b32 v228, v199
    v_mov_b32 v226, v199
    v_mfma_f32_16x16x32_bf16 v[200:203], a[112:115], v[152:155], 0
    v_cndmask_b32 v196, v196, v198, s[40:41]
    v_cndmask_b32 v197, v197, v199, s[40:41]
    v_permlane32_swap_b32 v226, v228
    v_mov_b32 v226, v228
    s_nop 1
    v_permlane16_swap_b32 v226, v228
    v_rcp_f32 v226, v228
    v_mfma_f32_16x16x32_bf16 v[200:203], a[120:123], v[160:163], v[200:203]
    s_nop 0
    v_pk_mul_f32 v[192:193], v[192:193], v[226:227] op_sel_hi:[1,0]
    v_pk_mul_f32 v[194:195], v[194:195], v[226:227] op_sel_hi:[1,0]
    v_pk_mul_f32 v[196:197], v[196:197], v[226:227] op_sel_hi:[1,0]
    v_cvt_pk_bf16_f32 v198, v196, v197
    v_cvt_pk_bf16_f32 v192, v192, v193
    v_cvt_pk_bf16_f32 v193, v194, v195
    ds_bpermute_b32 v227, v243, v198
    ds_write_b64 v251, v[192:193] offset:0
    v_mfma_f32_16x16x32_bf16 v[200:203], a[128:131], v[168:171], v[200:203]
    s_mov_b32 vcc_lo, 65535
    s_mov_b32 vcc_hi, 0
    s_waitcnt lgkmcnt(1)
    v_cndmask_b32 v12, v12, v227, vcc
    v_max_f32 v224, v72, v74
    v_max_f32 v225, v73, v75
    v_max3_f32 v224, v224, v76, v78
    v_max3_f32 v225, v225, v77, v79
    v_mfma_f32_16x16x32_bf16 v[200:203], a[136:139], v[176:179], v[200:203]
    v_max3_f32 v224, v224, v80, v82
    v_max3_f32 v225, v225, v81, v83
    v_max3_f32 v224, v224, v84, v86
    v_max3_f32 v225, v225, v85, v87
    v_max3_f32 v224, v224, v88, v90
    v_max3_f32 v225, v225, v89, v91
    v_max3_f32 v224, v224, v92, v94
    v_max3_f32 v225, v225, v93, v95
    v_max3_f32 v224, v224, v96, v98
    v_mfma_f32_16x16x32_bf16 v[200:203], a[144:147], v[184:187], v[200:203]
    v_max3_f32 v225, v225, v97, v99
    v_max3_f32 v224, v224, v100, v102
    v_max3_f32 v225, v225, v101, v103
    v_max3_f32 v224, v224, v104, v106
    v_max3_f32 v225, v225, v105, v107
    v_max3_f32 v224, v224, v108, v110
    v_max3_f32 v225, v225, v109, v111
    v_max3_f32 v224, v224, v112, v114
    v_mfma_f32_16x16x32_bf16 v[204:207], a[116:119], v[152:155], 0
    v_max3_f32 v225, v225, v113, v115
    v_max_f32 v224, v224, v225
    v_mov_b32 v225, v224
    s_nop 1
    v_permlane16_swap_b32 v224, v225
    v_max_f32 v224, v224, v225
    v_mov_b32 v225, v224
    s_nop 1
    v_permlane32_swap_b32 v224, v225
    v_max_f32 v224, v224, v225
    v_mfma_f32_16x16x32_bf16 v[204:207], a[124:127], v[160:163], v[204:207]
    v_sub_f32 v72, v72, v224
    v_sub_f32 v73, v73, v224
    v_sub_f32 v74, v74, v224
    v_sub_f32 v75, v75, v224
    v_exp_f32 v72, v72
    v_exp_f32 v73, v73
    v_mfma_f32_16x16x32_bf16 v[204:207], a[132:135], v[168:171], v[204:207]
    v_exp_f32 v74, v74
    v_exp_f32 v75, v75
    v_sub_f32 v76, v76, v224
    v_sub_f32 v77, v77, v224
    v_sub_f32 v78, v78, v224
    v_sub_f32 v79, v79, v224
    v_mfma_f32_16x16x32_bf16 v[204:207], a[140:143], v[176:179], v[204:207]
    v_exp_f32 v76, v76
    v_exp_f32 v77, v77
    v_exp_f32 v78, v78
    v_exp_f32 v79, v79
    v_mfma_f32_16x16x32_bf16 v[204:207], a[148:151], v[184:187], v[204:207]
    v_cvt_pk_bf16_f32 v72, v72, v73
    v_cvt_pk_bf16_f32 v73, v74, v75
    v_cvt_pk_bf16_f32 v74, v76, v77
    v_cvt_pk_bf16_f32 v75, v78, v79
    v_sub_f32 v80, v80, v224
    v_sub_f32 v81, v81, v224
    v_sub_f32 v82, v82, v224
    v_sub_f32 v83, v83, v224
    v_exp_f32 v80, v80
    v_mfma_f32_16x16x32_bf16 v[144:147], a[32:35], v[28:31], 0
    v_exp_f32 v81, v81
    v_exp_f32 v82, v82
    v_exp_f32 v83, v83
    v_sub_f32 v84, v84, v224
    v_sub_f32 v85, v85, v224
    v_mfma_f32_16x16x32_bf16 v[148:151], a[36:39], v[28:31], 0
    v_sub_f32 v86, v86, v224
    v_sub_f32 v87, v87, v224
    v_exp_f32 v84, v84
    v_exp_f32 v85, v85
    v_exp_f32 v86, v86
    v_mfma_f32_16x16x32_bf16 v[152:155], a[40:43], v[28:31], 0
    v_exp_f32 v87, v87
    v_cvt_pk_bf16_f32 v80, v80, v81
    v_cvt_pk_bf16_f32 v81, v82, v83
    v_cvt_pk_bf16_f32 v82, v84, v85
    v_cvt_pk_bf16_f32 v83, v86, v87
    v_sub_f32 v88, v88, v224
    v_sub_f32 v89, v89, v224
    v_sub_f32 v90, v90, v224
    v_mfma_f32_16x16x32_bf16 v[156:159], a[44:47], v[28:31], 0
    v_sub_f32 v91, v91, v224
    v_exp_f32 v88, v88
    v_exp_f32 v89, v89
    v_exp_f32 v90, v90
    v_exp_f32 v91, v91
    v_mfma_f32_16x16x32_bf16 v[160:163], a[48:51], v[28:31], 0
    v_sub_f32 v92, v92, v224
    v_sub_f32 v93, v93, v224
    v_sub_f32 v94, v94, v224
    v_sub_f32 v95, v95, v224
    v_exp_f32 v92, v92
    v_exp_f32 v93, v93
    v_mfma_f32_16x16x32_bf16 v[164:167], a[52:55], v[28:31], 0
    v_exp_f32 v94, v94
    v_exp_f32 v95, v95
    v_cvt_pk_bf16_f32 v88, v88, v89
    v_cvt_pk_bf16_f32 v89, v90, v91
    v_cvt_pk_bf16_f32 v90, v92, v93
    v_cvt_pk_bf16_f32 v91, v94, v95
    v_mfma_f32_16x16x32_bf16 v[168:171], a[56:59], v[28:31], 0
    v_sub_f32 v96, v96, v224
    v_sub_f32 v97, v97, v224
    v_sub_f32 v98, v98, v224
    v_sub_f32 v99, v99, v224
    v_exp_f32 v96, v96
    v_exp_f32 v97, v97
    v_exp_f32 v98, v98
    v_mfma_f32_16x16x32_bf16 v[172:175], a[60:63], v[28:31], 0
    v_exp_f32 v99, v99
    v_sub_f32 v100, v100, v224
    v_sub_f32 v101, v101, v224
    v_sub_f32 v102, v102, v224
    v_sub_f32 v103, v103, v224
    v_exp_f32 v100, v100
    v_mfma_f32_16x16x32_bf16 v[176:179], a[64:67], v[28:31], 0
    v_exp_f32 v101, v101
    v_exp_f32 v102, v102
    v_exp_f32 v103, v103
    v_cvt_pk_bf16_f32 v96, v96, v97
    v_cvt_pk_bf16_f32 v97, v98, v99
    v_mfma_f32_16x16x32_bf16 v[180:183], a[68:71], v[28:31], 0
    v_cvt_pk_bf16_f32 v98, v100, v101
    v_cvt_pk_bf16_f32 v99, v102, v103
    v_sub_f32 v104, v104, v224
    v_sub_f32 v105, v105, v224
    v_sub_f32 v106, v106, v224
    v_sub_f32 v107, v107, v224
    v_exp_f32 v104, v104
    v_mfma_f32_16x16x32_bf16 v[184:187], a[72:75], v[28:31], 0
    v_exp_f32 v105, v105
    v_exp_f32 v106, v106
    v_exp_f32 v107, v107
    v_sub_f32 v108, v108, v224
    v_sub_f32 v109, v109, v224
    v_sub_f32 v110, v110, v224
    v_mfma_f32_16x16x32_bf16 v[188:191], a[76:79], v[28:31], v[236:239]
    v_sub_f32 v111, v111, v224
    v_exp_f32 v108, v108
    v_exp_f32 v109, v109
    v_exp_f32 v110, v110
    v_exp_f32 v111, v111
    v_cvt_pk_bf16_f32 v104, v104, v105
    v_cvt_pk_bf16_f32 v105, v106, v107
    v_cvt_pk_bf16_f32 v106, v108, v109
    v_cvt_pk_bf16_f32 v107, v110, v111
    v_sub_f32 v112, v112, v224
    v_sub_f32 v113, v113, v224
    v_sub_f32 v114, v114, v224
    v_sub_f32 v115, v115, v224
    v_exp_f32 v112, v112
    v_exp_f32 v113, v113
    v_exp_f32 v114, v114
    v_exp_f32 v115, v115
    v_cvt_pk_bf16_f32 v112, v112, v113
    v_cvt_pk_bf16_f32 v113, v114, v115
    v_mov_b32 v114, 0
    v_mov_b32 v115, 0
    s_nop 1
    v_mov_b32 v228, v207
    v_mov_b32 v226, v207
    v_mfma_f32_16x16x32_bf16 v[208:211], a[112:115], v[72:75], 0
    v_cndmask_b32 v204, v204, v206, s[40:41]
    v_cndmask_b32 v205, v205, v207, s[40:41]
    v_permlane32_swap_b32 v226, v228
    v_mov_b32 v226, v228
    s_nop 1
    v_permlane16_swap_b32 v226, v228
    v_rcp_f32 v226, v228
    s_nop 0
    v_pk_mul_f32 v[200:201], v[200:201], v[226:227] op_sel_hi:[1,0]
    v_pk_mul_f32 v[202:203], v[202:203], v[226:227] op_sel_hi:[1,0]
    v_pk_mul_f32 v[204:205], v[204:205], v[226:227] op_sel_hi:[1,0]
    v_cvt_pk_bf16_f32 v206, v204, v205
    v_cvt_pk_bf16_f32 v200, v200, v201
    v_cvt_pk_bf16_f32 v201, v202, v203
    ds_bpermute_b32 v227, v243, v206
    v_mfma_f32_16x16x32_bf16 v[208:211], a[120:123], v[80:83], v[208:211]
    ds_write_b64 v251, v[200:201] offset:1024
    s_mov_b32 vcc_lo, 4294901760
    s_mov_b32 vcc_hi, 0
    s_waitcnt lgkmcnt(1)
    v_cndmask_b32 v12, v12, v227, vcc
    v_max_f32 v224, v144, v146
    v_max_f32 v225, v145, v147
    v_max3_f32 v224, v224, v148, v150
    v_max3_f32 v225, v225, v149, v151
    v_max3_f32 v224, v224, v152, v154
    v_max3_f32 v225, v225, v153, v155
    v_max3_f32 v224, v224, v156, v158
    v_max3_f32 v225, v225, v157, v159
    v_max3_f32 v224, v224, v160, v162
    v_max3_f32 v225, v225, v161, v163
    v_max3_f32 v224, v224, v164, v166
    v_max3_f32 v225, v225, v165, v167
    v_mfma_f32_16x16x32_bf16 v[208:211], a[128:131], v[88:91], v[208:211]
    v_max3_f32 v224, v224, v168, v170
    v_max3_f32 v225, v225, v169, v171
    v_max3_f32 v224, v224, v172, v174
    v_max3_f32 v225, v225, v173, v175
    v_max3_f32 v224, v224, v176, v178
    v_max3_f32 v225, v225, v177, v179
    v_max3_f32 v224, v224, v180, v182
    v_max3_f32 v225, v225, v181, v183
    v_max3_f32 v224, v224, v184, v186
    v_max3_f32 v225, v225, v185, v187
    v_max3_f32 v224, v224, v188, v190
    v_max3_f32 v225, v225, v189, v191
    v_max_f32 v224, v224, v225
    v_mov_b32 v225, v224
    s_nop 1
    v_permlane16_swap_b32 v224, v225
    v_max_f32 v224, v224, v225
    v_mfma_f32_16x16x32_bf16 v[208:211], a[136:139], v[96:99], v[208:211]
    v_mov_b32 v225, v224
    s_nop 1
    v_permlane32_swap_b32 v224, v225
    v_max_f32 v224, v224, v225
    v_sub_f32 v144, v144, v224
    v_sub_f32 v145, v145, v224
    v_sub_f32 v146, v146, v224
    v_sub_f32 v147, v147, v224
    v_exp_f32 v144, v144
    v_exp_f32 v145, v145
    v_exp_f32 v146, v146
    v_exp_f32 v147, v147
    v_mfma_f32_16x16x32_bf16 v[208:211], a[144:147], v[104:107], v[208:211]
    v_sub_f32 v148, v148, v224
    v_sub_f32 v149, v149, v224
    v_sub_f32 v150, v150, v224
    v_sub_f32 v151, v151, v224
    v_exp_f32 v148, v148
    v_exp_f32 v149, v149
    v_exp_f32 v150, v150
    v_exp_f32 v151, v151
    v_cvt_pk_bf16_f32 v144, v144, v145
    v_cvt_pk_bf16_f32 v145, v146, v147
    v_cvt_pk_bf16_f32 v146, v148, v149
    v_cvt_pk_bf16_f32 v147, v150, v151
    v_sub_f32 v152, v152, v224
    v_mfma_f32_16x16x32_bf16 v[208:211], a[152:155], v[112:115], v[208:211]
    v_sub_f32 v153, v153, v224
    v_sub_f32 v154, v154, v224
    v_sub_f32 v155, v155, v224
    v_exp_f32 v152, v152
    v_exp_f32 v153, v153
    v_exp_f32 v154, v154
    v_exp_f32 v155, v155
    v_sub_f32 v156, v156, v224
    v_sub_f32 v157, v157, v224
    v_sub_f32 v158, v158, v224
    v_sub_f32 v159, v159, v224
    v_exp_f32 v156, v156
    v_mfma_f32_16x16x32_bf16 v[212:215], a[116:119], v[72:75], 0
    v_exp_f32 v157, v157
    v_exp_f32 v158, v158
    v_exp_f32 v159, v159
    v_cvt_pk_bf16_f32 v152, v152, v153
    v_cvt_pk_bf16_f32 v153, v154, v155
    v_cvt_pk_bf16_f32 v154, v156, v157
    v_cvt_pk_bf16_f32 v155, v158, v159
    v_sub_f32 v160, v160, v224
    v_sub_f32 v161, v161, v224
    v_sub_f32 v162, v162, v224
    v_sub_f32 v163, v163, v224
    v_exp_f32 v160, v160
    v_exp_f32 v161, v161
    v_mfma_f32_16x16x32_bf16 v[212:215], a[124:127], v[80:83], v[212:215]
    v_exp_f32 v162, v162
    v_exp_f32 v163, v163
    v_sub_f32 v164, v164, v224
    v_sub_f32 v165, v165, v224
    v_sub_f32 v166, v166, v224
    v_sub_f32 v167, v167, v224
    v_exp_f32 v164, v164
    v_exp_f32 v165, v165
    v_exp_f32 v166, v166
    v_exp_f32 v167, v167
    v_mfma_f32_16x16x32_bf16 v[212:215], a[132:135], v[88:91], v[212:215]
    v_cvt_pk_bf16_f32 v160, v160, v161
    v_cvt_pk_bf16_f32 v161, v162, v163
    v_cvt_pk_bf16_f32 v162, v164, v165
    v_cvt_pk_bf16_f32 v163, v166, v167
    v_sub_f32 v168, v168, v224
    v_sub_f32 v169, v169, v224
    v_sub_f32 v170, v170, v224
    v_sub_f32 v171, v171, v224
    v_exp_f32 v168, v168
    v_exp_f32 v169, v169
    v_exp_f32 v170, v170
    v_exp_f32 v171, v171
    v_mfma_f32_16x16x32_bf16 v[212:215], a[140:143], v[96:99], v[212:215]
    v_sub_f32 v172, v172, v224
    v_sub_f32 v173, v173, v224
    v_sub_f32 v174, v174, v224
    v_sub_f32 v175, v175, v224
    v_exp_f32 v172, v172
    v_exp_f32 v173, v173
    v_exp_f32 v174, v174
    v_exp_f32 v175, v175
    v_cvt_pk_bf16_f32 v168, v168, v169
    v_cvt_pk_bf16_f32 v169, v170, v171
    v_cvt_pk_bf16_f32 v170, v172, v173
    v_cvt_pk_bf16_f32 v171, v174, v175
    v_sub_f32 v176, v176, v224
    v_mfma_f32_16x16x32_bf16 v[212:215], a[148:151], v[104:107], v[212:215]
    v_sub_f32 v177, v177, v224
    v_sub_f32 v178, v178, v224
    v_sub_f32 v179, v179, v224
    v_exp_f32 v176, v176
    v_exp_f32 v177, v177
    v_exp_f32 v178, v178
    v_exp_f32 v179, v179
    v_sub_f32 v180, v180, v224
    v_sub_f32 v181, v181, v224
    v_sub_f32 v182, v182, v224
    v_sub_f32 v183, v183, v224
    v_exp_f32 v180, v180
    v_mfma_f32_16x16x32_bf16 v[212:215], a[156:159], v[112:115], v[212:215]
    v_exp_f32 v181, v181
    v_exp_f32 v182, v182
    v_exp_f32 v183, v183
    v_cvt_pk_bf16_f32 v176, v176, v177
    v_cvt_pk_bf16_f32 v177, v178, v179
    v_cvt_pk_bf16_f32 v178, v180, v181
    v_cvt_pk_bf16_f32 v179, v182, v183
    v_sub_f32 v184, v184, v224
    v_sub_f32 v185, v185, v224
    v_sub_f32 v186, v186, v224
    v_sub_f32 v187, v187, v224
    v_exp_f32 v184, v184
    v_exp_f32 v185, v185
    v_exp_f32 v186, v186
    v_exp_f32 v187, v187
    v_sub_f32 v188, v188, v224
    v_sub_f32 v189, v189, v224
    v_sub_f32 v190, v190, v224
    v_sub_f32 v191, v191, v224
    v_exp_f32 v188, v188
    v_exp_f32 v189, v189
    v_exp_f32 v190, v190
    v_exp_f32 v191, v191
    v_cvt_pk_bf16_f32 v184, v184, v185
    v_cvt_pk_bf16_f32 v185, v186, v187
    v_cvt_pk_bf16_f32 v186, v188, v189
    v_cvt_pk_bf16_f32 v187, v190, v191
    s_nop 1
    v_mfma_f32_16x16x32_bf16 v[216:219], a[112:115], v[144:147], 0
    v_mov_b32 v228, v215
    v_mov_b32 v226, v215
    v_mfma_f32_16x16x32_bf16 v[216:219], a[120:123], v[152:155], v[216:219]
    v_cndmask_b32 v212, v212, v214, s[40:41]
    v_cndmask_b32 v213, v213, v215, s[40:41]
    v_mfma_f32_16x16x32_bf16 v[216:219], a[128:131], v[160:163], v[216:219]
    v_permlane32_swap_b32 v226, v228
    v_mov_b32 v226, v228
    s_nop 1
    v_permlane16_swap_b32 v226, v228
    v_mfma_f32_16x16x32_bf16 v[216:219], a[136:139], v[168:171], v[216:219]
    v_mfma_f32_16x16x32_bf16 v[216:219], a[144:147], v[176:179], v[216:219]
    v_mfma_f32_16x16x32_bf16 v[216:219], a[152:155], v[184:187], v[216:219]
    v_rcp_f32 v226, v228
    v_mfma_f32_16x16x32_bf16 v[220:223], a[116:119], v[144:147], 0
    s_nop 0
    v_pk_mul_f32 v[208:209], v[208:209], v[226:227] op_sel_hi:[1,0]
    v_mfma_f32_16x16x32_bf16 v[220:223], a[124:127], v[152:155], v[220:223]
    v_pk_mul_f32 v[210:211], v[210:211], v[226:227] op_sel_hi:[1,0]
    v_pk_mul_f32 v[212:213], v[212:213], v[226:227] op_sel_hi:[1,0]
    v_mfma_f32_16x16x32_bf16 v[220:223], a[132:135], v[160:163], v[220:223]
    v_cvt_pk_bf16_f32 v214, v212, v213
    v_cvt_pk_bf16_f32 v208, v208, v209
    v_mfma_f32_16x16x32_bf16 v[220:223], a[140:143], v[168:171], v[220:223]
    v_cvt_pk_bf16_f32 v209, v210, v211
    v_mfma_f32_16x16x32_bf16 v[220:223], a[148:151], v[176:179], v[220:223]
    ds_bpermute_b32 v227, v243, v214
    ds_write_b64 v251, v[208:209] offset:2048
    v_mfma_f32_16x16x32_bf16 v[220:223], a[156:159], v[184:187], v[220:223]
    s_mov_b32 vcc_lo, 0
    s_mov_b32 vcc_hi, 65535
    s_waitcnt lgkmcnt(1)
    v_cndmask_b32 v12, v12, v227, vcc
    s_nop 7
    v_mov_b32 v228, v223
    v_mov_b32 v226, v223
    v_cndmask_b32 v220, v220, v222, s[40:41]
    v_cndmask_b32 v221, v221, v223, s[40:41]
    v_permlane32_swap_b32 v226, v228
    v_mov_b32 v226, v228
    s_nop 1
    v_permlane16_swap_b32 v226, v228
    v_rcp_f32 v226, v228
    s_nop 0
    v_pk_mul_f32 v[216:217], v[216:217], v[226:227] op_sel_hi:[1,0]
    v_pk_mul_f32 v[218:219], v[218:219], v[226:227] op_sel_hi:[1,0]
    v_pk_mul_f32 v[220:221], v[220:221], v[226:227] op_sel_hi:[1,0]
    v_cvt_pk_bf16_f32 v222, v220, v221
    v_cvt_pk_bf16_f32 v216, v216, v217
    v_cvt_pk_bf16_f32 v217, v218, v219
    ds_bpermute_b32 v227, v243, v222
    ds_write_b64 v251, v[216:217] offset:3072
    s_mov_b32 vcc_lo, 0
    s_mov_b32 vcc_hi, 4294901760
    s_waitcnt lgkmcnt(1)
    v_cndmask_b32 v12, v12, v227, vcc
    ds_write_b32 v240, v12
    s_branch L_attn_done
L_attn_er12:
    v_mfma_f32_16x16x32_bf16 v[96:99], a[48:51], v[16:19], 0
    v_mfma_f32_16x16x32_bf16 v[100:103], a[52:55], v[16:19], 0
    v_mfma_f32_16x16x32_bf16 v[104:107], a[56:59], v[16:19], 0
    v_mfma_f32_16x16x32_bf16 v[108:111], a[60:63], v[16:19], 0
    v_mfma_f32_16x16x32_bf16 v[112:115], a[64:67], v[16:19], v[236:239]
    s_nop 7
    v_mfma_f32_16x16x32_bf16 v[168:171], a[48:51], v[20:23], 0
    v_max_f32 v224, v96, v98
    v_max_f32 v225, v97, v99
    v_max3_f32 v224, v224, v100, v102
    v_max3_f32 v225, v225, v101, v103
    v_max3_f32 v224, v224, v104, v106
    v_max3_f32 v225, v225, v105, v107
    v_max3_f32 v224, v224, v108, v110
    v_max3_f32 v225, v225, v109, v111
    v_max3_f32 v224, v224, v112, v114
    v_max3_f32 v225, v225, v113, v115
    v_max_f32 v224, v224, v225
    v_mov_b32 v225, v224
    s_nop 1
    v_permlane16_swap_b32 v224, v225
    v_max_f32 v224, v224, v225
    v_mfma_f32_16x16x32_bf16 v[172:175], a[52:55], v[20:23], 0
    v_mov_b32 v225, v224
    s_nop 1
    v_permlane32_swap_b32 v224, v225
    v_max_f32 v224, v224, v225
    v_sub_f32 v96, v96, v224
    v_sub_f32 v97, v97, v224
    v_sub_f32 v98, v98, v224
    v_sub_f32 v99, v99, v224
    v_exp_f32 v96, v96
    v_exp_f32 v97, v97
    v_exp_f32 v98, v98
    v_mfma_f32_16x16x32_bf16 v[176:179], a[56:59], v[20:23], 0
    v_exp_f32 v99, v99
    v_sub_f32 v100, v100, v224
    v_sub_f32 v101, v101, v224
    v_sub_f32 v102, v102, v224
    v_sub_f32 v103, v103, v224
    v_exp_f32 v100, v100
    v_exp_f32 v101, v101
    v_exp_f32 v102, v102
    v_mfma_f32_16x16x32_bf16 v[180:183], a[60:63], v[20:23], 0
    v_exp_f32 v103, v103
    v_cvt_pk_bf16_f32 v96, v96, v97
    v_cvt_pk_bf16_f32 v97, v98, v99
    v_cvt_pk_bf16_f32 v98, v100, v101
    v_cvt_pk_bf16_f32 v99, v102, v103
    v_sub_f32 v104, v104, v224
    v_sub_f32 v105, v105, v224
    v_sub_f32 v106, v106, v224
    v_sub_f32 v107, v107, v224
    v_exp_f32 v104, v104
    v_exp_f32 v105, v105
    v_mfma_f32_16x16x32_bf16 v[184:187], a[64:67], v[20:23], 0
    v_exp_f32 v106, v106
    v_exp_f32 v107, v107
    v_sub_f32 v108, v108, v224
    v_sub_f32 v109, v109, v224
    v_sub_f32 v110, v110, v224
    v_sub_f32 v111, v111, v224
    v_exp_f32 v108, v108
    v_exp_f32 v109, v109
    v_exp_f32 v110, v110
    v_mfma_f32_16x16x32_bf16 v[188:191], a[68:71], v[20:23], v[236:239]
    v_exp_f32 v111, v111
    v_cvt_pk_bf16_f32 v104, v104, v105
    v_cvt_pk_bf16_f32 v105, v106, v107
    v_cvt_pk_bf16_f32 v106, v108, v109
    v_cvt_pk_bf16_f32 v107, v110, v111
    v_sub_f32 v112, v112, v224
    v_sub_f32 v113, v113, v224
    v_sub_f32 v114, v114, v224
    v_sub_f32 v115, v115, v224
    v_exp_f32 v112, v112
    v_exp_f32 v113, v113
    v_exp_f32 v114, v114
    v_exp_f32 v115, v115
    v_cvt_pk_bf16_f32 v112, v112, v113
    v_cvt_pk_bf16_f32 v113, v114, v115
    v_mov_b32 v114, 0
    v_mov_b32 v115, 0
    s_nop 1
    v_max_f32 v224, v168, v170
    v_max_f32 v225, v169, v171
    v_mfma_f32_16x16x32_bf16 v[192:195], a[128:131], v[96:99], 0
    v_max3_f32 v224, v224, v172, v174
    v_max3_f32 v225, v225, v173, v175
    v_max3_f32 v224, v224, v176, v178
    v_max3_f32 v225, v225, v177, v179
    v_max3_f32 v224, v224, v180, v182
    v_max3_f32 v225, v225, v181, v183
    v_max3_f32 v224, v224, v184, v186
    v_max3_f32 v225, v225, v185, v187
    v_mfma_f32_16x16x32_bf16 v[192:195], a[136:139], v[104:107], v[192:195]
    v_max3_f32 v224, v224, v188, v190
    v_max3_f32 v225, v225, v189, v191
    v_max_f32 v224, v224, v225
    v_mov_b32 v225, v224
    s_nop 1
    v_permlane16_swap_b32 v224, v225
    v_max_f32 v224, v224, v225
    v_mfma_f32_16x16x32_bf16 v[192:195], a[144:147], v[112:115], v[192:195]
    v_mov_b32 v225, v224
    s_nop 1
    v_permlane32_swap_b32 v224, v225
    v_max_f32 v224, v224, v225
    v_sub_f32 v168, v168, v224
    v_sub_f32 v169, v169, v224
    v_sub_f32 v170, v170, v224
    v_mfma_f32_16x16x32_bf16 v[196:199], a[132:135], v[96:99], 0
    v_sub_f32 v171, v171, v224
    v_exp_f32 v168, v168
    v_exp_f32 v169, v169
    v_exp_f32 v170, v170
    v_mfma_f32_16x16x32_bf16 v[196:199], a[140:143], v[104:107], v[196:199]
    v_exp_f32 v171, v171
    v_sub_f32 v172, v172, v224
    v_sub_f32 v173, v173, v224
    v_sub_f32 v174, v174, v224
    v_sub_f32 v175, v175, v224
    v_exp_f32 v172, v172
    v_mfma_f32_16x16x32_bf16 v[196:199], a[148:151], v[112:115], v[196:199]
    v_exp_f32 v173, v173
    v_exp_f32 v174, v174
    v_exp_f32 v175, v175
    v_mfma_f32_16x16x32_bf16 v[88:91], a[48:51], v[24:27], 0
    v_cvt_pk_bf16_f32 v168, v168, v169
    v_cvt_pk_bf16_f32 v169, v170, v171
    v_cvt_pk_bf16_f32 v170, v172, v173
    v_cvt_pk_bf16_f32 v171, v174, v175
    v_sub_f32 v176, v176, v224
    v_sub_f32 v177, v177, v224
    v_sub_f32 v178, v178, v224
    v_mfma_f32_16x16x32_bf16 v[92:95], a[52:55], v[24:27], 0
    v_sub_f32 v179, v179, v224
    v_exp_f32 v176, v176
    v_exp_f32 v177, v177
    v_exp_f32 v178, v178
    v_exp_f32 v179, v179
    v_mfma_f32_16x16x32_bf16 v[96:99], a[56:59], v[24:27], 0
    v_sub_f32 v180, v180, v224
    v_sub_f32 v181, v181, v224
    v_sub_f32 v182, v182, v224
    v_sub_f32 v183, v183, v224
    v_exp_f32 v180, v180
    v_mfma_f32_16x16x32_bf16 v[100:103], a[60:63], v[24:27], 0
    v_exp_f32 v181, v181
    v_exp_f32 v182, v182
    v_exp_f32 v183, v183
    v_cvt_pk_bf16_f32 v176, v176, v177
    v_mfma_f32_16x16x32_bf16 v[104:107], a[64:67], v[24:27], 0
    v_cvt_pk_bf16_f32 v177, v178, v179
    v_cvt_pk_bf16_f32 v178, v180, v181
    v_cvt_pk_bf16_f32 v179, v182, v183
    v_sub_f32 v184, v184, v224
    v_sub_f32 v185, v185, v224
    v_sub_f32 v186, v186, v224
    v_sub_f32 v187, v187, v224
    v_mfma_f32_16x16x32_bf16 v[108:111], a[68:71], v[24:27], 0
    v_exp_f32 v184, v184
    v_exp_f32 v185, v185
    v_exp_f32 v186, v186
    v_exp_f32 v187, v187
    v_mfma_f32_16x16x32_bf16 v[112:115], a[72:75], v[24:27], v[236:239]
    v_sub_f32 v188, v188, v224
    v_sub_f32 v189, v189, v224
    v_sub_f32 v190, v190, v224
    v_sub_f32 v191, v191, v224
    v_exp_f32 v188, v188
    v_exp_f32 v189, v189
    v_exp_f32 v190, v190
    v_exp_f32 v191, v191
    v_cvt_pk_bf16_f32 v184, v184, v185
    v_cvt_pk_bf16_f32 v185, v186, v187
    v_cvt_pk_bf16_f32 v186, v188, v189
    v_cvt_pk_bf16_f32 v187, v190, v191
    s_nop 1
    v_mov_b32 v228, v199
    v_mov_b32 v226, v199
    v_mfma_f32_16x16x32_bf16 v[200:203], a[128:131], v[168:171], 0
    v_cndmask_b32 v196, v196, v198, s[40:41]
    v_cndmask_b32 v197, v197, v199, s[40:41]
    v_permlane32_swap_b32 v226, v228
    v_mov_b32 v226, v228
    s_nop 1
    v_permlane16_swap_b32 v226, v228
    v_rcp_f32 v226, v228
    s_nop 0
    v_mfma_f32_16x16x32_bf16 v[200:203], a[136:139], v[176:179], v[200:203]
    v_pk_mul_f32 v[192:193], v[192:193], v[226:227] op_sel_hi:[1,0]
    v_pk_mul_f32 v[194:195], v[194:195], v[226:227] op_sel_hi:[1,0]
    v_pk_mul_f32 v[196:197], v[196:197], v[226:227] op_sel_hi:[1,0]
    v_cvt_pk_bf16_f32 v198, v196, v197
    v_cvt_pk_bf16_f32 v192, v192, v193
    v_cvt_pk_bf16_f32 v193, v194, v195
    ds_bpermute_b32 v227, v243, v198
    ds_write_b64 v251, v[192:193] offset:0
    s_mov_b32 vcc_lo, 65535
    s_mov_b32 vcc_hi, 0
    v_mfma_f32_16x16x32_bf16 v[200:203], a[144:147], v[184:187], v[200:203]
    s_waitcnt lgkmcnt(1)
    v_cndmask_b32 v12, v12, v227, vcc
    v_max_f32 v224, v88, v90
    v_max_f32 v225, v89, v91
    v_max3_f32 v224, v224, v92, v94
    v_max3_f32 v225, v225, v93, v95
    v_max3_f32 v224, v224, v96, v98
    v_max3_f32 v225, v225, v97, v99
    v_mfma_f32_16x16x32_bf16 v[204:207], a[132:135], v[168:171], 0
    v_max3_f32 v224, v224, v100, v102
    v_max3_f32 v225, v225, v101, v103
    v_max3_f32 v224, v224, v104, v106
    v_max3_f32 v225, v225, v105, v107
    v_max3_f32 v224, v224, v108, v110
    v_max3_f32 v225, v225, v109, v111
    v_max3_f32 v224, v224, v112, v114
    v_max3_f32 v225, v225, v113, v115
    v_max_f32 v224, v224, v225
    v_mov_b32 v225, v224
    s_nop 1
    v_permlane16_swap_b32 v224, v225
    v_max_f32 v224, v224, v225
    v_mfma_f32_16x16x32_bf16 v[204:207], a[140:143], v[176:179], v[204:207]
    v_mov_b32 v225, v224
    s_nop 1
    v_permlane32_swap_b32 v224, v225
    v_max_f32 v224, v224, v225
    v_sub_f32 v88, v88, v224
    v_sub_f32 v89, v89, v224
    v_mfma_f32_16x16x32_bf16 v[204:207], a[148:151], v[184:187], v[204:207]
    v_sub_f32 v90, v90, v224
    v_sub_f32 v91, v91, v224
    v_exp_f32 v88, v88
    v_exp_f32 v89, v89
    v_exp_f32 v90, v90
    v_exp_f32 v91, v91
    v_mfma_f32_16x16x32_bf16 v[160:163], a[48:51], v[28:31], 0
    v_sub_f32 v92, v92, v224
    v_sub_f32 v93, v93, v224
    v_sub_f32 v94, v94, v224
    v_sub_f32 v95, v95, v224
    v_exp_f32 v92, v92
    v_exp_f32 v93, v93
    v_exp_f32 v94, v94
    v_mfma_f32_16x16x32_bf16 v[164:167], a[52:55], v[28:31], 0
    v_exp_f32 v95, v95
    v_cvt_pk_bf16_f32 v88, v88, v89
    v_cvt_pk_bf16_f32 v89, v90, v91
    v_cvt_pk_bf16_f32 v90, v92, v93
    v_cvt_pk_bf16_f32 v91, v94, v95
    v_sub_f32 v96, v96, v224
    v_sub_f32 v97, v97, v224
    v_mfma_f32_16x16x32_bf16 v[168:171], a[56:59], v[28:31], 0
    v_sub_f32 v98, v98, v224
    v_sub_f32 v99, v99, v224
    v_exp_f32 v96, v96
    v_exp_f32 v97, v97
    v_exp_f32 v98, v98
    v_exp_f32 v99, v99
    v_mfma_f32_16x16x32_bf16 v[172:175], a[60:63], v[28:31], 0
    v_sub_f32 v100, v100, v224
    v_sub_f32 v101, v101, v224
    v_sub_f32 v102, v102, v224
    v_sub_f32 v103, v103, v224
    v_exp_f32 v100, v100
    v_exp_f32 v101, v101
    v_exp_f32 v102, v102
    v_mfma_f32_16x16x32_bf16 v[176:179], a[64:67], v[28:31], 0
    v_exp_f32 v103, v103
    v_cvt_pk_bf16_f32 v96, v96, v97
    v_cvt_pk_bf16_f32 v97, v98, v99
    v_cvt_pk_bf16_f32 v98, v100, v101
    v_cvt_pk_bf16_f32 v99, v102, v103
    v_sub_f32 v104, v104, v224
    v_sub_f32 v105, v105, v224
    v_mfma_f32_16x16x32_bf16 v[180:183], a[68:71], v[28:31], 0
    v_sub_f32 v106, v106, v224
    v_sub_f32 v107, v107, v224
    v_exp_f32 v104, v104
    v_exp_f32 v105, v105
    v_exp_f32 v106, v106
    v_exp_f32 v107, v107
    v_mfma_f32_16x16x32_bf16 v[184:187], a[72:75], v[28:31], 0
    v_sub_f32 v108, v108, v224
    v_sub_f32 v109, v109, v224
    v_sub_f32 v110, v110, v224
    v_sub_f32 v111, v111, v224
    v_exp_f32 v108, v108
    v_exp_f32 v109, v109
    v_exp_f32 v110, v110
    v_mfma_f32_16x16x32_bf16 v[188:191], a[76:79], v[28:31], v[236:239]
    v_exp_f32 v111, v111
    v_cvt_pk_bf16_f32 v104, v104, v105
    v_cvt_pk_bf16_f32 v105, v106, v107
    v_cvt_pk_bf16_f32 v106, v108, v109
    v_cvt_pk_bf16_f32 v107, v110, v111
    v_sub_f32 v112, v112, v224
    v_sub_f32 v113, v113, v224
    v_sub_f32 v114, v114, v224
    v_sub_f32 v115, v115, v224
    v_exp_f32 v112, v112
    v_exp_f32 v113, v113
    v_exp_f32 v114, v114
    v_exp_f32 v115, v115
    v_cvt_pk_bf16_f32 v112, v112, v113
    v_cvt_pk_bf16_f32 v113, v114, v115
    v_mov_b32 v114, 0
    v_mov_b32 v115, 0
    s_nop 1
    v_mov_b32 v228, v207
    v_mov_b32 v226, v207
    v_mfma_f32_16x16x32_bf16 v[208:211], a[128:131], v[88:91], 0
    v_cndmask_b32 v204, v204, v206, s[40:41]
    v_cndmask_b32 v205, v205, v207, s[40:41]
    v_permlane32_swap_b32 v226, v228
    v_mov_b32 v226, v228
    s_nop 1
    v_permlane16_swap_b32 v226, v228
    v_rcp_f32 v226, v228
    s_nop 0
    v_pk_mul_f32 v[200:201], v[200:201], v[226:227] op_sel_hi:[1,0]
    v_pk_mul_f32 v[202:203], v[202:203], v[226:227] op_sel_hi:[1,0]
    v_pk_mul_f32 v[204:205], v[204:205], v[226:227] op_sel_hi:[1,0]
    v_cvt_pk_bf16_f32 v206, v204, v205
    v_cvt_pk_bf16_f32 v200, v200, v201
    v_cvt_pk_bf16_f32 v201, v202, v203
    ds_bpermute_b32 v227, v243, v206
    ds_write_b64 v251, v[200:201] offset:1024
    v_mfma_f32_16x16x32_bf16 v[208:211], a[136:139], v[96:99], v[208:211]
    s_mov_b32 vcc_lo, 4294901760
    s_mov_b32 vcc_hi, 0
    s_waitcnt lgkmcnt(1)
    v_cndmask_b32 v12, v12, v227, vcc
    v_max_f32 v224, v160, v162
    v_max_f32 v225, v161, v163
    v_max3_f32 v224, v224, v164, v166
    v_max3_f32 v225, v225, v165, v167
    v_max3_f32 v224, v224, v168, v170
    v_max3_f32 v225, v225, v169, v171
    v_max3_f32 v224, v224, v172, v174
    v_max3_f32 v225, v225, v173, v175
    v_max3_f32 v224, v224, v176, v178
    v_max3_f32 v225, v225, v177, v179
    v_max3_f32 v224, v224, v180, v182
    v_max3_f32 v225, v225, v181, v183
    v_max3_f32 v224, v224, v184, v186
    v_max3_f32 v225, v225, v185, v187
    v_mfma_f32_16x16x32_bf16 v[208:211], a[144:147], v[104:107], v[208:211]
    v_max3_f32 v224, v224, v188, v190
    v_max3_f32 v225, v225, v189, v191
    v_max_f32 v224, v224, v225
    v_mov_b32 v225, v224
    s_nop 1
    v_permlane16_swap_b32 v224, v225
    v_max_f32 v224, v224, v225
    v_mov_b32 v225, v224
    s_nop 1
    v_permlane32_swap_b32 v224, v225
    v_max_f32 v224, v224, v225
    v_sub_f32 v160, v160, v224
    v_sub_f32 v161, v161, v224
    v_sub_f32 v162, v162, v224
    v_sub_f32 v163, v163, v224
    v_exp_f32 v160, v160
    v_exp_f32 v161, v161
    v_mfma_f32_16x16x32_bf16 v[208:211], a[152:155], v[112:115], v[208:211]
    v_exp_f32 v162, v162
    v_exp_f32 v163, v163
    v_sub_f32 v164, v164, v224
    v_sub_f32 v165, v165, v224
    v_sub_f32 v166, v166, v224
    v_sub_f32 v167, v167, v224
    v_exp_f32 v164, v164
    v_exp_f32 v165, v165
    v_exp_f32 v166, v166
    v_exp_f32 v167, v167
    v_cvt_pk_bf16_f32 v160, v160, v161
    v_mfma_f32_16x16x32_bf16 v[212:215], a[132:135], v[88:91], 0
    v_cvt_pk_bf16_f32 v161, v162, v163
    v_cvt_pk_bf16_f32 v162, v164, v165
    v_cvt_pk_bf16_f32 v163, v166, v167
    v_sub_f32 v168, v168, v224
    v_sub_f32 v169, v169, v224
    v_sub_f32 v170, v170, v224
    v_sub_f32 v171, v171, v224
    v_exp_f32 v168, v168
    v_exp_f32 v169, v169
    v_exp_f32 v170, v170
    v_exp_f32 v171, v171
    v_sub_f32 v172, v172, v224
    v_sub_f32 v173, v173, v224
    v_sub_f32 v174, v174, v224
    v_mfma_f32_16x16x32_bf16 v[212:215], a[140:143], v[96:99], v[212:215]
    v_sub_f32 v175, v175, v224
    v_exp_f32 v172, v172
    v_exp_f32 v173, v173
    v_exp_f32 v174, v174
    v_exp_f32 v175, v175
    v_cvt_pk_bf16_f32 v168, v168, v169
    v_cvt_pk_bf16_f32 v169, v170, v171
    v_cvt_pk_bf16_f32 v170, v172, v173
    v_cvt_pk_bf16_f32 v171, v174, v175
    v_sub_f32 v176, v176, v224
    v_sub_f32 v177, v177, v224
    v_sub_f32 v178, v178, v224
    v_sub_f32 v179, v179, v224
    v_exp_f32 v176, v176
    v_mfma_f32_16x16x32_bf16 v[212:215], a[148:151], v[104:107], v[212:215]
    v_exp_f32 v177, v177
    v_exp_f32 v178, v178
    v_exp_f32 v179, v179
    v_sub_f32 v180, v180, v224
    v_sub_f32 v181, v181, v224
    v_sub_f32 v182, v182, v224
    v_sub_f32 v183, v183, v224
    v_exp_f32 v180, v180
    v_exp_f32 v181, v181
    v_exp_f32 v182, v182
    v_exp_f32 v183, v183
    v_mfma_f32_16x16x32_bf16 v[212:215], a[156:159], v[112:115], v[212:215]
    v_cvt_pk_bf16_f32 v176, v176, v177
    v_cvt_pk_bf16_f32 v177, v178, v179
    v_cvt_pk_bf16_f32 v178, v180, v181
    v_cvt_pk_bf16_f32 v179, v182, v183
    v_sub_f32 v184, v184, v224
    v_sub_f32 v185, v185, v224
    v_sub_f32 v186, v186, v224
    v_sub_f32 v187, v187, v224
    v_exp_f32 v184, v184
    v_exp_f32 v185, v185
    v_exp_f32 v186, v186
    v_exp_f32 v187, v187
    v_sub_f32 v188, v188, v224
    v_sub_f32 v189, v189, v224
    v_sub_f32 v190, v190, v224
    v_sub_f32 v191, v191, v224
    v_exp_f32 v188, v188
    v_exp_f32 v189, v189
    v_exp_f32 v190, v190
    v_exp_f32 v191, v191
    v_cvt_pk_bf16_f32 v184, v184, v185
    v_cvt_pk_bf16_f32 v185, v186, v187
    v_cvt_pk_bf16_f32 v186, v188, v189
    v_cvt_pk_bf16_f32 v187, v190, v191
    s_nop 1
    v_mfma_f32_16x16x32_bf16 v[216:219], a[128:131], v[160:163], 0
    v_mov_b32 v228, v215
    v_mov_b32 v226, v215
    v_cndmask_b32 v212, v212, v214, s[40:41]
    v_mfma_f32_16x16x32_bf16 v[216:219], a[136:139], v[168:171], v[216:219]
    v_cndmask_b32 v213, v213, v215, s[40:41]
    v_permlane32_swap_b32 v226, v228
    v_mov_b32 v226, v228
    s_nop 1
    v_permlane16_swap_b32 v226, v228
    v_mfma_f32_16x16x32_bf16 v[216:219], a[144:147], v[176:179], v[216:219]
    v_mfma_f32_16x16x32_bf16 v[216:219], a[152:155], v[184:187], v[216:219]
    v_rcp_f32 v226, v228
    v_mfma_f32_16x16x32_bf16 v[220:223], a[132:135], v[160:163], 0
    s_nop 0
    v_pk_mul_f32 v[208:209], v[208:209], v[226:227] op_sel_hi:[1,0]
    v_pk_mul_f32 v[210:211], v[210:211], v[226:227] op_sel_hi:[1,0]
    v_mfma_f32_16x16x32_bf16 v[220:223], a[140:143], v[168:171], v[220:223]
    v_pk_mul_f32 v[212:213], v[212:213], v[226:227] op_sel_hi:[1,0]
    v_cvt_pk_bf16_f32 v214, v212, v213
    v_cvt_pk_bf16_f32 v208, v208, v209
    v_mfma_f32_16x16x32_bf16 v[220:223], a[148:151], v[176:179], v[220:223]
    v_cvt_pk_bf16_f32 v209, v210, v211
    ds_bpermute_b32 v227, v243, v214
    v_mfma_f32_16x16x32_bf16 v[220:223], a[156:159], v[184:187], v[220:223]
    ds_write_b64 v251, v[208:209] offset:2048
    s_mov_b32 vcc_lo, 0
    s_mov_b32 vcc_hi, 65535
    s_waitcnt lgkmcnt(1)
    v_cndmask_b32 v12, v12, v227, vcc
    s_nop 7
    v_mov_b32 v228, v223
    v_mov_b32 v226, v223
    v_cndmask_b32 v220, v220, v222, s[40:41]
    v_cndmask_b32 v221, v221, v223, s[40:41]
    v_permlane32_swap_b32 v226, v228
    v_mov_b32 v226, v228
    s_nop 1
    v_permlane16_swap_b32 v226, v228
    v_rcp_f32 v226, v228
    s_nop 0
    v_pk_mul_f32 v[216:217], v[216:217], v[226:227] op_sel_hi:[1,0]
    v_pk_mul_f32 v[218:219], v[218:219], v[226:227] op_sel_hi:[1,0]
    v_pk_mul_f32 v[220:221], v[220:221], v[226:227] op_sel_hi:[1,0]
    v_cvt_pk_bf16_f32 v222, v220, v221
    v_cvt_pk_bf16_f32 v216, v216, v217
    v_cvt_pk_bf16_f32 v217, v218, v219
    ds_bpermute_b32 v227, v243, v222
    ds_write_b64 v251, v[216:217] offset:3072
    s_mov_b32 vcc_lo, 0
    s_mov_b32 vcc_hi, 4294901760
    s_waitcnt lgkmcnt(1)
    v_cndmask_b32 v12, v12, v227, vcc
    ds_write_b32 v240, v12
    s_branch L_attn_done
L_attn_er16:
    v_mfma_f32_16x16x32_bf16 v[112:115], a[64:67], v[16:19], v[236:239]
    s_nop 7
    v_mfma_f32_16x16x32_bf16 v[184:187], a[64:67], v[20:23], 0
    v_max_f32 v224, v112, v114
    v_max_f32 v225, v113, v115
    v_max_f32 v224, v224, v225
    v_mov_b32 v225, v224
    s_nop 1
    v_permlane16_swap_b32 v224, v225
    v_max_f32 v224, v224, v225
    v_mov_b32 v225, v224
    s_nop 1
    v_permlane32_swap_b32 v224, v225
    v_max_f32 v224, v224, v225
    v_sub_f32 v112, v112, v224
    v_sub_f32 v113, v113, v224
    v_mfma_f32_16x16x32_bf16 v[188:191], a[68:71], v[20:23], v[236:239]
    v_sub_f32 v114, v114, v224
    v_sub_f32 v115, v115, v224
    v_exp_f32 v112, v112
    v_exp_f32 v113, v113
    v_exp_f32 v114, v114
    v_exp_f32 v115, v115
    v_cvt_pk_bf16_f32 v112, v112, v113
    v_cvt_pk_bf16_f32 v113, v114, v115
    v_mov_b32 v114, 0
    v_mov_b32 v115, 0
    s_nop 1
    v_max_f32 v224, v184, v186
    v_max_f32 v225, v185, v187
    v_mfma_f32_16x16x32_bf16 v[192:195], a[144:147], v[112:115], 0
    v_max3_f32 v224, v224, v188, v190
    v_max3_f32 v225, v225, v189, v191
    v_max_f32 v224, v224, v225
    v_mov_b32 v225, v224
    s_nop 1
    v_permlane16_swap_b32 v224, v225
    v_max_f32 v224, v224, v225
    v_mov_b32 v225, v224
    s_nop 1
    v_permlane32_swap_b32 v224, v225
    v_max_f32 v224, v224, v225
    v_mfma_f32_16x16x32_bf16 v[196:199], a[148:151], v[112:115], 0
    v_sub_f32 v184, v184, v224
    v_sub_f32 v185, v185, v224
    v_sub_f32 v186, v186, v224
    v_sub_f32 v187, v187, v224
    v_mfma_f32_16x16x32_bf16 v[104:107], a[64:67], v[24:27], 0
    v_exp_f32 v184, v184
    v_exp_f32 v185, v185
    v_exp_f32 v186, v186
    v_exp_f32 v187, v187
    v_mfma_f32_16x16x32_bf16 v[108:111], a[68:71], v[24:27], 0
    v_sub_f32 v188, v188, v224
    v_sub_f32 v189, v189, v224
    v_sub_f32 v190, v190, v224
    v_sub_f32 v191, v191, v224
    v_exp_f32 v188, v188
    v_mfma_f32_16x16x32_bf16 v[112:115], a[72:75], v[24:27], v[236:239]
    v_exp_f32 v189, v189
    v_exp_f32 v190, v190
    v_exp_f32 v191, v191
    v_cvt_pk_bf16_f32 v184, v184, v185
    v_cvt_pk_bf16_f32 v185, v186, v187
    v_cvt_pk_bf16_f32 v186, v188, v189
    v_cvt_pk_bf16_f32 v187, v190, v191
    s_nop 1
    v_mov_b32 v228, v199
    v_mov_b32 v226, v199
    v_mfma_f32_16x16x32_bf16 v[200:203], a[144:147], v[184:187], 0
    v_cndmask_b32 v196, v196, v198, s[40:41]
    v_cndmask_b32 v197, v197, v199, s[40:41]
    v_permlane32_swap_b32 v226, v228
    v_mov_b32 v226, v228
    s_nop 1
    v_permlane16_swap_b32 v226, v228
    v_rcp_f32 v226, v228
    s_nop 0
    v_pk_mul_f32 v[192:193], v[192:193], v[226:227] op_sel_hi:[1,0]
    v_pk_mul_f32 v[194:195], v[194:195], v[226:227] op_sel_hi:[1,0]
    v_pk_mul_f32 v[196:197], v[196:197], v[226:227] op_sel_hi:[1,0]
    v_mfma_f32_16x16x32_bf16 v[204:207], a[148:151], v[184:187], 0
    v_cvt_pk_bf16_f32 v198, v196, v197
    v_cvt_pk_bf16_f32 v192, v192, v193
    v_cvt_pk_bf16_f32 v193, v194, v195
    ds_bpermute_b32 v227, v243, v198
    ds_write_b64 v251, v[192:193] offset:0
    s_mov_b32 vcc_lo, 65535
    s_mov_b32 vcc_hi, 0
    s_waitcnt lgkmcnt(1)
    v_cndmask_b32 v12, v12, v227, vcc
    v_max_f32 v224, v104, v106
    v_max_f32 v225, v105, v107
    v_max3_f32 v224, v224, v108, v110
    v_mfma_f32_16x16x32_bf16 v[176:179], a[64:67], v[28:31], 0
    v_max3_f32 v225, v225, v109, v111
    v_max3_f32 v224, v224, v112, v114
    v_max3_f32 v225, v225, v113, v115
    v_max_f32 v224, v224, v225
    v_mov_b32 v225, v224
    s_nop 1
    v_permlane16_swap_b32 v224, v225
    v_max_f32 v224, v224, v225
    v_mov_b32 v225, v224
    s_nop 1
    v_permlane32_swap_b32 v224, v225
    v_max_f32 v224, v224, v225
    v_mfma_f32_16x16x32_bf16 v[180:183], a[68:71], v[28:31], 0
    v_sub_f32 v104, v104, v224
    v_sub_f32 v105, v105, v224
    v_sub_f32 v106, v106, v224
    v_sub_f32 v107, v107, v224
    v_exp_f32 v104, v104
    v_exp_f32 v105, v105
    v_exp_f32 v106, v106
    v_exp_f32 v107, v107
    v_mfma_f32_16x16x32_bf16 v[184:187], a[72:75], v[28:31], 0
    v_sub_f32 v108, v108, v224
    v_sub_f32 v109, v109, v224
    v_sub_f32 v110, v110, v224
    v_sub_f32 v111, v111, v224
    v_exp_f32 v108, v108
    v_exp_f32 v109, v109
    v_exp_f32 v110, v110
    v_exp_f32 v111, v111
    v_mfma_f32_16x16x32_bf16 v[188:191], a[76:79], v[28:31], v[236:239]
    v_cvt_pk_bf16_f32 v104, v104, v105
    v_cvt_pk_bf16_f32 v105, v106, v107
    v_cvt_pk_bf16_f32 v106, v108, v109
    v_cvt_pk_bf16_f32 v107, v110, v111
    v_sub_f32 v112, v112, v224
    v_sub_f32 v113, v113, v224
    v_sub_f32 v114, v114, v224
    v_sub_f32 v115, v115, v224
    v_exp_f32 v112, v112
    v_exp_f32 v113, v113
    v_exp_f32 v114, v114
    v_exp_f32 v115, v115
    v_cvt_pk_bf16_f32 v112, v112, v113
    v_cvt_pk_bf16_f32 v113, v114, v115
    v_mov_b32 v114, 0
    v_mov_b32 v115, 0
    s_nop 1
    v_mov_b32 v228, v207
    v_mov_b32 v226, v207
    v_mfma_f32_16x16x32_bf16 v[208:211], a[144:147], v[104:107], 0
    v_cndmask_b32 v204, v204, v206, s[40:41]
    v_cndmask_b32 v205, v205, v207, s[40:41]
    v_permlane32_swap_b32 v226, v228
    v_mov_b32 v226, v228
    s_nop 1
    v_permlane16_swap_b32 v226, v228
    v_rcp_f32 v226, v228
    s_nop 0
    v_pk_mul_f32 v[200:201], v[200:201], v[226:227] op_sel_hi:[1,0]
    v_pk_mul_f32 v[202:203], v[202:203], v[226:227] op_sel_hi:[1,0]
    v_pk_mul_f32 v[204:205], v[204:205], v[226:227] op_sel_hi:[1,0]
    v_cvt_pk_bf16_f32 v206, v204, v205
    v_cvt_pk_bf16_f32 v200, v200, v201
    v_cvt_pk_bf16_f32 v201, v202, v203
    ds_bpermute_b32 v227, v243, v206
    ds_write_b64 v251, v[200:201] offset:1024
    s_mov_b32 vcc_lo, 4294901760
    s_mov_b32 vcc_hi, 0
    s_waitcnt lgkmcnt(1)
    v_cndmask_b32 v12, v12, v227, vcc
    v_mfma_f32_16x16x32_bf16 v[208:211], a[152:155], v[112:115], v[208:211]
    v_max_f32 v224, v176, v178
    v_max_f32 v225, v177, v179
    v_max3_f32 v224, v224, v180, v182
    v_max3_f32 v225, v225, v181, v183
    v_max3_f32 v224, v224, v184, v186
    v_max3_f32 v225, v225, v185, v187
    v_max3_f32 v224, v224, v188, v190
    v_max3_f32 v225, v225, v189, v191
    v_max_f32 v224, v224, v225
    v_mov_b32 v225, v224
    s_nop 1
    v_permlane16_swap_b32 v224, v225
    v_max_f32 v224, v224, v225
    v_mov_b32 v225, v224
    s_nop 1
    v_permlane32_swap_b32 v224, v225
    v_max_f32 v224, v224, v225
    v_sub_f32 v176, v176, v224
    v_sub_f32 v177, v177, v224
    v_sub_f32 v178, v178, v224
    v_sub_f32 v179, v179, v224
    v_mfma_f32_16x16x32_bf16 v[212:215], a[148:151], v[104:107], 0
    v_exp_f32 v176, v176
    v_exp_f32 v177, v177
    v_exp_f32 v178, v178
    v_exp_f32 v179, v179
    v_sub_f32 v180, v180, v224
    v_sub_f32 v181, v181, v224
    v_sub_f32 v182, v182, v224
    v_sub_f32 v183, v183, v224
    v_exp_f32 v180, v180
    v_exp_f32 v181, v181
    v_exp_f32 v182, v182
    v_exp_f32 v183, v183
    v_cvt_pk_bf16_f32 v176, v176, v177
    v_cvt_pk_bf16_f32 v177, v178, v179
    v_mfma_f32_16x16x32_bf16 v[212:215], a[156:159], v[112:115], v[212:215]
    v_cvt_pk_bf16_f32 v178, v180, v181
    v_cvt_pk_bf16_f32 v179, v182, v183
    v_sub_f32 v184, v184, v224
    v_sub_f32 v185, v185, v224
    v_sub_f32 v186, v186, v224
    v_sub_f32 v187, v187, v224
    v_exp_f32 v184, v184
    v_exp_f32 v185, v185
    v_exp_f32 v186, v186
    v_exp_f32 v187, v187
    v_sub_f32 v188, v188, v224
    v_sub_f32 v189, v189, v224
    v_sub_f32 v190, v190, v224
    v_sub_f32 v191, v191, v224
    v_exp_f32 v188, v188
    v_exp_f32 v189, v189
    v_exp_f32 v190, v190
    v_exp_f32 v191, v191
    v_cvt_pk_bf16_f32 v184, v184, v185
    v_cvt_pk_bf16_f32 v185, v186, v187
    v_cvt_pk_bf16_f32 v186, v188, v189
    v_cvt_pk_bf16_f32 v187, v190, v191
    s_nop 1
    v_mfma_f32_16x16x32_bf16 v[216:219], a[144:147], v[176:179], 0
    v_mov_b32 v228, v215
    v_mov_b32 v226, v215
    v_cndmask_b32 v212, v212, v214, s[40:41]
    v_cndmask_b32 v213, v213, v215, s[40:41]
    v_permlane32_swap_b32 v226, v228
    v_mov_b32 v226, v228
    s_nop 1
    v_permlane16_swap_b32 v226, v228
    v_mfma_f32_16x16x32_bf16 v[216:219], a[152:155], v[184:187], v[216:219]
    v_rcp_f32 v226, v228
    v_mfma_f32_16x16x32_bf16 v[220:223], a[148:151], v[176:179], 0
    s_nop 0
    v_pk_mul_f32 v[208:209], v[208:209], v[226:227] op_sel_hi:[1,0]
    v_pk_mul_f32 v[210:211], v[210:211], v[226:227] op_sel_hi:[1,0]
    v_pk_mul_f32 v[212:213], v[212:213], v[226:227] op_sel_hi:[1,0]
    v_cvt_pk_bf16_f32 v214, v212, v213
    v_cvt_pk_bf16_f32 v208, v208, v209
    v_mfma_f32_16x16x32_bf16 v[220:223], a[156:159], v[184:187], v[220:223]
    v_cvt_pk_bf16_f32 v209, v210, v211
    ds_bpermute_b32 v227, v243, v214
    ds_write_b64 v251, v[208:209] offset:2048
    s_mov_b32 vcc_lo, 0
    s_mov_b32 vcc_hi, 65535
    s_waitcnt lgkmcnt(1)
    v_cndmask_b32 v12, v12, v227, vcc
    s_nop 7
    v_mov_b32 v228, v223
    v_mov_b32 v226, v223
    v_cndmask_b32 v220, v220, v222, s[40:41]
    v_cndmask_b32 v221, v221, v223, s[40:41]
    v_permlane32_swap_b32 v226, v228
    v_mov_b32 v226, v228
    s_nop 1
    v_permlane16_swap_b32 v226, v228
    v_rcp_f32 v226, v228
    s_nop 0
    v_pk_mul_f32 v[216:217], v[216:217], v[226:227] op_sel_hi:[1,0]
    v_pk_mul_f32 v[218:219], v[218:219], v[226:227] op_sel_hi:[1,0]
    v_pk_mul_f32 v[220:221], v[220:221], v[226:227] op_sel_hi:[1,0]
    v_cvt_pk_bf16_f32 v222, v220, v221
    v_cvt_pk_bf16_f32 v216, v216, v217
    v_cvt_pk_bf16_f32 v217, v218, v219
    ds_bpermute_b32 v227, v243, v222
    ds_write_b64 v251, v[216:217] offset:3072
    s_mov_b32 vcc_lo, 0
    s_mov_b32 vcc_hi, 4294901760
    s_waitcnt lgkmcnt(1)
    v_cndmask_b32 v12, v12, v227, vcc
    ds_write_b32 v240, v12
    s_branch L_attn_done
L_attn_done:
    s_waitcnt lgkmcnt(0)
    s_barrier
    ds_read_b128 v[192:195], v230
    ds_read_b128 v[196:199], v230 offset:1024
    ds_read_b64 v[200:201], v231
    s_waitcnt lgkmcnt(2)
    buffer_store_dwordx4 v[192:195], v1, s[8:11], s47 offen sc1
    s_waitcnt lgkmcnt(1)
    buffer_store_dwordx4 v[196:199], v1, s[8:11], s48 offen sc1
    s_waitcnt lgkmcnt(0)
    buffer_store_dwordx2 v[200:201], v250, s[8:11], s46 offen sc1
    s_add_u32 s56, s56, s51
    s_cmp_eq_u32 s20, 0
    s_cselect_b32 s56, s56, 1073741824
    s_waitcnt vmcnt(0)
    s_barrier
    v_mov_b32 v254, s100
    v_mov_b32 v255, s101
    buffer_store_dwordx2 v[254:255], v13, s[8:11], s56 offen sc1
    s_cmp_eq_u32 s67, 0
    s_cbranch_scc1 L_pks
    s_lshl_b32 s66, s20, 13
    s_add_u32 s66, s66, 131072
    v_add_u32 v10, s66, v1
    v_bfe_u32 v11, v0, 2, 4
    v_lshlrev_b32 v11, 7, v11
    v_and_b32 v252, 3, v0
    v_lshl_add_u32 v11, v252, 3, v11
    v_add_u32 v11, s66, v11
    s_waitcnt lgkmcnt(0)
    ds_write_b128 v10, a[208:211] offset:0
    ds_write_b128 v10, a[212:215] offset:1024
    ds_write_b128 v10, a[216:219] offset:2048
    ds_write_b128 v10, a[220:223] offset:3072
    s_waitcnt lgkmcnt(0)
    ds_read_b64_tr_b16 v[220:221], v11 offset:0
    ds_read_b64_tr_b16 v[222:223], v11 offset:2048
    ds_read_b64_tr_b16 v[224:225], v11 offset:32
    ds_read_b64_tr_b16 v[226:227], v11 offset:2080
    ds_read_b64_tr_b16 v[228:229], v11 offset:64
    ds_read_b64_tr_b16 v[230:231], v11 offset:2112
    ds_read_b64_tr_b16 v[232:233], v11 offset:96
    ds_read_b64_tr_b16 v[234:235], v11 offset:2144
    ds_write_b128 v10, a[224:227] offset:4096
    ds_write_b128 v10, a[228:231] offset:5120
    ds_write_b128 v10, a[232:235] offset:6144
    ds_write_b128 v10, a[236:239] offset:7168
    s_waitcnt lgkmcnt(0)
    buffer_store_dwordx4 v[220:223], v1, s[8:11], s78 offen offset:0 sc1
    buffer_store_dwordx4 v[224:227], v1, s[8:11], s79 offen offset:0 sc1
    buffer_store_dwordx4 v[228:231], v1, s[8:11], s80 offen offset:0 sc1
    buffer_store_dwordx4 v[232:235], v1, s[8:11], s81 offen offset:0 sc1
    ds_read_b64_tr_b16 v[236:237], v11 offset:4096
    ds_read_b64_tr_b16 v[238:239], v11 offset:6144
    ds_read_b64_tr_b16 v[240:241], v11 offset:4128
    ds_read_b64_tr_b16 v[242:243], v11 offset:6176
    ds_read_b64_tr_b16 v[244:245], v11 offset:4160
    ds_read_b64_tr_b16 v[246:247], v11 offset:6208
    ds_read_b64_tr_b16 v[248:249], v11 offset:4192
    ds_read_b64_tr_b16 v[250:251], v11 offset:6240
    ds_write_b128 v10, a[240:243] offset:0
    ds_write_b128 v10, a[244:247] offset:1024
    ds_write_b128 v10, a[248:251] offset:2048
    ds_write_b128 v10, a[252:255] offset:3072
    s_waitcnt lgkmcnt(0)
    buffer_store_dwordx4 v[236:239], v1, s[8:11], s78 offen offset:1024 sc1
    buffer_store_dwordx4 v[240:243], v1, s[8:11], s79 offen offset:1024 sc1
    buffer_store_dwordx4 v[244:247], v1, s[8:11], s80 offen offset:1024 sc1
    buffer_store_dwordx4 v[248:251], v1, s[8:11], s81 offen offset:1024 sc1
    ds_read_b64_tr_b16 v[220:221], v11 offset:0
    ds_read_b64_tr_b16 v[222:223], v11 offset:2048
    ds_read_b64_tr_b16 v[224:225], v11 offset:32
    ds_read_b64_tr_b16 v[226:227], v11 offset:2080
    ds_read_b64_tr_b16 v[228:229], v11 offset:64
    ds_read_b64_tr_b16 v[230:231], v11 offset:2112
    ds_read_b64_tr_b16 v[232:233], v11 offset:96
    ds_read_b64_tr_b16 v[234:235], v11 offset:2144
    s_waitcnt lgkmcnt(0)
    buffer_store_dwordx4 v[220:223], v1, s[8:11], s78 offen offset:2048 sc1
    buffer_store_dwordx4 v[224:227], v1, s[8:11], s79 offen offset:2048 sc1
    buffer_store_dwordx4 v[228:231], v1, s[8:11], s80 offen offset:2048 sc1
    buffer_store_dwordx4 v[232:235], v1, s[8:11], s81 offen offset:2048 sc1
    s_mov_b32 s67, 0
L_pks:
    s_lshl_b32 s21, s19, 1
    s_and_b32 s22, s17, 1
    s_add_u32 s21, s21, s22
    s_lshl_b32 s24, s21, 2
    s_add_u32 s24, s24, s20
    s_mul_i32 s24, s24, 497664
    s_add_u32 s24, s24, 38273024
    s_add_u32 s12, s4, s24
    s_addc_u32 s13, s5, 0
    s_mov_b32 s14, 497664
    s_mov_b32 s15, 0x00020000
    s_mov_b32 s25, 0
    s_cmp_lg_u32 s20, 0
    s_cbranch_scc1 L_pollx_p
    s_cmp_lg_u32 s50, 0
    s_cbranch_scc1 L_pollx_p
    s_lshl_b32 s56, s21, 8
    s_add_u32 s56, s56, 63885312
    v_and_b32 v2, 31, v0
    v_min_u32 v2, 26, v2
    v_lshlrev_b32 v2, 3, v2
    s_mov_b32 s57, 300000
    s_add_u32 s56, s56, s51
L_poll_p:
    buffer_load_dwordx2 v[254:255], v2, s[8:11], s56 offen sc1
    s_sub_u32 s57, s57, 1
    s_waitcnt vmcnt(0)
    v_cmp_eq_u64 vcc, s[100:101], v[254:255]
    s_cmp_eq_u32 s57, 0
    s_cbranch_scc1 L_pollx_p
    s_cmp_eq_u64 vcc, -1
    s_cbranch_scc0 L_poll_p
L_pollx_p:
    s_lshl_b32 s21, s16, 2
    s_and_b32 s22, s17, 3
    s_add_u32 s26, s21, s22
    s_lshr_b32 s22, s17, 2
    s_lshl_b32 s21, s26, 2
    s_add_u32 s21, s21, s20
    s_mul_i32 s23, s21, 18432
    s_add_u32 s23, s23, 4718592
    s_mul_i32 s28, s21, 18432
    s_lshl_b32 s27, s22, 11
    s_add_u32 s27, s27, s28
    s_add_u32 s40, s27, 0
    s_add_u32 s41, s27, 7077888
    s_lshr_b32 s29, s22, 2
    s_lshr_b32 s30, s22, 1
    s_lshl_b32 s30, s30, 10
    s_and_b32 s31, s22, 1
    s_lshl_b32 s31, s31, 3
    s_add_u32 s30, s30, s31
    s_add_u32 s30, s30, s28
    s_add_u32 s42, s30, 16384
    s_lshl_b32 s30, s22, 9
    s_add_u32 s30, s30, s28
    s_add_u32 s43, s30, 7094272
    v_lshrrev_b32 v10, 1, v1
    s_lshr_b32 s56, s26, 1
    s_lshl_b32 s56, s56, 7
    s_add_u32 s56, s56, 63875072
    v_and_b32 v2, 15, v0
    v_lshlrev_b32 v2, 3, v2
    s_cmp_lg_u32 s20, 0
    s_cbranch_scc1 L_pollx_c
    s_mov_b32 s57, 300000
    s_add_u32 s56, s56, s51
L_poll_c:
    buffer_load_dwordx2 v[254:255], v2, s[8:11], s56 offen sc1
    s_sub_u32 s57, s57, 1
    s_waitcnt vmcnt(0)
    v_cmp_eq_u64 vcc, s[100:101], v[254:255]
    s_cmp_eq_u32 s57, 0
    s_cbranch_scc1 L_pollx_c
    s_cmp_eq_u64 vcc, -1
    s_cbranch_scc0 L_poll_c
L_pollx_c:
    s_barrier
    buffer_load_dwordx4 a[0:3], v1, s[8:11], s23 offen offset:0 sc1
    buffer_load_dwordx4 a[4:7], v1, s[8:11], s23 offen offset:1024 sc1
    buffer_load_dwordx4 a[8:11], v1, s[8:11], s23 offen offset:2048 sc1
    buffer_load_dwordx4 a[12:15], v1, s[8:11], s23 offen offset:3072 sc1
    s_add_u32 s23, s23, 4096
    buffer_load_dwordx4 a[16:19], v1, s[8:11], s23 offen offset:0 sc1
    buffer_load_dwordx4 a[20:23], v1, s[8:11], s23 offen offset:1024 sc1
    buffer_load_dwordx4 a[24:27], v1, s[8:11], s23 offen offset:2048 sc1
    buffer_load_dwordx4 a[28:31], v1, s[8:11], s23 offen offset:3072 sc1
    s_add_u32 s23, s23, 4096
    buffer_load_dwordx4 a[32:35], v1, s[8:11], s23 offen offset:0 sc1
    buffer_load_dwordx4 a[36:39], v1, s[8:11], s23 offen offset:1024 sc1
    buffer_load_dwordx4 a[40:43], v1, s[8:11], s23 offen offset:2048 sc1
    buffer_load_dwordx4 a[44:47], v1, s[8:11], s23 offen offset:3072 sc1
    s_add_u32 s23, s23, 4096
    v_mov_b32 v3, v1
    v_add_u32 v2, 0x10000, v1
    ds_read_b128 v[36:39], v3 offset:0
    ds_read_b128 v[40:43], v3 offset:1024
    ds_read_b128 v[44:47], v3 offset:2048
    ds_read_b128 v[48:51], v3 offset:3072
    ds_read_b128 v[52:55], v3 offset:4096
    ds_read_b128 v[56:59], v3 offset:5120
    ds_read_b128 v[60:63], v3 offset:6144
    ds_read_b128 v[64:67], v3 offset:7168
    ds_read_b128 v[68:71], v3 offset:8192
    ds_read_b128 v[72:75], v3 offset:9216
    s_waitcnt vmcnt(11)
    s_waitcnt lgkmcnt(5)
    v_mfma_f32_16x16x32_bf16 v[16:19], v[36:39], a[0:3], 0
    buffer_load_dwordx4 a[48:51], v1, s[8:11], s23 offen offset:0 sc1
    ds_read_b128 v[76:79], v3 offset:10240
    v_mfma_f32_16x16x32_bf16 v[20:23], v[40:43], a[0:3], 0
    ds_read_b128 v[80:83], v3 offset:11264
    buffer_load_dwordx4 a[52:55], v1, s[8:11], s23 offen offset:1024 sc1
    v_mfma_f32_16x16x32_bf16 v[24:27], v[44:47], a[0:3], 0
    ds_read_b128 v[84:87], v3 offset:12288
    v_mfma_f32_16x16x32_bf16 v[28:31], v[48:51], a[0:3], 0
    ds_read_b128 v[88:91], v3 offset:13312
    buffer_load_dwordx4 a[56:59], v1, s[8:11], s23 offen offset:2048 sc1
    v_mfma_f32_16x16x32_bf16 v[32:35], v[52:55], a[0:3], 0
    ds_read_b128 v[92:95], v3 offset:14336
    s_waitcnt vmcnt(13)
    s_waitcnt lgkmcnt(5)
    v_mfma_f32_16x16x32_bf16 v[16:19], v[56:59], a[4:7], v[16:19]
    ds_read_b128 v[36:39], v3 offset:15360
    buffer_load_dwordx4 a[60:63], v1, s[8:11], s23 offen offset:3072 sc1
    s_add_u32 s23, s23, 4096
    v_mfma_f32_16x16x32_bf16 v[20:23], v[60:63], a[4:7], v[20:23]
    ds_read_b128 v[40:43], v3 offset:16384
    v_mfma_f32_16x16x32_bf16 v[24:27], v[64:67], a[4:7], v[24:27]
    ds_read_b128 v[44:47], v3 offset:17408
    v_mfma_f32_16x16x32_bf16 v[28:31], v[68:71], a[4:7], v[28:31]
    ds_read_b128 v[48:51], v3 offset:18432
    v_mfma_f32_16x16x32_bf16 v[32:35], v[72:75], a[4:7], v[32:35]
    ds_read_b128 v[52:55], v3 offset:19456
    s_waitcnt vmcnt(13)
    s_waitcnt lgkmcnt(5)
    v_mfma_f32_16x16x32_bf16 v[16:19], v[76:79], a[8:11], v[16:19]
    ds_read_b128 v[56:59], v3 offset:20480
    buffer_load_dwordx2 a[64:65], v10, s[8:11], s23 offen offset:0 sc1
    v_mfma_f32_16x16x32_bf16 v[20:23], v[80:83], a[8:11], v[20:23]
    ds_read_b128 v[60:63], v3 offset:21504
    v_mfma_f32_16x16x32_bf16 v[24:27], v[84:87], a[8:11], v[24:27]
    ds_read_b128 v[64:67], v3 offset:22528
    v_mfma_f32_16x16x32_bf16 v[28:31], v[88:91], a[8:11], v[28:31]
    ds_read_b128 v[68:71], v3 offset:23552
    v_mfma_f32_16x16x32_bf16 v[32:35], v[92:95], a[8:11], v[32:35]
    ds_read_b128 v[72:75], v3 offset:24576
    s_waitcnt vmcnt(13)
    s_waitcnt lgkmcnt(5)
    v_mfma_f32_16x16x32_bf16 v[16:19], v[36:39], a[12:15], v[16:19]
    ds_read_b128 v[76:79], v3 offset:25600
    buffer_load_dwordx2 a[66:67], v10, s[8:11], s23 offen offset:512 sc1
    v_mfma_f32_16x16x32_bf16 v[20:23], v[40:43], a[12:15], v[20:23]
    ds_read_b128 v[80:83], v3 offset:26624
    v_mfma_f32_16x16x32_bf16 v[24:27], v[44:47], a[12:15], v[24:27]
    ds_read_b128 v[84:87], v3 offset:27648
    v_mfma_f32_16x16x32_bf16 v[28:31], v[48:51], a[12:15], v[28:31]
    ds_read_b128 v[88:91], v3 offset:28672
    v_mfma_f32_16x16x32_bf16 v[32:35], v[52:55], a[12:15], v[32:35]
    ds_read_b128 v[92:95], v3 offset:29696
    s_waitcnt vmcnt(13)
    s_waitcnt lgkmcnt(5)
    v_mfma_f32_16x16x32_bf16 v[16:19], v[56:59], a[16:19], v[16:19]
    ds_read_b128 v[36:39], v3 offset:30720
    buffer_load_dwordx2 a[68:69], v10, s[8:11], s23 offen offset:1024 sc1
    v_mfma_f32_16x16x32_bf16 v[20:23], v[60:63], a[16:19], v[20:23]
    ds_read_b128 v[40:43], v3 offset:31744
    v_mfma_f32_16x16x32_bf16 v[24:27], v[64:67], a[16:19], v[24:27]
    ds_read_b128 v[44:47], v3 offset:32768
    v_mfma_f32_16x16x32_bf16 v[28:31], v[68:71], a[16:19], v[28:31]
    ds_read_b128 v[48:51], v3 offset:33792
    v_mfma_f32_16x16x32_bf16 v[32:35], v[72:75], a[16:19], v[32:35]
    ds_read_b128 v[52:55], v3 offset:34816
    s_waitcnt vmcnt(13)
    s_waitcnt lgkmcnt(5)
    v_mfma_f32_16x16x32_bf16 v[16:19], v[76:79], a[20:23], v[16:19]
    ds_read_b128 v[56:59], v3 offset:35840
    buffer_load_dwordx2 a[70:71], v10, s[8:11], s23 offen offset:1536 sc1
    v_mfma_f32_16x16x32_bf16 v[20:23], v[80:83], a[20:23], v[20:23]
    ds_read_b128 v[60:63], v3 offset:36864
    v_mfma_f32_16x16x32_bf16 v[24:27], v[84:87], a[20:23], v[24:27]
    ds_read_b128 v[64:67], v3 offset:37888
    v_mfma_f32_16x16x32_bf16 v[28:31], v[88:91], a[20:23], v[28:31]
    ds_read_b128 v[68:71], v3 offset:38912
    v_mfma_f32_16x16x32_bf16 v[32:35], v[92:95], a[20:23], v[32:35]
    ds_read_b128 v[72:75], v3 offset:39936
    s_waitcnt vmcnt(13)
    s_waitcnt lgkmcnt(5)
    v_mfma_f32_16x16x32_bf16 v[16:19], v[36:39], a[24:27], v[16:19]
    ds_read_b128 v[76:79], v3 offset:40960
    buffer_load_dwordx4 v[240:243], v1, s[8:11], s40 offen offset:0 sc1
    v_mfma_f32_16x16x32_bf16 v[20:23], v[40:43], a[24:27], v[20:23]
    ds_read_b128 v[80:83], v3 offset:41984
    v_mfma_f32_16x16x32_bf16 v[24:27], v[44:47], a[24:27], v[24:27]
    ds_read_b128 v[84:87], v3 offset:43008
    v_mfma_f32_16x16x32_bf16 v[28:31], v[48:51], a[24:27], v[28:31]
    ds_read_b128 v[88:91], v3 offset:44032
    v_mfma_f32_16x16x32_bf16 v[32:35], v[52:55], a[24:27], v[32:35]
    ds_read_b128 v[92:95], v3 offset:45056
    s_waitcnt vmcnt(13)
    s_waitcnt lgkmcnt(5)
    v_mfma_f32_16x16x32_bf16 v[16:19], v[56:59], a[28:31], v[16:19]
    ds_read_b128 v[36:39], v3 offset:46080
    buffer_load_dwordx4 v[244:247], v1, s[8:11], s40 offen offset:1024 sc1
    v_mfma_f32_16x16x32_bf16 v[20:23], v[60:63], a[28:31], v[20:23]
    ds_read_b128 v[40:43], v3 offset:47104
    v_mfma_f32_16x16x32_bf16 v[24:27], v[64:67], a[28:31], v[24:27]
    ds_read_b128 v[44:47], v3 offset:48128
    v_mfma_f32_16x16x32_bf16 v[28:31], v[68:71], a[28:31], v[28:31]
    ds_read_b128 v[48:51], v3 offset:49152
    v_mfma_f32_16x16x32_bf16 v[32:35], v[72:75], a[28:31], v[32:35]
    ds_read_b128 v[52:55], v3 offset:50176
    s_waitcnt vmcnt(13)
    s_waitcnt lgkmcnt(5)
    v_mfma_f32_16x16x32_bf16 v[16:19], v[76:79], a[32:35], v[16:19]
    ds_read_b128 v[56:59], v3 offset:51200
    buffer_load_dwordx2 v[248:249], v1, s[8:11], s42 offen sc1
    v_mfma_f32_16x16x32_bf16 v[20:23], v[80:83], a[32:35], v[20:23]
    ds_read_b128 v[60:63], v3 offset:52224
    v_mfma_f32_16x16x32_bf16 v[24:27], v[84:87], a[32:35], v[24:27]
    ds_read_b128 v[64:67], v3 offset:53248
    v_mfma_f32_16x16x32_bf16 v[28:31], v[88:91], a[32:35], v[28:31]
    ds_read_b128 v[68:71], v3 offset:54272
    v_mfma_f32_16x16x32_bf16 v[32:35], v[92:95], a[32:35], v[32:35]
    ds_read_b128 v[72:75], v3 offset:55296
    s_waitcnt vmcnt(13)
    s_waitcnt lgkmcnt(5)
    v_mfma_f32_16x16x32_bf16 v[16:19], v[36:39], a[36:39], v[16:19]
    ds_read_b128 v[76:79], v3 offset:56320
    v_mfma_f32_16x16x32_bf16 v[20:23], v[40:43], a[36:39], v[20:23]
    ds_read_b128 v[80:83], v3 offset:57344
    v_mfma_f32_16x16x32_bf16 v[24:27], v[44:47], a[36:39], v[24:27]
    ds_read_b128 v[84:87], v3 offset:58368
    v_mfma_f32_16x16x32_bf16 v[28:31], v[48:51], a[36:39], v[28:31]
    ds_read_b128 v[88:91], v3 offset:59392
    v_mfma_f32_16x16x32_bf16 v[32:35], v[52:55], a[36:39], v[32:35]
    ds_read_b128 v[92:95], v3 offset:60416
    s_waitcnt vmcnt(12)
    s_waitcnt lgkmcnt(5)
    v_mfma_f32_16x16x32_bf16 v[16:19], v[56:59], a[40:43], v[16:19]
    ds_read_b128 v[36:39], v3 offset:61440
    v_mfma_f32_16x16x32_bf16 v[20:23], v[60:63], a[40:43], v[20:23]
    ds_read_b128 v[40:43], v3 offset:62464
    v_mfma_f32_16x16x32_bf16 v[24:27], v[64:67], a[40:43], v[24:27]
    ds_read_b128 v[44:47], v3 offset:63488
    v_mfma_f32_16x16x32_bf16 v[28:31], v[68:71], a[40:43], v[28:31]
    ds_read_b128 v[48:51], v3 offset:64512
    v_mfma_f32_16x16x32_bf16 v[32:35], v[72:75], a[40:43], v[32:35]
    ds_read_b128 v[52:55], v2 offset:0
    s_waitcnt vmcnt(11)
    s_waitcnt lgkmcnt(5)
    v_mfma_f32_16x16x32_bf16 v[16:19], v[76:79], a[44:47], v[16:19]
    ds_read_b128 v[56:59], v2 offset:1024
    v_mfma_f32_16x16x32_bf16 v[20:23], v[80:83], a[44:47], v[20:23]
    ds_read_b128 v[60:63], v2 offset:2048
    v_mfma_f32_16x16x32_bf16 v[24:27], v[84:87], a[44:47], v[24:27]
    ds_read_b128 v[64:67], v2 offset:3072
    v_mfma_f32_16x16x32_bf16 v[28:31], v[88:91], a[44:47], v[28:31]
    ds_read_b128 v[68:71], v2 offset:4096
    v_mfma_f32_16x16x32_bf16 v[32:35], v[92:95], a[44:47], v[32:35]
    ds_read_b128 v[72:75], v2 offset:5120
    s_waitcnt vmcnt(10)
    s_waitcnt lgkmcnt(5)
    v_mfma_f32_16x16x32_bf16 v[16:19], v[36:39], a[48:51], v[16:19]
    ds_read_b128 v[76:79], v2 offset:6144
    v_mfma_f32_16x16x32_bf16 v[20:23], v[40:43], a[48:51], v[20:23]
    ds_read_b128 v[80:83], v2 offset:7168
    v_mfma_f32_16x16x32_bf16 v[24:27], v[44:47], a[48:51], v[24:27]
    ds_read_b128 v[84:87], v2 offset:8192
    v_mfma_f32_16x16x32_bf16 v[28:31], v[48:51], a[48:51], v[28:31]
    ds_read_b128 v[88:91], v2 offset:9216
    v_mfma_f32_16x16x32_bf16 v[32:35], v[52:55], a[48:51], v[32:35]
    ds_read_b128 v[92:95], v2 offset:10240
    s_waitcnt vmcnt(9)
    s_waitcnt lgkmcnt(5)
    v_mfma_f32_16x16x32_bf16 v[16:19], v[56:59], a[52:55], v[16:19]
    ds_read_b128 v[36:39], v2 offset:11264
    v_mfma_f32_16x16x32_bf16 v[20:23], v[60:63], a[52:55], v[20:23]
    ds_read_b128 v[40:43], v2 offset:12288
    v_mfma_f32_16x16x32_bf16 v[24:27], v[64:67], a[52:55], v[24:27]
    ds_read_b128 v[44:47], v2 offset:13312
    v_mfma_f32_16x16x32_bf16 v[28:31], v[68:71], a[52:55], v[28:31]
    ds_read_b128 v[48:51], v2 offset:14336
    v_mfma_f32_16x16x32_bf16 v[32:35], v[72:75], a[52:55], v[32:35]
    ds_read_b128 v[52:55], v2 offset:15360
    s_waitcnt vmcnt(8)
    s_waitcnt lgkmcnt(5)
    v_mfma_f32_16x16x32_bf16 v[16:19], v[76:79], a[56:59], v[16:19]
    ds_read_b128 v[56:59], v2 offset:16384
    v_mfma_f32_16x16x32_bf16 v[20:23], v[80:83], a[56:59], v[20:23]
    ds_read_b128 v[60:63], v2 offset:17408
    v_mfma_f32_16x16x32_bf16 v[24:27], v[84:87], a[56:59], v[24:27]
    ds_read_b128 v[64:67], v2 offset:18432
    v_mfma_f32_16x16x32_bf16 v[28:31], v[88:91], a[56:59], v[28:31]
    ds_read_b128 v[68:71], v2 offset:19456
    v_mfma_f32_16x16x32_bf16 v[32:35], v[92:95], a[56:59], v[32:35]
    ds_read_b128 v[72:75], v2 offset:20480
    s_waitcnt vmcnt(7)
    s_waitcnt lgkmcnt(5)
    v_mfma_f32_16x16x32_bf16 v[16:19], v[36:39], a[60:63], v[16:19]
    ds_read_b128 v[76:79], v2 offset:21504
    v_mfma_f32_16x16x32_bf16 v[20:23], v[40:43], a[60:63], v[20:23]
    ds_read_b128 v[80:83], v2 offset:22528
    v_mfma_f32_16x16x32_bf16 v[24:27], v[44:47], a[60:63], v[24:27]
    ds_read_b128 v[84:87], v2 offset:23552
    v_mfma_f32_16x16x32_bf16 v[28:31], v[48:51], a[60:63], v[28:31]
    ds_read_b128 v[88:91], v2 offset:24576
    v_mfma_f32_16x16x32_bf16 v[32:35], v[52:55], a[60:63], v[32:35]
    ds_read_b128 v[92:95], v2 offset:25600
    s_waitcnt vmcnt(5)
    s_waitcnt lgkmcnt(5)
    v_mfma_f32_16x16x32_bf16 v[16:19], v[56:59], a[64:67], v[16:19]
    v_mfma_f32_16x16x32_bf16 v[20:23], v[60:63], a[64:67], v[20:23]
    v_mfma_f32_16x16x32_bf16 v[24:27], v[64:67], a[64:67], v[24:27]
    v_mfma_f32_16x16x32_bf16 v[28:31], v[68:71], a[64:67], v[28:31]
    v_mfma_f32_16x16x32_bf16 v[32:35], v[72:75], a[64:67], v[32:35]
    s_waitcnt vmcnt(3)
    s_waitcnt lgkmcnt(0)
    v_mfma_f32_16x16x32_bf16 v[16:19], v[76:79], a[68:71], v[16:19]
    v_mfma_f32_16x16x32_bf16 v[20:23], v[80:83], a[68:71], v[20:23]
    v_mfma_f32_16x16x32_bf16 v[24:27], v[84:87], a[68:71], v[24:27]
    v_mfma_f32_16x16x32_bf16 v[28:31], v[88:91], a[68:71], v[28:31]
    v_mfma_f32_16x16x32_bf16 v[32:35], v[92:95], a[68:71], v[32:35]
    s_waitcnt vmcnt(0)
    s_mov_b32 s31, 0xffff0000
    s_mov_b32 s32, 0x3f803f80
    v_mov_b32 v8, 0
    v_mov_b32 v9, 0
    v_mov_b32 v6, v10
    v_mov_b32 v10, 0
    s_add_u32 s33, s100, s50
    v_cmp_gt_u32 vcc, 256, v1
    v_mov_b32 v7, 1073741824
    v_mov_b32 v11, s33
    s_cmp_lg_u32 s29, 0
    s_cbranch_scc1 L_p3_two
    v_lshlrev_b32 v4, 16, v248
    v_and_b32 v5, s31, v248
    v_pk_add_f32 v[4:5], v[4:5], v[32:33]
    v_cvt_pk_bf16_f32 v248, v4, v5
    v_lshlrev_b32 v4, 16, v249
    v_and_b32 v5, s31, v249
    v_pk_add_f32 v[4:5], v[4:5], v[34:35]
    v_cvt_pk_bf16_f32 v249, v4, v5
    buffer_store_dwordx2 v[248:249], v6, s[8:11], s43 offen sc1
    v_dot2c_f32_bf16 v8, s32, v248
    v_dot2c_f32_bf16 v9, v248, v248
    v_dot2c_f32_bf16 v8, s32, v249
    v_dot2c_f32_bf16 v9, v249, v249
    v_bitop3_b32 v10, v10, v248, v249 bitop3:0x96
L_p3_two:
    v_lshlrev_b32 v4, 16, v240
    v_and_b32 v5, s31, v240
    v_pk_add_f32 v[4:5], v[4:5], v[16:17]
    v_cvt_pk_bf16_f32 v240, v4, v5
    v_lshlrev_b32 v4, 16, v241
    v_and_b32 v5, s31, v241
    v_pk_add_f32 v[4:5], v[4:5], v[18:19]
    v_cvt_pk_bf16_f32 v241, v4, v5
    v_lshlrev_b32 v4, 16, v242
    v_and_b32 v5, s31, v242
    v_pk_add_f32 v[4:5], v[4:5], v[20:21]
    v_cvt_pk_bf16_f32 v242, v4, v5
    v_lshlrev_b32 v4, 16, v243
    v_and_b32 v5, s31, v243
    v_pk_add_f32 v[4:5], v[4:5], v[22:23]
    v_cvt_pk_bf16_f32 v243, v4, v5
    buffer_store_dwordx4 v[240:243], v1, s[8:11], s41 offen offset:0 sc1
    v_dot2c_f32_bf16 v8, s32, v240
    v_dot2c_f32_bf16 v9, v240, v240
    v_dot2c_f32_bf16 v8, s32, v241
    v_dot2c_f32_bf16 v9, v241, v241
    v_dot2c_f32_bf16 v8, s32, v242
    v_dot2c_f32_bf16 v9, v242, v242
    v_dot2c_f32_bf16 v8, s32, v243
    v_dot2c_f32_bf16 v9, v243, v243
    v_bitop3_b32 v10, v10, v240, v241 bitop3:0x96
    v_bitop3_b32 v10, v10, v242, v243 bitop3:0x96
    v_lshlrev_b32 v4, 16, v244
    v_and_b32 v5, s31, v244
    v_pk_add_f32 v[4:5], v[4:5], v[24:25]
    v_cvt_pk_bf16_f32 v244, v4, v5
    v_lshlrev_b32 v4, 16, v245
    v_and_b32 v5, s31, v245
    v_pk_add_f32 v[4:5], v[4:5], v[26:27]
    v_cvt_pk_bf16_f32 v245, v4, v5
    v_lshlrev_b32 v4, 16, v246
    v_and_b32 v5, s31, v246
    v_pk_add_f32 v[4:5], v[4:5], v[28:29]
    v_cvt_pk_bf16_f32 v246, v4, v5
    v_lshlrev_b32 v4, 16, v247
    v_and_b32 v5, s31, v247
    v_pk_add_f32 v[4:5], v[4:5], v[30:31]
    v_cvt_pk_bf16_f32 v247, v4, v5
    buffer_store_dwordx4 v[244:247], v1, s[8:11], s41 offen offset:1024 sc1
    v_dot2c_f32_bf16 v8, s32, v244
    v_dot2c_f32_bf16 v9, v244, v244
    v_dot2c_f32_bf16 v8, s32, v245
    v_dot2c_f32_bf16 v9, v245, v245
    v_dot2c_f32_bf16 v8, s32, v246
    v_dot2c_f32_bf16 v9, v246, v246
    v_dot2c_f32_bf16 v8, s32, v247
    v_dot2c_f32_bf16 v9, v247, v247
    v_bitop3_b32 v10, v10, v244, v245 bitop3:0x96
    v_bitop3_b32 v10, v10, v246, v247 bitop3:0x96
    v_cndmask_b32 v7, v7, v1, vcc
    s_lshl_b32 s30, s21, 11
    s_lshl_b32 s31, s22, 8
    s_add_u32 s30, s30, s31
    s_add_u32 s30, s30, 63930368
    v_mov_b32 v4, v10
    v_mov_b32 v5, v8
    v_mov_b32 v6, v9
    v_permlane16_swap_b32 v10, v4
    v_permlane16_swap_b32 v8, v5
    v_permlane16_swap_b32 v9, v6
    v_xor_b32 v10, v10, v4
    v_add_f32 v8, v8, v5
    v_add_f32 v9, v9, v6
    v_mov_b32 v4, v10
    v_mov_b32 v5, v8
    v_mov_b32 v6, v9
    v_permlane32_swap_b32 v10, v4
    v_permlane32_swap_b32 v8, v5
    v_permlane32_swap_b32 v9, v6
    v_xor_b32 v10, v10, v4
    v_add_f32 v8, v8, v5
    v_add_f32 v9, v9, v6
    v_bitop3_b32 v10, v10, v8, v9 bitop3:0x96
    buffer_store_dwordx4 v[8:11], v7, s[8:11], s30 offen sc1
    s_lshl_b32 s56, s26, 7
    s_lshl_b32 s27, s22, 3
    s_add_u32 s56, s56, s27
    s_add_u32 s56, s56, 63868928
    s_add_u32 s56, s56, s51
    s_cmp_eq_u32 s20, 0
    s_cselect_b32 s56, s56, 1073741824
    s_barrier
    v_mov_b32 v254, s100
    v_mov_b32 v255, s101
    buffer_store_dwordx2 v[254:255], v13, s[8:11], s56 offen sc1
    s_lshl_b32 s21, s19, 1
    s_and_b32 s22, s17, 1
    s_add_u32 s21, s21, s22
    s_lshl_b32 s22, s18, 4
    s_lshr_b32 s23, s17, 1
    s_add_u32 s22, s22, s23
    buffer_load_dwordx4 v[112:115], v1, s[12:15], s25 offen offset:0
    buffer_load_dwordx4 v[116:119], v1, s[12:15], s25 offen offset:1024
    buffer_load_dwordx4 v[120:123], v1, s[12:15], s25 offen offset:2048
    buffer_load_dwordx4 v[124:127], v1, s[12:15], s25 offen offset:3072
    s_add_u32 s25, s25, 4096
    buffer_load_dwordx4 v[128:131], v1, s[12:15], s25 offen offset:0
    buffer_load_dwordx4 v[132:135], v1, s[12:15], s25 offen offset:1024
    buffer_load_dwordx4 v[136:139], v1, s[12:15], s25 offen offset:2048
    buffer_load_dwordx4 v[140:143], v1, s[12:15], s25 offen offset:3072
    s_add_u32 s25, s25, 4096
    buffer_load_dwordx4 v[144:147], v1, s[12:15], s25 offen offset:0
    buffer_load_dwordx4 v[148:151], v1, s[12:15], s25 offen offset:1024
    buffer_load_dwordx4 v[152:155], v1, s[12:15], s25 offen offset:2048
    buffer_load_dwordx4 v[156:159], v1, s[12:15], s25 offen offset:3072
    s_add_u32 s25, s25, 4096
    s_lshl_b32 s23, s22, 2
    s_add_u32 s23, s23, s20
    s_lshl_b32 s44, s23, 11
    s_add_u32 s44, s44, 63930368
    s_mul_i32 s45, s23, 18432
    s_add_u32 s45, s45, 7077888
    s_mov_b32 s30, 0x3f803f80
    s_mov_b32 s31, 0x3ae38e39
    s_mov_b32 s32, 0xffff0000
    v_and_b32 v12, 15, v0
    v_lshlrev_b32 v12, 4, v12
    v_bfe_u32 v5, v0, 4, 2
    v_lshl_add_u32 v12, v5, 9, v12
    s_add_u32 s46, s100, s50
    v_bfe_u32 v4, v0, 2, 2
    v_cmp_eq_u32 vcc, v4, v5
    v_and_b32 v4, 1, v0
    v_lshlrev_b32 v4, 4, v4
    v_mov_b32 v244, 0x3f80
    v_lshlrev_b32 v4, v4, v244
    v_cndmask_b32 v4, 0, v4, vcc
    v_and_b32 v245, 2, v0
    v_cmp_eq_u32 vcc, 0, v245
    v_mov_b32 v244, 0
    v_mov_b32 v245, 0
    v_mov_b32 v248, 0
    v_mov_b32 v249, 0
    v_cndmask_b32 v246, 0, v4, vcc
    v_cndmask_b32 v247, v4, 0, vcc
    s_mov_b32 s57, 300000
    s_lshl_b32 s26, s20, 10
    v_add_u32 v2, s26, v1
    v_add_u32 v3, 0x10000, v2
    s_mov_b32 s47, 0
    s_lshl_b32 s56, s22, 7
    s_add_u32 s56, s56, 63868928
    s_cmp_lg_u32 s20, 0
    s_cbranch_scc1 L_pollx_d
    s_mov_b32 s57, 300000
    s_add_u32 s56, s56, s51
L_poll_d0:
    s_load_dwordx16 s[84:99], s[4:5], s56 glc
    s_sub_u32 s57, s57, 1
    s_cmp_eq_u32 s57, 0
    s_waitcnt lgkmcnt(0)
    s_cbranch_scc1 L_pollx_d
    s_xor_b64 s[84:85], s[84:85], s[100:101]
    s_xor_b64 s[86:87], s[86:87], s[100:101]
    s_xor_b64 s[88:89], s[88:89], s[100:101]
    s_xor_b64 s[90:91], s[90:91], s[100:101]
    s_xor_b64 s[92:93], s[92:93], s[100:101]
    s_xor_b64 s[94:95], s[94:95], s[100:101]
    s_xor_b64 s[96:97], s[96:97], s[100:101]
    s_xor_b64 s[98:99], s[98:99], s[100:101]
    s_or_b64 s[84:85], s[84:85], s[86:87]
    s_or_b64 s[84:85], s[84:85], s[88:89]
    s_or_b64 s[84:85], s[84:85], s[90:91]
    s_or_b64 s[84:85], s[84:85], s[92:93]
    s_or_b64 s[84:85], s[84:85], s[94:95]
    s_or_b64 s[84:85], s[84:85], s[96:97]
    s_or_b64 s[84:85], s[84:85], s[98:99]
    s_cbranch_scc0 2
    s_sleep 2
    s_branch L_poll_d0
L_pollx_d:
    s_barrier
    s_mov_b32 s57, 300000
    v_mov_b32 v254, s100
    v_mov_b32 v255, s101
    s_mov_b32 s30, 159072863
    s_mul_hi_u32 s27, s2, s30
    s_mul_i32 s27, s27, 5
    s_add_u32 s27, s27, s2
    s_lshl_b32 s27, s27, 3
    s_add_u32 s27, s27, 63887360
    s_cmp_lt_u32 s2, 216
    s_cselect_b32 s27, s27, 1073741824
    s_cmp_eq_u32 s20, 0
    s_cselect_b32 s27, s27, 1073741824
    buffer_store_dwordx2 v[254:255], v13, s[8:11], s27 offen sc1
    s_mov_b32 s30, 0x3f803f80
    s_lshl_b32 s56, s21, 8
    s_add_u32 s56, s56, 63887360
    v_and_b32 v6, 31, v0
    v_min_u32 v6, 26, v6
    v_lshlrev_b32 v6, 3, v6
L_p4_go:
    buffer_load_dwordx4 v[88:91], v12, s[8:11], s44 offen sc1
    buffer_load_dwordx4 v[92:95], v12, s[8:11], s44 offen offset:256 sc1
    s_mov_b32 s23, s45
    v_lshrrev_b32 v7, 1, v1
    buffer_load_dwordx4 v[16:19], v1, s[8:11], s23 offen offset:0 sc1
    buffer_load_dwordx4 v[20:23], v1, s[8:11], s23 offen offset:1024 sc1
    buffer_load_dwordx4 v[24:27], v1, s[8:11], s23 offen offset:2048 sc1
    buffer_load_dwordx4 v[28:31], v1, s[8:11], s23 offen offset:3072 sc1
    s_add_u32 s23, s23, 4096
    buffer_load_dwordx4 v[32:35], v1, s[8:11], s23 offen offset:0 sc1
    buffer_load_dwordx4 v[36:39], v1, s[8:11], s23 offen offset:1024 sc1
    buffer_load_dwordx4 v[40:43], v1, s[8:11], s23 offen offset:2048 sc1
    buffer_load_dwordx4 v[44:47], v1, s[8:11], s23 offen offset:3072 sc1
    s_add_u32 s23, s23, 4096
    buffer_load_dwordx4 v[48:51], v1, s[8:11], s23 offen offset:0 sc1
    buffer_load_dwordx4 v[52:55], v1, s[8:11], s23 offen offset:1024 sc1
    buffer_load_dwordx4 v[56:59], v1, s[8:11], s23 offen offset:2048 sc1
    buffer_load_dwordx4 v[60:63], v1, s[8:11], s23 offen offset:3072 sc1
    s_add_u32 s23, s23, 4096
    buffer_load_dwordx4 v[64:67], v1, s[8:11], s23 offen offset:0 sc1
    buffer_load_dwordx4 v[68:71], v1, s[8:11], s23 offen offset:1024 sc1
    buffer_load_dwordx4 v[72:75], v1, s[8:11], s23 offen offset:2048 sc1
    buffer_load_dwordx4 v[76:79], v1, s[8:11], s23 offen offset:3072 sc1
    s_add_u32 s23, s23, 4096
    buffer_load_dwordx2 v[80:81], v7, s[8:11], s23 offen offset:0 sc1
    buffer_load_dwordx2 v[82:83], v7, s[8:11], s23 offen offset:512 sc1
    buffer_load_dwordx2 v[84:85], v7, s[8:11], s23 offen offset:1024 sc1
    buffer_load_dwordx2 v[86:87], v7, s[8:11], s23 offen offset:1536 sc1
    s_waitcnt vmcnt(20)
    v_bitop3_b32 v100, v88, v89, v90 bitop3:0x96
    v_bitop3_b32 v90, v92, v93, v94 bitop3:0x96
    v_xor_b32 v100, v100, v90
    v_xor_b32 v101, s46, v91
    v_bitop3_b32 v101, v101, v95, s46 bitop3:0xf6
    v_add_f32 v88, v88, v92
    v_add_f32 v89, v89, v93
    v_mov_b32 v90, v88
    s_nop 1
    v_permlane16_swap_b32 v88, v90
    v_add_f32 v88, v88, v90
    v_mov_b32 v90, v88
    s_nop 1
    v_permlane32_swap_b32 v88, v90
    v_add_f32 v88, v88, v90
    v_mul_f32 v88, s31, v88
    v_sub_f32 v91, 0, v88
    s_mov_b32 s26, 0x00003f80
    s_mov_b32 s27, 0x3f800000
    v_mov_b32 v240, v91
    v_mov_b32 v241, v91
    v_mov_b32 v242, v91
    v_mov_b32 v243, v91
    s_nop 0
    s_waitcnt vmcnt(19)
    v_mfma_f32_16x16x32_bf16 v[224:227], v[246:249], v[16:19], v[240:243]
    v_bitop3_b32 v100, v100, v16, v17 bitop3:0x96
    v_bitop3_b32 v100, v100, v18, v19 bitop3:0x96
    v_mfma_f32_16x16x32_bf16 v[228:231], v[244:247], v[16:19], v[240:243]
    v_mov_b32 v90, v89
    s_nop 1
    v_permlane16_swap_b32 v89, v90
    v_add_f32 v89, v89, v90
    v_mov_b32 v90, v89
    s_nop 1
    v_permlane32_swap_b32 v89, v90
    v_add_f32 v89, v89, v90
    v_mul_f32 v89, s31, v89
    v_fma_f32 v89, -v88, v88, v89
    v_max_f32 v89, 0, v89
    v_add_f32 v89, 0x3727c5ac, v89
    v_and_b32 v4, 15, v0
    v_lshlrev_b32 v4, 2, v4
    v_add_u32 v4, 147456, v4
    s_lshl_b32 s33, s20, 6
    v_add_u32 v5, s33, v4
    ds_write_b32 v5, v89
    s_waitcnt vmcnt(18)
    v_mfma_f32_16x16x32_bf16 v[232:235], v[246:249], v[20:23], v[240:243]
    v_bitop3_b32 v100, v100, v20, v21 bitop3:0x96
    v_bitop3_b32 v100, v100, v22, v23 bitop3:0x96
    v_mfma_f32_16x16x32_bf16 v[236:239], v[244:247], v[20:23], v[240:243]
    v_cvt_pk_bf16_f32 v16, v224, v225
    v_cvt_pk_bf16_f32 v17, v226, v227
    v_cvt_pk_bf16_f32 v18, v228, v229
    v_cvt_pk_bf16_f32 v19, v230, v231
    ds_write_b128 v2, v[16:19] offset:0
    s_waitcnt vmcnt(17)
    v_mfma_f32_16x16x32_bf16 v[224:227], v[246:249], v[24:27], v[240:243]
    v_bitop3_b32 v100, v100, v24, v25 bitop3:0x96
    v_bitop3_b32 v100, v100, v26, v27 bitop3:0x96
    v_mfma_f32_16x16x32_bf16 v[228:231], v[244:247], v[24:27], v[240:243]
    v_cvt_pk_bf16_f32 v20, v232, v233
    v_cvt_pk_bf16_f32 v21, v234, v235
    v_cvt_pk_bf16_f32 v22, v236, v237
    v_cvt_pk_bf16_f32 v23, v238, v239
    ds_write_b128 v2, v[20:23] offset:4096
    s_waitcnt vmcnt(16)
    v_mfma_f32_16x16x32_bf16 v[232:235], v[246:249], v[28:31], v[240:243]
    v_bitop3_b32 v100, v100, v28, v29 bitop3:0x96
    v_bitop3_b32 v100, v100, v30, v31 bitop3:0x96
    v_mfma_f32_16x16x32_bf16 v[236:239], v[244:247], v[28:31], v[240:243]
    v_cvt_pk_bf16_f32 v24, v224, v225
    v_cvt_pk_bf16_f32 v25, v226, v227
    v_cvt_pk_bf16_f32 v26, v228, v229
    v_cvt_pk_bf16_f32 v27, v230, v231
    ds_write_b128 v2, v[24:27] offset:8192
    s_waitcnt vmcnt(15)
    v_mfma_f32_16x16x32_bf16 v[224:227], v[246:249], v[32:35], v[240:243]
    v_bitop3_b32 v100, v100, v32, v33 bitop3:0x96
    v_bitop3_b32 v100, v100, v34, v35 bitop3:0x96
    v_mfma_f32_16x16x32_bf16 v[228:231], v[244:247], v[32:35], v[240:243]
    v_cvt_pk_bf16_f32 v28, v232, v233
    v_cvt_pk_bf16_f32 v29, v234, v235
    v_cvt_pk_bf16_f32 v30, v236, v237
    v_cvt_pk_bf16_f32 v31, v238, v239
    ds_write_b128 v2, v[28:31] offset:12288
    s_waitcnt vmcnt(14)
    v_mfma_f32_16x16x32_bf16 v[232:235], v[246:249], v[36:39], v[240:243]
    v_bitop3_b32 v100, v100, v36, v37 bitop3:0x96
    v_bitop3_b32 v100, v100, v38, v39 bitop3:0x96
    v_mfma_f32_16x16x32_bf16 v[236:239], v[244:247], v[36:39], v[240:243]
    v_cvt_pk_bf16_f32 v32, v224, v225
    v_cvt_pk_bf16_f32 v33, v226, v227
    v_cvt_pk_bf16_f32 v34, v228, v229
    v_cvt_pk_bf16_f32 v35, v230, v231
    ds_write_b128 v2, v[32:35] offset:16384
    s_waitcnt vmcnt(13)
    v_mfma_f32_16x16x32_bf16 v[224:227], v[246:249], v[40:43], v[240:243]
    v_bitop3_b32 v100, v100, v40, v41 bitop3:0x96
    v_bitop3_b32 v100, v100, v42, v43 bitop3:0x96
    v_mfma_f32_16x16x32_bf16 v[228:231], v[244:247], v[40:43], v[240:243]
    v_cvt_pk_bf16_f32 v36, v232, v233
    v_cvt_pk_bf16_f32 v37, v234, v235
    v_cvt_pk_bf16_f32 v38, v236, v237
    v_cvt_pk_bf16_f32 v39, v238, v239
    ds_write_b128 v2, v[36:39] offset:20480
    s_waitcnt vmcnt(12)
    v_mfma_f32_16x16x32_bf16 v[232:235], v[246:249], v[44:47], v[240:243]
    v_bitop3_b32 v100, v100, v44, v45 bitop3:0x96
    v_bitop3_b32 v100, v100, v46, v47 bitop3:0x96
    v_mfma_f32_16x16x32_bf16 v[236:239], v[244:247], v[44:47], v[240:243]
    v_cvt_pk_bf16_f32 v40, v224, v225
    v_cvt_pk_bf16_f32 v41, v226, v227
    v_cvt_pk_bf16_f32 v42, v228, v229
    v_cvt_pk_bf16_f32 v43, v230, v231
    ds_write_b128 v2, v[40:43] offset:24576
    s_waitcnt vmcnt(11)
    v_mfma_f32_16x16x32_bf16 v[224:227], v[246:249], v[48:51], v[240:243]
    v_bitop3_b32 v100, v100, v48, v49 bitop3:0x96
    v_bitop3_b32 v100, v100, v50, v51 bitop3:0x96
    v_mfma_f32_16x16x32_bf16 v[228:231], v[244:247], v[48:51], v[240:243]
    v_cvt_pk_bf16_f32 v44, v232, v233
    v_cvt_pk_bf16_f32 v45, v234, v235
    v_cvt_pk_bf16_f32 v46, v236, v237
    v_cvt_pk_bf16_f32 v47, v238, v239
    ds_write_b128 v2, v[44:47] offset:28672
    s_waitcnt vmcnt(10)
    v_mfma_f32_16x16x32_bf16 v[232:235], v[246:249], v[52:55], v[240:243]
    v_bitop3_b32 v100, v100, v52, v53 bitop3:0x96
    v_bitop3_b32 v100, v100, v54, v55 bitop3:0x96
    v_mfma_f32_16x16x32_bf16 v[236:239], v[244:247], v[52:55], v[240:243]
    v_cvt_pk_bf16_f32 v48, v224, v225
    v_cvt_pk_bf16_f32 v49, v226, v227
    v_cvt_pk_bf16_f32 v50, v228, v229
    v_cvt_pk_bf16_f32 v51, v230, v231
    ds_write_b128 v2, v[48:51] offset:32768
    s_waitcnt vmcnt(9)
    v_mfma_f32_16x16x32_bf16 v[224:227], v[246:249], v[56:59], v[240:243]
    v_bitop3_b32 v100, v100, v56, v57 bitop3:0x96
    v_bitop3_b32 v100, v100, v58, v59 bitop3:0x96
    v_mfma_f32_16x16x32_bf16 v[228:231], v[244:247], v[56:59], v[240:243]
    v_cvt_pk_bf16_f32 v52, v232, v233
    v_cvt_pk_bf16_f32 v53, v234, v235
    v_cvt_pk_bf16_f32 v54, v236, v237
    v_cvt_pk_bf16_f32 v55, v238, v239
    ds_write_b128 v2, v[52:55] offset:36864
    s_waitcnt vmcnt(8)
    v_mfma_f32_16x16x32_bf16 v[232:235], v[246:249], v[60:63], v[240:243]
    v_bitop3_b32 v100, v100, v60, v61 bitop3:0x96
    v_bitop3_b32 v100, v100, v62, v63 bitop3:0x96
    v_mfma_f32_16x16x32_bf16 v[236:239], v[244:247], v[60:63], v[240:243]
    v_cvt_pk_bf16_f32 v56, v224, v225
    v_cvt_pk_bf16_f32 v57, v226, v227
    v_cvt_pk_bf16_f32 v58, v228, v229
    v_cvt_pk_bf16_f32 v59, v230, v231
    ds_write_b128 v2, v[56:59] offset:40960
    s_waitcnt vmcnt(7)
    v_mfma_f32_16x16x32_bf16 v[224:227], v[246:249], v[64:67], v[240:243]
    v_bitop3_b32 v100, v100, v64, v65 bitop3:0x96
    v_bitop3_b32 v100, v100, v66, v67 bitop3:0x96
    v_mfma_f32_16x16x32_bf16 v[228:231], v[244:247], v[64:67], v[240:243]
    v_cvt_pk_bf16_f32 v60, v232, v233
    v_cvt_pk_bf16_f32 v61, v234, v235
    v_cvt_pk_bf16_f32 v62, v236, v237
    v_cvt_pk_bf16_f32 v63, v238, v239
    ds_write_b128 v2, v[60:63] offset:45056
    buffer_load_dwordx2 v[102:103], v6, s[8:11], s56 offen sc1
    s_waitcnt vmcnt(7)
    v_mfma_f32_16x16x32_bf16 v[232:235], v[246:249], v[68:71], v[240:243]
    v_bitop3_b32 v100, v100, v68, v69 bitop3:0x96
    v_bitop3_b32 v100, v100, v70, v71 bitop3:0x96
    v_mfma_f32_16x16x32_bf16 v[236:239], v[244:247], v[68:71], v[240:243]
    v_cvt_pk_bf16_f32 v64, v224, v225
    v_cvt_pk_bf16_f32 v65, v226, v227
    v_cvt_pk_bf16_f32 v66, v228, v229
    v_cvt_pk_bf16_f32 v67, v230, v231
    ds_write_b128 v2, v[64:67] offset:49152
    s_waitcnt vmcnt(6)
    v_mfma_f32_16x16x32_bf16 v[224:227], v[246:249], v[72:75], v[240:243]
    v_bitop3_b32 v100, v100, v72, v73 bitop3:0x96
    v_bitop3_b32 v100, v100, v74, v75 bitop3:0x96
    v_mfma_f32_16x16x32_bf16 v[228:231], v[244:247], v[72:75], v[240:243]
    v_cvt_pk_bf16_f32 v68, v232, v233
    v_cvt_pk_bf16_f32 v69, v234, v235
    v_cvt_pk_bf16_f32 v70, v236, v237
    v_cvt_pk_bf16_f32 v71, v238, v239
    ds_write_b128 v2, v[68:71] offset:53248
    s_waitcnt vmcnt(5)
    v_mfma_f32_16x16x32_bf16 v[232:235], v[246:249], v[76:79], v[240:243]
    v_bitop3_b32 v100, v100, v76, v77 bitop3:0x96
    v_bitop3_b32 v100, v100, v78, v79 bitop3:0x96
    v_mfma_f32_16x16x32_bf16 v[236:239], v[244:247], v[76:79], v[240:243]
    v_cvt_pk_bf16_f32 v72, v224, v225
    v_cvt_pk_bf16_f32 v73, v226, v227
    v_cvt_pk_bf16_f32 v74, v228, v229
    v_cvt_pk_bf16_f32 v75, v230, v231
    ds_write_b128 v2, v[72:75] offset:57344
    s_waitcnt vmcnt(3)
    v_mfma_f32_16x16x32_bf16 v[224:227], v[246:249], v[80:83], v[240:243]
    v_bitop3_b32 v100, v100, v80, v81 bitop3:0x96
    v_bitop3_b32 v100, v100, v82, v83 bitop3:0x96
    v_mfma_f32_16x16x32_bf16 v[228:231], v[244:247], v[80:83], v[240:243]
    v_cvt_pk_bf16_f32 v76, v232, v233
    v_cvt_pk_bf16_f32 v77, v234, v235
    v_cvt_pk_bf16_f32 v78, v236, v237
    v_cvt_pk_bf16_f32 v79, v238, v239
    ds_write_b128 v2, v[76:79] offset:61440
    s_waitcnt vmcnt(1)
    v_mfma_f32_16x16x32_bf16 v[232:235], v[246:249], v[84:87], v[240:243]
    v_bitop3_b32 v100, v100, v84, v85 bitop3:0x96
    v_bitop3_b32 v100, v100, v86, v87 bitop3:0x96
    v_mfma_f32_16x16x32_bf16 v[236:239], v[244:247], v[84:87], v[240:243]
    v_cvt_pk_bf16_f32 v80, v224, v225
    v_cvt_pk_bf16_f32 v81, v226, v227
    v_cvt_pk_bf16_f32 v82, v228, v229
    v_cvt_pk_bf16_f32 v83, v230, v231
    ds_write_b128 v3, v[80:83] offset:0
    v_mov_b32 v90, v100
    s_nop 1
    v_permlane16_swap_b32 v100, v90
    v_xor_b32 v100, v100, v90
    v_mov_b32 v90, v100
    s_nop 1
    v_permlane32_swap_b32 v100, v90
    v_xor_b32 v100, v100, v90
    v_cvt_pk_bf16_f32 v84, v232, v233
    v_cvt_pk_bf16_f32 v85, v234, v235
    v_cvt_pk_bf16_f32 v86, v236, v237
    v_cvt_pk_bf16_f32 v87, v238, v239
    ds_write_b128 v3, v[84:87] offset:4096
    v_or_b32 v100, v100, v101
    v_cmp_ne_u32 vcc, s47, v100
    s_mov_b32 s47, 0
    s_cmp_eq_u32 s57, 0
    s_cbranch_scc1 L_p4_ok
    s_sub_u32 s57, s57, 1
    s_cmp_eq_u64 vcc, 0
    s_cbranch_scc0 L_p4_go
L_p4_ok:
    buffer_load_dwordx4 v[160:163], v1, s[12:15], s25 offen offset:0
    buffer_load_dwordx4 v[164:167], v1, s[12:15], s25 offen offset:1024
    buffer_load_dwordx4 v[168:171], v1, s[12:15], s25 offen offset:2048
    buffer_load_dwordx4 v[172:175], v1, s[12:15], s25 offen offset:3072
    s_add_u32 s25, s25, 4096
    buffer_load_dwordx4 v[176:179], v1, s[12:15], s25 offen offset:0
    buffer_load_dwordx4 v[180:183], v1, s[12:15], s25 offen offset:1024
    buffer_load_dwordx4 v[184:187], v1, s[12:15], s25 offen offset:2048
    buffer_load_dwordx4 v[188:191], v1, s[12:15], s25 offen offset:3072
    s_add_u32 s25, s25, 4096
    buffer_load_dwordx4 v[192:195], v1, s[12:15], s25 offen offset:0
    buffer_load_dwordx4 v[196:199], v1, s[12:15], s25 offen offset:1024
    buffer_load_dwordx4 v[200:203], v1, s[12:15], s25 offen offset:2048
    buffer_load_dwordx4 v[204:207], v1, s[12:15], s25 offen offset:3072
    s_add_u32 s25, s25, 4096
    v_mov_b32 v2, v1
    v_add_u32 v3, 0x10000, v1
    s_mov_b32 s33, 0xbfb8aa3b
    s_lshl_b32 s29, s20, 14
    s_add_u32 s29, s29, 73728
    s_mov_b32 s28, 8
    s_mov_b32 s34, 7
    s_waitcnt lgkmcnt(0)
    s_barrier
    ds_read_b32 v9, v4 offset:0
    ds_read_b32 v10, v4 offset:64
    ds_read_b32 v11, v4 offset:128
    ds_read_b32 v12, v4 offset:192
    ds_read_b128 a[0:3], v2 offset:0
    ds_read_b128 a[4:7], v2 offset:1024
    ds_read_b128 a[8:11], v2 offset:2048
    ds_read_b128 a[12:15], v2 offset:3072
    ds_read_b128 a[16:19], v2 offset:4096
    ds_read_b128 a[20:23], v2 offset:5120
    ds_read_b128 a[24:27], v2 offset:6144
    ds_read_b128 a[28:31], v2 offset:7168
    ds_read_b128 a[32:35], v2 offset:8192
    ds_read_b128 a[36:39], v2 offset:9216
    ds_read_b128 a[40:43], v2 offset:10240
    ds_read_b128 a[44:47], v2 offset:11264
    s_waitcnt vmcnt(44)
    s_waitcnt lgkmcnt(0)
    v_mfma_f32_16x16x32_bf16 v[16:19], v[112:115], a[0:3], 0
    ds_read_b128 a[48:51], v2 offset:12288
    buffer_load_dwordx4 v[208:211], v1, s[12:15], s25 offen offset:0
    v_mfma_f32_16x16x32_bf16 v[16:19], v[116:119], a[16:19], v[16:19]
    ds_read_b128 a[52:55], v2 offset:13312
    v_mfma_f32_16x16x32_bf16 v[16:19], v[120:123], a[32:35], v[16:19]
    s_waitcnt vmcnt(13)
    v_cmp_eq_u64 s[48:49], s[100:101], v[102:103]
    ds_read_b128 a[56:59], v2 offset:14336
    v_mfma_f32_16x16x32_bf16 v[20:23], v[112:115], a[4:7], 0
    buffer_load_dwordx4 v[212:215], v1, s[12:15], s25 offen offset:1024
    ds_read_b128 a[60:63], v2 offset:15360
    v_mfma_f32_16x16x32_bf16 v[20:23], v[116:119], a[20:23], v[20:23]
    v_rsq_f32 v5, v9
    v_mfma_f32_16x16x32_bf16 v[20:23], v[120:123], a[36:39], v[20:23]
    ds_read_b128 a[64:67], v2 offset:16384
    buffer_load_dwordx4 v[216:219], v1, s[12:15], s25 offen offset:2048
    v_mfma_f32_16x16x32_bf16 v[24:27], v[112:115], a[8:11], 0
    ds_read_b128 a[68:71], v2 offset:17408
    v_mfma_f32_16x16x32_bf16 v[24:27], v[116:119], a[24:27], v[24:27]
    ds_read_b128 a[72:75], v2 offset:18432
    v_mfma_f32_16x16x32_bf16 v[24:27], v[120:123], a[40:43], v[24:27]
    ds_read_b128 a[76:79], v2 offset:19456
    v_rsq_f32 v6, v10
    ds_read_b128 a[80:83], v2 offset:20480
    ds_read_b128 a[84:87], v2 offset:21504
    ds_read_b128 a[88:91], v2 offset:22528
    ds_read_b128 a[92:95], v2 offset:23552
    v_mfma_f32_16x16x32_bf16 v[28:31], v[112:115], a[12:15], 0
    v_mfma_f32_16x16x32_bf16 v[28:31], v[116:119], a[28:31], v[28:31]
    v_mfma_f32_16x16x32_bf16 v[28:31], v[120:123], a[44:47], v[28:31]
    s_waitcnt vmcnt(44)
    s_waitcnt lgkmcnt(0)
    v_mfma_f32_16x16x32_bf16 v[16:19], v[124:127], a[48:51], v[16:19]
    buffer_load_dwordx4 v[220:223], v1, s[12:15], s25 offen offset:3072
    s_add_u32 s25, s25, 4096
    v_mfma_f32_16x16x32_bf16 v[16:19], v[128:131], a[64:67], v[16:19]
    buffer_load_dwordx4 v[224:227], v1, s[12:15], s25 offen offset:0
    v_mfma_f32_16x16x32_bf16 v[16:19], v[132:135], a[80:83], v[16:19]
    v_rsq_f32 v7, v11
    ds_read_b128 a[96:99], v2 offset:24576
    v_mfma_f32_16x16x32_bf16 v[20:23], v[124:127], a[52:55], v[20:23]
    ds_read_b128 a[100:103], v2 offset:25600
    v_mfma_f32_16x16x32_bf16 v[20:23], v[128:131], a[68:71], v[20:23]
    buffer_load_dwordx4 v[228:231], v1, s[12:15], s25 offen offset:1024
    ds_read_b128 a[104:107], v2 offset:26624
    v_mfma_f32_16x16x32_bf16 v[20:23], v[132:135], a[84:87], v[20:23]
    v_mfma_f32_16x16x32_bf16 v[24:27], v[124:127], a[56:59], v[24:27]
    ds_read_b128 a[108:111], v2 offset:27648
    v_mfma_f32_16x16x32_bf16 v[24:27], v[128:131], a[72:75], v[24:27]
    buffer_load_dwordx4 v[232:235], v1, s[12:15], s25 offen offset:2048
    ds_read_b128 a[112:115], v2 offset:28672
    v_mfma_f32_16x16x32_bf16 v[24:27], v[132:135], a[88:91], v[24:27]
    v_rsq_f32 v8, v12
    ds_read_b128 a[116:119], v2 offset:29696
    ds_read_b128 a[120:123], v2 offset:30720
    ds_read_b128 a[124:127], v2 offset:31744
    ds_read_b128 a[128:131], v2 offset:32768
    ds_read_b128 a[132:135], v2 offset:33792
    ds_read_b128 a[136:139], v2 offset:34816
    ds_read_b128 a[140:143], v2 offset:35840
    v_mfma_f32_16x16x32_bf16 v[28:31], v[124:127], a[60:63], v[28:31]
    v_mfma_f32_16x16x32_bf16 v[28:31], v[128:131], a[76:79], v[28:31]
    v_mfma_f32_16x16x32_bf16 v[28:31], v[132:135], a[92:95], v[28:31]
    s_waitcnt vmcnt(45)
    s_waitcnt lgkmcnt(0)
    v_mfma_f32_16x16x32_bf16 v[16:19], v[136:139], a[96:99], v[16:19]
    buffer_load_dwordx4 v[236:239], v1, s[12:15], s25 offen offset:3072
    s_add_u32 s25, s25, 4096
    v_mfma_f32_16x16x32_bf16 v[16:19], v[140:143], a[112:115], v[16:19]
    v_sqrt_f32 v9, v9
    v_mfma_f32_16x16x32_bf16 v[16:19], v[144:147], a[128:131], v[16:19]
    buffer_load_dwordx4 v[240:243], v1, s[12:15], s25 offen offset:0
    v_mfma_f32_16x16x32_bf16 v[20:23], v[136:139], a[100:103], v[20:23]
    v_mfma_f32_16x16x32_bf16 v[20:23], v[140:143], a[116:119], v[20:23]
    ds_read_b128 a[144:147], v2 offset:36864
    v_mfma_f32_16x16x32_bf16 v[20:23], v[144:147], a[132:135], v[20:23]
    buffer_load_dwordx4 v[244:247], v1, s[12:15], s25 offen offset:1024
    v_mfma_f32_16x16x32_bf16 v[24:27], v[136:139], a[104:107], v[24:27]
    ds_read_b128 a[148:151], v2 offset:37888
    v_mfma_f32_16x16x32_bf16 v[24:27], v[140:143], a[120:123], v[24:27]
    ds_read_b128 a[152:155], v2 offset:38912
    v_sqrt_f32 v10, v10
    v_mfma_f32_16x16x32_bf16 v[24:27], v[144:147], a[136:139], v[24:27]
    buffer_load_dwordx4 v[248:251], v1, s[12:15], s25 offen offset:2048
    ds_read_b128 a[156:159], v2 offset:39936
    ds_read_b128 a[160:163], v2 offset:40960
    ds_read_b128 a[164:167], v2 offset:41984
    ds_read_b128 a[168:171], v2 offset:43008
    ds_read_b128 a[172:175], v2 offset:44032
    ds_read_b128 a[176:179], v2 offset:45056
    ds_read_b128 a[180:183], v2 offset:46080
    ds_read_b128 a[184:187], v2 offset:47104
    ds_read_b128 a[188:191], v2 offset:48128
    v_mfma_f32_16x16x32_bf16 v[28:31], v[136:139], a[108:111], v[28:31]
    v_mfma_f32_16x16x32_bf16 v[28:31], v[140:143], a[124:127], v[28:31]
    v_mfma_f32_16x16x32_bf16 v[28:31], v[144:147], a[140:143], v[28:31]
    s_waitcnt vmcnt(46)
    s_waitcnt lgkmcnt(0)
    v_mfma_f32_16x16x32_bf16 v[16:19], v[148:151], a[144:147], v[16:19]
    buffer_load_dwordx4 v[252:255], v1, s[12:15], s25 offen offset:3072
    v_mfma_f32_16x16x32_bf16 v[16:19], v[152:155], a[160:163], v[16:19]
    v_sqrt_f32 v11, v11
    v_mfma_f32_16x16x32_bf16 v[16:19], v[156:159], a[176:179], v[16:19]
    s_add_u32 s25, s25, 4096
    v_mfma_f32_16x16x32_bf16 v[20:23], v[148:151], a[148:151], v[20:23]
    buffer_load_dwordx4 v[112:115], v1, s[12:15], s25 offen offset:0
    v_mfma_f32_16x16x32_bf16 v[20:23], v[152:155], a[164:167], v[20:23]
    v_mfma_f32_16x16x32_bf16 v[20:23], v[156:159], a[180:183], v[20:23]
    v_mfma_f32_16x16x32_bf16 v[24:27], v[148:151], a[152:155], v[24:27]
    buffer_load_dwordx4 v[116:119], v1, s[12:15], s25 offen offset:1024
    v_mfma_f32_16x16x32_bf16 v[24:27], v[152:155], a[168:171], v[24:27]
    ds_read_b128 a[192:195], v2 offset:49152
    v_sqrt_f32 v12, v12
    v_mfma_f32_16x16x32_bf16 v[24:27], v[156:159], a[184:187], v[24:27]
    ds_read_b128 a[196:199], v2 offset:50176
    ds_read_b128 a[200:203], v2 offset:51200
    ds_read_b128 a[204:207], v2 offset:52224
    ds_read_b128 a[208:211], v2 offset:53248
    ds_read_b128 a[212:215], v2 offset:54272
    ds_read_b128 a[216:219], v2 offset:55296
    ds_read_b128 a[220:223], v2 offset:56320
    ds_read_b128 a[224:227], v2 offset:57344
    ds_read_b128 a[228:231], v2 offset:58368
    ds_read_b128 a[232:235], v2 offset:59392
    ds_read_b128 a[236:239], v2 offset:60416
    v_mfma_f32_16x16x32_bf16 v[28:31], v[148:151], a[156:159], v[28:31]
    v_mfma_f32_16x16x32_bf16 v[28:31], v[152:155], a[172:175], v[28:31]
    v_mfma_f32_16x16x32_bf16 v[28:31], v[156:159], a[188:191], v[28:31]
    s_waitcnt vmcnt(23)
    s_waitcnt lgkmcnt(0)
    v_mfma_f32_16x16x32_bf16 v[16:19], v[160:163], a[192:195], v[16:19]
    buffer_load_dwordx4 v[120:123], v1, s[12:15], s25 offen offset:2048
    v_mul_f32 v5, s33, v5
    v_mfma_f32_16x16x32_bf16 v[16:19], v[164:167], a[208:211], v[16:19]
    buffer_load_dwordx4 v[124:127], v1, s[12:15], s25 offen offset:3072
    v_mfma_f32_16x16x32_bf16 v[16:19], v[168:171], a[224:227], v[16:19]
    v_mfma_f32_16x16x32_bf16 v[20:23], v[160:163], a[196:199], v[20:23]
    s_add_u32 s25, s25, 4096
    v_mul_f32 v6, s33, v6
    v_mfma_f32_16x16x32_bf16 v[20:23], v[164:167], a[212:215], v[20:23]
    buffer_load_dwordx4 v[128:131], v1, s[12:15], s25 offen offset:0
    v_mfma_f32_16x16x32_bf16 v[20:23], v[168:171], a[228:231], v[20:23]
    v_mfma_f32_16x16x32_bf16 v[24:27], v[160:163], a[200:203], v[24:27]
    v_mul_f32 v7, s33, v7
    v_mfma_f32_16x16x32_bf16 v[24:27], v[164:167], a[216:219], v[24:27]
    buffer_load_dwordx4 v[132:135], v1, s[12:15], s25 offen offset:1024
    v_mfma_f32_16x16x32_bf16 v[24:27], v[168:171], a[232:235], v[24:27]
    ds_read_b128 a[240:243], v2 offset:61440
    ds_read_b128 a[244:247], v2 offset:62464
    ds_read_b128 a[248:251], v2 offset:63488
    ds_read_b128 a[252:255], v2 offset:64512
    ds_read_b128 v[80:83], v3 offset:0
    ds_read_b128 v[84:87], v3 offset:1024
    ds_read_b128 v[88:91], v3 offset:2048
    ds_read_b128 v[92:95], v3 offset:3072
    ds_read_b128 v[96:99], v3 offset:4096
    ds_read_b128 v[100:103], v3 offset:5120
    ds_read_b128 v[104:107], v3 offset:6144
    ds_read_b128 v[108:111], v3 offset:7168
    v_mfma_f32_16x16x32_bf16 v[28:31], v[160:163], a[204:207], v[28:31]
    v_mul_f32 v8, s33, v8
    v_mfma_f32_16x16x32_bf16 v[28:31], v[164:167], a[220:223], v[28:31]
    v_mfma_f32_16x16x32_bf16 v[28:31], v[168:171], a[236:239], v[28:31]
    s_waitcnt vmcnt(24)
    s_waitcnt lgkmcnt(0)
    v_mfma_f32_16x16x32_bf16 v[16:19], v[172:175], a[240:243], v[16:19]
    buffer_load_dwordx4 v[136:139], v1, s[12:15], s25 offen offset:2048
    v_mul_f32 v9, s33, v9
    v_mfma_f32_16x16x32_bf16 v[16:19], v[176:179], v[80:83], v[16:19]
    buffer_load_dwordx4 v[140:143], v1, s[12:15], s25 offen offset:3072
    v_mfma_f32_16x16x32_bf16 v[16:19], v[180:183], v[96:99], v[16:19]
    v_mfma_f32_16x16x32_bf16 v[20:23], v[172:175], a[244:247], v[20:23]
    v_mul_f32 v10, s33, v10
    v_mfma_f32_16x16x32_bf16 v[20:23], v[176:179], v[84:87], v[20:23]
    s_add_u32 s25, s25, 4096
    v_mfma_f32_16x16x32_bf16 v[20:23], v[180:183], v[100:103], v[20:23]
    v_mfma_f32_16x16x32_bf16 v[24:27], v[172:175], a[248:251], v[24:27]
    buffer_load_dwordx4 v[144:147], v1, s[12:15], s25 offen offset:0
    v_mul_f32 v11, s33, v11
    v_mfma_f32_16x16x32_bf16 v[24:27], v[176:179], v[88:91], v[24:27]
    v_mfma_f32_16x16x32_bf16 v[24:27], v[180:183], v[104:107], v[24:27]
    v_mfma_f32_16x16x32_bf16 v[28:31], v[172:175], a[252:255], v[28:31]
    buffer_load_dwordx4 v[148:151], v1, s[12:15], s25 offen offset:1024
    v_mul_f32 v12, s33, v12
    v_mfma_f32_16x16x32_bf16 v[28:31], v[176:179], v[92:95], v[28:31]
    v_mfma_f32_16x16x32_bf16 v[28:31], v[180:183], v[108:111], v[28:31]
    s_waitcnt vmcnt(25)
    v_mfma_f32_16x16x32_bf16 v[32:35], v[184:187], a[0:3], 0
    buffer_load_dwordx4 v[152:155], v1, s[12:15], s25 offen offset:2048
    v_mfma_f32_16x16x32_bf16 v[32:35], v[188:191], a[16:19], v[32:35]
    v_mfma_f32_16x16x32_bf16 v[32:35], v[192:195], a[32:35], v[32:35]
    v_mul_f32 v48, v5, v16
    v_mul_f32 v49, v5, v17
    v_mul_f32 v50, v5, v18
    v_mfma_f32_16x16x32_bf16 v[36:39], v[184:187], a[4:7], 0
    v_mul_f32 v51, v5, v19
    buffer_load_dwordx4 v[156:159], v1, s[12:15], s25 offen offset:3072
    v_mfma_f32_16x16x32_bf16 v[36:39], v[188:191], a[20:23], v[36:39]
    v_exp_f32 v64, v48
    v_mfma_f32_16x16x32_bf16 v[36:39], v[192:195], a[36:39], v[36:39]
    v_exp_f32 v65, v49
    s_add_u32 s25, s25, 4096
    v_mfma_f32_16x16x32_bf16 v[40:43], v[184:187], a[8:11], 0
    v_exp_f32 v66, v50
    v_mfma_f32_16x16x32_bf16 v[40:43], v[188:191], a[24:27], v[40:43]
    buffer_load_dwordx4 v[160:163], v1, s[12:15], s25 offen offset:0
    v_mfma_f32_16x16x32_bf16 v[40:43], v[192:195], a[40:43], v[40:43]
    v_exp_f32 v67, v51
    v_mfma_f32_16x16x32_bf16 v[44:47], v[184:187], a[12:15], 0
    v_fma_f32 v64, v64, v9, v9
    v_fma_f32 v65, v65, v9, v9
    v_mfma_f32_16x16x32_bf16 v[44:47], v[188:191], a[28:31], v[44:47]
    v_fma_f32 v66, v66, v9, v9
    v_mfma_f32_16x16x32_bf16 v[44:47], v[192:195], a[44:47], v[44:47]
    v_fma_f32 v67, v67, v9, v9
    s_waitcnt vmcnt(25)
    v_mfma_f32_16x16x32_bf16 v[32:35], v[196:199], a[48:51], v[32:35]
    buffer_load_dwordx4 v[164:167], v1, s[12:15], s25 offen offset:1024
    v_mfma_f32_16x16x32_bf16 v[32:35], v[200:203], a[64:67], v[32:35]
    v_rcp_f32 v64, v64
    v_mfma_f32_16x16x32_bf16 v[32:35], v[204:207], a[80:83], v[32:35]
    buffer_load_dwordx4 v[168:171], v1, s[12:15], s25 offen offset:2048
    v_mfma_f32_16x16x32_bf16 v[36:39], v[196:199], a[52:55], v[36:39]
    v_rcp_f32 v65, v65
    v_mfma_f32_16x16x32_bf16 v[36:39], v[200:203], a[68:71], v[36:39]
    v_rcp_f32 v66, v66
    v_mfma_f32_16x16x32_bf16 v[36:39], v[204:207], a[84:87], v[36:39]
    buffer_load_dwordx4 v[172:175], v1, s[12:15], s25 offen offset:3072
    v_mfma_f32_16x16x32_bf16 v[40:43], v[196:199], a[56:59], v[40:43]
    v_rcp_f32 v67, v67
    v_mul_f32 v52, v6, v20
    v_mfma_f32_16x16x32_bf16 v[40:43], v[200:203], a[72:75], v[40:43]
    s_add_u32 s25, s25, 4096
    v_mul_f32 v53, v6, v21
    v_mul_f32 v54, v6, v22
    v_mfma_f32_16x16x32_bf16 v[40:43], v[204:207], a[88:91], v[40:43]
    buffer_load_dwordx4 v[176:179], v1, s[12:15], s25 offen offset:0
    v_mul_f32 v55, v6, v23
    v_mfma_f32_16x16x32_bf16 v[44:47], v[196:199], a[60:63], v[44:47]
    v_exp_f32 v68, v52
    v_mfma_f32_16x16x32_bf16 v[44:47], v[200:203], a[76:79], v[44:47]
    v_exp_f32 v69, v53
    v_mfma_f32_16x16x32_bf16 v[44:47], v[204:207], a[92:95], v[44:47]
    s_waitcnt vmcnt(26)
    v_mfma_f32_16x16x32_bf16 v[32:35], v[208:211], a[96:99], v[32:35]
    buffer_load_dwordx4 v[180:183], v1, s[12:15], s25 offen offset:1024
    v_mfma_f32_16x16x32_bf16 v[32:35], v[212:215], a[112:115], v[32:35]
    v_exp_f32 v70, v54
    v_mfma_f32_16x16x32_bf16 v[32:35], v[216:219], a[128:131], v[32:35]
    buffer_load_dwordx4 v[184:187], v1, s[12:15], s25 offen offset:2048
    v_mfma_f32_16x16x32_bf16 v[36:39], v[208:211], a[100:103], v[36:39]
    v_exp_f32 v71, v55
    v_fma_f32 v68, v68, v10, v10
    v_mfma_f32_16x16x32_bf16 v[36:39], v[212:215], a[116:119], v[36:39]
    buffer_load_dwordx4 v[188:191], v1, s[12:15], s25 offen offset:3072
    v_fma_f32 v69, v69, v10, v10
    v_mfma_f32_16x16x32_bf16 v[36:39], v[216:219], a[132:135], v[36:39]
    v_fma_f32 v70, v70, v10, v10
    v_fma_f32 v71, v71, v10, v10
    v_mfma_f32_16x16x32_bf16 v[40:43], v[208:211], a[104:107], v[40:43]
    v_rcp_f32 v68, v68
    s_add_u32 s25, s25, 4096
    v_mfma_f32_16x16x32_bf16 v[40:43], v[212:215], a[120:123], v[40:43]
    v_rcp_f32 v69, v69
    v_mfma_f32_16x16x32_bf16 v[40:43], v[216:219], a[136:139], v[40:43]
    buffer_load_dwordx4 v[192:195], v1, s[12:15], s25 offen offset:0
    v_mfma_f32_16x16x32_bf16 v[44:47], v[208:211], a[108:111], v[44:47]
    v_rcp_f32 v70, v70
    v_mfma_f32_16x16x32_bf16 v[44:47], v[212:215], a[124:127], v[44:47]
    v_rcp_f32 v71, v71
    v_mfma_f32_16x16x32_bf16 v[44:47], v[216:219], a[140:143], v[44:47]
    s_waitcnt vmcnt(27)
    v_mfma_f32_16x16x32_bf16 v[32:35], v[220:223], a[144:147], v[32:35]
    buffer_load_dwordx4 v[196:199], v1, s[12:15], s25 offen offset:1024
    v_mul_f32 v56, v7, v24
    v_mfma_f32_16x16x32_bf16 v[32:35], v[224:227], a[160:163], v[32:35]
    v_mul_f32 v57, v7, v25
    buffer_load_dwordx4 v[200:203], v1, s[12:15], s25 offen offset:2048
    v_mfma_f32_16x16x32_bf16 v[32:35], v[228:231], a[176:179], v[32:35]
    v_mul_f32 v58, v7, v26
    v_mul_f32 v59, v7, v27
    v_mfma_f32_16x16x32_bf16 v[36:39], v[220:223], a[148:151], v[36:39]
    v_exp_f32 v72, v56
    v_mfma_f32_16x16x32_bf16 v[36:39], v[224:227], a[164:167], v[36:39]
    buffer_load_dwordx4 v[204:207], v1, s[12:15], s25 offen offset:3072
    v_mfma_f32_16x16x32_bf16 v[36:39], v[228:231], a[180:183], v[36:39]
    v_exp_f32 v73, v57
    v_mfma_f32_16x16x32_bf16 v[40:43], v[220:223], a[152:155], v[40:43]
    v_exp_f32 v74, v58
    s_add_u32 s25, s25, 4096
    v_mfma_f32_16x16x32_bf16 v[40:43], v[224:227], a[168:171], v[40:43]
    v_exp_f32 v75, v59
    v_mfma_f32_16x16x32_bf16 v[40:43], v[228:231], a[184:187], v[40:43]
    buffer_load_dwordx4 v[208:211], v1, s[12:15], s25 offen offset:0
    v_mfma_f32_16x16x32_bf16 v[44:47], v[220:223], a[156:159], v[44:47]
    v_fma_f32 v72, v72, v11, v11
    v_fma_f32 v73, v73, v11, v11
    v_mfma_f32_16x16x32_bf16 v[44:47], v[224:227], a[172:175], v[44:47]
    v_fma_f32 v74, v74, v11, v11
    v_mfma_f32_16x16x32_bf16 v[44:47], v[228:231], a[188:191], v[44:47]
    v_fma_f32 v75, v75, v11, v11
    s_waitcnt vmcnt(28)
    v_mfma_f32_16x16x32_bf16 v[32:35], v[232:235], a[192:195], v[32:35]
    buffer_load_dwordx4 v[212:215], v1, s[12:15], s25 offen offset:1024
    v_mfma_f32_16x16x32_bf16 v[32:35], v[236:239], a[208:211], v[32:35]
    v_rcp_f32 v72, v72
    v_mfma_f32_16x16x32_bf16 v[32:35], v[240:243], a[224:227], v[32:35]
    v_rcp_f32 v73, v73
    v_mfma_f32_16x16x32_bf16 v[36:39], v[232:235], a[196:199], v[36:39]
    buffer_load_dwordx4 v[216:219], v1, s[12:15], s25 offen offset:2048
    v_mfma_f32_16x16x32_bf16 v[36:39], v[236:239], a[212:215], v[36:39]
    v_rcp_f32 v74, v74
    v_mfma_f32_16x16x32_bf16 v[36:39], v[240:243], a[228:231], v[36:39]
    v_rcp_f32 v75, v75
    v_mfma_f32_16x16x32_bf16 v[40:43], v[232:235], a[200:203], v[40:43]
    buffer_load_dwordx4 v[220:223], v1, s[12:15], s25 offen offset:3072
    v_mul_f32 v60, v8, v28
    v_mfma_f32_16x16x32_bf16 v[40:43], v[236:239], a[216:219], v[40:43]
    v_mul_f32 v61, v8, v29
    s_add_u32 s25, s25, 4096
    v_mul_f32 v62, v8, v30
    v_mfma_f32_16x16x32_bf16 v[40:43], v[240:243], a[232:235], v[40:43]
    v_mul_f32 v63, v8, v31
    buffer_load_dwordx4 v[224:227], v1, s[12:15], s25 offen offset:0
    v_mfma_f32_16x16x32_bf16 v[44:47], v[232:235], a[204:207], v[44:47]
    v_exp_f32 v76, v60
    v_mfma_f32_16x16x32_bf16 v[44:47], v[236:239], a[220:223], v[44:47]
    v_exp_f32 v77, v61
    v_mfma_f32_16x16x32_bf16 v[44:47], v[240:243], a[236:239], v[44:47]
    s_waitcnt vmcnt(29)
    v_mfma_f32_16x16x32_bf16 v[32:35], v[244:247], a[240:243], v[32:35]
    buffer_load_dwordx4 v[228:231], v1, s[12:15], s25 offen offset:1024
    v_mfma_f32_16x16x32_bf16 v[32:35], v[248:251], v[80:83], v[32:35]
    v_exp_f32 v78, v62
    v_mfma_f32_16x16x32_bf16 v[32:35], v[252:255], v[96:99], v[32:35]
    v_exp_f32 v79, v63
    v_mfma_f32_16x16x32_bf16 v[36:39], v[244:247], a[244:247], v[36:39]
    buffer_load_dwordx4 v[232:235], v1, s[12:15], s25 offen offset:2048
    v_fma_f32 v76, v76, v12, v12
    v_mfma_f32_16x16x32_bf16 v[36:39], v[248:251], v[84:87], v[36:39]
    v_fma_f32 v77, v77, v12, v12
    v_fma_f32 v78, v78, v12, v12
    v_mfma_f32_16x16x32_bf16 v[36:39], v[252:255], v[100:103], v[36:39]
    buffer_load_dwordx4 v[236:239], v1, s[12:15], s25 offen offset:3072
    v_fma_f32 v79, v79, v12, v12
    v_mfma_f32_16x16x32_bf16 v[40:43], v[244:247], a[248:251], v[40:43]
    v_rcp_f32 v76, v76
    v_mfma_f32_16x16x32_bf16 v[40:43], v[248:251], v[88:91], v[40:43]
    v_rcp_f32 v77, v77
    s_add_u32 s25, s25, 4096
    v_mfma_f32_16x16x32_bf16 v[40:43], v[252:255], v[104:107], v[40:43]
    v_mfma_f32_16x16x32_bf16 v[44:47], v[244:247], a[252:255], v[44:47]
    v_rcp_f32 v78, v78
    v_mfma_f32_16x16x32_bf16 v[44:47], v[248:251], v[92:95], v[44:47]
    buffer_load_dwordx4 v[240:243], v1, s[12:15], s25 offen offset:0
    v_mfma_f32_16x16x32_bf16 v[44:47], v[252:255], v[108:111], v[44:47]
    v_rcp_f32 v79, v79
    v_add_u32 v2, 73728, v1
    v_add_u32 v3, 139264, v1
L_ffn_gu:
    s_waitcnt vmcnt(30)
    v_mfma_f32_16x16x32_bf16 v[16:19], v[112:115], a[0:3], 0
    buffer_load_dwordx4 v[244:247], v1, s[12:15], s25 offen offset:1024
    v_mfma_f32_16x16x32_bf16 v[16:19], v[116:119], a[16:19], v[16:19]
    v_add_u32 v4, s29, v1
    v_mfma_f32_16x16x32_bf16 v[16:19], v[120:123], a[32:35], v[16:19]
    v_mfma_f32_16x16x32_bf16 v[20:23], v[112:115], a[4:7], 0
    v_mul_f32 v48, v48, v32
    v_mul_f32 v49, v49, v33
    v_mfma_f32_16x16x32_bf16 v[20:23], v[116:119], a[20:23], v[20:23]
    buffer_load_dwordx4 v[248:251], v1, s[12:15], s25 offen offset:2048
    v_mfma_f32_16x16x32_bf16 v[20:23], v[120:123], a[36:39], v[20:23]
    v_mul_f32 v50, v50, v34
    v_mfma_f32_16x16x32_bf16 v[24:27], v[112:115], a[8:11], 0
    v_mul_f32 v51, v51, v35
    v_mfma_f32_16x16x32_bf16 v[24:27], v[116:119], a[24:27], v[24:27]
    buffer_load_dwordx4 v[252:255], v1, s[12:15], s25 offen offset:3072
    v_mfma_f32_16x16x32_bf16 v[24:27], v[120:123], a[40:43], v[24:27]
    v_mul_f32 v48, v48, v64
    v_mfma_f32_16x16x32_bf16 v[28:31], v[112:115], a[12:15], 0
    v_mul_f32 v49, v49, v65
    v_mfma_f32_16x16x32_bf16 v[28:31], v[116:119], a[28:31], v[28:31]
    v_mul_f32 v50, v50, v66
    s_add_u32 s25, s25, 4096
    v_mfma_f32_16x16x32_bf16 v[28:31], v[120:123], a[44:47], v[28:31]
    s_waitcnt vmcnt(30)
    v_mfma_f32_16x16x32_bf16 v[16:19], v[124:127], a[48:51], v[16:19]
    v_mul_f32 v51, v51, v67
    v_mfma_f32_16x16x32_bf16 v[16:19], v[128:131], a[64:67], v[16:19]
    buffer_load_dwordx4 v[112:115], v1, s[12:15], s25 offen offset:0
    v_mfma_f32_16x16x32_bf16 v[16:19], v[132:135], a[80:83], v[16:19]
    v_cvt_pk_bf16_f32 v64, v48, v49
    v_mfma_f32_16x16x32_bf16 v[20:23], v[124:127], a[52:55], v[20:23]
    v_cvt_pk_bf16_f32 v65, v50, v51
    v_mfma_f32_16x16x32_bf16 v[20:23], v[128:131], a[68:71], v[20:23]
    buffer_load_dwordx4 v[116:119], v1, s[12:15], s25 offen offset:1024
    v_mfma_f32_16x16x32_bf16 v[20:23], v[132:135], a[84:87], v[20:23]
    ds_write_b64 v4, v[64:65] offset:0
    v_mfma_f32_16x16x32_bf16 v[24:27], v[124:127], a[56:59], v[24:27]
    v_mul_f32 v52, v52, v36
    v_mfma_f32_16x16x32_bf16 v[24:27], v[128:131], a[72:75], v[24:27]
    v_mul_f32 v53, v53, v37
    v_mfma_f32_16x16x32_bf16 v[24:27], v[132:135], a[88:91], v[24:27]
    buffer_load_dwordx4 v[120:123], v1, s[12:15], s25 offen offset:2048
    v_mfma_f32_16x16x32_bf16 v[28:31], v[124:127], a[60:63], v[28:31]
    v_mul_f32 v54, v54, v38
    v_mfma_f32_16x16x32_bf16 v[28:31], v[128:131], a[76:79], v[28:31]
    v_mul_f32 v55, v55, v39
    v_mfma_f32_16x16x32_bf16 v[28:31], v[132:135], a[92:95], v[28:31]
    s_waitcnt vmcnt(30)
    v_mfma_f32_16x16x32_bf16 v[16:19], v[136:139], a[96:99], v[16:19]
    buffer_load_dwordx4 v[124:127], v1, s[12:15], s25 offen offset:3072
    v_mfma_f32_16x16x32_bf16 v[16:19], v[140:143], a[112:115], v[16:19]
    v_mul_f32 v52, v52, v68
    v_mul_f32 v53, v53, v69
    v_mfma_f32_16x16x32_bf16 v[16:19], v[144:147], a[128:131], v[16:19]
    v_mfma_f32_16x16x32_bf16 v[20:23], v[136:139], a[100:103], v[20:23]
    v_mul_f32 v54, v54, v70
    s_add_u32 s25, s25, 4096
    v_mfma_f32_16x16x32_bf16 v[20:23], v[140:143], a[116:119], v[20:23]
    v_mul_f32 v55, v55, v71
    v_mfma_f32_16x16x32_bf16 v[20:23], v[144:147], a[132:135], v[20:23]
    buffer_load_dwordx4 v[128:131], v1, s[12:15], s25 offen offset:0
    v_mfma_f32_16x16x32_bf16 v[24:27], v[136:139], a[104:107], v[24:27]
    v_cvt_pk_bf16_f32 v68, v52, v53
    v_mfma_f32_16x16x32_bf16 v[24:27], v[140:143], a[120:123], v[24:27]
    v_cvt_pk_bf16_f32 v69, v54, v55
    v_mfma_f32_16x16x32_bf16 v[24:27], v[144:147], a[136:139], v[24:27]
    buffer_load_dwordx4 v[132:135], v1, s[12:15], s25 offen offset:1024
    v_mfma_f32_16x16x32_bf16 v[28:31], v[136:139], a[108:111], v[28:31]
    ds_write_b64 v4, v[68:69] offset:1024
    v_mfma_f32_16x16x32_bf16 v[28:31], v[140:143], a[124:127], v[28:31]
    v_mul_f32 v56, v56, v40
    v_mfma_f32_16x16x32_bf16 v[28:31], v[144:147], a[140:143], v[28:31]
    s_waitcnt vmcnt(30)
    v_mfma_f32_16x16x32_bf16 v[16:19], v[148:151], a[144:147], v[16:19]
    buffer_load_dwordx4 v[136:139], v1, s[12:15], s25 offen offset:2048
    v_mfma_f32_16x16x32_bf16 v[16:19], v[152:155], a[160:163], v[16:19]
    v_mul_f32 v57, v57, v41
    v_mul_f32 v58, v58, v42
    v_mfma_f32_16x16x32_bf16 v[16:19], v[156:159], a[176:179], v[16:19]
    v_mfma_f32_16x16x32_bf16 v[20:23], v[148:151], a[148:151], v[20:23]
    v_mul_f32 v59, v59, v43
    v_mfma_f32_16x16x32_bf16 v[20:23], v[152:155], a[164:167], v[20:23]
    buffer_load_dwordx4 v[140:143], v1, s[12:15], s25 offen offset:3072
    v_mfma_f32_16x16x32_bf16 v[20:23], v[156:159], a[180:183], v[20:23]
    v_mul_f32 v56, v56, v72
    v_mfma_f32_16x16x32_bf16 v[24:27], v[148:151], a[152:155], v[24:27]
    v_mul_f32 v57, v57, v73
    v_mfma_f32_16x16x32_bf16 v[24:27], v[152:155], a[168:171], v[24:27]
    s_add_u32 s25, s25, 4096
    v_mul_f32 v58, v58, v74
    v_mfma_f32_16x16x32_bf16 v[24:27], v[156:159], a[184:187], v[24:27]
    v_mfma_f32_16x16x32_bf16 v[28:31], v[148:151], a[156:159], v[28:31]
    buffer_load_dwordx4 v[144:147], v1, s[12:15], s25 offen offset:0
    v_mfma_f32_16x16x32_bf16 v[28:31], v[152:155], a[172:175], v[28:31]
    v_mul_f32 v59, v59, v75
    v_cvt_pk_bf16_f32 v72, v56, v57
    v_mfma_f32_16x16x32_bf16 v[28:31], v[156:159], a[188:191], v[28:31]
    s_waitcnt vmcnt(30)
    v_mfma_f32_16x16x32_bf16 v[16:19], v[160:163], a[192:195], v[16:19]
    v_cvt_pk_bf16_f32 v73, v58, v59
    v_mfma_f32_16x16x32_bf16 v[16:19], v[164:167], a[208:211], v[16:19]
    buffer_load_dwordx4 v[148:151], v1, s[12:15], s25 offen offset:1024
    v_mfma_f32_16x16x32_bf16 v[16:19], v[168:171], a[224:227], v[16:19]
    ds_write_b64 v4, v[72:73] offset:2048
    v_mfma_f32_16x16x32_bf16 v[20:23], v[160:163], a[196:199], v[20:23]
    v_mul_f32 v60, v60, v44
    v_mfma_f32_16x16x32_bf16 v[20:23], v[164:167], a[212:215], v[20:23]
    buffer_load_dwordx4 v[152:155], v1, s[12:15], s25 offen offset:2048
    v_mfma_f32_16x16x32_bf16 v[20:23], v[168:171], a[228:231], v[20:23]
    v_mul_f32 v61, v61, v45
    v_mfma_f32_16x16x32_bf16 v[24:27], v[160:163], a[200:203], v[24:27]
    v_mul_f32 v62, v62, v46
    v_mfma_f32_16x16x32_bf16 v[24:27], v[164:167], a[216:219], v[24:27]
    v_mul_f32 v63, v63, v47
    v_mfma_f32_16x16x32_bf16 v[24:27], v[168:171], a[232:235], v[24:27]
    buffer_load_dwordx4 v[156:159], v1, s[12:15], s25 offen offset:3072
    v_mfma_f32_16x16x32_bf16 v[28:31], v[160:163], a[204:207], v[28:31]
    v_mul_f32 v60, v60, v76
    v_mfma_f32_16x16x32_bf16 v[28:31], v[164:167], a[220:223], v[28:31]
    v_mul_f32 v61, v61, v77
    v_mfma_f32_16x16x32_bf16 v[28:31], v[168:171], a[236:239], v[28:31]
    s_add_u32 s25, s25, 4096
    s_waitcnt vmcnt(30)
    v_mfma_f32_16x16x32_bf16 v[16:19], v[172:175], a[240:243], v[16:19]
    v_mul_f32 v62, v62, v78
    v_mfma_f32_16x16x32_bf16 v[16:19], v[176:179], v[80:83], v[16:19]
    buffer_load_dwordx4 v[160:163], v1, s[12:15], s25 offen offset:0
    v_mfma_f32_16x16x32_bf16 v[16:19], v[180:183], v[96:99], v[16:19]
    v_mul_f32 v63, v63, v79
    v_mfma_f32_16x16x32_bf16 v[20:23], v[172:175], a[244:247], v[20:23]
    v_cvt_pk_bf16_f32 v76, v60, v61
    v_mfma_f32_16x16x32_bf16 v[20:23], v[176:179], v[84:87], v[20:23]
    v_cvt_pk_bf16_f32 v77, v62, v63
    v_mfma_f32_16x16x32_bf16 v[20:23], v[180:183], v[100:103], v[20:23]
    buffer_load_dwordx4 v[164:167], v1, s[12:15], s25 offen offset:1024
    v_mfma_f32_16x16x32_bf16 v[24:27], v[172:175], a[248:251], v[24:27]
    ds_write_b64 v4, v[76:77] offset:3072
    v_mfma_f32_16x16x32_bf16 v[24:27], v[176:179], v[88:91], v[24:27]
    s_add_u32 s29, s29, s28
    v_mfma_f32_16x16x32_bf16 v[24:27], v[180:183], v[104:107], v[24:27]
    buffer_load_dwordx4 v[168:171], v1, s[12:15], s25 offen offset:2048
    v_mfma_f32_16x16x32_bf16 v[28:31], v[172:175], a[252:255], v[28:31]
    s_sub_u32 s28, 4096, s28
    v_mfma_f32_16x16x32_bf16 v[28:31], v[176:179], v[92:95], v[28:31]
    s_sub_u32 s34, s34, 1
    v_mfma_f32_16x16x32_bf16 v[28:31], v[180:183], v[108:111], v[28:31]
    s_waitcnt vmcnt(30)
    v_mfma_f32_16x16x32_bf16 v[32:35], v[184:187], a[0:3], 0
    buffer_load_dwordx4 v[172:175], v1, s[12:15], s25 offen offset:3072
    v_mfma_f32_16x16x32_bf16 v[32:35], v[188:191], a[16:19], v[32:35]
    v_mfma_f32_16x16x32_bf16 v[32:35], v[192:195], a[32:35], v[32:35]
    v_mul_f32 v48, v5, v16
    v_mul_f32 v49, v5, v17
    v_mfma_f32_16x16x32_bf16 v[36:39], v[184:187], a[4:7], 0
    v_mul_f32 v50, v5, v18
    v_mul_f32 v51, v5, v19
    v_mfma_f32_16x16x32_bf16 v[36:39], v[188:191], a[20:23], v[36:39]
    v_exp_f32 v64, v48
    v_mfma_f32_16x16x32_bf16 v[36:39], v[192:195], a[36:39], v[36:39]
    s_add_u32 s25, s25, 4096
    v_mfma_f32_16x16x32_bf16 v[40:43], v[184:187], a[8:11], 0
    v_exp_f32 v65, v49
    v_mfma_f32_16x16x32_bf16 v[40:43], v[188:191], a[24:27], v[40:43]
    buffer_load_dwordx4 v[176:179], v1, s[12:15], s25 offen offset:0
    v_mfma_f32_16x16x32_bf16 v[40:43], v[192:195], a[40:43], v[40:43]
    v_exp_f32 v66, v50
    v_mfma_f32_16x16x32_bf16 v[44:47], v[184:187], a[12:15], 0
    v_exp_f32 v67, v51
    v_mfma_f32_16x16x32_bf16 v[44:47], v[188:191], a[28:31], v[44:47]
    buffer_load_dwordx4 v[180:183], v1, s[12:15], s25 offen offset:1024
    v_mfma_f32_16x16x32_bf16 v[44:47], v[192:195], a[44:47], v[44:47]
    v_fma_f32 v64, v64, v9, v9
    s_waitcnt vmcnt(30)
    v_mfma_f32_16x16x32_bf16 v[32:35], v[196:199], a[48:51], v[32:35]
    v_fma_f32 v65, v65, v9, v9
    v_fma_f32 v66, v66, v9, v9
    v_mfma_f32_16x16x32_bf16 v[32:35], v[200:203], a[64:67], v[32:35]
    v_fma_f32 v67, v67, v9, v9
    v_mfma_f32_16x16x32_bf16 v[32:35], v[204:207], a[80:83], v[32:35]
    v_rcp_f32 v64, v64
    v_mfma_f32_16x16x32_bf16 v[36:39], v[196:199], a[52:55], v[36:39]
    buffer_load_dwordx4 v[184:187], v1, s[12:15], s25 offen offset:2048
    v_mfma_f32_16x16x32_bf16 v[36:39], v[200:203], a[68:71], v[36:39]
    v_rcp_f32 v65, v65
    v_mfma_f32_16x16x32_bf16 v[36:39], v[204:207], a[84:87], v[36:39]
    v_rcp_f32 v66, v66
    v_mfma_f32_16x16x32_bf16 v[40:43], v[196:199], a[56:59], v[40:43]
    buffer_load_dwordx4 v[188:191], v1, s[12:15], s25 offen offset:3072
    v_mfma_f32_16x16x32_bf16 v[40:43], v[200:203], a[72:75], v[40:43]
    v_rcp_f32 v67, v67
    v_mfma_f32_16x16x32_bf16 v[40:43], v[204:207], a[88:91], v[40:43]
    v_mul_f32 v52, v6, v20
    v_mul_f32 v53, v6, v21
    v_mfma_f32_16x16x32_bf16 v[44:47], v[196:199], a[60:63], v[44:47]
    s_add_u32 s25, s25, 4096
    v_mul_f32 v54, v6, v22
    v_mfma_f32_16x16x32_bf16 v[44:47], v[200:203], a[76:79], v[44:47]
    v_mul_f32 v55, v6, v23
    v_mfma_f32_16x16x32_bf16 v[44:47], v[204:207], a[92:95], v[44:47]
    buffer_load_dwordx4 v[192:195], v1, s[12:15], s25 offen offset:0
    s_waitcnt vmcnt(30)
    v_mfma_f32_16x16x32_bf16 v[32:35], v[208:211], a[96:99], v[32:35]
    v_exp_f32 v68, v52
    v_mfma_f32_16x16x32_bf16 v[32:35], v[212:215], a[112:115], v[32:35]
    v_exp_f32 v69, v53
    v_mfma_f32_16x16x32_bf16 v[32:35], v[216:219], a[128:131], v[32:35]
    v_exp_f32 v70, v54
    v_mfma_f32_16x16x32_bf16 v[36:39], v[208:211], a[100:103], v[36:39]
    buffer_load_dwordx4 v[196:199], v1, s[12:15], s25 offen offset:1024
    v_mfma_f32_16x16x32_bf16 v[36:39], v[212:215], a[116:119], v[36:39]
    v_exp_f32 v71, v55
    v_mfma_f32_16x16x32_bf16 v[36:39], v[216:219], a[132:135], v[36:39]
    v_fma_f32 v68, v68, v10, v10
    v_fma_f32 v69, v69, v10, v10
    v_mfma_f32_16x16x32_bf16 v[40:43], v[208:211], a[104:107], v[40:43]
    buffer_load_dwordx4 v[200:203], v1, s[12:15], s25 offen offset:2048
    v_mfma_f32_16x16x32_bf16 v[40:43], v[212:215], a[120:123], v[40:43]
    v_fma_f32 v70, v70, v10, v10
    v_fma_f32 v71, v71, v10, v10
    v_mfma_f32_16x16x32_bf16 v[40:43], v[216:219], a[136:139], v[40:43]
    v_rcp_f32 v68, v68
    v_mfma_f32_16x16x32_bf16 v[44:47], v[208:211], a[108:111], v[44:47]
    v_rcp_f32 v69, v69
    v_mfma_f32_16x16x32_bf16 v[44:47], v[212:215], a[124:127], v[44:47]
    buffer_load_dwordx4 v[204:207], v1, s[12:15], s25 offen offset:3072
    v_mfma_f32_16x16x32_bf16 v[44:47], v[216:219], a[140:143], v[44:47]
    s_add_u32 s25, s25, 4096
    s_waitcnt vmcnt(30)
    v_mfma_f32_16x16x32_bf16 v[32:35], v[220:223], a[144:147], v[32:35]
    v_rcp_f32 v70, v70
    v_mfma_f32_16x16x32_bf16 v[32:35], v[224:227], a[160:163], v[32:35]
    v_rcp_f32 v71, v71
    v_mfma_f32_16x16x32_bf16 v[32:35], v[228:231], a[176:179], v[32:35]
    v_mul_f32 v56, v7, v24
    v_mul_f32 v57, v7, v25
    v_mfma_f32_16x16x32_bf16 v[36:39], v[220:223], a[148:151], v[36:39]
    buffer_load_dwordx4 v[208:211], v1, s[12:15], s25 offen offset:0
    v_mfma_f32_16x16x32_bf16 v[36:39], v[224:227], a[164:167], v[36:39]
    v_mul_f32 v58, v7, v26
    v_mul_f32 v59, v7, v27
    v_mfma_f32_16x16x32_bf16 v[36:39], v[228:231], a[180:183], v[36:39]
    v_exp_f32 v72, v56
    v_mfma_f32_16x16x32_bf16 v[40:43], v[220:223], a[152:155], v[40:43]
    buffer_load_dwordx4 v[212:215], v1, s[12:15], s25 offen offset:1024
    v_mfma_f32_16x16x32_bf16 v[40:43], v[224:227], a[168:171], v[40:43]
    v_exp_f32 v73, v57
    v_mfma_f32_16x16x32_bf16 v[40:43], v[228:231], a[184:187], v[40:43]
    v_exp_f32 v74, v58
    v_mfma_f32_16x16x32_bf16 v[44:47], v[220:223], a[156:159], v[44:47]
    v_exp_f32 v75, v59
    v_mfma_f32_16x16x32_bf16 v[44:47], v[224:227], a[172:175], v[44:47]
    buffer_load_dwordx4 v[216:219], v1, s[12:15], s25 offen offset:2048
    v_mfma_f32_16x16x32_bf16 v[44:47], v[228:231], a[188:191], v[44:47]
    v_fma_f32 v72, v72, v11, v11
    s_waitcnt vmcnt(30)
    v_mfma_f32_16x16x32_bf16 v[32:35], v[232:235], a[192:195], v[32:35]
    v_fma_f32 v73, v73, v11, v11
    v_fma_f32 v74, v74, v11, v11
    v_mfma_f32_16x16x32_bf16 v[32:35], v[236:239], a[208:211], v[32:35]
    v_fma_f32 v75, v75, v11, v11
    v_mfma_f32_16x16x32_bf16 v[32:35], v[240:243], a[224:227], v[32:35]
    buffer_load_dwordx4 v[220:223], v1, s[12:15], s25 offen offset:3072
    v_mfma_f32_16x16x32_bf16 v[36:39], v[232:235], a[196:199], v[36:39]
    v_rcp_f32 v72, v72
    v_mfma_f32_16x16x32_bf16 v[36:39], v[236:239], a[212:215], v[36:39]
    v_rcp_f32 v73, v73
    v_mfma_f32_16x16x32_bf16 v[36:39], v[240:243], a[228:231], v[36:39]
    s_add_u32 s25, s25, 4096
    v_mfma_f32_16x16x32_bf16 v[40:43], v[232:235], a[200:203], v[40:43]
    v_rcp_f32 v74, v74
    v_mfma_f32_16x16x32_bf16 v[40:43], v[236:239], a[216:219], v[40:43]
    v_rcp_f32 v75, v75
    v_mfma_f32_16x16x32_bf16 v[40:43], v[240:243], a[232:235], v[40:43]
    buffer_load_dwordx4 v[224:227], v1, s[12:15], s25 offen offset:0
    v_mfma_f32_16x16x32_bf16 v[44:47], v[232:235], a[204:207], v[44:47]
    v_mul_f32 v60, v8, v28
    v_mul_f32 v61, v8, v29
    v_mfma_f32_16x16x32_bf16 v[44:47], v[236:239], a[220:223], v[44:47]
    v_mul_f32 v62, v8, v30
    v_mul_f32 v63, v8, v31
    v_mfma_f32_16x16x32_bf16 v[44:47], v[240:243], a[236:239], v[44:47]
    buffer_load_dwordx4 v[228:231], v1, s[12:15], s25 offen offset:1024
    s_waitcnt vmcnt(30)
    v_mfma_f32_16x16x32_bf16 v[32:35], v[244:247], a[240:243], v[32:35]
    v_exp_f32 v76, v60
    v_mfma_f32_16x16x32_bf16 v[32:35], v[248:251], v[80:83], v[32:35]
    v_exp_f32 v77, v61
    v_mfma_f32_16x16x32_bf16 v[32:35], v[252:255], v[96:99], v[32:35]
    buffer_load_dwordx4 v[232:235], v1, s[12:15], s25 offen offset:2048
    v_mfma_f32_16x16x32_bf16 v[36:39], v[244:247], a[244:247], v[36:39]
    v_exp_f32 v78, v62
    v_mfma_f32_16x16x32_bf16 v[36:39], v[248:251], v[84:87], v[36:39]
    v_exp_f32 v79, v63
    v_mfma_f32_16x16x32_bf16 v[36:39], v[252:255], v[100:103], v[36:39]
    v_fma_f32 v76, v76, v12, v12
    v_fma_f32 v77, v77, v12, v12
    v_mfma_f32_16x16x32_bf16 v[40:43], v[244:247], a[248:251], v[40:43]
    buffer_load_dwordx4 v[236:239], v1, s[12:15], s25 offen offset:3072
    v_mfma_f32_16x16x32_bf16 v[40:43], v[248:251], v[88:91], v[40:43]
    v_fma_f32 v78, v78, v12, v12
    v_fma_f32 v79, v79, v12, v12
    v_mfma_f32_16x16x32_bf16 v[40:43], v[252:255], v[104:107], v[40:43]
    v_rcp_f32 v76, v76
    v_mfma_f32_16x16x32_bf16 v[44:47], v[244:247], a[252:255], v[44:47]
    s_add_u32 s25, s25, 4096
    v_mfma_f32_16x16x32_bf16 v[44:47], v[248:251], v[92:95], v[44:47]
    v_rcp_f32 v77, v77
    v_mfma_f32_16x16x32_bf16 v[44:47], v[252:255], v[108:111], v[44:47]
    buffer_load_dwordx4 v[240:243], v1, s[12:15], s25 offen offset:0
    v_rcp_f32 v78, v78
    v_rcp_f32 v79, v79
    s_cmp_lg_u32 s34, 0
    s_cbranch_scc1 L_ffn_gu
    v_mov_b32 v4, v2
    s_cmp_eq_u64 s[48:49], -1
    s_cbranch_scc1 L_pollx_p2
    s_cmp_lg_u32 s50, 0
    s_cbranch_scc1 L_pollx_p2
    s_lshl_b32 s56, s21, 8
    s_add_u32 s56, s56, 63887360
    v_and_b32 v2, 31, v0
    v_min_u32 v2, 26, v2
    v_lshlrev_b32 v2, 3, v2
    s_mov_b32 s57, 300000
    s_add_u32 s56, s56, s51
L_poll_p2:
    buffer_load_dwordx2 v[254:255], v2, s[8:11], s56 offen sc1
    s_sub_u32 s57, s57, 1
    s_waitcnt vmcnt(0)
    v_cmp_eq_u64 vcc, s[100:101], v[254:255]
    s_cmp_eq_u32 s57, 0
    s_cbranch_scc1 L_pollx_p2
    s_cmp_eq_u64 vcc, -1
    s_cbranch_scc0 L_poll_p2
L_pollx_p2:
    v_mov_b32 v2, v4
    s_waitcnt vmcnt(30)
    v_mfma_f32_16x16x32_bf16 v[16:19], v[112:115], a[0:3], 0
    buffer_load_dwordx4 v[244:247], v1, s[12:15], s25 offen offset:1024
    v_mfma_f32_16x16x32_bf16 v[16:19], v[116:119], a[16:19], v[16:19]
    v_add_u32 v4, s29, v1
    v_mfma_f32_16x16x32_bf16 v[16:19], v[120:123], a[32:35], v[16:19]
    v_mfma_f32_16x16x32_bf16 v[20:23], v[112:115], a[4:7], 0
    v_mul_f32 v48, v48, v32
    v_mul_f32 v49, v49, v33
    v_mfma_f32_16x16x32_bf16 v[20:23], v[116:119], a[20:23], v[20:23]
    buffer_load_dwordx4 v[248:251], v1, s[12:15], s25 offen offset:2048
    v_mfma_f32_16x16x32_bf16 v[20:23], v[120:123], a[36:39], v[20:23]
    v_mul_f32 v50, v50, v34
    v_mfma_f32_16x16x32_bf16 v[24:27], v[112:115], a[8:11], 0
    v_mul_f32 v51, v51, v35
    v_mfma_f32_16x16x32_bf16 v[24:27], v[116:119], a[24:27], v[24:27]
    buffer_load_dwordx4 v[252:255], v1, s[12:15], s25 offen offset:3072
    v_mfma_f32_16x16x32_bf16 v[24:27], v[120:123], a[40:43], v[24:27]
    v_mul_f32 v48, v48, v64
    v_mfma_f32_16x16x32_bf16 v[28:31], v[112:115], a[12:15], 0
    v_mul_f32 v49, v49, v65
    v_mfma_f32_16x16x32_bf16 v[28:31], v[116:119], a[28:31], v[28:31]
    s_add_u32 s25, s25, 4096
    v_mfma_f32_16x16x32_bf16 v[28:31], v[120:123], a[44:47], v[28:31]
    v_mul_f32 v50, v50, v66
    s_waitcnt vmcnt(30)
    v_mfma_f32_16x16x32_bf16 v[16:19], v[124:127], a[48:51], v[16:19]
    buffer_load_dwordx4 v[112:115], v1, s[12:15], s25 offen offset:0
    v_mfma_f32_16x16x32_bf16 v[16:19], v[128:131], a[64:67], v[16:19]
    v_mul_f32 v51, v51, v67
    v_mfma_f32_16x16x32_bf16 v[16:19], v[132:135], a[80:83], v[16:19]
    v_cvt_pk_bf16_f32 v64, v48, v49
    v_mfma_f32_16x16x32_bf16 v[20:23], v[124:127], a[52:55], v[20:23]
    v_mfma_f32_16x16x32_bf16 v[20:23], v[128:131], a[68:71], v[20:23]
    v_cvt_pk_bf16_f32 v65, v50, v51
    v_mfma_f32_16x16x32_bf16 v[20:23], v[132:135], a[84:87], v[20:23]
    buffer_load_dwordx4 v[116:119], v1, s[12:15], s25 offen offset:1024
    v_mfma_f32_16x16x32_bf16 v[24:27], v[124:127], a[56:59], v[24:27]
    ds_write_b64 v4, v[64:65] offset:0
    v_mfma_f32_16x16x32_bf16 v[24:27], v[128:131], a[72:75], v[24:27]
    v_mul_f32 v52, v52, v36
    v_mfma_f32_16x16x32_bf16 v[24:27], v[132:135], a[88:91], v[24:27]
    buffer_load_dwordx4 v[120:123], v1, s[12:15], s25 offen offset:2048
    v_mfma_f32_16x16x32_bf16 v[28:31], v[124:127], a[60:63], v[28:31]
    v_mul_f32 v53, v53, v37
    v_mfma_f32_16x16x32_bf16 v[28:31], v[128:131], a[76:79], v[28:31]
    v_mul_f32 v54, v54, v38
    v_mfma_f32_16x16x32_bf16 v[28:31], v[132:135], a[92:95], v[28:31]
    s_waitcnt vmcnt(30)
    v_mfma_f32_16x16x32_bf16 v[16:19], v[136:139], a[96:99], v[16:19]
    buffer_load_dwordx4 v[124:127], v1, s[12:15], s25 offen offset:3072
    v_mfma_f32_16x16x32_bf16 v[16:19], v[140:143], a[112:115], v[16:19]
    v_mul_f32 v55, v55, v39
    v_mul_f32 v52, v52, v68
    v_mfma_f32_16x16x32_bf16 v[16:19], v[144:147], a[128:131], v[16:19]
    v_mfma_f32_16x16x32_bf16 v[20:23], v[136:139], a[100:103], v[20:23]
    s_add_u32 s25, s25, 4096
    v_mul_f32 v53, v53, v69
    v_mfma_f32_16x16x32_bf16 v[20:23], v[140:143], a[116:119], v[20:23]
    v_mul_f32 v54, v54, v70
    v_mfma_f32_16x16x32_bf16 v[20:23], v[144:147], a[132:135], v[20:23]
    buffer_load_dwordx4 v[128:131], v1, s[12:15], s25 offen offset:0
    v_mfma_f32_16x16x32_bf16 v[24:27], v[136:139], a[104:107], v[24:27]
    v_mul_f32 v55, v55, v71
    v_mfma_f32_16x16x32_bf16 v[24:27], v[140:143], a[120:123], v[24:27]
    v_mfma_f32_16x16x32_bf16 v[24:27], v[144:147], a[136:139], v[24:27]
    v_cvt_pk_bf16_f32 v68, v52, v53
    v_mfma_f32_16x16x32_bf16 v[28:31], v[136:139], a[108:111], v[28:31]
    buffer_load_dwordx4 v[132:135], v1, s[12:15], s25 offen offset:1024
    v_mfma_f32_16x16x32_bf16 v[28:31], v[140:143], a[124:127], v[28:31]
    v_cvt_pk_bf16_f32 v69, v54, v55
    v_mfma_f32_16x16x32_bf16 v[28:31], v[144:147], a[140:143], v[28:31]
    ds_write_b64 v4, v[68:69] offset:1024
    s_waitcnt vmcnt(30)
    v_mfma_f32_16x16x32_bf16 v[16:19], v[148:151], a[144:147], v[16:19]
    buffer_load_dwordx4 v[136:139], v1, s[12:15], s25 offen offset:2048
    v_mfma_f32_16x16x32_bf16 v[16:19], v[152:155], a[160:163], v[16:19]
    v_mul_f32 v56, v56, v40
    v_mfma_f32_16x16x32_bf16 v[16:19], v[156:159], a[176:179], v[16:19]
    v_mul_f32 v57, v57, v41
    v_mfma_f32_16x16x32_bf16 v[20:23], v[148:151], a[148:151], v[20:23]
    buffer_load_dwordx4 v[140:143], v1, s[12:15], s25 offen offset:3072
    v_mfma_f32_16x16x32_bf16 v[20:23], v[152:155], a[164:167], v[20:23]
    v_mul_f32 v58, v58, v42
    v_mfma_f32_16x16x32_bf16 v[20:23], v[156:159], a[180:183], v[20:23]
    v_mul_f32 v59, v59, v43
    v_mfma_f32_16x16x32_bf16 v[24:27], v[148:151], a[152:155], v[24:27]
    v_mfma_f32_16x16x32_bf16 v[24:27], v[152:155], a[168:171], v[24:27]
    v_mul_f32 v56, v56, v72
    s_add_u32 s25, s25, 4096
    v_mfma_f32_16x16x32_bf16 v[24:27], v[156:159], a[184:187], v[24:27]
    v_mul_f32 v57, v57, v73
    v_mfma_f32_16x16x32_bf16 v[28:31], v[148:151], a[156:159], v[28:31]
    buffer_load_dwordx4 v[144:147], v1, s[12:15], s25 offen offset:0
    v_mfma_f32_16x16x32_bf16 v[28:31], v[152:155], a[172:175], v[28:31]
    v_mul_f32 v58, v58, v74
    v_mfma_f32_16x16x32_bf16 v[28:31], v[156:159], a[188:191], v[28:31]
    s_waitcnt vmcnt(30)
    v_mfma_f32_16x16x32_bf16 v[16:19], v[160:163], a[192:195], v[16:19]
    v_mul_f32 v59, v59, v75
    v_mfma_f32_16x16x32_bf16 v[16:19], v[164:167], a[208:211], v[16:19]
    buffer_load_dwordx4 v[148:151], v1, s[12:15], s25 offen offset:1024
    v_mfma_f32_16x16x32_bf16 v[16:19], v[168:171], a[224:227], v[16:19]
    v_cvt_pk_bf16_f32 v72, v56, v57
    v_mfma_f32_16x16x32_bf16 v[20:23], v[160:163], a[196:199], v[20:23]
    v_cvt_pk_bf16_f32 v73, v58, v59
    v_mfma_f32_16x16x32_bf16 v[20:23], v[164:167], a[212:215], v[20:23]
    buffer_load_dwordx4 v[152:155], v1, s[12:15], s25 offen offset:2048
    v_mfma_f32_16x16x32_bf16 v[20:23], v[168:171], a[228:231], v[20:23]
    ds_write_b64 v4, v[72:73] offset:2048
    v_mfma_f32_16x16x32_bf16 v[24:27], v[160:163], a[200:203], v[24:27]
    v_mul_f32 v60, v60, v44
    v_mfma_f32_16x16x32_bf16 v[24:27], v[164:167], a[216:219], v[24:27]
    buffer_load_dwordx4 v[156:159], v1, s[12:15], s25 offen offset:3072
    v_mfma_f32_16x16x32_bf16 v[24:27], v[168:171], a[232:235], v[24:27]
    v_mul_f32 v61, v61, v45
    v_mfma_f32_16x16x32_bf16 v[28:31], v[160:163], a[204:207], v[28:31]
    v_mul_f32 v62, v62, v46
    v_mfma_f32_16x16x32_bf16 v[28:31], v[164:167], a[220:223], v[28:31]
    v_mfma_f32_16x16x32_bf16 v[28:31], v[168:171], a[236:239], v[28:31]
    v_mul_f32 v63, v63, v47
    s_add_u32 s25, s25, 4096
    s_waitcnt vmcnt(30)
    v_mfma_f32_16x16x32_bf16 v[16:19], v[172:175], a[240:243], v[16:19]
    v_mul_f32 v60, v60, v76
    v_mfma_f32_16x16x32_bf16 v[16:19], v[176:179], v[80:83], v[16:19]
    buffer_load_dwordx4 v[160:163], v1, s[12:15], s25 offen offset:0
    v_mfma_f32_16x16x32_bf16 v[16:19], v[180:183], v[96:99], v[16:19]
    v_mul_f32 v61, v61, v77
    v_mfma_f32_16x16x32_bf16 v[20:23], v[172:175], a[244:247], v[20:23]
    v_mfma_f32_16x16x32_bf16 v[20:23], v[176:179], v[84:87], v[20:23]
    v_mul_f32 v62, v62, v78
    v_mfma_f32_16x16x32_bf16 v[20:23], v[180:183], v[100:103], v[20:23]
    buffer_load_dwordx4 v[164:167], v1, s[12:15], s25 offen offset:1024
    v_mfma_f32_16x16x32_bf16 v[24:27], v[172:175], a[248:251], v[24:27]
    v_mul_f32 v63, v63, v79
    v_mfma_f32_16x16x32_bf16 v[24:27], v[176:179], v[88:91], v[24:27]
    v_cvt_pk_bf16_f32 v76, v60, v61
    v_mfma_f32_16x16x32_bf16 v[24:27], v[180:183], v[104:107], v[24:27]
    buffer_load_dwordx4 v[168:171], v1, s[12:15], s25 offen offset:2048
    v_mfma_f32_16x16x32_bf16 v[28:31], v[172:175], a[252:255], v[28:31]
    v_cvt_pk_bf16_f32 v77, v62, v63
    v_mfma_f32_16x16x32_bf16 v[28:31], v[176:179], v[92:95], v[28:31]
    ds_write_b64 v4, v[76:77] offset:3072
    v_mfma_f32_16x16x32_bf16 v[28:31], v[180:183], v[108:111], v[28:31]
    s_waitcnt lgkmcnt(0)
    s_barrier
    s_waitcnt vmcnt(30)
    v_mfma_f32_16x16x32_bf16 v[32:35], v[184:187], a[0:3], 0
    buffer_load_dwordx4 v[172:175], v1, s[12:15], s25 offen offset:3072
    v_mfma_f32_16x16x32_bf16 v[32:35], v[188:191], a[16:19], v[32:35]
    v_mfma_f32_16x16x32_bf16 v[32:35], v[192:195], a[32:35], v[32:35]
    v_mul_f32 v48, v5, v16
    v_mul_f32 v49, v5, v17
    v_mul_f32 v50, v5, v18
    v_mfma_f32_16x16x32_bf16 v[36:39], v[184:187], a[4:7], 0
    v_mul_f32 v51, v5, v19
    v_exp_f32 v64, v48
    v_mfma_f32_16x16x32_bf16 v[36:39], v[188:191], a[20:23], v[36:39]
    s_add_u32 s25, s25, 4096
    v_exp_f32 v65, v49
    v_mfma_f32_16x16x32_bf16 v[36:39], v[192:195], a[36:39], v[36:39]
    buffer_load_dwordx4 v[176:179], v1, s[12:15], s25 offen offset:0
    v_mfma_f32_16x16x32_bf16 v[40:43], v[184:187], a[8:11], 0
    v_exp_f32 v66, v50
    v_mfma_f32_16x16x32_bf16 v[40:43], v[188:191], a[24:27], v[40:43]
    v_exp_f32 v67, v51
    v_mfma_f32_16x16x32_bf16 v[40:43], v[192:195], a[40:43], v[40:43]
    buffer_load_dwordx4 v[180:183], v1, s[12:15], s25 offen offset:1024
    v_mfma_f32_16x16x32_bf16 v[44:47], v[184:187], a[12:15], 0
    v_fma_f32 v64, v64, v9, v9
    v_fma_f32 v65, v65, v9, v9
    v_mfma_f32_16x16x32_bf16 v[44:47], v[188:191], a[28:31], v[44:47]
    v_fma_f32 v66, v66, v9, v9
    v_mfma_f32_16x16x32_bf16 v[44:47], v[192:195], a[44:47], v[44:47]
    v_fma_f32 v67, v67, v9, v9
    s_waitcnt vmcnt(30)
    v_mfma_f32_16x16x32_bf16 v[32:35], v[196:199], a[48:51], v[32:35]
    ds_read_b128 a[0:3], v2 offset:0
    ds_read_b128 a[4:7], v2 offset:1024
    ds_read_b128 a[8:11], v2 offset:2048
    v_mfma_f32_16x16x32_bf16 v[32:35], v[200:203], a[64:67], v[32:35]
    ds_read_b128 a[12:15], v2 offset:3072
    ds_read_b128 a[16:19], v2 offset:4096
    ds_read_b128 a[20:23], v2 offset:5120
    v_mfma_f32_16x16x32_bf16 v[32:35], v[204:207], a[80:83], v[32:35]
    ds_read_b128 a[24:27], v2 offset:6144
    ds_read_b128 a[28:31], v2 offset:7168
    ds_read_b128 a[32:35], v2 offset:8192
    v_mfma_f32_16x16x32_bf16 v[36:39], v[196:199], a[52:55], v[36:39]
    ds_read_b128 a[36:39], v2 offset:9216
    v_rcp_f32 v64, v64
    v_mfma_f32_16x16x32_bf16 v[36:39], v[200:203], a[68:71], v[36:39]
    ds_read_b128 a[40:43], v2 offset:10240
    buffer_load_dwordx4 v[184:187], v1, s[12:15], s25 offen offset:2048
    v_mfma_f32_16x16x32_bf16 v[36:39], v[204:207], a[84:87], v[36:39]
    ds_read_b128 a[44:47], v2 offset:11264
    v_rcp_f32 v65, v65
    v_mfma_f32_16x16x32_bf16 v[40:43], v[196:199], a[56:59], v[40:43]
    v_rcp_f32 v66, v66
    v_mfma_f32_16x16x32_bf16 v[40:43], v[200:203], a[72:75], v[40:43]
    buffer_load_dwordx4 v[188:191], v1, s[12:15], s25 offen offset:3072
    s_add_u32 s25, s25, 4096
    v_mfma_f32_16x16x32_bf16 v[40:43], v[204:207], a[88:91], v[40:43]
    v_rcp_f32 v67, v67
    v_mul_f32 v52, v6, v20
    v_mfma_f32_16x16x32_bf16 v[44:47], v[196:199], a[60:63], v[44:47]
    v_mul_f32 v53, v6, v21
    v_mul_f32 v54, v6, v22
    v_mul_f32 v55, v6, v23
    v_mfma_f32_16x16x32_bf16 v[44:47], v[200:203], a[76:79], v[44:47]
    v_exp_f32 v68, v52
    v_mfma_f32_16x16x32_bf16 v[44:47], v[204:207], a[92:95], v[44:47]
    buffer_load_dwordx4 v[192:195], v1, s[12:15], s25 offen offset:0
    s_waitcnt vmcnt(30)
    v_mfma_f32_16x16x32_bf16 v[32:35], v[208:211], a[96:99], v[32:35]
    ds_read_b128 a[48:51], v2 offset:12288
    ds_read_b128 a[52:55], v2 offset:13312
    ds_read_b128 a[56:59], v2 offset:14336
    v_mfma_f32_16x16x32_bf16 v[32:35], v[212:215], a[112:115], v[32:35]
    ds_read_b128 a[60:63], v2 offset:15360
    ds_read_b128 a[64:67], v2 offset:16384
    ds_read_b128 a[68:71], v2 offset:17408
    v_mfma_f32_16x16x32_bf16 v[32:35], v[216:219], a[128:131], v[32:35]
    ds_read_b128 a[72:75], v2 offset:18432
    v_exp_f32 v69, v53
    v_mfma_f32_16x16x32_bf16 v[36:39], v[208:211], a[100:103], v[36:39]
    ds_read_b128 a[76:79], v2 offset:19456
    v_exp_f32 v70, v54
    v_mfma_f32_16x16x32_bf16 v[36:39], v[212:215], a[116:119], v[36:39]
    ds_read_b128 a[80:83], v2 offset:20480
    buffer_load_dwordx4 v[196:199], v1, s[12:15], s25 offen offset:1024
    v_mfma_f32_16x16x32_bf16 v[36:39], v[216:219], a[132:135], v[36:39]
    ds_read_b128 a[84:87], v2 offset:21504
    v_exp_f32 v71, v55
    v_mfma_f32_16x16x32_bf16 v[40:43], v[208:211], a[104:107], v[40:43]
    ds_read_b128 a[88:91], v2 offset:22528
    v_fma_f32 v68, v68, v10, v10
    ds_read_b128 a[92:95], v2 offset:23552
    v_mfma_f32_16x16x32_bf16 v[40:43], v[212:215], a[120:123], v[40:43]
    v_fma_f32 v69, v69, v10, v10
    buffer_load_dwordx4 v[200:203], v1, s[12:15], s25 offen offset:2048
    v_mfma_f32_16x16x32_bf16 v[40:43], v[216:219], a[136:139], v[40:43]
    v_fma_f32 v70, v70, v10, v10
    v_fma_f32 v71, v71, v10, v10
    v_mfma_f32_16x16x32_bf16 v[44:47], v[208:211], a[108:111], v[44:47]
    v_rcp_f32 v68, v68
    v_mfma_f32_16x16x32_bf16 v[44:47], v[212:215], a[124:127], v[44:47]
    v_rcp_f32 v69, v69
    v_mfma_f32_16x16x32_bf16 v[44:47], v[216:219], a[140:143], v[44:47]
    buffer_load_dwordx4 v[204:207], v1, s[12:15], s25 offen offset:3072
    s_add_u32 s25, s25, 4096
    s_waitcnt vmcnt(30)
    v_mfma_f32_16x16x32_bf16 v[32:35], v[220:223], a[144:147], v[32:35]
    ds_read_b128 a[96:99], v2 offset:24576
    ds_read_b128 a[100:103], v2 offset:25600
    ds_read_b128 a[104:107], v2 offset:26624
    v_mfma_f32_16x16x32_bf16 v[32:35], v[224:227], a[160:163], v[32:35]
    ds_read_b128 a[108:111], v2 offset:27648
    v_rcp_f32 v70, v70
    v_mfma_f32_16x16x32_bf16 v[32:35], v[228:231], a[176:179], v[32:35]
    ds_read_b128 a[112:115], v2 offset:28672
    v_rcp_f32 v71, v71
    v_mfma_f32_16x16x32_bf16 v[36:39], v[220:223], a[148:151], v[36:39]
    ds_read_b128 a[116:119], v2 offset:29696
    ds_read_b128 a[120:123], v2 offset:30720
    v_mul_f32 v56, v7, v24
    v_mfma_f32_16x16x32_bf16 v[36:39], v[224:227], a[164:167], v[36:39]
    v_mul_f32 v57, v7, v25
    buffer_load_dwordx4 v[208:211], v1, s[12:15], s25 offen offset:0
    v_mfma_f32_16x16x32_bf16 v[36:39], v[228:231], a[180:183], v[36:39]
    ds_read_b128 a[124:127], v2 offset:31744
    v_mul_f32 v58, v7, v26
    v_mul_f32 v59, v7, v27
    v_mfma_f32_16x16x32_bf16 v[40:43], v[220:223], a[152:155], v[40:43]
    ds_read_b128 a[128:131], v2 offset:32768
    v_exp_f32 v72, v56
    v_mfma_f32_16x16x32_bf16 v[40:43], v[224:227], a[168:171], v[40:43]
    ds_read_b128 a[132:135], v2 offset:33792
    buffer_load_dwordx4 v[212:215], v1, s[12:15], s25 offen offset:1024
    v_mfma_f32_16x16x32_bf16 v[40:43], v[228:231], a[184:187], v[40:43]
    v_exp_f32 v73, v57
    ds_read_b128 a[136:139], v2 offset:34816
    v_mfma_f32_16x16x32_bf16 v[44:47], v[220:223], a[156:159], v[44:47]
    v_exp_f32 v74, v58
    ds_read_b128 a[140:143], v2 offset:35840
    v_mfma_f32_16x16x32_bf16 v[44:47], v[224:227], a[172:175], v[44:47]
    v_exp_f32 v75, v59
    v_fma_f32 v72, v72, v11, v11
    v_mfma_f32_16x16x32_bf16 v[44:47], v[228:231], a[188:191], v[44:47]
    buffer_load_dwordx4 v[216:219], v1, s[12:15], s25 offen offset:2048
    s_waitcnt vmcnt(30)
    v_mfma_f32_16x16x32_bf16 v[32:35], v[232:235], a[192:195], v[32:35]
    ds_read_b128 a[144:147], v2 offset:36864
    ds_read_b128 a[148:151], v2 offset:37888
    ds_read_b128 a[152:155], v2 offset:38912
    v_mfma_f32_16x16x32_bf16 v[32:35], v[236:239], a[208:211], v[32:35]
    v_fma_f32 v73, v73, v11, v11
    v_fma_f32 v74, v74, v11, v11
    ds_read_b128 a[156:159], v2 offset:39936
    v_mfma_f32_16x16x32_bf16 v[32:35], v[240:243], a[224:227], v[32:35]
    v_fma_f32 v75, v75, v11, v11
    buffer_load_dwordx4 v[220:223], v1, s[12:15], s25 offen offset:3072
    v_mfma_f32_16x16x32_bf16 v[36:39], v[232:235], a[196:199], v[36:39]
    ds_read_b128 a[160:163], v2 offset:40960
    v_rcp_f32 v72, v72
    v_mfma_f32_16x16x32_bf16 v[36:39], v[236:239], a[212:215], v[36:39]
    ds_read_b128 a[164:167], v2 offset:41984
    v_rcp_f32 v73, v73
    v_mfma_f32_16x16x32_bf16 v[36:39], v[240:243], a[228:231], v[36:39]
    ds_read_b128 a[168:171], v2 offset:43008
    s_add_u32 s25, s25, 4096
    ds_read_b128 a[172:175], v2 offset:44032
    v_mfma_f32_16x16x32_bf16 v[40:43], v[232:235], a[200:203], v[40:43]
    v_rcp_f32 v74, v74
    ds_read_b128 a[176:179], v2 offset:45056
    v_mfma_f32_16x16x32_bf16 v[40:43], v[236:239], a[216:219], v[40:43]
    v_rcp_f32 v75, v75
    v_mul_f32 v60, v8, v28
    v_mfma_f32_16x16x32_bf16 v[40:43], v[240:243], a[232:235], v[40:43]
    buffer_load_dwordx4 v[224:227], v1, s[12:15], s25 offen offset:0
    ds_read_b128 a[180:183], v2 offset:46080
    v_mfma_f32_16x16x32_bf16 v[44:47], v[232:235], a[204:207], v[44:47]
    v_mul_f32 v61, v8, v29
    ds_read_b128 a[184:187], v2 offset:47104
    v_mul_f32 v62, v8, v30
    v_mfma_f32_16x16x32_bf16 v[44:47], v[236:239], a[220:223], v[44:47]
    buffer_load_dwordx4 v[228:231], v1, s[12:15], s25 offen offset:1024
    v_mul_f32 v63, v8, v31
    v_mfma_f32_16x16x32_bf16 v[44:47], v[240:243], a[236:239], v[44:47]
    ds_read_b128 a[188:191], v2 offset:48128
    s_waitcnt vmcnt(30)
    v_mfma_f32_16x16x32_bf16 v[32:35], v[244:247], a[240:243], v[32:35]
    v_exp_f32 v76, v60
    ds_read_b128 a[192:195], v2 offset:49152
    v_mfma_f32_16x16x32_bf16 v[32:35], v[248:251], v[80:83], v[32:35]
    v_exp_f32 v77, v61
    ds_read_b128 a[196:199], v2 offset:50176
    v_mfma_f32_16x16x32_bf16 v[32:35], v[252:255], v[96:99], v[32:35]
    buffer_load_dwordx4 v[232:235], v1, s[12:15], s25 offen offset:2048
    ds_read_b128 a[200:203], v2 offset:51200
    v_mfma_f32_16x16x32_bf16 v[36:39], v[244:247], a[244:247], v[36:39]
    v_exp_f32 v78, v62
    ds_read_b128 a[204:207], v2 offset:52224
    v_mfma_f32_16x16x32_bf16 v[36:39], v[248:251], v[84:87], v[36:39]
    v_exp_f32 v79, v63
    ds_read_b128 a[208:211], v2 offset:53248
    v_mfma_f32_16x16x32_bf16 v[36:39], v[252:255], v[100:103], v[36:39]
    v_fma_f32 v76, v76, v12, v12
    buffer_load_dwordx4 v[236:239], v1, s[12:15], s25 offen offset:3072
    v_mfma_f32_16x16x32_bf16 v[40:43], v[244:247], a[248:251], v[40:43]
    ds_read_b128 a[212:215], v2 offset:54272
    v_fma_f32 v77, v77, v12, v12
    v_fma_f32 v78, v78, v12, v12
    v_mfma_f32_16x16x32_bf16 v[40:43], v[248:251], v[88:91], v[40:43]
    ds_read_b128 a[216:219], v2 offset:55296
    v_fma_f32 v79, v79, v12, v12
    ds_read_b128 a[220:223], v2 offset:56320
    v_mfma_f32_16x16x32_bf16 v[40:43], v[252:255], v[104:107], v[40:43]
    v_rcp_f32 v76, v76
    s_add_u32 s25, s25, 4096
    v_mfma_f32_16x16x32_bf16 v[44:47], v[244:247], a[252:255], v[44:47]
    ds_read_b128 a[224:227], v2 offset:57344
    v_rcp_f32 v77, v77
    v_mfma_f32_16x16x32_bf16 v[44:47], v[248:251], v[92:95], v[44:47]
    ds_read_b128 a[228:231], v2 offset:58368
    buffer_load_dwordx4 v[240:243], v1, s[12:15], s25 offen offset:0
    v_mfma_f32_16x16x32_bf16 v[44:47], v[252:255], v[108:111], v[44:47]
    v_rcp_f32 v78, v78
    ds_read_b128 a[232:235], v2 offset:59392
    v_rcp_f32 v79, v79
    ds_read_b128 a[236:239], v2 offset:60416
    s_lshr_b32 s29, s20, 1
    s_lshl_b32 s29, s29, 12
    s_and_b32 s35, s20, 1
    s_lshl_b32 s36, s35, 3
    s_add_u32 s29, s29, s36
    v_add_u32 v9, s29, v1
    s_add_u32 s29, s29, 139264
    s_lshl_b32 s41, s20, 11
    v_add_u32 v10, s41, v1
    s_lshl_b32 s37, s21, 7
    s_lshl_b32 s38, s22, 2
    s_add_u32 s37, s37, s38
    s_mul_i32 s37, s37, 18432
    s_add_u32 s37, s37, 16515072
    s_lshr_b32 s39, s20, 1
    s_add_u32 s39, s39, 16
    s_lshl_b32 s39, s39, 10
    s_mul_i32 s40, s35, 36864
    s_add_u32 s39, s39, s40
    s_add_u32 s39, s39, s37
    s_lshl_b32 s38, s20, 10
    s_add_u32 s38, s38, s37
    s_lshl_b32 s56, s22, 7
    s_lshl_b32 s27, s21, 3
    s_add_u32 s56, s56, s27
    s_add_u32 s56, s56, 63881216
    v_add_u32 v5, 0, v1
    v_add_u32 v6, 18432, v1
    v_add_u32 v7, 36864, v1
    v_add_u32 v8, 55296, v1
    s_lshr_b32 s44, s21, 1
    s_lshl_b32 s45, s35, 1
    s_sub_u32 s45, s44, s45
    s_sub_u32 s30, s38, s37
    s_add_u32 s30, s30, 133120
    v_add_u32 v11, s30, v1
    s_sub_u32 s30, s39, s37
    s_sub_u32 s30, s30, s40
    s_add_u32 s30, s30, 133120
    v_add_u32 v12, s30, v1
    s_waitcnt vmcnt(30)
    s_waitcnt lgkmcnt(15)
    v_mfma_f32_16x16x32_bf16 v[16:19], v[112:115], a[0:3], 0
    buffer_load_dwordx4 v[244:247], v1, s[12:15], s25 offen offset:1024
    v_mfma_f32_16x16x32_bf16 v[16:19], v[116:119], a[16:19], v[16:19]
    v_add_u32 v4, s29, v1
    v_mfma_f32_16x16x32_bf16 v[16:19], v[120:123], a[32:35], v[16:19]
    v_mfma_f32_16x16x32_bf16 v[20:23], v[112:115], a[4:7], 0
    v_mul_f32 v48, v48, v32
    v_mul_f32 v49, v49, v33
    v_mfma_f32_16x16x32_bf16 v[20:23], v[116:119], a[20:23], v[20:23]
    buffer_load_dwordx4 v[248:251], v1, s[12:15], s25 offen offset:2048
    v_mfma_f32_16x16x32_bf16 v[20:23], v[120:123], a[36:39], v[20:23]
    v_mul_f32 v50, v50, v34
    v_mfma_f32_16x16x32_bf16 v[24:27], v[112:115], a[8:11], 0
    v_mul_f32 v51, v51, v35
    v_mfma_f32_16x16x32_bf16 v[24:27], v[116:119], a[24:27], v[24:27]
    buffer_load_dwordx4 v[252:255], v1, s[12:15], s25 offen offset:3072
    v_mfma_f32_16x16x32_bf16 v[24:27], v[120:123], a[40:43], v[24:27]
    v_mul_f32 v48, v48, v64
    v_mfma_f32_16x16x32_bf16 v[28:31], v[112:115], a[12:15], 0
    v_mul_f32 v49, v49, v65
    v_mfma_f32_16x16x32_bf16 v[28:31], v[116:119], a[28:31], v[28:31]
    s_add_u32 s25, s25, 4096
    v_mfma_f32_16x16x32_bf16 v[28:31], v[120:123], a[44:47], v[28:31]
    v_mul_f32 v50, v50, v66
    s_waitcnt vmcnt(30)
    v_mfma_f32_16x16x32_bf16 v[16:19], v[124:127], a[48:51], v[16:19]
    buffer_load_dwordx4 v[112:115], v1, s[12:15], s25 offen offset:0
    v_mfma_f32_16x16x32_bf16 v[16:19], v[128:131], a[64:67], v[16:19]
    v_mul_f32 v51, v51, v67
    v_mfma_f32_16x16x32_bf16 v[16:19], v[132:135], a[80:83], v[16:19]
    v_cvt_pk_bf16_f32 v64, v48, v49
    v_mfma_f32_16x16x32_bf16 v[20:23], v[124:127], a[52:55], v[20:23]
    v_mfma_f32_16x16x32_bf16 v[20:23], v[128:131], a[68:71], v[20:23]
    v_cvt_pk_bf16_f32 v65, v50, v51
    v_mfma_f32_16x16x32_bf16 v[20:23], v[132:135], a[84:87], v[20:23]
    buffer_load_dwordx4 v[116:119], v1, s[12:15], s25 offen offset:1024
    v_mfma_f32_16x16x32_bf16 v[24:27], v[124:127], a[56:59], v[24:27]
    ds_write_b64 v4, v[64:65] offset:0
    v_mfma_f32_16x16x32_bf16 v[24:27], v[128:131], a[72:75], v[24:27]
    v_mul_f32 v52, v52, v36
    v_mfma_f32_16x16x32_bf16 v[24:27], v[132:135], a[88:91], v[24:27]
    buffer_load_dwordx4 v[120:123], v1, s[12:15], s25 offen offset:2048
    v_mfma_f32_16x16x32_bf16 v[28:31], v[124:127], a[60:63], v[28:31]
    v_mul_f32 v53, v53, v37
    v_mfma_f32_16x16x32_bf16 v[28:31], v[128:131], a[76:79], v[28:31]
    v_mul_f32 v54, v54, v38
    v_mfma_f32_16x16x32_bf16 v[28:31], v[132:135], a[92:95], v[28:31]
    s_waitcnt vmcnt(30)
    v_mfma_f32_16x16x32_bf16 v[16:19], v[136:139], a[96:99], v[16:19]
    buffer_load_dwordx4 v[124:127], v1, s[12:15], s25 offen offset:3072
    v_mfma_f32_16x16x32_bf16 v[16:19], v[140:143], a[112:115], v[16:19]
    v_mul_f32 v55, v55, v39
    v_mul_f32 v52, v52, v68
    v_mfma_f32_16x16x32_bf16 v[16:19], v[144:147], a[128:131], v[16:19]
    v_mfma_f32_16x16x32_bf16 v[20:23], v[136:139], a[100:103], v[20:23]
    s_add_u32 s25, s25, 4096
    v_mul_f32 v53, v53, v69
    v_mfma_f32_16x16x32_bf16 v[20:23], v[140:143], a[116:119], v[20:23]
    v_mul_f32 v54, v54, v70
    v_mfma_f32_16x16x32_bf16 v[20:23], v[144:147], a[132:135], v[20:23]
    buffer_load_dwordx4 v[128:131], v1, s[12:15], s25 offen offset:0
    v_mfma_f32_16x16x32_bf16 v[24:27], v[136:139], a[104:107], v[24:27]
    v_mul_f32 v55, v55, v71
    v_mfma_f32_16x16x32_bf16 v[24:27], v[140:143], a[120:123], v[24:27]
    v_mfma_f32_16x16x32_bf16 v[24:27], v[144:147], a[136:139], v[24:27]
    v_cvt_pk_bf16_f32 v68, v52, v53
    v_mfma_f32_16x16x32_bf16 v[28:31], v[136:139], a[108:111], v[28:31]
    buffer_load_dwordx4 v[132:135], v1, s[12:15], s25 offen offset:1024
    v_mfma_f32_16x16x32_bf16 v[28:31], v[140:143], a[124:127], v[28:31]
    v_cvt_pk_bf16_f32 v69, v54, v55
    v_mfma_f32_16x16x32_bf16 v[28:31], v[144:147], a[140:143], v[28:31]
    ds_write_b64 v4, v[68:69] offset:1024
    v_mul_f32 v56, v56, v40
    v_mul_f32 v57, v57, v41
    v_mul_f32 v58, v58, v42
    v_mul_f32 v59, v59, v43
    v_mul_f32 v56, v56, v72
    v_mul_f32 v57, v57, v73
    v_mul_f32 v58, v58, v74
    v_mul_f32 v59, v59, v75
    v_cvt_pk_bf16_f32 v72, v56, v57
    v_cvt_pk_bf16_f32 v73, v58, v59
    ds_write_b64 v4, v[72:73] offset:2048
    v_mul_f32 v60, v60, v44
    v_mul_f32 v61, v61, v45
    v_mul_f32 v62, v62, v46
    v_mul_f32 v63, v63, v47
    v_mul_f32 v60, v60, v76
    v_mul_f32 v61, v61, v77
    v_mul_f32 v62, v62, v78
    v_mul_f32 v63, v63, v79
    v_cvt_pk_bf16_f32 v76, v60, v61
    v_cvt_pk_bf16_f32 v77, v62, v63
    ds_write_b64 v4, v[76:77] offset:3072
    s_waitcnt lgkmcnt(0)
    s_barrier
    ds_read_b128 a[240:243], v2 offset:61440
    ds_read_b128 a[244:247], v2 offset:62464
    ds_read_b128 a[248:251], v2 offset:63488
    ds_read_b128 a[252:255], v2 offset:64512
    ds_read_b128 v[80:83], v3 offset:0
    ds_read_b128 v[84:87], v3 offset:1024
    ds_read_b128 v[88:91], v3 offset:2048
    ds_read_b128 v[92:95], v3 offset:3072
    ds_read_b128 v[96:99], v3 offset:4096
    ds_read_b128 v[100:103], v3 offset:5120
    ds_read_b128 v[104:107], v3 offset:6144
    ds_read_b128 v[108:111], v3 offset:7168
    s_waitcnt vmcnt(30)
    v_mfma_f32_16x16x32_bf16 v[16:19], v[148:151], a[144:147], v[16:19]
    buffer_load_dwordx4 v[136:139], v1, s[12:15], s25 offen offset:2048
    v_mfma_f32_16x16x32_bf16 v[16:19], v[152:155], a[160:163], v[16:19]
    v_mfma_f32_16x16x32_bf16 v[16:19], v[156:159], a[176:179], v[16:19]
    v_mfma_f32_16x16x32_bf16 v[20:23], v[148:151], a[148:151], v[20:23]
    buffer_load_dwordx4 v[140:143], v1, s[12:15], s25 offen offset:3072
    v_mfma_f32_16x16x32_bf16 v[20:23], v[152:155], a[164:167], v[20:23]
    v_mfma_f32_16x16x32_bf16 v[20:23], v[156:159], a[180:183], v[20:23]
    v_mfma_f32_16x16x32_bf16 v[24:27], v[148:151], a[152:155], v[24:27]
    v_mfma_f32_16x16x32_bf16 v[24:27], v[152:155], a[168:171], v[24:27]
    s_add_u32 s25, s25, 4096
    v_mfma_f32_16x16x32_bf16 v[24:27], v[156:159], a[184:187], v[24:27]
    v_mfma_f32_16x16x32_bf16 v[28:31], v[148:151], a[156:159], v[28:31]
    buffer_load_dwordx4 v[144:147], v1, s[12:15], s25 offen offset:0
    v_mfma_f32_16x16x32_bf16 v[28:31], v[152:155], a[172:175], v[28:31]
    v_mfma_f32_16x16x32_bf16 v[28:31], v[156:159], a[188:191], v[28:31]
    s_waitcnt vmcnt(30)
    v_mfma_f32_16x16x32_bf16 v[16:19], v[160:163], a[192:195], v[16:19]
    buffer_load_dwordx4 v[148:151], v1, s[12:15], s25 offen offset:1024
    v_mfma_f32_16x16x32_bf16 v[16:19], v[164:167], a[208:211], v[16:19]
    v_mfma_f32_16x16x32_bf16 v[16:19], v[168:171], a[224:227], v[16:19]
    v_mfma_f32_16x16x32_bf16 v[20:23], v[160:163], a[196:199], v[20:23]
    v_mfma_f32_16x16x32_bf16 v[20:23], v[164:167], a[212:215], v[20:23]
    buffer_load_dwordx4 v[152:155], v1, s[12:15], s25 offen offset:2048
    v_mfma_f32_16x16x32_bf16 v[20:23], v[168:171], a[228:231], v[20:23]
    v_mfma_f32_16x16x32_bf16 v[24:27], v[160:163], a[200:203], v[24:27]
    v_mfma_f32_16x16x32_bf16 v[24:27], v[164:167], a[216:219], v[24:27]
    buffer_load_dwordx4 v[156:159], v1, s[12:15], s25 offen offset:3072
    v_mfma_f32_16x16x32_bf16 v[24:27], v[168:171], a[232:235], v[24:27]
    v_mfma_f32_16x16x32_bf16 v[28:31], v[160:163], a[204:207], v[28:31]
    v_mfma_f32_16x16x32_bf16 v[28:31], v[164:167], a[220:223], v[28:31]
    v_mfma_f32_16x16x32_bf16 v[28:31], v[168:171], a[236:239], v[28:31]
    s_add_u32 s25, s25, 4096
    s_waitcnt vmcnt(30)
    s_waitcnt lgkmcnt(0)
    v_mfma_f32_16x16x32_bf16 v[16:19], v[172:175], a[240:243], v[16:19]
    v_mfma_f32_16x16x32_bf16 v[16:19], v[176:179], v[80:83], v[16:19]
    buffer_load_dwordx4 v[160:163], v1, s[12:15], s25 offen offset:0
    v_mfma_f32_16x16x32_bf16 v[16:19], v[180:183], v[96:99], v[16:19]
    v_mfma_f32_16x16x32_bf16 v[20:23], v[172:175], a[244:247], v[20:23]
    v_mfma_f32_16x16x32_bf16 v[20:23], v[176:179], v[84:87], v[20:23]
    buffer_load_dwordx4 v[164:167], v1, s[12:15], s25 offen offset:1024
    v_mfma_f32_16x16x32_bf16 v[20:23], v[180:183], v[100:103], v[20:23]
    v_mfma_f32_16x16x32_bf16 v[24:27], v[172:175], a[248:251], v[24:27]
    v_mfma_f32_16x16x32_bf16 v[24:27], v[176:179], v[88:91], v[24:27]
    v_mfma_f32_16x16x32_bf16 v[24:27], v[180:183], v[104:107], v[24:27]
    buffer_load_dwordx4 v[168:171], v1, s[12:15], s25 offen offset:2048
    v_mfma_f32_16x16x32_bf16 v[28:31], v[172:175], a[252:255], v[28:31]
    v_mfma_f32_16x16x32_bf16 v[28:31], v[176:179], v[92:95], v[28:31]
    v_mfma_f32_16x16x32_bf16 v[28:31], v[180:183], v[108:111], v[28:31]
    s_waitcnt vmcnt(30)
    v_mfma_f32_16x16x32_bf16 v[32:35], v[184:187], a[0:3], 0
    buffer_load_dwordx4 v[172:175], v1, s[12:15], s25 offen offset:3072
    v_mfma_f32_16x16x32_bf16 v[32:35], v[188:191], a[16:19], v[32:35]
    v_mfma_f32_16x16x32_bf16 v[32:35], v[192:195], a[32:35], v[32:35]
    v_mfma_f32_16x16x32_bf16 v[36:39], v[184:187], a[4:7], 0
    s_add_u32 s25, s25, 4096
    v_mfma_f32_16x16x32_bf16 v[36:39], v[188:191], a[20:23], v[36:39]
    v_mfma_f32_16x16x32_bf16 v[36:39], v[192:195], a[36:39], v[36:39]
    buffer_load_dwordx4 v[176:179], v1, s[12:15], s25 offen offset:0
    v_mfma_f32_16x16x32_bf16 v[40:43], v[184:187], a[8:11], 0
    v_mfma_f32_16x16x32_bf16 v[40:43], v[188:191], a[24:27], v[40:43]
    v_mfma_f32_16x16x32_bf16 v[40:43], v[192:195], a[40:43], v[40:43]
    v_cvt_pk_bf16_f32 v64, v16, v17
    v_cvt_pk_bf16_f32 v65, v18, v19
    v_mfma_f32_16x16x32_bf16 v[44:47], v[184:187], a[12:15], 0
    buffer_load_dwordx4 v[180:183], v1, s[12:15], s25 offen offset:1024
    v_mfma_f32_16x16x32_bf16 v[44:47], v[188:191], a[28:31], v[44:47]
    v_mfma_f32_16x16x32_bf16 v[44:47], v[192:195], a[44:47], v[44:47]
    s_waitcnt vmcnt(30)
    v_mfma_f32_16x16x32_bf16 v[32:35], v[196:199], a[48:51], v[32:35]
    ds_write_b64 v9, v[64:65] offset:0
    v_mfma_f32_16x16x32_bf16 v[32:35], v[200:203], a[64:67], v[32:35]
    buffer_load_dwordx4 v[184:187], v1, s[12:15], s25 offen offset:2048
    v_mfma_f32_16x16x32_bf16 v[32:35], v[204:207], a[80:83], v[32:35]
    v_mfma_f32_16x16x32_bf16 v[36:39], v[196:199], a[52:55], v[36:39]
    buffer_load_dwordx4 v[188:191], v1, s[12:15], s25 offen offset:3072
    v_mfma_f32_16x16x32_bf16 v[36:39], v[200:203], a[68:71], v[36:39]
    v_mfma_f32_16x16x32_bf16 v[36:39], v[204:207], a[84:87], v[36:39]
    v_mfma_f32_16x16x32_bf16 v[40:43], v[196:199], a[56:59], v[40:43]
    v_cvt_pk_bf16_f32 v68, v20, v21
    v_mfma_f32_16x16x32_bf16 v[40:43], v[200:203], a[72:75], v[40:43]
    s_add_u32 s25, s25, 4096
    v_mfma_f32_16x16x32_bf16 v[40:43], v[204:207], a[88:91], v[40:43]
    v_mfma_f32_16x16x32_bf16 v[44:47], v[196:199], a[60:63], v[44:47]
    buffer_load_dwordx4 v[192:195], v1, s[12:15], s25 offen offset:0
    v_mfma_f32_16x16x32_bf16 v[44:47], v[200:203], a[76:79], v[44:47]
    v_mfma_f32_16x16x32_bf16 v[44:47], v[204:207], a[92:95], v[44:47]
    s_waitcnt vmcnt(30)
    v_mfma_f32_16x16x32_bf16 v[32:35], v[208:211], a[96:99], v[32:35]
    v_cvt_pk_bf16_f32 v69, v22, v23
    v_mfma_f32_16x16x32_bf16 v[32:35], v[212:215], a[112:115], v[32:35]
    buffer_load_dwordx4 v[196:199], v1, s[12:15], s25 offen offset:1024
    v_mfma_f32_16x16x32_bf16 v[32:35], v[216:219], a[128:131], v[32:35]
    v_mfma_f32_16x16x32_bf16 v[36:39], v[208:211], a[100:103], v[36:39]
    v_mfma_f32_16x16x32_bf16 v[36:39], v[212:215], a[116:119], v[36:39]
    buffer_load_dwordx4 v[200:203], v1, s[12:15], s25 offen offset:2048
    v_mfma_f32_16x16x32_bf16 v[36:39], v[216:219], a[132:135], v[36:39]
    v_mfma_f32_16x16x32_bf16 v[40:43], v[208:211], a[104:107], v[40:43]
    ds_write_b64 v9, v[68:69] offset:1024
    v_mfma_f32_16x16x32_bf16 v[40:43], v[212:215], a[120:123], v[40:43]
    buffer_load_dwordx4 v[204:207], v1, s[12:15], s25 offen offset:3072
    v_mfma_f32_16x16x32_bf16 v[40:43], v[216:219], a[136:139], v[40:43]
    v_mfma_f32_16x16x32_bf16 v[44:47], v[208:211], a[108:111], v[44:47]
    v_mfma_f32_16x16x32_bf16 v[44:47], v[212:215], a[124:127], v[44:47]
    v_mfma_f32_16x16x32_bf16 v[44:47], v[216:219], a[140:143], v[44:47]
    s_add_u32 s25, s25, 4096
    v_cvt_pk_bf16_f32 v72, v24, v25
    v_cvt_pk_bf16_f32 v73, v26, v27
    ds_write_b64 v9, v[72:73] offset:2048
    v_cvt_pk_bf16_f32 v76, v28, v29
    v_cvt_pk_bf16_f32 v77, v30, v31
    ds_write_b64 v9, v[76:77] offset:3072
    s_waitcnt lgkmcnt(0)
    s_barrier
    ds_read_b128 v[64:67], v10
    ds_read_b128 v[68:71], v10 offset:1024
    s_waitcnt vmcnt(30)
    v_mfma_f32_16x16x32_bf16 v[32:35], v[220:223], a[144:147], v[32:35]
    buffer_load_dwordx4 v[208:211], v1, s[12:15], s25 offen offset:0
    v_mfma_f32_16x16x32_bf16 v[32:35], v[224:227], a[160:163], v[32:35]
    v_mfma_f32_16x16x32_bf16 v[32:35], v[228:231], a[176:179], v[32:35]
    v_mfma_f32_16x16x32_bf16 v[36:39], v[220:223], a[148:151], v[36:39]
    v_mfma_f32_16x16x32_bf16 v[36:39], v[224:227], a[164:167], v[36:39]
    buffer_load_dwordx4 v[212:215], v1, s[12:15], s25 offen offset:1024
    v_mfma_f32_16x16x32_bf16 v[36:39], v[228:231], a[180:183], v[36:39]
    v_mfma_f32_16x16x32_bf16 v[40:43], v[220:223], a[152:155], v[40:43]
    v_mfma_f32_16x16x32_bf16 v[40:43], v[224:227], a[168:171], v[40:43]
    buffer_load_dwordx4 v[216:219], v1, s[12:15], s25 offen offset:2048
    v_mfma_f32_16x16x32_bf16 v[40:43], v[228:231], a[184:187], v[40:43]
    v_mfma_f32_16x16x32_bf16 v[44:47], v[220:223], a[156:159], v[44:47]
    v_mfma_f32_16x16x32_bf16 v[44:47], v[224:227], a[172:175], v[44:47]
    v_mfma_f32_16x16x32_bf16 v[44:47], v[228:231], a[188:191], v[44:47]
    s_waitcnt vmcnt(30)
    v_mfma_f32_16x16x32_bf16 v[32:35], v[232:235], a[192:195], v[32:35]
    buffer_load_dwordx4 v[220:223], v1, s[12:15], s25 offen offset:3072
    v_mfma_f32_16x16x32_bf16 v[32:35], v[236:239], a[208:211], v[32:35]
    v_mfma_f32_16x16x32_bf16 v[32:35], v[240:243], a[224:227], v[32:35]
    s_waitcnt lgkmcnt(0)
    s_add_u32 s25, s25, 4096
    v_mfma_f32_16x16x32_bf16 v[36:39], v[232:235], a[196:199], v[36:39]
    v_mfma_f32_16x16x32_bf16 v[36:39], v[236:239], a[212:215], v[36:39]
    buffer_store_dwordx4 v[64:67], v5, s[8:11], s39 offen sc1
    v_mfma_f32_16x16x32_bf16 v[36:39], v[240:243], a[228:231], v[36:39]
    buffer_load_dwordx4 v[224:227], v1, s[12:15], s25 offen offset:0
    v_mfma_f32_16x16x32_bf16 v[40:43], v[232:235], a[200:203], v[40:43]
    v_mfma_f32_16x16x32_bf16 v[40:43], v[236:239], a[216:219], v[40:43]
    v_mfma_f32_16x16x32_bf16 v[40:43], v[240:243], a[232:235], v[40:43]
    buffer_load_dwordx4 v[228:231], v1, s[12:15], s25 offen offset:1024
    v_mfma_f32_16x16x32_bf16 v[44:47], v[232:235], a[204:207], v[44:47]
    v_mfma_f32_16x16x32_bf16 v[44:47], v[236:239], a[220:223], v[44:47]
    v_mfma_f32_16x16x32_bf16 v[44:47], v[240:243], a[236:239], v[44:47]
    s_waitcnt vmcnt(31)
    v_mfma_f32_16x16x32_bf16 v[32:35], v[244:247], a[240:243], v[32:35]
    buffer_load_dwordx4 v[232:235], v1, s[12:15], s25 offen offset:2048
    v_mfma_f32_16x16x32_bf16 v[32:35], v[248:251], v[80:83], v[32:35]
    v_mfma_f32_16x16x32_bf16 v[32:35], v[252:255], v[96:99], v[32:35]
    buffer_store_dwordx4 v[68:71], v6, s[8:11], s39 offen sc1
    v_mfma_f32_16x16x32_bf16 v[36:39], v[244:247], a[244:247], v[36:39]
    s_cmp_lg_u32 s45, 0
    s_cbranch_scc1 2
    ds_write_b128 v12, v[64:67]
    v_mfma_f32_16x16x32_bf16 v[36:39], v[248:251], v[84:87], v[36:39]
    s_cmp_lg_u32 s45, 1
    s_cbranch_scc1 2
    ds_write_b128 v12, v[68:71]
    v_mfma_f32_16x16x32_bf16 v[36:39], v[252:255], v[100:103], v[36:39]
    buffer_load_dwordx4 v[236:239], v1, s[12:15], s25 offen offset:3072
    v_mfma_f32_16x16x32_bf16 v[40:43], v[244:247], a[248:251], v[40:43]
    s_add_u32 s25, s25, 4096
    v_mfma_f32_16x16x32_bf16 v[40:43], v[248:251], v[88:91], v[40:43]
    v_mfma_f32_16x16x32_bf16 v[40:43], v[252:255], v[104:107], v[40:43]
    buffer_load_dwordx4 v[240:243], v1, s[12:15], s25 offen offset:0
    v_mfma_f32_16x16x32_bf16 v[44:47], v[244:247], a[252:255], v[44:47]
    v_mfma_f32_16x16x32_bf16 v[44:47], v[248:251], v[92:95], v[44:47]
    v_mfma_f32_16x16x32_bf16 v[44:47], v[252:255], v[108:111], v[44:47]
    s_waitcnt vmcnt(32)
    v_mfma_f32_16x16x32_bf16 v[16:19], v[112:115], a[0:3], 0
    buffer_load_dwordx4 v[244:247], v1, s[12:15], s25 offen offset:1024
    v_mfma_f32_16x16x32_bf16 v[16:19], v[116:119], a[16:19], v[16:19]
    s_lshl_b32 s28, s22, 3
    s_add_u32 s28, s28, s21
    v_mfma_f32_16x16x32_bf16 v[16:19], v[120:123], a[32:35], v[16:19]
    s_mov_b32 s42, s22
    s_mov_b32 s47, s21
    v_mfma_f32_16x16x32_bf16 v[20:23], v[112:115], a[4:7], 0
    buffer_load_dwordx4 v[248:251], v1, s[12:15], s25 offen offset:2048
    v_mfma_f32_16x16x32_bf16 v[20:23], v[116:119], a[20:23], v[20:23]
    v_bfe_u32 v9, v0, 4, 2
    v_lshlrev_b32 v9, 8, v9
    v_mfma_f32_16x16x32_bf16 v[20:23], v[120:123], a[36:39], v[20:23]
    v_bfe_u32 v10, v0, 3, 1
    v_lshl_add_u32 v9, v10, 10, v9
    v_mfma_f32_16x16x32_bf16 v[24:27], v[112:115], a[8:11], 0
    v_mfma_f32_16x16x32_bf16 v[24:27], v[116:119], a[24:27], v[24:27]
    buffer_load_dwordx4 v[252:255], v1, s[12:15], s25 offen offset:3072
    v_mfma_f32_16x16x32_bf16 v[24:27], v[120:123], a[40:43], v[24:27]
    v_cvt_pk_bf16_f32 v48, v32, v33
    v_mfma_f32_16x16x32_bf16 v[28:31], v[112:115], a[12:15], 0
    v_and_b32 v10, 7, v0
    v_lshl_add_u32 v9, v10, 4, v9
    v_mfma_f32_16x16x32_bf16 v[28:31], v[116:119], a[28:31], v[28:31]
    v_cvt_pk_bf16_f32 v49, v34, v35
    s_add_u32 s25, s25, 4096
    v_mfma_f32_16x16x32_bf16 v[28:31], v[120:123], a[44:47], v[28:31]
    s_waitcnt vmcnt(32)
    v_mfma_f32_16x16x32_bf16 v[16:19], v[124:127], a[48:51], v[16:19]
    s_and_b32 s31, s28, 1
    s_lshl_b32 s31, s31, 7
    v_mfma_f32_16x16x32_bf16 v[16:19], v[128:131], a[64:67], v[16:19]
    s_lshl_b32 s26, s20, 11
    s_add_u32 s31, s31, s26
    v_mfma_f32_16x16x32_bf16 v[16:19], v[132:135], a[80:83], v[16:19]
    buffer_load_dwordx4 v[112:115], v1, s[12:15], s25 offen offset:0
    v_mfma_f32_16x16x32_bf16 v[20:23], v[124:127], a[52:55], v[20:23]
    v_add_u32 v9, s31, v9
    v_lshlrev_b32 v4, 3, v10
    v_mfma_f32_16x16x32_bf16 v[20:23], v[128:131], a[68:71], v[20:23]
    v_and_b32 v10, 0x3ff, v9
    v_lshrrev_b32 v10, 1, v10
    v_mfma_f32_16x16x32_bf16 v[20:23], v[132:135], a[84:87], v[20:23]
    buffer_load_dwordx4 v[116:119], v1, s[12:15], s25 offen offset:1024
    v_mfma_f32_16x16x32_bf16 v[24:27], v[124:127], a[56:59], v[24:27]
    v_and_b32 v3, 0x400, v9
    v_add_u32 v10, v10, v3
    v_mfma_f32_16x16x32_bf16 v[24:27], v[128:131], a[72:75], v[24:27]
    v_cvt_pk_bf16_f32 v52, v36, v37
    v_mfma_f32_16x16x32_bf16 v[24:27], v[132:135], a[88:91], v[24:27]
    s_lshr_b32 s24, s28, 1
    s_mul_i32 s24, s24, 18432
    v_mfma_f32_16x16x32_bf16 v[28:31], v[124:127], a[60:63], v[28:31]
    buffer_load_dwordx4 v[120:123], v1, s[12:15], s25 offen offset:2048
    v_mfma_f32_16x16x32_bf16 v[28:31], v[128:131], a[76:79], v[28:31]
    s_add_u32 s30, s24, 7077888
    s_add_u32 s31, s30, 16384
    v_mfma_f32_16x16x32_bf16 v[28:31], v[132:135], a[92:95], v[28:31]
    s_waitcnt vmcnt(32)
    v_mfma_f32_16x16x32_bf16 v[16:19], v[136:139], a[96:99], v[16:19]
    s_cmp_eq_u32 s20, 0
    s_cselect_b32 s31, s31, 1073741824
    v_mfma_f32_16x16x32_bf16 v[16:19], v[140:143], a[112:115], v[16:19]
    buffer_load_dwordx4 v[124:127], v1, s[12:15], s25 offen offset:3072
    v_mfma_f32_16x16x32_bf16 v[16:19], v[144:147], a[128:131], v[16:19]
    s_add_u32 s32, s30, 8192
    s_add_u32 s46, s56, 11264
    v_mfma_f32_16x16x32_bf16 v[20:23], v[136:139], a[100:103], v[20:23]
    v_cvt_pk_bf16_f32 v53, v38, v39
    s_add_u32 s25, s25, 4096
    v_mfma_f32_16x16x32_bf16 v[20:23], v[140:143], a[116:119], v[20:23]
    s_add_u32 s46, s46, s51
    s_and_b32 s48, s46, 0xffffff80
    v_mfma_f32_16x16x32_bf16 v[20:23], v[144:147], a[132:135], v[20:23]
    buffer_load_dwordx4 v[128:131], v1, s[12:15], s25 offen offset:0
    v_mfma_f32_16x16x32_bf16 v[24:27], v[136:139], a[104:107], v[24:27]
    s_cmp_eq_u32 s20, 0
    s_cselect_b32 s46, s46, 1073741824
    v_mfma_f32_16x16x32_bf16 v[24:27], v[140:143], a[120:123], v[24:27]
    s_cmp_gt_u32 s47, 0
    s_cselect_b32 s26, 0, 1
    v_mfma_f32_16x16x32_bf16 v[24:27], v[144:147], a[136:139], v[24:27]
    buffer_load_dwordx4 v[132:135], v1, s[12:15], s25 offen offset:1024
    v_mfma_f32_16x16x32_bf16 v[28:31], v[136:139], a[108:111], v[28:31]
    s_mul_i32 s26, s26, 2359296
    s_add_u32 s26, s26, s24
    v_mfma_f32_16x16x32_bf16 v[28:31], v[140:143], a[124:127], v[28:31]
    v_mfma_f32_16x16x32_bf16 v[28:31], v[144:147], a[140:143], v[28:31]
    s_waitcnt vmcnt(32)
    v_mfma_f32_16x16x32_bf16 v[16:19], v[148:151], a[144:147], v[16:19]
    s_add_u32 s72, s26, 16515072
    v_mfma_f32_16x16x32_bf16 v[16:19], v[152:155], a[160:163], v[16:19]
    v_cvt_pk_bf16_f32 v56, v40, v41
    v_mfma_f32_16x16x32_bf16 v[16:19], v[156:159], a[176:179], v[16:19]
    buffer_load_dwordx4 v[136:139], v1, s[12:15], s25 offen offset:2048
    v_mfma_f32_16x16x32_bf16 v[20:23], v[148:151], a[148:151], v[20:23]
    s_cmp_gt_u32 s47, 1
    s_cselect_b32 s26, 1, 2
    v_mfma_f32_16x16x32_bf16 v[20:23], v[152:155], a[164:167], v[20:23]
    s_mul_i32 s26, s26, 2359296
    s_add_u32 s26, s26, s24
    v_mfma_f32_16x16x32_bf16 v[20:23], v[156:159], a[180:183], v[20:23]
    buffer_load_dwordx4 v[140:143], v1, s[12:15], s25 offen offset:3072
    v_mfma_f32_16x16x32_bf16 v[24:27], v[148:151], a[152:155], v[24:27]
    s_add_u32 s73, s26, 16515072
    v_mfma_f32_16x16x32_bf16 v[24:27], v[152:155], a[168:171], v[24:27]
    s_cmp_gt_u32 s47, 2
    s_cselect_b32 s26, 2, 3
    v_mfma_f32_16x16x32_bf16 v[24:27], v[156:159], a[184:187], v[24:27]
    s_add_u32 s25, s25, 4096
    v_mfma_f32_16x16x32_bf16 v[28:31], v[148:151], a[156:159], v[28:31]
    s_mul_i32 s26, s26, 2359296
    s_add_u32 s26, s26, s24
    v_mfma_f32_16x16x32_bf16 v[28:31], v[152:155], a[172:175], v[28:31]
    v_cvt_pk_bf16_f32 v57, v42, v43
    v_mfma_f32_16x16x32_bf16 v[28:31], v[156:159], a[188:191], v[28:31]
    buffer_load_dwordx4 v[144:147], v1, s[12:15], s25 offen offset:0
    s_waitcnt vmcnt(32)
    v_mfma_f32_16x16x32_bf16 v[16:19], v[160:163], a[192:195], v[16:19]
    s_add_u32 s74, s26, 16515072
    v_mfma_f32_16x16x32_bf16 v[16:19], v[164:167], a[208:211], v[16:19]
    buffer_load_dwordx4 v[148:151], v1, s[12:15], s25 offen offset:1024
    v_mfma_f32_16x16x32_bf16 v[16:19], v[168:171], a[224:227], v[16:19]
    s_cmp_gt_u32 s47, 3
    s_cselect_b32 s26, 3, 4
    v_mfma_f32_16x16x32_bf16 v[20:23], v[160:163], a[196:199], v[20:23]
    s_mul_i32 s26, s26, 2359296
    s_add_u32 s26, s26, s24
    v_mfma_f32_16x16x32_bf16 v[20:23], v[164:167], a[212:215], v[20:23]
    buffer_load_dwordx4 v[152:155], v1, s[12:15], s25 offen offset:2048
    v_mfma_f32_16x16x32_bf16 v[20:23], v[168:171], a[228:231], v[20:23]
    s_add_u32 s75, s26, 16515072
    v_mfma_f32_16x16x32_bf16 v[24:27], v[160:163], a[200:203], v[24:27]
    v_cvt_pk_bf16_f32 v60, v44, v45
    v_mfma_f32_16x16x32_bf16 v[24:27], v[164:167], a[216:219], v[24:27]
    s_cmp_gt_u32 s47, 4
    s_cselect_b32 s26, 4, 5
    v_mfma_f32_16x16x32_bf16 v[24:27], v[168:171], a[232:235], v[24:27]
    buffer_load_dwordx4 v[156:159], v1, s[12:15], s25 offen offset:3072
    v_mfma_f32_16x16x32_bf16 v[28:31], v[160:163], a[204:207], v[28:31]
    s_mul_i32 s26, s26, 2359296
    s_add_u32 s26, s26, s24
    v_mfma_f32_16x16x32_bf16 v[28:31], v[164:167], a[220:223], v[28:31]
    s_add_u32 s76, s26, 16515072
    v_mfma_f32_16x16x32_bf16 v[28:31], v[168:171], a[236:239], v[28:31]
    s_add_u32 s25, s25, 4096
    s_waitcnt vmcnt(32)
    v_mfma_f32_16x16x32_bf16 v[16:19], v[172:175], a[240:243], v[16:19]
    s_cmp_gt_u32 s47, 5
    s_cselect_b32 s26, 5, 6
    v_mfma_f32_16x16x32_bf16 v[16:19], v[176:179], v[80:83], v[16:19]
    buffer_load_dwordx4 v[160:163], v1, s[12:15], s25 offen offset:0
    v_mfma_f32_16x16x32_bf16 v[16:19], v[180:183], v[96:99], v[16:19]
    s_mul_i32 s26, s26, 2359296
    s_add_u32 s26, s26, s24
    v_mfma_f32_16x16x32_bf16 v[20:23], v[172:175], a[244:247], v[20:23]
    v_cvt_pk_bf16_f32 v61, v46, v47
    v_mfma_f32_16x16x32_bf16 v[20:23], v[176:179], v[84:87], v[20:23]
    s_add_u32 s77, s26, 16515072
    v_mfma_f32_16x16x32_bf16 v[20:23], v[180:183], v[100:103], v[20:23]
    buffer_load_dwordx4 v[164:167], v1, s[12:15], s25 offen offset:1024
    v_mfma_f32_16x16x32_bf16 v[24:27], v[172:175], a[248:251], v[24:27]
    s_cmp_gt_u32 s47, 6
    s_cselect_b32 s26, 6, 7
    v_mfma_f32_16x16x32_bf16 v[24:27], v[176:179], v[88:91], v[24:27]
    v_mfma_f32_16x16x32_bf16 v[24:27], v[180:183], v[104:107], v[24:27]
    s_mul_i32 s26, s26, 2359296
    s_add_u32 s26, s26, s24
    v_mfma_f32_16x16x32_bf16 v[28:31], v[172:175], a[252:255], v[28:31]
    buffer_load_dwordx4 v[168:171], v1, s[12:15], s25 offen offset:2048
    v_mfma_f32_16x16x32_bf16 v[28:31], v[176:179], v[92:95], v[28:31]
    s_add_u32 s78, s26, 16515072
    v_mfma_f32_16x16x32_bf16 v[28:31], v[180:183], v[108:111], v[28:31]
    s_mov_b32 s34, 2
L_ffn_dn:
    s_waitcnt vmcnt(32)
    v_mfma_f32_16x16x32_bf16 v[32:35], v[184:187], a[0:3], 0
    buffer_load_dwordx4 v[172:175], v1, s[12:15], s25 offen offset:3072
    v_mfma_f32_16x16x32_bf16 v[32:35], v[188:191], a[16:19], v[32:35]
    v_mov_b32 v64, v48
    v_mfma_f32_16x16x32_bf16 v[32:35], v[192:195], a[32:35], v[32:35]
    v_mov_b32 v65, v49
    v_mfma_f32_16x16x32_bf16 v[36:39], v[184:187], a[4:7], 0
    s_add_u32 s25, s25, 4096
    v_mfma_f32_16x16x32_bf16 v[36:39], v[188:191], a[20:23], v[36:39]
    v_mov_b32 v68, v52
    v_mfma_f32_16x16x32_bf16 v[36:39], v[192:195], a[36:39], v[36:39]
    buffer_load_dwordx4 v[176:179], v1, s[12:15], s25 offen offset:0
    v_mfma_f32_16x16x32_bf16 v[40:43], v[184:187], a[8:11], 0
    v_mfma_f32_16x16x32_bf16 v[40:43], v[188:191], a[24:27], v[40:43]
    v_mov_b32 v69, v53
    v_mfma_f32_16x16x32_bf16 v[40:43], v[192:195], a[40:43], v[40:43]
    buffer_load_dwordx4 v[180:183], v1, s[12:15], s25 offen offset:1024
    v_mfma_f32_16x16x32_bf16 v[44:47], v[184:187], a[12:15], 0
    v_mov_b32 v72, v56
    v_mfma_f32_16x16x32_bf16 v[44:47], v[188:191], a[28:31], v[44:47]
    v_mfma_f32_16x16x32_bf16 v[44:47], v[192:195], a[44:47], v[44:47]
    s_waitcnt vmcnt(32)
    v_mfma_f32_16x16x32_bf16 v[32:35], v[196:199], a[48:51], v[32:35]
    buffer_load_dwordx4 v[184:187], v1, s[12:15], s25 offen offset:2048
    v_mfma_f32_16x16x32_bf16 v[32:35], v[200:203], a[64:67], v[32:35]
    v_mov_b32 v73, v57
    v_mfma_f32_16x16x32_bf16 v[32:35], v[204:207], a[80:83], v[32:35]
    v_mov_b32 v76, v60
    v_mfma_f32_16x16x32_bf16 v[36:39], v[196:199], a[52:55], v[36:39]
    buffer_load_dwordx4 v[188:191], v1, s[12:15], s25 offen offset:3072
    v_mfma_f32_16x16x32_bf16 v[36:39], v[200:203], a[68:71], v[36:39]
    v_mfma_f32_16x16x32_bf16 v[36:39], v[204:207], a[84:87], v[36:39]
    v_mov_b32 v77, v61
    v_mfma_f32_16x16x32_bf16 v[40:43], v[196:199], a[56:59], v[40:43]
    v_mfma_f32_16x16x32_bf16 v[40:43], v[200:203], a[72:75], v[40:43]
    s_add_u32 s25, s25, 4096
    v_cvt_pk_bf16_f32 v66, v16, v17
    v_mfma_f32_16x16x32_bf16 v[40:43], v[204:207], a[88:91], v[40:43]
    v_mfma_f32_16x16x32_bf16 v[44:47], v[196:199], a[60:63], v[44:47]
    buffer_load_dwordx4 v[192:195], v1, s[12:15], s25 offen offset:0
    v_mfma_f32_16x16x32_bf16 v[44:47], v[200:203], a[76:79], v[44:47]
    v_cvt_pk_bf16_f32 v67, v18, v19
    v_mfma_f32_16x16x32_bf16 v[44:47], v[204:207], a[92:95], v[44:47]
    s_waitcnt vmcnt(32)
    v_mfma_f32_16x16x32_bf16 v[32:35], v[208:211], a[96:99], v[32:35]
    buffer_load_dwordx4 v[196:199], v1, s[12:15], s25 offen offset:1024
    v_mfma_f32_16x16x32_bf16 v[32:35], v[212:215], a[112:115], v[32:35]
    v_cvt_pk_bf16_f32 v70, v20, v21
    v_mfma_f32_16x16x32_bf16 v[32:35], v[216:219], a[128:131], v[32:35]
    v_mfma_f32_16x16x32_bf16 v[36:39], v[208:211], a[100:103], v[36:39]
    v_cvt_pk_bf16_f32 v71, v22, v23
    v_mfma_f32_16x16x32_bf16 v[36:39], v[212:215], a[116:119], v[36:39]
    buffer_load_dwordx4 v[200:203], v1, s[12:15], s25 offen offset:2048
    v_mfma_f32_16x16x32_bf16 v[36:39], v[216:219], a[132:135], v[36:39]
    v_cvt_pk_bf16_f32 v74, v24, v25
    v_mfma_f32_16x16x32_bf16 v[40:43], v[208:211], a[104:107], v[40:43]
    v_mfma_f32_16x16x32_bf16 v[40:43], v[212:215], a[120:123], v[40:43]
    buffer_load_dwordx4 v[204:207], v1, s[12:15], s25 offen offset:3072
    v_mfma_f32_16x16x32_bf16 v[40:43], v[216:219], a[136:139], v[40:43]
    v_cvt_pk_bf16_f32 v75, v26, v27
    v_mfma_f32_16x16x32_bf16 v[44:47], v[208:211], a[108:111], v[44:47]
    v_mfma_f32_16x16x32_bf16 v[44:47], v[212:215], a[124:127], v[44:47]
    v_cvt_pk_bf16_f32 v78, v28, v29
    v_mfma_f32_16x16x32_bf16 v[44:47], v[216:219], a[140:143], v[44:47]
    s_add_u32 s25, s25, 4096
    s_waitcnt vmcnt(31)
    v_mfma_f32_16x16x32_bf16 v[32:35], v[220:223], a[144:147], v[32:35]
    buffer_load_dwordx4 v[208:211], v1, s[12:15], s25 offen offset:0
    v_mfma_f32_16x16x32_bf16 v[32:35], v[224:227], a[160:163], v[32:35]
    v_cvt_pk_bf16_f32 v79, v30, v31
    v_mfma_f32_16x16x32_bf16 v[32:35], v[228:231], a[176:179], v[32:35]
    v_mfma_f32_16x16x32_bf16 v[36:39], v[220:223], a[148:151], v[36:39]
    s_cmp_lg_u32 s44, 0
    s_cbranch_scc1 2
    ds_write_b128 v11, v[64:67]
    v_mfma_f32_16x16x32_bf16 v[36:39], v[224:227], a[164:167], v[36:39]
    buffer_load_dwordx4 v[212:215], v1, s[12:15], s25 offen offset:1024
    v_mfma_f32_16x16x32_bf16 v[36:39], v[228:231], a[180:183], v[36:39]
    v_mfma_f32_16x16x32_bf16 v[40:43], v[220:223], a[152:155], v[40:43]
    v_mfma_f32_16x16x32_bf16 v[40:43], v[224:227], a[168:171], v[40:43]
    buffer_load_dwordx4 v[216:219], v1, s[12:15], s25 offen offset:2048
    v_mfma_f32_16x16x32_bf16 v[40:43], v[228:231], a[184:187], v[40:43]
    s_cmp_lg_u32 s44, 1
    s_cbranch_scc1 2
    ds_write_b128 v11, v[68:71]
    v_mfma_f32_16x16x32_bf16 v[44:47], v[220:223], a[156:159], v[44:47]
    v_mfma_f32_16x16x32_bf16 v[44:47], v[224:227], a[172:175], v[44:47]
    v_mfma_f32_16x16x32_bf16 v[44:47], v[228:231], a[188:191], v[44:47]
    s_waitcnt vmcnt(30)
    v_mfma_f32_16x16x32_bf16 v[32:35], v[232:235], a[192:195], v[32:35]
    buffer_load_dwordx4 v[220:223], v1, s[12:15], s25 offen offset:3072
    v_mfma_f32_16x16x32_bf16 v[32:35], v[236:239], a[208:211], v[32:35]
    s_cmp_lg_u32 s44, 2
    s_cbranch_scc1 2
    ds_write_b128 v11, v[72:75]
    v_mfma_f32_16x16x32_bf16 v[32:35], v[240:243], a[224:227], v[32:35]
    s_add_u32 s25, s25, 4096
    v_mfma_f32_16x16x32_bf16 v[36:39], v[232:235], a[196:199], v[36:39]
    v_mfma_f32_16x16x32_bf16 v[36:39], v[236:239], a[212:215], v[36:39]
    buffer_load_dwordx4 v[224:227], v1, s[12:15], s25 offen offset:0
    v_mfma_f32_16x16x32_bf16 v[36:39], v[240:243], a[228:231], v[36:39]
    v_mfma_f32_16x16x32_bf16 v[40:43], v[232:235], a[200:203], v[40:43]
    s_cmp_lg_u32 s44, 3
    s_cbranch_scc1 2
    ds_write_b128 v11, v[76:79]
    v_mfma_f32_16x16x32_bf16 v[40:43], v[236:239], a[216:219], v[40:43]
    v_mfma_f32_16x16x32_bf16 v[40:43], v[240:243], a[232:235], v[40:43]
    buffer_load_dwordx4 v[228:231], v1, s[12:15], s25 offen offset:1024
    v_mfma_f32_16x16x32_bf16 v[44:47], v[232:235], a[204:207], v[44:47]
    v_mfma_f32_16x16x32_bf16 v[44:47], v[236:239], a[220:223], v[44:47]
    v_mfma_f32_16x16x32_bf16 v[44:47], v[240:243], a[236:239], v[44:47]
    v_add_u32 v11, 0x1000, v11
    s_waitcnt vmcnt(30)
    v_mfma_f32_16x16x32_bf16 v[32:35], v[244:247], a[240:243], v[32:35]
    buffer_load_dwordx4 v[232:235], v1, s[12:15], s25 offen offset:2048
    v_mfma_f32_16x16x32_bf16 v[32:35], v[248:251], v[80:83], v[32:35]
    v_mfma_f32_16x16x32_bf16 v[32:35], v[252:255], v[96:99], v[32:35]
    buffer_store_dwordx4 v[64:67], v5, s[8:11], s38 offen sc1
    v_mfma_f32_16x16x32_bf16 v[36:39], v[244:247], a[244:247], v[36:39]
    buffer_load_dwordx4 v[236:239], v1, s[12:15], s25 offen offset:3072
    v_mfma_f32_16x16x32_bf16 v[36:39], v[248:251], v[84:87], v[36:39]
    v_mfma_f32_16x16x32_bf16 v[36:39], v[252:255], v[100:103], v[36:39]
    v_mfma_f32_16x16x32_bf16 v[40:43], v[244:247], a[248:251], v[40:43]
    s_add_u32 s25, s25, 4096
    v_mfma_f32_16x16x32_bf16 v[40:43], v[248:251], v[88:91], v[40:43]
    buffer_store_dwordx4 v[68:71], v6, s[8:11], s38 offen sc1
    v_mfma_f32_16x16x32_bf16 v[40:43], v[252:255], v[104:107], v[40:43]
    buffer_load_dwordx4 v[240:243], v1, s[12:15], s25 offen offset:0
    v_mfma_f32_16x16x32_bf16 v[44:47], v[244:247], a[252:255], v[44:47]
    v_mfma_f32_16x16x32_bf16 v[44:47], v[248:251], v[92:95], v[44:47]
    v_mfma_f32_16x16x32_bf16 v[44:47], v[252:255], v[108:111], v[44:47]
    s_waitcnt vmcnt(32)
    v_mfma_f32_16x16x32_bf16 v[16:19], v[112:115], a[0:3], 0
    buffer_load_dwordx4 v[244:247], v1, s[12:15], s25 offen offset:1024
    v_mfma_f32_16x16x32_bf16 v[16:19], v[116:119], a[16:19], v[16:19]
    v_mfma_f32_16x16x32_bf16 v[16:19], v[120:123], a[32:35], v[16:19]
    v_mfma_f32_16x16x32_bf16 v[20:23], v[112:115], a[4:7], 0
    buffer_load_dwordx4 v[248:251], v1, s[12:15], s25 offen offset:2048
    v_mfma_f32_16x16x32_bf16 v[20:23], v[116:119], a[20:23], v[20:23]
    v_mfma_f32_16x16x32_bf16 v[20:23], v[120:123], a[36:39], v[20:23]
    v_mfma_f32_16x16x32_bf16 v[24:27], v[112:115], a[8:11], 0
    v_mfma_f32_16x16x32_bf16 v[24:27], v[116:119], a[24:27], v[24:27]
    buffer_load_dwordx4 v[252:255], v1, s[12:15], s25 offen offset:3072
    v_mfma_f32_16x16x32_bf16 v[24:27], v[120:123], a[40:43], v[24:27]
    v_cvt_pk_bf16_f32 v48, v32, v33
    v_mfma_f32_16x16x32_bf16 v[28:31], v[112:115], a[12:15], 0
    v_cvt_pk_bf16_f32 v49, v34, v35
    v_mfma_f32_16x16x32_bf16 v[28:31], v[116:119], a[28:31], v[28:31]
    s_add_u32 s25, s25, 4096
    v_mfma_f32_16x16x32_bf16 v[28:31], v[120:123], a[44:47], v[28:31]
    s_waitcnt vmcnt(32)
    v_mfma_f32_16x16x32_bf16 v[16:19], v[124:127], a[48:51], v[16:19]
    buffer_load_dwordx4 v[112:115], v1, s[12:15], s25 offen offset:0
    v_mfma_f32_16x16x32_bf16 v[16:19], v[128:131], a[64:67], v[16:19]
    v_mfma_f32_16x16x32_bf16 v[16:19], v[132:135], a[80:83], v[16:19]
    v_mfma_f32_16x16x32_bf16 v[20:23], v[124:127], a[52:55], v[20:23]
    v_mfma_f32_16x16x32_bf16 v[20:23], v[128:131], a[68:71], v[20:23]
    buffer_load_dwordx4 v[116:119], v1, s[12:15], s25 offen offset:1024
    v_mfma_f32_16x16x32_bf16 v[20:23], v[132:135], a[84:87], v[20:23]
    v_mfma_f32_16x16x32_bf16 v[24:27], v[124:127], a[56:59], v[24:27]
    v_cvt_pk_bf16_f32 v52, v36, v37
    v_mfma_f32_16x16x32_bf16 v[24:27], v[128:131], a[72:75], v[24:27]
    buffer_load_dwordx4 v[120:123], v1, s[12:15], s25 offen offset:2048
    v_mfma_f32_16x16x32_bf16 v[24:27], v[132:135], a[88:91], v[24:27]
    buffer_store_dwordx4 v[72:75], v7, s[8:11], s38 offen sc1
    v_mfma_f32_16x16x32_bf16 v[28:31], v[124:127], a[60:63], v[28:31]
    v_mfma_f32_16x16x32_bf16 v[28:31], v[128:131], a[76:79], v[28:31]
    v_mfma_f32_16x16x32_bf16 v[28:31], v[132:135], a[92:95], v[28:31]
    s_waitcnt vmcnt(33)
    v_mfma_f32_16x16x32_bf16 v[16:19], v[136:139], a[96:99], v[16:19]
    buffer_load_dwordx4 v[124:127], v1, s[12:15], s25 offen offset:3072
    v_mfma_f32_16x16x32_bf16 v[16:19], v[140:143], a[112:115], v[16:19]
    v_mfma_f32_16x16x32_bf16 v[16:19], v[144:147], a[128:131], v[16:19]
    v_mfma_f32_16x16x32_bf16 v[20:23], v[136:139], a[100:103], v[20:23]
    v_cvt_pk_bf16_f32 v53, v38, v39
    s_add_u32 s25, s25, 4096
    v_mfma_f32_16x16x32_bf16 v[20:23], v[140:143], a[116:119], v[20:23]
    buffer_load_dwordx4 v[128:131], v1, s[12:15], s25 offen offset:0
    v_mfma_f32_16x16x32_bf16 v[20:23], v[144:147], a[132:135], v[20:23]
    v_mfma_f32_16x16x32_bf16 v[24:27], v[136:139], a[104:107], v[24:27]
    v_mfma_f32_16x16x32_bf16 v[24:27], v[140:143], a[120:123], v[24:27]
    v_mfma_f32_16x16x32_bf16 v[24:27], v[144:147], a[136:139], v[24:27]
    buffer_load_dwordx4 v[132:135], v1, s[12:15], s25 offen offset:1024
    v_mfma_f32_16x16x32_bf16 v[28:31], v[136:139], a[108:111], v[28:31]
    v_mfma_f32_16x16x32_bf16 v[28:31], v[140:143], a[124:127], v[28:31]
    v_mfma_f32_16x16x32_bf16 v[28:31], v[144:147], a[140:143], v[28:31]
    s_waitcnt vmcnt(33)
    v_mfma_f32_16x16x32_bf16 v[16:19], v[148:151], a[144:147], v[16:19]
    buffer_load_dwordx4 v[136:139], v1, s[12:15], s25 offen offset:2048
    v_mfma_f32_16x16x32_bf16 v[16:19], v[152:155], a[160:163], v[16:19]
    v_cvt_pk_bf16_f32 v56, v40, v41
    v_mfma_f32_16x16x32_bf16 v[16:19], v[156:159], a[176:179], v[16:19]
    v_mfma_f32_16x16x32_bf16 v[20:23], v[148:151], a[148:151], v[20:23]
    buffer_load_dwordx4 v[140:143], v1, s[12:15], s25 offen offset:3072
    v_mfma_f32_16x16x32_bf16 v[20:23], v[152:155], a[164:167], v[20:23]
    v_mfma_f32_16x16x32_bf16 v[20:23], v[156:159], a[180:183], v[20:23]
    v_mfma_f32_16x16x32_bf16 v[24:27], v[148:151], a[152:155], v[24:27]
    v_mfma_f32_16x16x32_bf16 v[24:27], v[152:155], a[168:171], v[24:27]
    s_add_u32 s25, s25, 4096
    v_mfma_f32_16x16x32_bf16 v[24:27], v[156:159], a[184:187], v[24:27]
    v_mfma_f32_16x16x32_bf16 v[28:31], v[148:151], a[156:159], v[28:31]
    buffer_load_dwordx4 v[144:147], v1, s[12:15], s25 offen offset:0
    v_mfma_f32_16x16x32_bf16 v[28:31], v[152:155], a[172:175], v[28:31]
    v_cvt_pk_bf16_f32 v57, v42, v43
    v_mfma_f32_16x16x32_bf16 v[28:31], v[156:159], a[188:191], v[28:31]
    s_waitcnt vmcnt(33)
    v_mfma_f32_16x16x32_bf16 v[16:19], v[160:163], a[192:195], v[16:19]
    buffer_load_dwordx4 v[148:151], v1, s[12:15], s25 offen offset:1024
    v_mfma_f32_16x16x32_bf16 v[16:19], v[164:167], a[208:211], v[16:19]
    v_mfma_f32_16x16x32_bf16 v[16:19], v[168:171], a[224:227], v[16:19]
    v_mfma_f32_16x16x32_bf16 v[20:23], v[160:163], a[196:199], v[20:23]
    v_mfma_f32_16x16x32_bf16 v[20:23], v[164:167], a[212:215], v[20:23]
    buffer_store_dwordx4 v[76:79], v8, s[8:11], s38 offen sc1
    v_mfma_f32_16x16x32_bf16 v[20:23], v[168:171], a[228:231], v[20:23]
    s_add_u32 s38, s38, 4096
    v_mfma_f32_16x16x32_bf16 v[24:27], v[160:163], a[200:203], v[24:27]
    buffer_load_dwordx4 v[152:155], v1, s[12:15], s25 offen offset:2048
    v_mfma_f32_16x16x32_bf16 v[24:27], v[164:167], a[216:219], v[24:27]
    v_cvt_pk_bf16_f32 v60, v44, v45
    v_mfma_f32_16x16x32_bf16 v[24:27], v[168:171], a[232:235], v[24:27]
    buffer_load_dwordx4 v[156:159], v1, s[12:15], s25 offen offset:3072
    v_mfma_f32_16x16x32_bf16 v[28:31], v[160:163], a[204:207], v[28:31]
    v_mfma_f32_16x16x32_bf16 v[28:31], v[164:167], a[220:223], v[28:31]
    v_mfma_f32_16x16x32_bf16 v[28:31], v[168:171], a[236:239], v[28:31]
    s_add_u32 s25, s25, 4096
    s_waitcnt vmcnt(34)
    v_mfma_f32_16x16x32_bf16 v[16:19], v[172:175], a[240:243], v[16:19]
    s_sub_u32 s34, s34, 1
    v_mfma_f32_16x16x32_bf16 v[16:19], v[176:179], v[80:83], v[16:19]
    buffer_load_dwordx4 v[160:163], v1, s[12:15], s25 offen offset:0
    v_mfma_f32_16x16x32_bf16 v[16:19], v[180:183], v[96:99], v[16:19]
    v_mfma_f32_16x16x32_bf16 v[20:23], v[172:175], a[244:247], v[20:23]
    v_cvt_pk_bf16_f32 v61, v46, v47
    v_mfma_f32_16x16x32_bf16 v[20:23], v[176:179], v[84:87], v[20:23]
    buffer_load_dwordx4 v[164:167], v1, s[12:15], s25 offen offset:1024
    v_mfma_f32_16x16x32_bf16 v[20:23], v[180:183], v[100:103], v[20:23]
    v_mfma_f32_16x16x32_bf16 v[24:27], v[172:175], a[248:251], v[24:27]
    v_mfma_f32_16x16x32_bf16 v[24:27], v[176:179], v[88:91], v[24:27]
    v_mfma_f32_16x16x32_bf16 v[24:27], v[180:183], v[104:107], v[24:27]
    buffer_load_dwordx4 v[168:171], v1, s[12:15], s25 offen offset:2048
    v_mfma_f32_16x16x32_bf16 v[28:31], v[172:175], a[252:255], v[28:31]
    v_mfma_f32_16x16x32_bf16 v[28:31], v[176:179], v[92:95], v[28:31]
    v_mfma_f32_16x16x32_bf16 v[28:31], v[180:183], v[108:111], v[28:31]
    s_cmp_lg_u32 s34, 0
    s_cbranch_scc1 L_ffn_dn
    s_waitcnt vmcnt(34)
    v_mfma_f32_16x16x32_bf16 v[32:35], v[184:187], a[0:3], 0
    v_mov_b32 v64, v48
    v_mfma_f32_16x16x32_bf16 v[32:35], v[188:191], a[16:19], v[32:35]
    buffer_load_dwordx4 v[172:175], v1, s[12:15], s25 offen offset:3072
    v_mfma_f32_16x16x32_bf16 v[32:35], v[192:195], a[32:35], v[32:35]
    v_mov_b32 v65, v49
    v_mfma_f32_16x16x32_bf16 v[36:39], v[184:187], a[4:7], 0
    v_mfma_f32_16x16x32_bf16 v[36:39], v[188:191], a[20:23], v[36:39]
    v_mov_b32 v68, v52
    v_mfma_f32_16x16x32_bf16 v[36:39], v[192:195], a[36:39], v[36:39]
    v_mfma_f32_16x16x32_bf16 v[40:43], v[184:187], a[8:11], 0
    v_mov_b32 v69, v53
    v_mfma_f32_16x16x32_bf16 v[40:43], v[188:191], a[24:27], v[40:43]
    v_mfma_f32_16x16x32_bf16 v[40:43], v[192:195], a[40:43], v[40:43]
    v_mov_b32 v72, v56
    v_mfma_f32_16x16x32_bf16 v[44:47], v[184:187], a[12:15], 0
    v_mfma_f32_16x16x32_bf16 v[44:47], v[188:191], a[28:31], v[44:47]
    v_mov_b32 v73, v57
    v_mfma_f32_16x16x32_bf16 v[44:47], v[192:195], a[44:47], v[44:47]
    s_add_u32 s25, s25, 4096
    buffer_load_dwordx4 v[176:179], v1, s[12:15], s25 offen offset:0
    buffer_load_dwordx4 v[180:183], v1, s[12:15], s25 offen offset:1024
    s_waitcnt vmcnt(34)
    v_mfma_f32_16x16x32_bf16 v[32:35], v[196:199], a[48:51], v[32:35]
    v_mfma_f32_16x16x32_bf16 v[32:35], v[200:203], a[64:67], v[32:35]
    v_mov_b32 v76, v60
    v_mfma_f32_16x16x32_bf16 v[32:35], v[204:207], a[80:83], v[32:35]
    buffer_load_dwordx4 v[184:187], v9, s[8:11], s30 offen sc1
    v_mfma_f32_16x16x32_bf16 v[36:39], v[196:199], a[52:55], v[36:39]
    v_mov_b32 v77, v61
    v_mfma_f32_16x16x32_bf16 v[36:39], v[200:203], a[68:71], v[36:39]
    v_mfma_f32_16x16x32_bf16 v[36:39], v[204:207], a[84:87], v[36:39]
    v_cvt_pk_bf16_f32 v66, v16, v17
    v_mfma_f32_16x16x32_bf16 v[40:43], v[196:199], a[56:59], v[40:43]
    buffer_load_dwordx4 v[192:195], v9, s[8:11], s32 offen sc1
    v_mfma_f32_16x16x32_bf16 v[40:43], v[200:203], a[72:75], v[40:43]
    v_cvt_pk_bf16_f32 v67, v18, v19
    v_mfma_f32_16x16x32_bf16 v[40:43], v[204:207], a[88:91], v[40:43]
    v_mfma_f32_16x16x32_bf16 v[44:47], v[196:199], a[60:63], v[44:47]
    v_cvt_pk_bf16_f32 v70, v20, v21
    v_mfma_f32_16x16x32_bf16 v[44:47], v[200:203], a[76:79], v[44:47]
    v_mfma_f32_16x16x32_bf16 v[44:47], v[204:207], a[92:95], v[44:47]
    s_waitcnt vmcnt(33)
    v_mfma_f32_16x16x32_bf16 v[32:35], v[208:211], a[96:99], v[32:35]
    v_cvt_pk_bf16_f32 v71, v22, v23
    v_mfma_f32_16x16x32_bf16 v[32:35], v[212:215], a[112:115], v[32:35]
    v_cvt_pk_bf16_f32 v74, v24, v25
    v_cvt_pk_bf16_f32 v75, v26, v27
    v_cvt_pk_bf16_f32 v78, v28, v29
    v_cvt_pk_bf16_f32 v79, v30, v31
    s_cmp_lg_u32 s44, 0
    s_cbranch_scc1 2
    ds_write_b128 v11, v[64:67]
    s_cmp_lg_u32 s44, 1
    s_cbranch_scc1 2
    ds_write_b128 v11, v[68:71]
    s_cmp_lg_u32 s44, 2
    s_cbranch_scc1 2
    ds_write_b128 v11, v[72:75]
    s_cmp_lg_u32 s44, 3
    s_cbranch_scc1 2
    ds_write_b128 v11, v[76:79]
    v_add_u32 v11, 0x1000, v11
    v_mfma_f32_16x16x32_bf16 v[32:35], v[216:219], a[128:131], v[32:35]
    v_mfma_f32_16x16x32_bf16 v[36:39], v[208:211], a[100:103], v[36:39]
    buffer_store_dwordx4 v[64:67], v5, s[8:11], s38 offen sc1
    v_mfma_f32_16x16x32_bf16 v[36:39], v[212:215], a[116:119], v[36:39]
    v_mfma_f32_16x16x32_bf16 v[36:39], v[216:219], a[132:135], v[36:39]
    v_mfma_f32_16x16x32_bf16 v[40:43], v[208:211], a[104:107], v[40:43]
    v_mfma_f32_16x16x32_bf16 v[40:43], v[212:215], a[120:123], v[40:43]
    v_mfma_f32_16x16x32_bf16 v[40:43], v[216:219], a[136:139], v[40:43]
    v_mfma_f32_16x16x32_bf16 v[44:47], v[208:211], a[108:111], v[44:47]
    v_mfma_f32_16x16x32_bf16 v[44:47], v[212:215], a[124:127], v[44:47]
    v_mfma_f32_16x16x32_bf16 v[44:47], v[216:219], a[140:143], v[44:47]
    buffer_store_dwordx4 v[68:71], v6, s[8:11], s38 offen sc1
    s_waitcnt vmcnt(32)
    v_mfma_f32_16x16x32_bf16 v[32:35], v[220:223], a[144:147], v[32:35]
    buffer_load_dwordx2 v[188:189], v10, s[8:11], s31 offen offset:0 sc1
    v_mfma_f32_16x16x32_bf16 v[32:35], v[224:227], a[160:163], v[32:35]
    v_mfma_f32_16x16x32_bf16 v[32:35], v[228:231], a[176:179], v[32:35]
    v_mfma_f32_16x16x32_bf16 v[36:39], v[220:223], a[148:151], v[36:39]
    v_mfma_f32_16x16x32_bf16 v[36:39], v[224:227], a[164:167], v[36:39]
    v_mfma_f32_16x16x32_bf16 v[36:39], v[228:231], a[180:183], v[36:39]
    v_mfma_f32_16x16x32_bf16 v[40:43], v[220:223], a[152:155], v[40:43]
    v_mfma_f32_16x16x32_bf16 v[40:43], v[224:227], a[168:171], v[40:43]
    buffer_store_dwordx4 v[72:75], v7, s[8:11], s38 offen sc1
    v_mfma_f32_16x16x32_bf16 v[40:43], v[228:231], a[184:187], v[40:43]
    v_mfma_f32_16x16x32_bf16 v[44:47], v[220:223], a[156:159], v[44:47]
    v_mfma_f32_16x16x32_bf16 v[44:47], v[224:227], a[172:175], v[44:47]
    v_mfma_f32_16x16x32_bf16 v[44:47], v[228:231], a[188:191], v[44:47]
    s_waitcnt vmcnt(29)
    v_mfma_f32_16x16x32_bf16 v[32:35], v[232:235], a[192:195], v[32:35]
    v_mfma_f32_16x16x32_bf16 v[32:35], v[236:239], a[208:211], v[32:35]
    v_mfma_f32_16x16x32_bf16 v[32:35], v[240:243], a[224:227], v[32:35]
    v_mfma_f32_16x16x32_bf16 v[36:39], v[232:235], a[196:199], v[36:39]
    buffer_store_dwordx4 v[76:79], v8, s[8:11], s38 offen sc1
    v_mfma_f32_16x16x32_bf16 v[36:39], v[236:239], a[212:215], v[36:39]
    v_mfma_f32_16x16x32_bf16 v[36:39], v[240:243], a[228:231], v[36:39]
    v_mfma_f32_16x16x32_bf16 v[40:43], v[232:235], a[200:203], v[40:43]
    buffer_load_dwordx2 v[190:191], v10, s[8:11], s31 offen offset:512 sc1
    v_mfma_f32_16x16x32_bf16 v[40:43], v[236:239], a[216:219], v[40:43]
    v_mfma_f32_16x16x32_bf16 v[40:43], v[240:243], a[232:235], v[40:43]
    v_mfma_f32_16x16x32_bf16 v[44:47], v[232:235], a[204:207], v[44:47]
    v_mfma_f32_16x16x32_bf16 v[44:47], v[236:239], a[220:223], v[44:47]
    v_mfma_f32_16x16x32_bf16 v[44:47], v[240:243], a[236:239], v[44:47]
    s_waitcnt vmcnt(16)
    s_barrier
    v_mov_b32 v2, s100
    v_mov_b32 v3, s101
    buffer_store_dwordx2 v[2:3], v13, s[8:11], s46 offen sc1
    s_waitcnt vmcnt(29)
    v_mfma_f32_16x16x32_bf16 v[32:35], v[244:247], a[240:243], v[32:35]
    v_mfma_f32_16x16x32_bf16 v[32:35], v[248:251], v[80:83], v[32:35]
    v_mfma_f32_16x16x32_bf16 v[32:35], v[252:255], v[96:99], v[32:35]
    v_mfma_f32_16x16x32_bf16 v[36:39], v[244:247], a[244:247], v[36:39]
    v_mfma_f32_16x16x32_bf16 v[36:39], v[248:251], v[84:87], v[36:39]
    v_mfma_f32_16x16x32_bf16 v[36:39], v[252:255], v[100:103], v[36:39]
    v_mfma_f32_16x16x32_bf16 v[40:43], v[244:247], a[248:251], v[40:43]
    v_mfma_f32_16x16x32_bf16 v[40:43], v[248:251], v[88:91], v[40:43]
    v_mfma_f32_16x16x32_bf16 v[40:43], v[252:255], v[104:107], v[40:43]
    v_mfma_f32_16x16x32_bf16 v[44:47], v[244:247], a[252:255], v[44:47]
    v_mfma_f32_16x16x32_bf16 v[44:47], v[248:251], v[92:95], v[44:47]
    v_mfma_f32_16x16x32_bf16 v[44:47], v[252:255], v[108:111], v[44:47]
    s_waitcnt vmcnt(9)
    v_mfma_f32_16x16x32_bf16 v[16:19], v[112:115], a[0:3], 0
    s_add_u32 s38, s38, 4096
    v_mfma_f32_16x16x32_bf16 v[16:19], v[116:119], a[16:19], v[16:19]
    v_mfma_f32_16x16x32_bf16 v[16:19], v[120:123], a[32:35], v[16:19]
    v_mfma_f32_16x16x32_bf16 v[16:19], v[124:127], a[48:51], v[16:19]
    v_mfma_f32_16x16x32_bf16 v[16:19], v[128:131], a[64:67], v[16:19]
    v_mfma_f32_16x16x32_bf16 v[16:19], v[132:135], a[80:83], v[16:19]
    v_mfma_f32_16x16x32_bf16 v[16:19], v[136:139], a[96:99], v[16:19]
    v_mfma_f32_16x16x32_bf16 v[16:19], v[140:143], a[112:115], v[16:19]
    v_mfma_f32_16x16x32_bf16 v[16:19], v[144:147], a[128:131], v[16:19]
    v_cvt_pk_bf16_f32 v48, v32, v33
    v_mfma_f32_16x16x32_bf16 v[16:19], v[148:151], a[144:147], v[16:19]
    v_cvt_pk_bf16_f32 v49, v34, v35
    v_mfma_f32_16x16x32_bf16 v[16:19], v[152:155], a[160:163], v[16:19]
    v_mfma_f32_16x16x32_bf16 v[16:19], v[156:159], a[176:179], v[16:19]
    v_mfma_f32_16x16x32_bf16 v[16:19], v[160:163], a[192:195], v[16:19]
    v_mfma_f32_16x16x32_bf16 v[16:19], v[164:167], a[208:211], v[16:19]
    v_mfma_f32_16x16x32_bf16 v[16:19], v[168:171], a[224:227], v[16:19]
    v_mfma_f32_16x16x32_bf16 v[16:19], v[172:175], a[240:243], v[16:19]
    v_mfma_f32_16x16x32_bf16 v[16:19], v[176:179], v[80:83], v[16:19]
    v_mfma_f32_16x16x32_bf16 v[16:19], v[180:183], v[96:99], v[16:19]
    v_mfma_f32_16x16x32_bf16 v[20:23], v[112:115], a[4:7], 0
    v_cvt_pk_bf16_f32 v52, v36, v37
    v_mfma_f32_16x16x32_bf16 v[20:23], v[116:119], a[20:23], v[20:23]
    v_mfma_f32_16x16x32_bf16 v[20:23], v[120:123], a[36:39], v[20:23]
    v_mfma_f32_16x16x32_bf16 v[20:23], v[124:127], a[52:55], v[20:23]
    v_mfma_f32_16x16x32_bf16 v[20:23], v[128:131], a[68:71], v[20:23]
    v_mfma_f32_16x16x32_bf16 v[20:23], v[132:135], a[84:87], v[20:23]
    v_cvt_pk_bf16_f32 v53, v38, v39
    v_cvt_pk_bf16_f32 v56, v40, v41
    v_cvt_pk_bf16_f32 v57, v42, v43
    v_cvt_pk_bf16_f32 v60, v44, v45
    v_cvt_pk_bf16_f32 v61, v46, v47
    v_mfma_f32_16x16x32_bf16 v[20:23], v[136:139], a[100:103], v[20:23]
    v_mfma_f32_16x16x32_bf16 v[20:23], v[140:143], a[116:119], v[20:23]
    v_cvt_pk_bf16_f32 v50, v16, v17
    v_cvt_pk_bf16_f32 v51, v18, v19
    v_mfma_f32_16x16x32_bf16 v[20:23], v[144:147], a[132:135], v[20:23]
    buffer_store_dwordx4 v[48:51], v5, s[8:11], s38 offen sc1
    v_mfma_f32_16x16x32_bf16 v[20:23], v[148:151], a[148:151], v[20:23]
    s_cmp_lg_u32 s44, 0
    s_cbranch_scc1 2
    ds_write_b128 v11, v[48:51]
    v_mfma_f32_16x16x32_bf16 v[20:23], v[152:155], a[164:167], v[20:23]
    v_mfma_f32_16x16x32_bf16 v[20:23], v[156:159], a[180:183], v[20:23]
    v_mfma_f32_16x16x32_bf16 v[20:23], v[160:163], a[196:199], v[20:23]
    v_mfma_f32_16x16x32_bf16 v[20:23], v[164:167], a[212:215], v[20:23]
    v_mfma_f32_16x16x32_bf16 v[20:23], v[168:171], a[228:231], v[20:23]
    v_mfma_f32_16x16x32_bf16 v[20:23], v[172:175], a[244:247], v[20:23]
    v_mfma_f32_16x16x32_bf16 v[20:23], v[176:179], v[84:87], v[20:23]
    v_mfma_f32_16x16x32_bf16 v[20:23], v[180:183], v[100:103], v[20:23]
    v_mfma_f32_16x16x32_bf16 v[24:27], v[112:115], a[8:11], 0
    v_mfma_f32_16x16x32_bf16 v[24:27], v[116:119], a[24:27], v[24:27]
    v_mfma_f32_16x16x32_bf16 v[24:27], v[120:123], a[40:43], v[24:27]
    v_mfma_f32_16x16x32_bf16 v[24:27], v[124:127], a[56:59], v[24:27]
    v_mfma_f32_16x16x32_bf16 v[24:27], v[128:131], a[72:75], v[24:27]
    v_mfma_f32_16x16x32_bf16 v[24:27], v[132:135], a[88:91], v[24:27]
    v_mfma_f32_16x16x32_bf16 v[24:27], v[136:139], a[104:107], v[24:27]
    v_mfma_f32_16x16x32_bf16 v[24:27], v[140:143], a[120:123], v[24:27]
    v_cvt_pk_bf16_f32 v54, v20, v21
    v_cvt_pk_bf16_f32 v55, v22, v23
    v_mfma_f32_16x16x32_bf16 v[24:27], v[144:147], a[136:139], v[24:27]
    buffer_store_dwordx4 v[52:55], v6, s[8:11], s38 offen sc1
    v_mfma_f32_16x16x32_bf16 v[24:27], v[148:151], a[152:155], v[24:27]
    s_cmp_lg_u32 s44, 1
    s_cbranch_scc1 2
    ds_write_b128 v11, v[52:55]
    v_mfma_f32_16x16x32_bf16 v[24:27], v[152:155], a[168:171], v[24:27]
    v_mfma_f32_16x16x32_bf16 v[24:27], v[156:159], a[184:187], v[24:27]
    v_mfma_f32_16x16x32_bf16 v[24:27], v[160:163], a[200:203], v[24:27]
    v_mfma_f32_16x16x32_bf16 v[24:27], v[164:167], a[216:219], v[24:27]
    v_mfma_f32_16x16x32_bf16 v[24:27], v[168:171], a[232:235], v[24:27]
    v_mfma_f32_16x16x32_bf16 v[24:27], v[172:175], a[248:251], v[24:27]
    v_mfma_f32_16x16x32_bf16 v[24:27], v[176:179], v[88:91], v[24:27]
    v_mfma_f32_16x16x32_bf16 v[24:27], v[180:183], v[104:107], v[24:27]
    v_mfma_f32_16x16x32_bf16 v[28:31], v[112:115], a[12:15], 0
    v_mfma_f32_16x16x32_bf16 v[28:31], v[116:119], a[28:31], v[28:31]
    v_mfma_f32_16x16x32_bf16 v[28:31], v[120:123], a[44:47], v[28:31]
    v_mfma_f32_16x16x32_bf16 v[28:31], v[124:127], a[60:63], v[28:31]
    v_mfma_f32_16x16x32_bf16 v[28:31], v[128:131], a[76:79], v[28:31]
    v_mfma_f32_16x16x32_bf16 v[28:31], v[132:135], a[92:95], v[28:31]
    s_waitcnt vmcnt(4)
    s_barrier
    s_sub_u32 s46, s46, 15360
    buffer_store_dwordx2 v[2:3], v13, s[8:11], s46 offen sc1
    v_mfma_f32_16x16x32_bf16 v[28:31], v[136:139], a[108:111], v[28:31]
    v_mfma_f32_16x16x32_bf16 v[28:31], v[140:143], a[124:127], v[28:31]
    v_cvt_pk_bf16_f32 v58, v24, v25
    v_cvt_pk_bf16_f32 v59, v26, v27
    v_mfma_f32_16x16x32_bf16 v[28:31], v[144:147], a[140:143], v[28:31]
    buffer_load_dwordx2 v[2:3], v4, s[8:11], s48 offen sc1
    v_mfma_f32_16x16x32_bf16 v[28:31], v[148:151], a[156:159], v[28:31]
    buffer_store_dwordx4 v[56:59], v7, s[8:11], s38 offen sc1
    v_mfma_f32_16x16x32_bf16 v[28:31], v[152:155], a[172:175], v[28:31]
    s_cmp_lg_u32 s44, 2
    s_cbranch_scc1 2
    ds_write_b128 v11, v[56:59]
    v_mfma_f32_16x16x32_bf16 v[28:31], v[156:159], a[188:191], v[28:31]
    v_mfma_f32_16x16x32_bf16 v[28:31], v[160:163], a[204:207], v[28:31]
    v_mfma_f32_16x16x32_bf16 v[28:31], v[164:167], a[220:223], v[28:31]
    v_mfma_f32_16x16x32_bf16 v[28:31], v[168:171], a[236:239], v[28:31]
    v_mfma_f32_16x16x32_bf16 v[28:31], v[172:175], a[252:255], v[28:31]
    v_mfma_f32_16x16x32_bf16 v[28:31], v[176:179], v[92:95], v[28:31]
    v_mfma_f32_16x16x32_bf16 v[28:31], v[180:183], v[108:111], v[28:31]
    s_nop 7
    v_cvt_pk_bf16_f32 v62, v28, v29
    v_cvt_pk_bf16_f32 v63, v30, v31
    buffer_store_dwordx4 v[60:63], v8, s[8:11], s38 offen sc1
    s_cmp_lg_u32 s44, 3
    s_cbranch_scc1 2
    ds_write_b128 v11, v[60:63]
    s_waitcnt vmcnt(2)
    v_cmp_eq_u64 vcc, s[100:101], v[2:3]
    s_add_u32 s56, s56, s51
    s_cmp_eq_u32 s20, 0
    s_cselect_b32 s56, s56, 1073741824
    s_cmp_eq_u64 vcc, -1
    s_cselect_b32 s49, 1, 0
    s_cbranch_scc0 L_ffn_noe
    buffer_load_dwordx4 v[48:51], v9, s[8:11], s72 offen sc1
    buffer_load_dwordx4 v[52:55], v9, s[8:11], s73 offen sc1
    buffer_load_dwordx4 v[56:59], v9, s[8:11], s74 offen sc1
    buffer_load_dwordx4 v[60:63], v9, s[8:11], s75 offen sc1
    buffer_load_dwordx4 v[64:67], v9, s[8:11], s76 offen sc1
    buffer_load_dwordx4 v[68:71], v9, s[8:11], s77 offen sc1
    buffer_load_dwordx4 v[72:75], v9, s[8:11], s78 offen sc1
    s_waitcnt vmcnt(7) lgkmcnt(0)
    s_branch L_ffn_sig
L_ffn_noe:
    s_waitcnt vmcnt(0) lgkmcnt(0)
L_ffn_sig:
    s_barrier
    v_mov_b32 v254, s100
    v_mov_b32 v255, s101
    buffer_store_dwordx2 v[254:255], v13, s[8:11], s56 offen sc1
    v_mov_b32 v8, v9
    v_add_u32 v10, 0x2000, v9
    s_cmp_eq_u32 s20, 0
    s_cselect_b32 s35, 16384, 1073741824
    v_add_u32 v9, s35, v9
    s_cmp_eq_u32 s49, 1
    s_cbranch_scc1 L_p5_e1
    s_mov_b32 s56, s48
    v_mov_b32 v2, v4
    s_mov_b32 s57, 300000
L_poll_e1:
    buffer_load_dwordx2 v[254:255], v2, s[8:11], s56 offen sc1
    s_sub_u32 s57, s57, 1
    s_waitcnt vmcnt(0)
    v_cmp_eq_u64 vcc, s[100:101], v[254:255]
    s_cmp_eq_u32 s57, 0
    s_cbranch_scc1 L_pollx_e1
    s_cmp_eq_u64 vcc, -1
    s_cbranch_scc0 L_poll_e1
L_pollx_e1:
    buffer_load_dwordx4 v[48:51], v8, s[8:11], s72 offen sc1
    buffer_load_dwordx4 v[52:55], v8, s[8:11], s73 offen sc1
    buffer_load_dwordx4 v[56:59], v8, s[8:11], s74 offen sc1
    buffer_load_dwordx4 v[60:63], v8, s[8:11], s75 offen sc1
    buffer_load_dwordx4 v[64:67], v8, s[8:11], s76 offen sc1
    buffer_load_dwordx4 v[68:71], v8, s[8:11], s77 offen sc1
    buffer_load_dwordx4 v[72:75], v8, s[8:11], s78 offen sc1
L_p5_e1:
    s_cmp_lg_u32 s20, 0
    s_cbranch_scc1 L_p5_n1
    buffer_load_dwordx4 v[76:79], v9, s[8:11], s72 offen sc1
    buffer_load_dwordx4 v[80:83], v9, s[8:11], s73 offen sc1
    buffer_load_dwordx4 v[84:87], v9, s[8:11], s74 offen sc1
    buffer_load_dwordx4 v[88:91], v9, s[8:11], s75 offen sc1
    buffer_load_dwordx4 v[92:95], v9, s[8:11], s76 offen sc1
    buffer_load_dwordx4 v[96:99], v9, s[8:11], s77 offen sc1
    buffer_load_dwordx4 v[100:103], v9, s[8:11], s78 offen sc1
L_p5_n1:
    v_bfe_u32 v4, v0, 4, 2
    v_bfe_u32 v5, v0, 3, 1
    v_and_b32 v6, 7, v0
    s_mov_b32 s30, 0x3f803f80
    s_mov_b32 s31, 0x3ae38e39
    s_mov_b32 s32, 0xffff0000
    s_mov_b32 s26, 0x00003f80
    s_mov_b32 s27, 0x3f800000
    v_min_u32 v12, 0x4800, v9
    v_add_u32 v11, 133120, v8
    v_add_u32 v12, 133120, v12
    s_waitcnt lgkmcnt(0)
    ds_read_b128 v[136:139], v11
    ds_read_b128 v[140:143], v12
    ds_read_b128 v[144:147], v11 offset:8192
    s_lshl_b32 s56, s42, 7
    s_add_u32 s56, s56, 63881216
    v_lshlrev_b32 v2, 3, v6
    v_lshlrev_b32 v112, 16, v184
    v_and_b32 v113, s32, v184
    v_lshlrev_b32 v114, 16, v185
    v_and_b32 v115, s32, v185
    v_lshlrev_b32 v116, 16, v186
    v_and_b32 v117, s32, v186
    v_lshlrev_b32 v118, 16, v187
    v_and_b32 v119, s32, v187
    v_lshlrev_b32 v120, 16, v188
    v_and_b32 v121, s32, v188
    v_lshlrev_b32 v122, 16, v189
    v_and_b32 v123, s32, v189
    v_lshlrev_b32 v124, 16, v190
    v_and_b32 v125, s32, v190
    v_lshlrev_b32 v126, 16, v191
    v_and_b32 v127, s32, v191
    v_lshlrev_b32 v128, 16, v192
    v_and_b32 v129, s32, v192
    v_lshlrev_b32 v130, 16, v193
    v_and_b32 v131, s32, v193
    v_lshlrev_b32 v132, 16, v194
    v_and_b32 v133, s32, v194
    v_lshlrev_b32 v134, 16, v195
    v_and_b32 v135, s32, v195
    s_waitcnt lgkmcnt(0)
    v_dot2c_f32_bf16 v112, s26, v136
    v_dot2c_f32_bf16 v113, s27, v136
    v_dot2c_f32_bf16 v114, s26, v137
    v_dot2c_f32_bf16 v115, s27, v137
    v_dot2c_f32_bf16 v116, s26, v138
    v_dot2c_f32_bf16 v117, s27, v138
    v_dot2c_f32_bf16 v118, s26, v139
    v_dot2c_f32_bf16 v119, s27, v139
    v_dot2c_f32_bf16 v120, s26, v140
    v_dot2c_f32_bf16 v121, s27, v140
    v_dot2c_f32_bf16 v122, s26, v141
    v_dot2c_f32_bf16 v123, s27, v141
    v_dot2c_f32_bf16 v124, s26, v142
    v_dot2c_f32_bf16 v125, s27, v142
    v_dot2c_f32_bf16 v126, s26, v143
    v_dot2c_f32_bf16 v127, s27, v143
    v_dot2c_f32_bf16 v128, s26, v144
    v_dot2c_f32_bf16 v129, s27, v144
    v_dot2c_f32_bf16 v130, s26, v145
    v_dot2c_f32_bf16 v131, s27, v145
    v_dot2c_f32_bf16 v132, s26, v146
    v_dot2c_f32_bf16 v133, s27, v146
    v_dot2c_f32_bf16 v134, s26, v147
    v_dot2c_f32_bf16 v135, s27, v147
    s_cmp_lt_u32 s20, 2
    s_cselect_b32 s23, 4096, 0
    s_sub_u32 s56, s56, s23
    s_mov_b32 s57, 300000
    s_add_u32 s56, s56, s51
L_poll_e0:
    s_load_dwordx16 s[84:99], s[4:5], s56 glc
    s_sub_u32 s57, s57, 1
    s_cmp_eq_u32 s57, 0
    s_waitcnt lgkmcnt(0)
    s_cbranch_scc1 L_pollx_e
    s_xor_b64 s[84:85], s[84:85], s[100:101]
    s_xor_b64 s[86:87], s[86:87], s[100:101]
    s_xor_b64 s[88:89], s[88:89], s[100:101]
    s_xor_b64 s[90:91], s[90:91], s[100:101]
    s_xor_b64 s[92:93], s[92:93], s[100:101]
    s_xor_b64 s[94:95], s[94:95], s[100:101]
    s_xor_b64 s[96:97], s[96:97], s[100:101]
    s_xor_b64 s[98:99], s[98:99], s[100:101]
    s_or_b64 s[84:85], s[84:85], s[86:87]
    s_or_b64 s[84:85], s[84:85], s[88:89]
    s_or_b64 s[84:85], s[84:85], s[90:91]
    s_or_b64 s[84:85], s[84:85], s[92:93]
    s_or_b64 s[84:85], s[84:85], s[94:95]
    s_or_b64 s[84:85], s[84:85], s[96:97]
    s_or_b64 s[84:85], s[84:85], s[98:99]
    s_cbranch_scc0 2
    s_sleep 2
    s_branch L_poll_e0
L_pollx_e:
    buffer_load_dwordx4 v[16:19], v10, s[8:11], s72 offen sc1
    buffer_load_dwordx4 v[20:23], v10, s[8:11], s73 offen sc1
    buffer_load_dwordx4 v[24:27], v10, s[8:11], s74 offen sc1
    buffer_load_dwordx4 v[28:31], v10, s[8:11], s75 offen sc1
    buffer_load_dwordx4 v[32:35], v10, s[8:11], s76 offen sc1
    buffer_load_dwordx4 v[36:39], v10, s[8:11], s77 offen sc1
    buffer_load_dwordx4 v[40:43], v10, s[8:11], s78 offen sc1
    s_waitcnt vmcnt(7)
    v_dot2c_f32_bf16 v112, s26, v48
    v_dot2c_f32_bf16 v113, s27, v48
    v_dot2c_f32_bf16 v114, s26, v49
    v_dot2c_f32_bf16 v115, s27, v49
    v_dot2c_f32_bf16 v116, s26, v50
    v_dot2c_f32_bf16 v117, s27, v50
    v_dot2c_f32_bf16 v118, s26, v51
    v_dot2c_f32_bf16 v119, s27, v51
    v_dot2c_f32_bf16 v112, s26, v52
    v_dot2c_f32_bf16 v113, s27, v52
    v_dot2c_f32_bf16 v114, s26, v53
    v_dot2c_f32_bf16 v115, s27, v53
    v_dot2c_f32_bf16 v116, s26, v54
    v_dot2c_f32_bf16 v117, s27, v54
    v_dot2c_f32_bf16 v118, s26, v55
    v_dot2c_f32_bf16 v119, s27, v55
    v_dot2c_f32_bf16 v112, s26, v56
    v_dot2c_f32_bf16 v113, s27, v56
    v_dot2c_f32_bf16 v114, s26, v57
    v_dot2c_f32_bf16 v115, s27, v57
    v_dot2c_f32_bf16 v116, s26, v58
    v_dot2c_f32_bf16 v117, s27, v58
    v_dot2c_f32_bf16 v118, s26, v59
    v_dot2c_f32_bf16 v119, s27, v59
    v_dot2c_f32_bf16 v112, s26, v60
    v_dot2c_f32_bf16 v113, s27, v60
    v_dot2c_f32_bf16 v114, s26, v61
    v_dot2c_f32_bf16 v115, s27, v61
    v_dot2c_f32_bf16 v116, s26, v62
    v_dot2c_f32_bf16 v117, s27, v62
    v_dot2c_f32_bf16 v118, s26, v63
    v_dot2c_f32_bf16 v119, s27, v63
    v_dot2c_f32_bf16 v112, s26, v64
    v_dot2c_f32_bf16 v113, s27, v64
    v_dot2c_f32_bf16 v114, s26, v65
    v_dot2c_f32_bf16 v115, s27, v65
    v_dot2c_f32_bf16 v116, s26, v66
    v_dot2c_f32_bf16 v117, s27, v66
    v_dot2c_f32_bf16 v118, s26, v67
    v_dot2c_f32_bf16 v119, s27, v67
    v_dot2c_f32_bf16 v112, s26, v68
    v_dot2c_f32_bf16 v113, s27, v68
    v_dot2c_f32_bf16 v114, s26, v69
    v_dot2c_f32_bf16 v115, s27, v69
    v_dot2c_f32_bf16 v116, s26, v70
    v_dot2c_f32_bf16 v117, s27, v70
    v_dot2c_f32_bf16 v118, s26, v71
    v_dot2c_f32_bf16 v119, s27, v71
    v_dot2c_f32_bf16 v112, s26, v72
    v_dot2c_f32_bf16 v113, s27, v72
    v_dot2c_f32_bf16 v114, s26, v73
    v_dot2c_f32_bf16 v115, s27, v73
    v_dot2c_f32_bf16 v116, s26, v74
    v_dot2c_f32_bf16 v117, s27, v74
    v_dot2c_f32_bf16 v118, s26, v75
    v_dot2c_f32_bf16 v119, s27, v75
    s_cmp_lg_u32 s20, 0
    s_cbranch_scc1 L_p5_n2
    v_dot2c_f32_bf16 v120, s26, v76
    v_dot2c_f32_bf16 v121, s27, v76
    v_dot2c_f32_bf16 v122, s26, v77
    v_dot2c_f32_bf16 v123, s27, v77
    v_dot2c_f32_bf16 v124, s26, v78
    v_dot2c_f32_bf16 v125, s27, v78
    v_dot2c_f32_bf16 v126, s26, v79
    v_dot2c_f32_bf16 v127, s27, v79
    v_dot2c_f32_bf16 v120, s26, v80
    v_dot2c_f32_bf16 v121, s27, v80
    v_dot2c_f32_bf16 v122, s26, v81
    v_dot2c_f32_bf16 v123, s27, v81
    v_dot2c_f32_bf16 v124, s26, v82
    v_dot2c_f32_bf16 v125, s27, v82
    v_dot2c_f32_bf16 v126, s26, v83
    v_dot2c_f32_bf16 v127, s27, v83
    v_dot2c_f32_bf16 v120, s26, v84
    v_dot2c_f32_bf16 v121, s27, v84
    v_dot2c_f32_bf16 v122, s26, v85
    v_dot2c_f32_bf16 v123, s27, v85
    v_dot2c_f32_bf16 v124, s26, v86
    v_dot2c_f32_bf16 v125, s27, v86
    v_dot2c_f32_bf16 v126, s26, v87
    v_dot2c_f32_bf16 v127, s27, v87
    v_dot2c_f32_bf16 v120, s26, v88
    v_dot2c_f32_bf16 v121, s27, v88
    v_dot2c_f32_bf16 v122, s26, v89
    v_dot2c_f32_bf16 v123, s27, v89
    v_dot2c_f32_bf16 v124, s26, v90
    v_dot2c_f32_bf16 v125, s27, v90
    v_dot2c_f32_bf16 v126, s26, v91
    v_dot2c_f32_bf16 v127, s27, v91
    v_dot2c_f32_bf16 v120, s26, v92
    v_dot2c_f32_bf16 v121, s27, v92
    v_dot2c_f32_bf16 v122, s26, v93
    v_dot2c_f32_bf16 v123, s27, v93
    v_dot2c_f32_bf16 v124, s26, v94
    v_dot2c_f32_bf16 v125, s27, v94
    v_dot2c_f32_bf16 v126, s26, v95
    v_dot2c_f32_bf16 v127, s27, v95
    v_dot2c_f32_bf16 v120, s26, v96
    v_dot2c_f32_bf16 v121, s27, v96
    v_dot2c_f32_bf16 v122, s26, v97
    v_dot2c_f32_bf16 v123, s27, v97
    v_dot2c_f32_bf16 v124, s26, v98
    v_dot2c_f32_bf16 v125, s27, v98
    v_dot2c_f32_bf16 v126, s26, v99
    v_dot2c_f32_bf16 v127, s27, v99
    v_dot2c_f32_bf16 v120, s26, v100
    v_dot2c_f32_bf16 v121, s27, v100
    v_dot2c_f32_bf16 v122, s26, v101
    v_dot2c_f32_bf16 v123, s27, v101
    v_dot2c_f32_bf16 v124, s26, v102
    v_dot2c_f32_bf16 v125, s27, v102
    v_dot2c_f32_bf16 v126, s26, v103
    v_dot2c_f32_bf16 v127, s27, v103
L_p5_n2:
    s_nop 1
    v_cvt_pk_bf16_f32 v136, v112, v113
    v_cvt_pk_bf16_f32 v137, v114, v115
    v_cvt_pk_bf16_f32 v138, v116, v117
    v_cvt_pk_bf16_f32 v139, v118, v119
    v_cvt_pk_bf16_f32 v140, v120, v121
    v_cvt_pk_bf16_f32 v141, v122, v123
    v_cvt_pk_bf16_f32 v142, v124, v125
    v_cvt_pk_bf16_f32 v143, v126, v127
    s_add_u32 s25, s24, 0
    s_cmp_eq_u32 s50, 1
    s_cbranch_scc1 L_p5_final
    buffer_store_dwordx4 v[136:139], v8, s[8:11], s25 offen sc1
    buffer_store_dwordx4 v[140:143], v9, s[8:11], s25 offen sc1
    s_cmp_eq_u32 s20, 0
    s_cbranch_scc1 L_p5_w0
    v_mov_b32 v140, 0
    v_mov_b32 v141, 0
    v_mov_b32 v142, 0
    v_mov_b32 v143, 0
L_p5_w0:
    v_mov_b32 v152, 0
    v_mov_b32 v153, 0
    v_mov_b32 v154, 0
    v_mov_b32 v155, 0
    v_dot2c_f32_bf16 v152, s30, v136
    v_dot2c_f32_bf16 v154, v136, v136
    v_dot2c_f32_bf16 v153, s30, v137
    v_dot2c_f32_bf16 v155, v137, v137
    v_dot2c_f32_bf16 v152, s30, v138
    v_dot2c_f32_bf16 v154, v138, v138
    v_dot2c_f32_bf16 v153, s30, v139
    v_dot2c_f32_bf16 v155, v139, v139
    v_dot2c_f32_bf16 v152, s30, v140
    v_dot2c_f32_bf16 v154, v140, v140
    v_dot2c_f32_bf16 v153, s30, v141
    v_dot2c_f32_bf16 v155, v141, v141
    v_dot2c_f32_bf16 v152, s30, v142
    v_dot2c_f32_bf16 v154, v142, v142
    v_dot2c_f32_bf16 v153, s30, v143
    v_dot2c_f32_bf16 v155, v143, v143
    s_waitcnt vmcnt(8)
    v_dot2c_f32_bf16 v128, s26, v16
    v_dot2c_f32_bf16 v129, s27, v16
    v_dot2c_f32_bf16 v130, s26, v17
    v_dot2c_f32_bf16 v131, s27, v17
    v_dot2c_f32_bf16 v132, s26, v18
    v_dot2c_f32_bf16 v133, s27, v18
    v_dot2c_f32_bf16 v134, s26, v19
    v_dot2c_f32_bf16 v135, s27, v19
    s_waitcnt vmcnt(7)
    v_dot2c_f32_bf16 v128, s26, v20
    v_dot2c_f32_bf16 v129, s27, v20
    v_dot2c_f32_bf16 v130, s26, v21
    v_dot2c_f32_bf16 v131, s27, v21
    v_dot2c_f32_bf16 v132, s26, v22
    v_dot2c_f32_bf16 v133, s27, v22
    v_dot2c_f32_bf16 v134, s26, v23
    v_dot2c_f32_bf16 v135, s27, v23
    s_waitcnt vmcnt(6)
    v_dot2c_f32_bf16 v128, s26, v24
    v_dot2c_f32_bf16 v129, s27, v24
    v_dot2c_f32_bf16 v130, s26, v25
    v_dot2c_f32_bf16 v131, s27, v25
    v_dot2c_f32_bf16 v132, s26, v26
    v_dot2c_f32_bf16 v133, s27, v26
    v_dot2c_f32_bf16 v134, s26, v27
    v_dot2c_f32_bf16 v135, s27, v27
    s_waitcnt vmcnt(5)
    v_dot2c_f32_bf16 v128, s26, v28
    v_dot2c_f32_bf16 v129, s27, v28
    v_dot2c_f32_bf16 v130, s26, v29
    v_dot2c_f32_bf16 v131, s27, v29
    v_dot2c_f32_bf16 v132, s26, v30
    v_dot2c_f32_bf16 v133, s27, v30
    v_dot2c_f32_bf16 v134, s26, v31
    v_dot2c_f32_bf16 v135, s27, v31
    s_waitcnt vmcnt(4)
    v_dot2c_f32_bf16 v128, s26, v32
    v_dot2c_f32_bf16 v129, s27, v32
    v_dot2c_f32_bf16 v130, s26, v33
    v_dot2c_f32_bf16 v131, s27, v33
    v_dot2c_f32_bf16 v132, s26, v34
    v_dot2c_f32_bf16 v133, s27, v34
    v_dot2c_f32_bf16 v134, s26, v35
    v_dot2c_f32_bf16 v135, s27, v35
    s_waitcnt vmcnt(3)
    v_dot2c_f32_bf16 v128, s26, v36
    v_dot2c_f32_bf16 v129, s27, v36
    v_dot2c_f32_bf16 v130, s26, v37
    v_dot2c_f32_bf16 v131, s27, v37
    v_dot2c_f32_bf16 v132, s26, v38
    v_dot2c_f32_bf16 v133, s27, v38
    v_dot2c_f32_bf16 v134, s26, v39
    v_dot2c_f32_bf16 v135, s27, v39
    s_waitcnt vmcnt(2)
    v_dot2c_f32_bf16 v128, s26, v40
    v_dot2c_f32_bf16 v129, s27, v40
    v_dot2c_f32_bf16 v130, s26, v41
    v_dot2c_f32_bf16 v131, s27, v41
    v_dot2c_f32_bf16 v132, s26, v42
    v_dot2c_f32_bf16 v133, s27, v42
    v_dot2c_f32_bf16 v134, s26, v43
    v_dot2c_f32_bf16 v135, s27, v43
    s_nop 2
    v_cvt_pk_bf16_f32 v144, v128, v129
    v_cvt_pk_bf16_f32 v145, v130, v131
    v_cvt_pk_bf16_f32 v146, v132, v133
    v_cvt_pk_bf16_f32 v147, v134, v135
    buffer_store_dwordx4 v[144:147], v10, s[8:11], s25 offen sc1
    v_dot2c_f32_bf16 v152, s30, v144
    v_dot2c_f32_bf16 v154, v144, v144
    v_dot2c_f32_bf16 v153, s30, v145
    v_dot2c_f32_bf16 v155, v145, v145
    v_dot2c_f32_bf16 v152, s30, v146
    v_dot2c_f32_bf16 v154, v146, v146
    v_dot2c_f32_bf16 v153, s30, v147
    v_dot2c_f32_bf16 v155, v147, v147
    s_nop 2
    v_add_f32 v152, v152, v153
    v_add_f32 v153, v154, v155
    s_nop 1
    v_add_f32_dpp v152, v152, v152 row_ror:8 row_mask:0xf bank_mask:0xf
    v_add_f32_dpp v153, v153, v153 row_ror:8 row_mask:0xf bank_mask:0xf
    v_mov_b32 v154, v152
    v_mov_b32 v155, v153
    s_nop 0
    v_permlane16_swap_b32 v152, v154
    v_permlane16_swap_b32 v153, v155
    v_pk_add_f32 v[152:153], v[152:153], v[154:155]
    v_mov_b32 v154, v152
    v_mov_b32 v155, v153
    s_nop 0
    v_permlane32_swap_b32 v152, v154
    v_permlane32_swap_b32 v153, v155
    v_pk_add_f32 v[152:153], v[152:153], v[154:155]
    v_lshlrev_b32 v11, 3, v6
    v_add_u32 v11, 153600, v11
    s_lshl_b32 s23, s20, 6
    v_add_u32 v12, s23, v11
    ds_write_b64 v12, v[152:153]
    s_waitcnt lgkmcnt(0)
    s_barrier
    ds_read_b64 v[152:153], v11 offset:0
    ds_read_b64 v[154:155], v11 offset:64
    ds_read_b64 v[156:157], v11 offset:128
    ds_read_b64 v[158:159], v11 offset:192
    s_add_u32 s23, s24, 2359296
    s_waitcnt lgkmcnt(0)
    v_pk_add_f32 v[152:153], v[152:153], v[154:155]
    v_pk_add_f32 v[156:157], v[156:157], v[158:159]
    v_pk_add_f32 v[152:153], v[152:153], v[156:157]
    v_mul_f32 v152, s31, v152
    v_mul_f32 v153, s31, v153
    v_fma_f32 v153, -v152, v152, v153
    v_max_f32 v153, 0, v153
    v_add_f32 v153, 0x3727c5ac, v153
    v_rsq_f32 v153, v153
    s_nop 0
    v_mul_f32 v152, v152, v153
    v_sub_f32 v152, 0, v152
    v_lshlrev_b32 v154, 16, v136
    v_and_b32 v155, s32, v136
    v_pk_fma_f32 v[154:155], v[154:155], v[152:153], v[152:153] op_sel:[0,1,0] op_sel_hi:[1,1,0]
    v_cvt_pk_bf16_f32 v160, v154, v155
    v_lshlrev_b32 v156, 16, v137
    v_and_b32 v157, s32, v137
    v_pk_fma_f32 v[156:157], v[156:157], v[152:153], v[152:153] op_sel:[0,1,0] op_sel_hi:[1,1,0]
    v_cvt_pk_bf16_f32 v161, v156, v157
    v_lshlrev_b32 v154, 16, v138
    v_and_b32 v155, s32, v138
    v_pk_fma_f32 v[154:155], v[154:155], v[152:153], v[152:153] op_sel:[0,1,0] op_sel_hi:[1,1,0]
    v_cvt_pk_bf16_f32 v162, v154, v155
    v_lshlrev_b32 v156, 16, v139
    v_and_b32 v157, s32, v139
    v_pk_fma_f32 v[156:157], v[156:157], v[152:153], v[152:153] op_sel:[0,1,0] op_sel_hi:[1,1,0]
    v_cvt_pk_bf16_f32 v163, v156, v157
    buffer_store_dwordx4 v[160:163], v8, s[8:11], s23 offen sc1
    v_lshlrev_b32 v154, 16, v140
    v_and_b32 v155, s32, v140
    v_pk_fma_f32 v[154:155], v[154:155], v[152:153], v[152:153] op_sel:[0,1,0] op_sel_hi:[1,1,0]
    v_cvt_pk_bf16_f32 v164, v154, v155
    v_lshlrev_b32 v156, 16, v141
    v_and_b32 v157, s32, v141
    v_pk_fma_f32 v[156:157], v[156:157], v[152:153], v[152:153] op_sel:[0,1,0] op_sel_hi:[1,1,0]
    v_cvt_pk_bf16_f32 v165, v156, v157
    v_lshlrev_b32 v154, 16, v142
    v_and_b32 v155, s32, v142
    v_pk_fma_f32 v[154:155], v[154:155], v[152:153], v[152:153] op_sel:[0,1,0] op_sel_hi:[1,1,0]
    v_cvt_pk_bf16_f32 v166, v154, v155
    v_lshlrev_b32 v156, 16, v143
    v_and_b32 v157, s32, v143
    v_pk_fma_f32 v[156:157], v[156:157], v[152:153], v[152:153] op_sel:[0,1,0] op_sel_hi:[1,1,0]
    v_cvt_pk_bf16_f32 v167, v156, v157
    buffer_store_dwordx4 v[164:167], v9, s[8:11], s23 offen sc1
    v_lshlrev_b32 v154, 16, v144
    v_and_b32 v155, s32, v144
    v_pk_fma_f32 v[154:155], v[154:155], v[152:153], v[152:153] op_sel:[0,1,0] op_sel_hi:[1,1,0]
    v_cvt_pk_bf16_f32 v168, v154, v155
    v_lshlrev_b32 v156, 16, v145
    v_and_b32 v157, s32, v145
    v_pk_fma_f32 v[156:157], v[156:157], v[152:153], v[152:153] op_sel:[0,1,0] op_sel_hi:[1,1,0]
    v_cvt_pk_bf16_f32 v169, v156, v157
    v_lshlrev_b32 v154, 16, v146
    v_and_b32 v155, s32, v146
    v_pk_fma_f32 v[154:155], v[154:155], v[152:153], v[152:153] op_sel:[0,1,0] op_sel_hi:[1,1,0]
    v_cvt_pk_bf16_f32 v170, v154, v155
    v_lshlrev_b32 v156, 16, v147
    v_and_b32 v157, s32, v147
    v_pk_fma_f32 v[156:157], v[156:157], v[152:153], v[152:153] op_sel:[0,1,0] op_sel_hi:[1,1,0]
    v_cvt_pk_bf16_f32 v171, v156, v157
    buffer_store_dwordx4 v[168:171], v10, s[8:11], s23 offen sc1
    s_lshr_b32 s56, s28, 4
    s_lshl_b32 s56, s56, 7
    s_and_b32 s27, s28, 15
    s_lshl_b32 s27, s27, 3
    s_add_u32 s56, s56, s27
    s_add_u32 s56, s56, 63864832
    s_add_u32 s50, s50, 1
    s_add_u32 s51, s51, 32768
    s_mov_b32 s53, 54689792
    s_add_u32 s56, s56, s51
    s_cmp_eq_u32 s20, 0
    s_cselect_b32 s56, s56, 1073741824
    s_waitcnt vmcnt(0)
    s_barrier
    v_mov_b32 v254, s100
    v_mov_b32 v255, s101
    buffer_store_dwordx2 v[254:255], v13, s[8:11], s56 offen sc1
    s_branch L_p0_fetch
L_p5_final:
    s_mov_b32 s12, s6
    s_mov_b32 s13, s7
    s_mov_b32 s14, 2359296
    s_mov_b32 s15, 0x00020000
    v_mul_u32_u24 v7, 1152, v6
    v_lshl_add_u32 v7, v5, 6, v7
    v_and_b32 v9, 1, v4
    v_lshl_add_u32 v7, v9, 5, v7
    v_lshrrev_b32 v9, 1, v4
    v_lshl_add_u32 v7, v9, 4, v7
    s_mul_i32 s33, s28, 9216
    s_add_u32 s35, s33, 1024
    s_cmp_eq_u32 s20, 0
    s_cselect_b32 s35, s35, 1073741824
    s_lshl_b32 s25, s20, 7
    s_add_u32 s34, s33, s25
    s_add_u32 s36, s34, 512
    v_permlane16_swap_b32 v136, v138
    v_permlane16_swap_b32 v137, v139
    buffer_store_dwordx4 v[136:139], v7, s[12:15], s34 offen sc1
    v_permlane16_swap_b32 v140, v142
    v_permlane16_swap_b32 v141, v143
    buffer_store_dwordx4 v[140:143], v7, s[12:15], s35 offen sc1
    s_waitcnt vmcnt(8)
    v_dot2c_f32_bf16 v128, s26, v16
    v_dot2c_f32_bf16 v129, s27, v16
    v_dot2c_f32_bf16 v130, s26, v17
    v_dot2c_f32_bf16 v131, s27, v17
    v_dot2c_f32_bf16 v132, s26, v18
    v_dot2c_f32_bf16 v133, s27, v18
    v_dot2c_f32_bf16 v134, s26, v19
    v_dot2c_f32_bf16 v135, s27, v19
    s_waitcnt vmcnt(7)
    v_dot2c_f32_bf16 v128, s26, v20
    v_dot2c_f32_bf16 v129, s27, v20
    v_dot2c_f32_bf16 v130, s26, v21
    v_dot2c_f32_bf16 v131, s27, v21
    v_dot2c_f32_bf16 v132, s26, v22
    v_dot2c_f32_bf16 v133, s27, v22
    v_dot2c_f32_bf16 v134, s26, v23
    v_dot2c_f32_bf16 v135, s27, v23
    s_waitcnt vmcnt(6)
    v_dot2c_f32_bf16 v128, s26, v24
    v_dot2c_f32_bf16 v129, s27, v24
    v_dot2c_f32_bf16 v130, s26, v25
    v_dot2c_f32_bf16 v131, s27, v25
    v_dot2c_f32_bf16 v132, s26, v26
    v_dot2c_f32_bf16 v133, s27, v26
    v_dot2c_f32_bf16 v134, s26, v27
    v_dot2c_f32_bf16 v135, s27, v27
    s_waitcnt vmcnt(5)
    v_dot2c_f32_bf16 v128, s26, v28
    v_dot2c_f32_bf16 v129, s27, v28
    v_dot2c_f32_bf16 v130, s26, v29
    v_dot2c_f32_bf16 v131, s27, v29
    v_dot2c_f32_bf16 v132, s26, v30
    v_dot2c_f32_bf16 v133, s27, v30
    v_dot2c_f32_bf16 v134, s26, v31
    v_dot2c_f32_bf16 v135, s27, v31
    s_waitcnt vmcnt(4)
    v_dot2c_f32_bf16 v128, s26, v32
    v_dot2c_f32_bf16 v129, s27, v32
    v_dot2c_f32_bf16 v130, s26, v33
    v_dot2c_f32_bf16 v131, s27, v33
    v_dot2c_f32_bf16 v132, s26, v34
    v_dot2c_f32_bf16 v133, s27, v34
    v_dot2c_f32_bf16 v134, s26, v35
    v_dot2c_f32_bf16 v135, s27, v35
    s_waitcnt vmcnt(3)
    v_dot2c_f32_bf16 v128, s26, v36
    v_dot2c_f32_bf16 v129, s27, v36
    v_dot2c_f32_bf16 v130, s26, v37
    v_dot2c_f32_bf16 v131, s27, v37
    v_dot2c_f32_bf16 v132, s26, v38
    v_dot2c_f32_bf16 v133, s27, v38
    v_dot2c_f32_bf16 v134, s26, v39
    v_dot2c_f32_bf16 v135, s27, v39
    s_waitcnt vmcnt(2)
    v_dot2c_f32_bf16 v128, s26, v40
    v_dot2c_f32_bf16 v129, s27, v40
    v_dot2c_f32_bf16 v130, s26, v41
    v_dot2c_f32_bf16 v131, s27, v41
    v_dot2c_f32_bf16 v132, s26, v42
    v_dot2c_f32_bf16 v133, s27, v42
    v_dot2c_f32_bf16 v134, s26, v43
    v_dot2c_f32_bf16 v135, s27, v43
    s_nop 2
    v_cvt_pk_bf16_f32 v144, v128, v129
    v_cvt_pk_bf16_f32 v145, v130, v131
    v_cvt_pk_bf16_f32 v146, v132, v133
    v_cvt_pk_bf16_f32 v147, v134, v135
    s_nop 0
    v_permlane16_swap_b32 v144, v146
    v_permlane16_swap_b32 v145, v147
    buffer_store_dwordx4 v[144:147], v7, s[12:15], s36 offen sc1
L_main_fin:
L_end:
    s_endpgm

.section .rodata,"a"
.p2align 6
.amdhsa_kernel interleave_layers__sliding_block__swiglu_ffn__prompt_kernel
  .amdhsa_next_free_vgpr 512
  .amdhsa_next_free_sgpr 102
  .amdhsa_accum_offset 256
  .amdhsa_group_segment_fixed_size 0
  .amdhsa_kernarg_size 80
  .amdhsa_user_sgpr_count 2
  .amdhsa_user_sgpr_kernarg_segment_ptr 1
  .amdhsa_system_sgpr_workgroup_id_x 1
  .amdhsa_float_denorm_mode_32 3
.end_amdhsa_kernel
```
